```python
import torch

def _softmax(x, axis=-1):
    return torch.softmax(x, dim=axis)
def _gelu(x):
    return torch.nn.functional.gelu(x, approximate="tanh")
def _silu(x):
    return torch.nn.functional.silu(x)
def _sigmoid(x):
    return torch.sigmoid(x)
def _layernorm(x, axis=-1, eps=1e-5):
    m = x.mean(dim=axis, keepdim=True)
    v = x.var(dim=axis, keepdim=True, unbiased=False)
    return (x - m) / torch.sqrt(v + eps)
def _scatter_add(tgt, idx, src, axis=0):
    return tgt.clone().index_add_(axis, idx, src)
def _segment_sum(src, seg, n):
    out = torch.zeros((n,) + src.shape[1:], dtype=src.dtype)
    return out.index_add_(0, seg, src)
def _pad(x, pw):
    flat = tuple(v for pair in reversed(pw) for v in pair)
    return torch.nn.functional.pad(x, flat)

kernel_name = 'recurrent_scan__mha_block_cached__mixer_s_mlp__prompt'

def setup_inputs():

    _w = (lambda a: (lambda t: t.to(torch.bfloat16) if t.is_floating_point() else t)(torch.as_tensor(a)))
    def _A_setup():
        B, Sq, D = 1, 2048, 576
        H, Sk, Dh = 32, 2048, 128
        return {
            "x": _w((lambda *s: torch.randn(*s, dtype=torch.bfloat16) * 0.05)(B, Sq, D)),
            "k_cache": _w((lambda *s: torch.randn(*s, dtype=torch.bfloat16) * 0.8)(B, H, Sk, Dh)),
            "v_cache": _w((lambda *s: torch.randn(*s, dtype=torch.bfloat16) * 0.8)(B, H, Sk, Dh)),
            "wq": _w((lambda *s: torch.randn(*s, dtype=torch.bfloat16) * 0.8)(D, H * Dh) * (D ** -0.5)),
            "wo": _w((lambda *s: torch.randn(*s, dtype=torch.bfloat16) * 0.8)(H * Dh, D) * ((H * Dh) ** -0.5)),
        }
    _A_in = _A_setup()

    def _B_setup():
        B, S, D, F = 1, 2048, 576, 4608
        return {
            "x":  _w((lambda *s: torch.randn(*s, dtype=torch.bfloat16) * 0.05)(B, S, D)),
            "w1": _w((lambda *s: torch.randn(*s, dtype=torch.bfloat16) * 3.2)(D, D) * (D ** -0.5)),
            "w2": _w((lambda *s: torch.randn(*s, dtype=torch.bfloat16) * 3.2)(D, D) * (D ** -0.5)),
            "w3": _w((lambda *s: torch.randn(*s, dtype=torch.bfloat16) * 3.2)(D, F) * (D ** -0.5)),
            "w4": _w((lambda *s: torch.randn(*s, dtype=torch.bfloat16) * 3.2)(F, D) * (F ** -0.5)),
        }
    _B_in = _B_setup()

    return {
        "A_x": _A_in["x"],
        "A_k_cache": _A_in["k_cache"],
        "A_v_cache": _A_in["v_cache"],
        "A_wq": _A_in["wq"],
        "A_wo": _A_in["wo"],
        "B_x": _B_in["x"],
        "B_w1": _B_in["w1"],
        "B_w2": _B_in["w2"],
        "B_w3": _B_in["w3"],
        "B_w4": _B_in["w4"],
    }

def reference(A_x, A_k_cache, A_v_cache, A_wq, A_wo, B_x, B_w1, B_w2, B_w3, B_w4):
    def _A_ref(x, k_cache, v_cache, wq, wo):
        B, Sq, D = x.shape
        H, Dh = 32, 128
        q = (lambda x, *d: x.permute(*d))((x @ wq).reshape(B, Sq, H, Dh), 0, 2, 1, 3)
        scores = torch.einsum("bhqd,bhkd->bhqk", q, k_cache) * (Dh ** -0.5)
        p = _softmax(scores, axis=-1)
        o = torch.einsum("bhqk,bhkd->bhqd", p, v_cache)
        return (lambda x, *d: x.permute(*d))(o, 0, 2, 1, 3).reshape(B, Sq, H * Dh) @ wo

    def _B_ref(x, w1, w2, w3, w4):
        B, S, D = x.shape
        h = _gelu(_layernorm(x, axis=-1) @ w1)
        c = D // 4
        g0 = _pad(h[:, :, 0*c:1*c], ((0, 0), (1, 0), (0, 0)))[:, :S, :]
        g1 = _pad(h[:, :, 1*c:2*c], ((0, 0), (0, 1), (0, 0)))[:, 1:, :]
        g2 = _pad(h[:, :, 2*c:3*c], ((0, 0), (2, 0), (0, 0)))[:, :S, :]
        g3 = _pad(h[:, :, 3*c:   ], ((0, 0), (0, 2), (0, 0)))[:, 2:, :]
        hs = torch.concatenate([g0, g1, g2, g3], axis=-1) @ w2
        x1 = x + hs
        h2 = _gelu(_layernorm(x1, axis=-1) @ w3) @ w4
        return x1 + h2

    x = A_x
    xn = _layernorm(x, axis=-1)
    s = _A_ref(xn, A_k_cache, A_v_cache, A_wq, A_wo)
    g = _silu(_B_ref(xn, B_w1, B_w2, B_w3, B_w4))
    return x + s * g
```

```asm
; @launch grid=(256,1,1) block=(256,1,1) lds=163840
.amdgcn_target "amdgcn-amd-amdhsa--gfx950"
.text
.globl recurrent_scan__mha_block_cached__mixer_s_mlp__prompt_kernel
.p2align 8
.type recurrent_scan__mha_block_cached__mixer_s_mlp__prompt_kernel,@function
recurrent_scan__mha_block_cached__mixer_s_mlp__prompt_kernel:
    s_cmp_ge_u32 s2, 256
    s_cbranch_scc1 L_end_1
    s_load_dwordx16 s[64:79], s[0:1], 0
    s_getpc_b64 s[8:9]
CODE_PC:
    s_mov_b32 s10, CODE_END - CODE_PC
    s_mov_b32 s11, 0x20000
    v_lshlrev_b32 v1, 7, v0
    buffer_load_dword v254, v1, s[8:11], 0 offen
    s_lshr_b32 s3, s2, 3
    s_mul_i32 s3, s3, 3072
    s_add_u32 s3, s3, 32768
    v_min_u32 v1, 2944, v1
    buffer_load_dword v255, v1, s[8:11], s3 offen
    s_load_dwordx8 s[80:87], s[0:1], 64
    s_load_dwordx2 s[88:89], s[0:1], 96
    v_lshrrev_b32 v1, 6, v0
    s_mov_b32 s5, 4096
    v_readfirstlane_b32 s4, v1
    s_waitcnt lgkmcnt(0)
    s_add_u32 s44, s88, 0xa00000
    s_addc_u32 s45, s89, 0
    s_mov_b32 s46, 0x40000
    s_mov_b32 s47, 0x20000
    s_mov_b32 s8, s86
    s_mov_b32 s9, s87
    s_mov_b32 s10, 0x100
    s_mov_b32 s11, 0x20000
    v_mov_b32 v4, 0
    s_or_b32 s3, s2, s4
    s_cmp_lg_u32 s3, 0
    s_cbranch_scc1 L_tagskip_3
    s_memrealtime s[62:63]
    s_waitcnt lgkmcnt(0)
    s_or_b32 s62, s62, 1
    s_mov_b64 exec, 1
    v_mov_b32 v2, s62
    v_mov_b32 v3, s63
    buffer_store_dwordx2 v[2:3], v4, s[8:11], 0 offen sc1
    s_mov_b64 exec, -1
L_tagskip_3:
    s_cmp_ge_u32 s4, 2
    s_cbranch_scc1 L_lnskip_2
    s_mov_b32 s12, s64
    s_mov_b32 s13, s65
    s_mov_b32 s14, 0x240000
    s_mov_b32 s15, 0x20000
    s_lshl_b32 s3, s2, 3
    v_lshrrev_b32 v62, 4, v0
    v_add_u32 v62, s3, v62
    v_and_b32 v63, 15, v0
    v_mul_u32_u24 v3, 1152, v62
    v_lshl_add_u32 v3, v63, 3, v3
    buffer_load_dwordx2 v[64:65], v3, s[12:15], 0 offen offset:0
    buffer_load_dwordx2 v[66:67], v3, s[12:15], 0 offen offset:128
    buffer_load_dwordx2 v[68:69], v3, s[12:15], 0 offen offset:256
    buffer_load_dwordx2 v[70:71], v3, s[12:15], 0 offen offset:384
    buffer_load_dwordx2 v[72:73], v3, s[12:15], 0 offen offset:512
    buffer_load_dwordx2 v[74:75], v3, s[12:15], 0 offen offset:640
    buffer_load_dwordx2 v[76:77], v3, s[12:15], 0 offen offset:768
    buffer_load_dwordx2 v[78:79], v3, s[12:15], 0 offen offset:896
    buffer_load_dwordx2 v[80:81], v3, s[12:15], 0 offen offset:1024
L_lnskip_2:
    s_cmp_lt_u32 s2, 192
    s_cselect_b32 s92, 0x240000, 0
    s_cselect_b32 s93, 663552, 0
    s_lshr_b32 s29, s2, 3
    s_and_b32 s28, s2, 7
    s_lshl_b32 s28, s28, 1
    s_and_b32 s30, s29, 1
    s_add_u32 s28, s28, s30
    s_lshr_b32 s29, s29, 1
    v_lshrrev_b32 v1, 6, v0
    v_and_b32 v2, 63, v0
    s_lshl_b32 s30, s28, 3
    v_lshl_add_u32 v17, v1, 1, s30
    v_mul_u32_u24 v6, 18432, v17
    v_lshl_add_u32 v11, v2, 4, v6
    v_add_u32 v12, 18432, v11
    s_add_u32 s16, s88, 0x240000
    s_addc_u32 s17, s89, 0
    s_mov_b32 s18, s92
    s_mov_b32 s19, 0x20000
    s_add_u32 s24, s88, 0x480000
    s_addc_u32 s25, s89, 0
    s_mov_b32 s26, s92
    s_mov_b32 s27, 0x20000
    s_mov_b32 s8, s76
    s_mov_b32 s9, s77
    s_mov_b32 s10, s93
    s_mov_b32 s11, 0x20000
    s_mov_b32 s12, s78
    s_mov_b32 s13, s79
    s_mov_b32 s14, s93
    s_mov_b32 s15, 0x20000
    s_mul_i32 s30, s29, 96
    v_add_u32 v3, 0, v1
    v_mul_u32_u24 v4, 0xaaab, v3
    v_lshrrev_b32 v4, 17, v4
    v_mul_u32_u24 v5, 3, v4
    v_sub_u32 v5, v3, v5
    v_lshl_add_u32 v5, v5, 6, v2
    v_mul_u32_u24 v6, 0xaaab, v5
    v_lshrrev_b32 v6, 18, v6
    v_mul_u32_u24 v3, 6, v6
    v_sub_u32 v7, v5, v3
    v_and_b32 v3, 3, v6
    v_bfe_u32 v5, v6, 2, 2
    v_lshl_or_b32 v3, v5, 3, v3
    v_lshrrev_b32 v5, 4, v6
    v_lshl_or_b32 v3, v5, 2, v3
    v_lshl_add_u32 v3, v4, 5, v3
    v_mul_u32_u24 v3, 1152, v3
    v_lshl_add_u32 v3, v7, 4, v3
    v_add_u32 v58, s30, v3
    v_lshl_add_u32 v6, v4, 5, v6
    v_mul_u32_u24 v6, 1152, v6
    v_lshl_add_u32 v6, v7, 4, v6
    v_add_u32 v8, s30, v6
    v_add_u32 v3, 4, v1
    v_mul_u32_u24 v4, 0xaaab, v3
    v_lshrrev_b32 v4, 17, v4
    v_mul_u32_u24 v5, 3, v4
    v_sub_u32 v5, v3, v5
    v_lshl_add_u32 v5, v5, 6, v2
    v_mul_u32_u24 v6, 0xaaab, v5
    v_lshrrev_b32 v6, 18, v6
    v_mul_u32_u24 v3, 6, v6
    v_sub_u32 v7, v5, v3
    v_and_b32 v3, 3, v6
    v_bfe_u32 v5, v6, 2, 2
    v_lshl_or_b32 v3, v5, 3, v3
    v_lshrrev_b32 v5, 4, v6
    v_lshl_or_b32 v3, v5, 2, v3
    v_lshl_add_u32 v3, v4, 5, v3
    v_mul_u32_u24 v3, 1152, v3
    v_lshl_add_u32 v3, v7, 4, v3
    v_add_u32 v59, s30, v3
    v_lshl_add_u32 v6, v4, 5, v6
    v_mul_u32_u24 v6, 1152, v6
    v_lshl_add_u32 v6, v7, 4, v6
    v_add_u32 v9, s30, v6
    v_add_u32 v3, 8, v1
    v_mul_u32_u24 v4, 0xaaab, v3
    v_lshrrev_b32 v4, 17, v4
    v_mul_u32_u24 v5, 3, v4
    v_sub_u32 v5, v3, v5
    v_lshl_add_u32 v5, v5, 6, v2
    v_mul_u32_u24 v6, 0xaaab, v5
    v_lshrrev_b32 v6, 18, v6
    v_mul_u32_u24 v3, 6, v6
    v_sub_u32 v7, v5, v3
    v_and_b32 v3, 3, v6
    v_bfe_u32 v5, v6, 2, 2
    v_lshl_or_b32 v3, v5, 3, v3
    v_lshrrev_b32 v5, 4, v6
    v_lshl_or_b32 v3, v5, 2, v3
    v_lshl_add_u32 v3, v4, 5, v3
    v_mul_u32_u24 v3, 1152, v3
    v_lshl_add_u32 v3, v7, 4, v3
    v_add_u32 v60, s30, v3
    v_lshl_add_u32 v6, v4, 5, v6
    v_mul_u32_u24 v6, 1152, v6
    v_lshl_add_u32 v6, v7, 4, v6
    v_add_u32 v10, s30, v6
    s_lshl_b32 s32, s4, 10
    s_add_u32 m0, s32, 0
    s_mov_b32 s30, 0
    buffer_load_dwordx4 v8, s[8:11], s30 offen lds
    s_add_u32 m0, s32, 4096
    s_mov_b32 s30, 0
    buffer_load_dwordx4 v9, s[8:11], s30 offen lds
    s_add_u32 m0, s32, 8192
    s_mov_b32 s30, 0
    buffer_load_dwordx4 v10, s[8:11], s30 offen lds
    s_add_u32 m0, s32, 12288
    s_mov_b32 s30, 147456
    buffer_load_dwordx4 v8, s[8:11], s30 offen lds
    s_add_u32 m0, s32, 16384
    s_mov_b32 s30, 147456
    buffer_load_dwordx4 v9, s[8:11], s30 offen lds
    s_add_u32 m0, s32, 20480
    s_mov_b32 s30, 147456
    buffer_load_dwordx4 v10, s[8:11], s30 offen lds
    s_add_u32 m0, s32, 24576
    s_mov_b32 s30, 294912
    buffer_load_dwordx4 v8, s[8:11], s30 offen lds
    s_add_u32 m0, s32, 28672
    s_mov_b32 s30, 294912
    buffer_load_dwordx4 v9, s[8:11], s30 offen lds
    s_add_u32 m0, s32, 32768
    s_mov_b32 s30, 294912
    buffer_load_dwordx4 v10, s[8:11], s30 offen lds
    s_add_u32 m0, s32, 36864
    s_mov_b32 s30, 442368
    buffer_load_dwordx4 v8, s[8:11], s30 offen lds
    s_add_u32 m0, s32, 40960
    s_mov_b32 s30, 442368
    buffer_load_dwordx4 v9, s[8:11], s30 offen lds
    s_add_u32 m0, s32, 45056
    s_mov_b32 s30, 442368
    buffer_load_dwordx4 v10, s[8:11], s30 offen lds
    s_add_u32 m0, s32, 49152
    s_mov_b32 s30, 589824
    buffer_load_dwordx4 v8, s[8:11], s30 offen lds
    s_add_u32 m0, s32, 53248
    s_mov_b32 s30, 589824
    buffer_load_dwordx4 v9, s[8:11], s30 offen lds
    s_bfe_u32 s94, s2, 0x20001
    s_lshl_b32 s94, s94, 3
    s_bfe_u32 s3, s2, 0x30003
    s_add_u32 s94, s94, s3
    s_and_b32 s95, s2, 1
    s_lshl_b32 s95, s95, 2
    s_lshr_b32 s3, s2, 6
    s_add_u32 s95, s95, s3
    s_and_b32 s93, s94, 7
    s_and_b32 s3, s95, 3
    s_lshl_b32 s3, s3, 1
    s_add_u32 s93, s93, s3
    s_sub_u32 s3, s93, 9
    s_cselect_b32 s93, s93, s3
    s_mov_b32 s93, 0
    v_lshrrev_b32 v1, 6, v0
    v_and_b32 v2, 63, v0
    v_and_b32 v3, 15, v2
    v_lshrrev_b32 v4, 4, v2
    v_lshl_add_u32 v5, v1, 4, v4
    v_lshlrev_b32 v6, 1, v4
    v_xor_b32 v6, v6, v3
    v_xor_b32 v7, 8, v6
    v_lshlrev_b32 v5, 13, v5
    v_lshl_add_u32 v26, v6, 4, v5
    v_lshl_add_u32 v27, v7, 4, v5
    v_add_u32 v27, 31744, v27
    v_lshl_add_u32 v28, v6, 4, v5
    v_add_u32 v28, 63488, v28
    v_lshl_add_u32 v29, v7, 4, v5
    v_add_u32 v29, 95232, v29
    s_lshl_b32 s95, s95, 4
    v_lshl_add_u32 v5, v1, 2, s95
    v_mul_u32_u24 v5, 18432, v5
    v_lshl_add_u32 v30, v2, 4, v5
    v_add_u32 v31, 18432, v30
    v_add_u32 v32, 36864, v30
    v_add_u32 v33, 55296, v30
    s_lshl_b32 s100, s4, 12
    s_lshl_b32 s94, s94, 8
    s_sub_u32 s95, 4718592, s94
    s_add_u32 s96, s70, s94
    s_addc_u32 s97, s71, 0
    s_mov_b32 s98, s95
    s_mov_b32 s99, 0x20000
    s_add_u32 s20, s88, 0x0
    s_addc_u32 s21, s89, 0
    s_mov_b32 s22, 0x240000
    s_mov_b32 s23, 0x20000
    v_lshrrev_b32 v5, 2, v2
    v_and_b32 v6, 7, v5
    v_lshlrev_b32 v6, 5, v6
    v_lshl_or_b32 v6, v5, 8, v6
    v_and_b32 v7, 3, v2
    v_lshlrev_b32 v7, 4, v7
    v_xor_b32 v7, v7, v6
    v_xor_b32 v38, 0, v7
    v_add_u32 v34, 114688, v38
    v_xor_b32 v39, 64, v7
    v_add_u32 v35, 114688, v39
    v_xor_b32 v40, 128, v7
    v_add_u32 v36, 114688, v40
    v_xor_b32 v41, 192, v7
    v_add_u32 v37, 114688, v41
    s_add_u32 s94, s93, 0
    s_sub_u32 s3, s94, 9
    s_cselect_b32 s94, s94, s3
    s_add_u32 m0, s100, 114688
    s_lshl_b32 s94, s94, 19
    buffer_load_dwordx4 v26, s[96:99], s94 offen offset:0 lds
    buffer_load_dwordx4 v27, s[96:99], s94 offen offset:1024 lds
    buffer_load_dwordx4 v28, s[96:99], s94 offen offset:2048 lds
    buffer_load_dwordx4 v29, s[96:99], s94 offen offset:3072 lds
    s_add_u32 s94, s93, 1
    s_sub_u32 s3, s94, 9
    s_cselect_b32 s94, s94, s3
    s_add_u32 m0, s100, 131072
    s_lshl_b32 s94, s94, 19
    buffer_load_dwordx4 v26, s[96:99], s94 offen offset:0 lds
    buffer_load_dwordx4 v27, s[96:99], s94 offen offset:1024 lds
    buffer_load_dwordx4 v28, s[96:99], s94 offen offset:2048 lds
    buffer_load_dwordx4 v29, s[96:99], s94 offen offset:3072 lds
    s_add_u32 s94, s93, 2
    s_sub_u32 s3, s94, 9
    s_cselect_b32 s94, s94, s3
    s_add_u32 m0, s100, 147456
    s_lshl_b32 s94, s94, 19
    buffer_load_dwordx4 v26, s[96:99], s94 offen offset:0 lds
    buffer_load_dwordx4 v27, s[96:99], s94 offen offset:1024 lds
    buffer_load_dwordx4 v28, s[96:99], s94 offen offset:2048 lds
    buffer_load_dwordx4 v29, s[96:99], s94 offen offset:3072 lds
    v_lshrrev_b32 v3, 2, v2
    v_mul_u32_u24 v3, 96, v3
    v_and_b32 v4, 3, v2
    v_lshl_add_u32 v13, v4, 3, v3
    v_add_u32 v14, 57344, v13
    s_mul_i32 s30, s29, 3
    s_add_u32 s31, s30, 0
    s_lshr_b32 s33, s31, 1
    s_lshl_b32 s33, s33, 10
    s_and_b32 s31, s31, 1
    s_lshl_b32 s31, s31, 3
    s_add_u32 s33, s33, s31
    s_add_u32 s31, s30, 1
    s_lshr_b32 s34, s31, 1
    s_lshl_b32 s34, s34, 10
    s_and_b32 s31, s31, 1
    s_lshl_b32 s31, s31, 3
    s_add_u32 s34, s34, s31
    s_add_u32 s31, s30, 2
    s_lshr_b32 s35, s31, 1
    s_lshl_b32 s35, s35, 10
    s_and_b32 s31, s31, 1
    s_lshl_b32 s31, s31, 3
    s_add_u32 s35, s35, s31
    s_cmp_ge_u32 s29, 6
    s_cselect_b32 s30, 2, 1
    s_sub_u32 s31, 0, s30
    s_cmp_ge_u32 s29, 3
    s_cselect_b32 s3, s31, s30
    s_cmp_ge_u32 s29, 6
    s_cselect_b32 s3, s30, s3
    s_cmp_ge_u32 s29, 9
    s_cselect_b32 s3, s31, s3
    v_and_b32 v3, 15, v2
    v_lshl_add_u32 v3, v17, 4, v3
    v_lshlrev_b32 v22, 3, v3
    v_and_b32 v4, 16, v2
    v_add_u32 v3, v3, v4
    v_lshrrev_b32 v4, 5, v2
    v_mov_b32 v19, 0x800
    v_lshrrev_b32 v7, 4, v3
    v_mul_u32_u24 v7, 18432, v7
    v_and_b32 v6, 15, v3
    v_lshl_add_u32 v7, v6, 4, v7
    v_lshl_add_u32 v16, v4, 8, v7
    v_add_u32 v3, s3, v3
    v_cmp_gt_u32 vcc, v19, v3
    v_and_b32 v3, 0x7ff, v3
    v_lshrrev_b32 v7, 4, v3
    v_mul_u32_u24 v7, 18432, v7
    v_and_b32 v6, 15, v3
    v_lshl_add_u32 v7, v6, 4, v7
    v_lshl_add_u32 v15, v4, 8, v7
    v_cndmask_b32 v20, 0, -1, vcc
    s_mul_i32 s101, s29, 1536
    v_mov_b32 v18, 0xbdd2d3e8
    v_min_u32 v3, 35, v2
    v_mul_u32_u24 v4, 43, v3
    v_lshrrev_b32 v4, 9, v4
    v_mul_u32_u24 v6, 12, v4
    v_sub_u32 v3, v3, v6
    s_add_u32 s30, s28, 15
    v_add_u32 v4, s30, v4
    v_and_b32 v4, 15, v4
    v_lshlrev_b32 v3, 4, v3
    v_and_b32 v6, 1, v4
    v_lshl_add_u32 v3, v6, 3, v3
    v_lshrrev_b32 v4, 1, v4
    v_add_lshl_u32 v23, v3, v4, 7
    s_bfe_u32 s90, s2, 0x20001
    s_lshl_b32 s90, s90, 3
    s_bfe_u32 s3, s2, 0x30003
    s_add_u32 s90, s90, s3
    s_and_b32 s91, s2, 1
    s_lshl_b32 s91, s91, 2
    s_lshr_b32 s3, s2, 6
    s_add_u32 s91, s91, s3
    v_subrev_u32 v3, 16, v2
    v_min_u32 v3, 31, v3
    s_lshl_b32 s91, s91, 5
    v_add_u32 v3, s91, v3
    s_lshl_b32 s90, s28, 4
    v_add_u32 v4, s90, v2
    v_cmp_gt_u32 vcc, 16, v2
    s_nop 1
    v_cndmask_b32 v61, v3, v4, vcc
    s_mov_b32 s40, s86
    s_mov_b32 s41, s87
    s_mov_b32 s42, 0x100
    s_mov_b32 s43, 0x20000
    v_mov_b32 v138, 0
    s_mov_b32 s3, 0x40000
    s_cmp_ge_u32 s4, 2
    s_cbranch_scc1 L_tag_6
    buffer_load_dwordx2 v[136:137], v138, s[40:43], 0 offen sc1
    v_lshrrev_b32 v4, 4, v62
    v_mul_u32_u24 v4, 18432, v4
    v_lshrrev_b32 v5, 3, v63
    v_lshl_add_u32 v4, v5, 10, v4
    v_and_b32 v5, 15, v62
    v_lshl_add_u32 v4, v5, 4, v4
    v_and_b32 v5, 3, v63
    v_lshl_add_u32 v4, v5, 8, v4
    v_bfe_u32 v5, v63, 2, 1
    v_lshl_add_u32 v4, v5, 3, v4
    v_add_u32 v5, 4096, v4
    v_add_u32 v6, 8192, v4
    v_add_u32 v7, 12288, v4
    v_add_u32 v3, 16384, v4
    s_mov_b32 s36, s88
    s_mov_b32 s37, s89
    s_mov_b32 s38, 0x480000
    s_mov_b32 s39, 0x20000
    s_mov_b32 s90, 0x240000
    s_waitcnt vmcnt(27)
    v_lshlrev_b32 v96, 16, v64
    v_and_b32 v97, 0xffff0000, v64
    v_lshlrev_b32 v98, 16, v65
    v_and_b32 v99, 0xffff0000, v65
    v_lshlrev_b32 v100, 16, v66
    v_and_b32 v101, 0xffff0000, v66
    v_lshlrev_b32 v102, 16, v67
    v_and_b32 v103, 0xffff0000, v67
    v_lshlrev_b32 v104, 16, v68
    v_and_b32 v105, 0xffff0000, v68
    v_lshlrev_b32 v106, 16, v69
    v_and_b32 v107, 0xffff0000, v69
    v_lshlrev_b32 v108, 16, v70
    v_and_b32 v109, 0xffff0000, v70
    v_lshlrev_b32 v110, 16, v71
    v_and_b32 v111, 0xffff0000, v71
    v_lshlrev_b32 v112, 16, v72
    v_and_b32 v113, 0xffff0000, v72
    v_lshlrev_b32 v114, 16, v73
    v_and_b32 v115, 0xffff0000, v73
    v_lshlrev_b32 v116, 16, v74
    v_and_b32 v117, 0xffff0000, v74
    v_lshlrev_b32 v118, 16, v75
    v_and_b32 v119, 0xffff0000, v75
    v_lshlrev_b32 v120, 16, v76
    v_and_b32 v121, 0xffff0000, v76
    v_lshlrev_b32 v122, 16, v77
    v_and_b32 v123, 0xffff0000, v77
    v_lshlrev_b32 v124, 16, v78
    v_and_b32 v125, 0xffff0000, v78
    v_lshlrev_b32 v126, 16, v79
    v_and_b32 v127, 0xffff0000, v79
    v_lshlrev_b32 v128, 16, v80
    v_and_b32 v129, 0xffff0000, v80
    v_lshlrev_b32 v130, 16, v81
    v_and_b32 v131, 0xffff0000, v81
    v_add_f32 v132, v96, v97
    v_add_f32 v133, v98, v99
    v_add_f32 v132, v132, v100
    v_add_f32 v133, v133, v101
    v_add_f32 v132, v132, v102
    v_add_f32 v133, v133, v103
    v_add_f32 v132, v132, v104
    v_add_f32 v133, v133, v105
    v_add_f32 v132, v132, v106
    v_add_f32 v133, v133, v107
    v_add_f32 v132, v132, v108
    v_add_f32 v133, v133, v109
    v_add_f32 v132, v132, v110
    v_add_f32 v133, v133, v111
    v_add_f32 v132, v132, v112
    v_add_f32 v133, v133, v113
    v_add_f32 v132, v132, v114
    v_add_f32 v133, v133, v115
    v_add_f32 v132, v132, v116
    v_add_f32 v133, v133, v117
    v_add_f32 v132, v132, v118
    v_add_f32 v133, v133, v119
    v_add_f32 v132, v132, v120
    v_add_f32 v133, v133, v121
    v_add_f32 v132, v132, v122
    v_add_f32 v133, v133, v123
    v_add_f32 v132, v132, v124
    v_add_f32 v133, v133, v125
    v_add_f32 v132, v132, v126
    v_add_f32 v133, v133, v127
    v_add_f32 v132, v132, v128
    v_add_f32 v133, v133, v129
    v_add_f32 v132, v132, v130
    v_add_f32 v133, v133, v131
    v_add_f32 v132, v132, v133
    s_nop 1
    v_add_f32_dpp v132, v132, v132 quad_perm:[1,0,3,2] row_mask:0xf bank_mask:0xf
    s_nop 1
    v_add_f32_dpp v132, v132, v132 quad_perm:[2,3,0,1] row_mask:0xf bank_mask:0xf
    s_nop 1
    v_add_f32_dpp v132, v132, v132 row_half_mirror row_mask:0xf bank_mask:0xf
    s_nop 1
    v_add_f32_dpp v132, v132, v132 row_mirror row_mask:0xf bank_mask:0xf
    v_mul_f32 v132, 0x3ae38e39, v132
    v_mov_b32 v133, 0
    v_mov_b32 v134, 0
    v_sub_f32 v158, v96, v132
    v_sub_f32 v159, v97, v132
    v_fmac_f32 v133, v158, v158
    v_fmac_f32 v134, v159, v159
    v_sub_f32 v158, v98, v132
    v_sub_f32 v159, v99, v132
    v_fmac_f32 v133, v158, v158
    v_fmac_f32 v134, v159, v159
    v_sub_f32 v158, v100, v132
    v_sub_f32 v159, v101, v132
    v_fmac_f32 v133, v158, v158
    v_fmac_f32 v134, v159, v159
    v_sub_f32 v158, v102, v132
    v_sub_f32 v159, v103, v132
    v_fmac_f32 v133, v158, v158
    v_fmac_f32 v134, v159, v159
    v_sub_f32 v158, v104, v132
    v_sub_f32 v159, v105, v132
    v_fmac_f32 v133, v158, v158
    v_fmac_f32 v134, v159, v159
    v_sub_f32 v158, v106, v132
    v_sub_f32 v159, v107, v132
    v_fmac_f32 v133, v158, v158
    v_fmac_f32 v134, v159, v159
    v_sub_f32 v158, v108, v132
    v_sub_f32 v159, v109, v132
    v_fmac_f32 v133, v158, v158
    v_fmac_f32 v134, v159, v159
    v_sub_f32 v158, v110, v132
    v_sub_f32 v159, v111, v132
    v_fmac_f32 v133, v158, v158
    v_fmac_f32 v134, v159, v159
    v_sub_f32 v158, v112, v132
    v_sub_f32 v159, v113, v132
    v_fmac_f32 v133, v158, v158
    v_fmac_f32 v134, v159, v159
    v_sub_f32 v158, v114, v132
    v_sub_f32 v159, v115, v132
    v_fmac_f32 v133, v158, v158
    v_fmac_f32 v134, v159, v159
    v_sub_f32 v158, v116, v132
    v_sub_f32 v159, v117, v132
    v_fmac_f32 v133, v158, v158
    v_fmac_f32 v134, v159, v159
    v_sub_f32 v158, v118, v132
    v_sub_f32 v159, v119, v132
    v_fmac_f32 v133, v158, v158
    v_fmac_f32 v134, v159, v159
    v_sub_f32 v158, v120, v132
    v_sub_f32 v159, v121, v132
    v_fmac_f32 v133, v158, v158
    v_fmac_f32 v134, v159, v159
    v_sub_f32 v158, v122, v132
    v_sub_f32 v159, v123, v132
    v_fmac_f32 v133, v158, v158
    v_fmac_f32 v134, v159, v159
    v_sub_f32 v158, v124, v132
    v_sub_f32 v159, v125, v132
    v_fmac_f32 v133, v158, v158
    v_fmac_f32 v134, v159, v159
    v_sub_f32 v158, v126, v132
    v_sub_f32 v159, v127, v132
    v_fmac_f32 v133, v158, v158
    v_fmac_f32 v134, v159, v159
    v_sub_f32 v158, v128, v132
    v_sub_f32 v159, v129, v132
    v_fmac_f32 v133, v158, v158
    v_fmac_f32 v134, v159, v159
    v_sub_f32 v158, v130, v132
    v_sub_f32 v159, v131, v132
    v_fmac_f32 v133, v158, v158
    v_fmac_f32 v134, v159, v159
    v_add_f32 v133, v133, v134
    s_nop 1
    v_add_f32_dpp v133, v133, v133 quad_perm:[1,0,3,2] row_mask:0xf bank_mask:0xf
    s_nop 1
    v_add_f32_dpp v133, v133, v133 quad_perm:[2,3,0,1] row_mask:0xf bank_mask:0xf
    s_nop 1
    v_add_f32_dpp v133, v133, v133 row_half_mirror row_mask:0xf bank_mask:0xf
    s_nop 1
    v_add_f32_dpp v133, v133, v133 row_mirror row_mask:0xf bank_mask:0xf
    v_mul_f32 v133, 0x3ae38e39, v133
    v_cvt_pk_bf16_f32 v132, v132, v132
    v_lshlrev_b32 v132, 16, v132
    v_cvt_pk_bf16_f32 v133, v133, v133
    v_lshlrev_b32 v133, 16, v133
    v_add_f32 v133, 0x3727c5ac, v133
    v_cvt_pk_bf16_f32 v133, v133, v133
    v_lshlrev_b32 v133, 16, v133
    v_sqrt_f32 v133, v133
    s_nop 0
    v_cvt_pk_bf16_f32 v133, v133, v133
    v_lshlrev_b32 v133, 16, v133
    v_rcp_f32 v133, v133
    v_sub_f32 v96, v96, v132
    v_sub_f32 v97, v97, v132
    v_cvt_pk_bf16_f32 v158, v96, v97
    v_lshlrev_b32 v96, 16, v158
    v_and_b32 v97, 0xffff0000, v158
    v_mul_f32 v96, v96, v133
    v_mul_f32 v97, v97, v133
    v_cvt_pk_bf16_f32 v64, v96, v97
    v_sub_f32 v98, v98, v132
    v_sub_f32 v99, v99, v132
    v_cvt_pk_bf16_f32 v158, v98, v99
    v_lshlrev_b32 v98, 16, v158
    v_and_b32 v99, 0xffff0000, v158
    v_mul_f32 v98, v98, v133
    v_mul_f32 v99, v99, v133
    v_cvt_pk_bf16_f32 v65, v98, v99
    buffer_store_dwordx2 v[64:65], v4, s[36:39], 0 offen offset:0 sc1
    v_sub_f32 v100, v100, v132
    v_sub_f32 v101, v101, v132
    v_cvt_pk_bf16_f32 v158, v100, v101
    v_lshlrev_b32 v100, 16, v158
    v_and_b32 v101, 0xffff0000, v158
    v_mul_f32 v100, v100, v133
    v_mul_f32 v101, v101, v133
    v_cvt_pk_bf16_f32 v66, v100, v101
    v_sub_f32 v102, v102, v132
    v_sub_f32 v103, v103, v132
    v_cvt_pk_bf16_f32 v158, v102, v103
    v_lshlrev_b32 v102, 16, v158
    v_and_b32 v103, 0xffff0000, v158
    v_mul_f32 v102, v102, v133
    v_mul_f32 v103, v103, v133
    v_cvt_pk_bf16_f32 v67, v102, v103
    buffer_store_dwordx2 v[66:67], v4, s[36:39], 0 offen offset:2048 sc1
    v_sub_f32 v104, v104, v132
    v_sub_f32 v105, v105, v132
    v_cvt_pk_bf16_f32 v158, v104, v105
    v_lshlrev_b32 v104, 16, v158
    v_and_b32 v105, 0xffff0000, v158
    v_mul_f32 v104, v104, v133
    v_mul_f32 v105, v105, v133
    v_cvt_pk_bf16_f32 v68, v104, v105
    v_sub_f32 v106, v106, v132
    v_sub_f32 v107, v107, v132
    v_cvt_pk_bf16_f32 v158, v106, v107
    v_lshlrev_b32 v106, 16, v158
    v_and_b32 v107, 0xffff0000, v158
    v_mul_f32 v106, v106, v133
    v_mul_f32 v107, v107, v133
    v_cvt_pk_bf16_f32 v69, v106, v107
    buffer_store_dwordx2 v[68:69], v5, s[36:39], 0 offen offset:0 sc1
    v_sub_f32 v108, v108, v132
    v_sub_f32 v109, v109, v132
    v_cvt_pk_bf16_f32 v158, v108, v109
    v_lshlrev_b32 v108, 16, v158
    v_and_b32 v109, 0xffff0000, v158
    v_mul_f32 v108, v108, v133
    v_mul_f32 v109, v109, v133
    v_cvt_pk_bf16_f32 v70, v108, v109
    v_sub_f32 v110, v110, v132
    v_sub_f32 v111, v111, v132
    v_cvt_pk_bf16_f32 v158, v110, v111
    v_lshlrev_b32 v110, 16, v158
    v_and_b32 v111, 0xffff0000, v158
    v_mul_f32 v110, v110, v133
    v_mul_f32 v111, v111, v133
    v_cvt_pk_bf16_f32 v71, v110, v111
    buffer_store_dwordx2 v[70:71], v5, s[36:39], 0 offen offset:2048 sc1
    v_sub_f32 v112, v112, v132
    v_sub_f32 v113, v113, v132
    v_cvt_pk_bf16_f32 v158, v112, v113
    v_lshlrev_b32 v112, 16, v158
    v_and_b32 v113, 0xffff0000, v158
    v_mul_f32 v112, v112, v133
    v_mul_f32 v113, v113, v133
    v_cvt_pk_bf16_f32 v72, v112, v113
    v_sub_f32 v114, v114, v132
    v_sub_f32 v115, v115, v132
    v_cvt_pk_bf16_f32 v158, v114, v115
    v_lshlrev_b32 v114, 16, v158
    v_and_b32 v115, 0xffff0000, v158
    v_mul_f32 v114, v114, v133
    v_mul_f32 v115, v115, v133
    v_cvt_pk_bf16_f32 v73, v114, v115
    buffer_store_dwordx2 v[72:73], v6, s[36:39], 0 offen offset:0 sc1
    v_sub_f32 v116, v116, v132
    v_sub_f32 v117, v117, v132
    v_cvt_pk_bf16_f32 v158, v116, v117
    v_lshlrev_b32 v116, 16, v158
    v_and_b32 v117, 0xffff0000, v158
    v_mul_f32 v116, v116, v133
    v_mul_f32 v117, v117, v133
    v_cvt_pk_bf16_f32 v74, v116, v117
    v_sub_f32 v118, v118, v132
    v_sub_f32 v119, v119, v132
    v_cvt_pk_bf16_f32 v158, v118, v119
    v_lshlrev_b32 v118, 16, v158
    v_and_b32 v119, 0xffff0000, v158
    v_mul_f32 v118, v118, v133
    v_mul_f32 v119, v119, v133
    v_cvt_pk_bf16_f32 v75, v118, v119
    buffer_store_dwordx2 v[74:75], v6, s[36:39], 0 offen offset:2048 sc1
    v_sub_f32 v120, v120, v132
    v_sub_f32 v121, v121, v132
    v_cvt_pk_bf16_f32 v158, v120, v121
    v_lshlrev_b32 v120, 16, v158
    v_and_b32 v121, 0xffff0000, v158
    v_mul_f32 v120, v120, v133
    v_mul_f32 v121, v121, v133
    v_cvt_pk_bf16_f32 v76, v120, v121
    v_sub_f32 v122, v122, v132
    v_sub_f32 v123, v123, v132
    v_cvt_pk_bf16_f32 v158, v122, v123
    v_lshlrev_b32 v122, 16, v158
    v_and_b32 v123, 0xffff0000, v158
    v_mul_f32 v122, v122, v133
    v_mul_f32 v123, v123, v133
    v_cvt_pk_bf16_f32 v77, v122, v123
    buffer_store_dwordx2 v[76:77], v7, s[36:39], 0 offen offset:0 sc1
    v_sub_f32 v124, v124, v132
    v_sub_f32 v125, v125, v132
    v_cvt_pk_bf16_f32 v158, v124, v125
    v_lshlrev_b32 v124, 16, v158
    v_and_b32 v125, 0xffff0000, v158
    v_mul_f32 v124, v124, v133
    v_mul_f32 v125, v125, v133
    v_cvt_pk_bf16_f32 v78, v124, v125
    v_sub_f32 v126, v126, v132
    v_sub_f32 v127, v127, v132
    v_cvt_pk_bf16_f32 v158, v126, v127
    v_lshlrev_b32 v126, 16, v158
    v_and_b32 v127, 0xffff0000, v158
    v_mul_f32 v126, v126, v133
    v_mul_f32 v127, v127, v133
    v_cvt_pk_bf16_f32 v79, v126, v127
    buffer_store_dwordx2 v[78:79], v7, s[36:39], 0 offen offset:2048 sc1
    v_sub_f32 v128, v128, v132
    v_sub_f32 v129, v129, v132
    v_cvt_pk_bf16_f32 v158, v128, v129
    v_lshlrev_b32 v128, 16, v158
    v_and_b32 v129, 0xffff0000, v158
    v_mul_f32 v128, v128, v133
    v_mul_f32 v129, v129, v133
    v_cvt_pk_bf16_f32 v80, v128, v129
    v_sub_f32 v130, v130, v132
    v_sub_f32 v131, v131, v132
    v_cvt_pk_bf16_f32 v158, v130, v131
    v_lshlrev_b32 v130, 16, v158
    v_and_b32 v131, 0xffff0000, v158
    v_mul_f32 v130, v130, v133
    v_mul_f32 v131, v131, v133
    v_cvt_pk_bf16_f32 v81, v130, v131
    buffer_store_dwordx2 v[80:81], v3, s[36:39], 0 offen offset:0 sc1
    v_lshlrev_b32 v96, 16, v64
    v_and_b32 v97, 0xffff0000, v64
    v_lshlrev_b32 v98, 16, v65
    v_and_b32 v99, 0xffff0000, v65
    v_lshlrev_b32 v100, 16, v66
    v_and_b32 v101, 0xffff0000, v66
    v_lshlrev_b32 v102, 16, v67
    v_and_b32 v103, 0xffff0000, v67
    v_lshlrev_b32 v104, 16, v68
    v_and_b32 v105, 0xffff0000, v68
    v_lshlrev_b32 v106, 16, v69
    v_and_b32 v107, 0xffff0000, v69
    v_lshlrev_b32 v108, 16, v70
    v_and_b32 v109, 0xffff0000, v70
    v_lshlrev_b32 v110, 16, v71
    v_and_b32 v111, 0xffff0000, v71
    v_lshlrev_b32 v112, 16, v72
    v_and_b32 v113, 0xffff0000, v72
    v_lshlrev_b32 v114, 16, v73
    v_and_b32 v115, 0xffff0000, v73
    v_lshlrev_b32 v116, 16, v74
    v_and_b32 v117, 0xffff0000, v74
    v_lshlrev_b32 v118, 16, v75
    v_and_b32 v119, 0xffff0000, v75
    v_lshlrev_b32 v120, 16, v76
    v_and_b32 v121, 0xffff0000, v76
    v_lshlrev_b32 v122, 16, v77
    v_and_b32 v123, 0xffff0000, v77
    v_lshlrev_b32 v124, 16, v78
    v_and_b32 v125, 0xffff0000, v78
    v_lshlrev_b32 v126, 16, v79
    v_and_b32 v127, 0xffff0000, v79
    v_lshlrev_b32 v128, 16, v80
    v_and_b32 v129, 0xffff0000, v80
    v_lshlrev_b32 v130, 16, v81
    v_and_b32 v131, 0xffff0000, v81
    v_add_f32 v132, v96, v97
    v_add_f32 v133, v98, v99
    v_add_f32 v132, v132, v100
    v_add_f32 v133, v133, v101
    v_add_f32 v132, v132, v102
    v_add_f32 v133, v133, v103
    v_add_f32 v132, v132, v104
    v_add_f32 v133, v133, v105
    v_add_f32 v132, v132, v106
    v_add_f32 v133, v133, v107
    v_add_f32 v132, v132, v108
    v_add_f32 v133, v133, v109
    v_add_f32 v132, v132, v110
    v_add_f32 v133, v133, v111
    v_add_f32 v132, v132, v112
    v_add_f32 v133, v133, v113
    v_add_f32 v132, v132, v114
    v_add_f32 v133, v133, v115
    v_add_f32 v132, v132, v116
    v_add_f32 v133, v133, v117
    v_add_f32 v132, v132, v118
    v_add_f32 v133, v133, v119
    v_add_f32 v132, v132, v120
    v_add_f32 v133, v133, v121
    v_add_f32 v132, v132, v122
    v_add_f32 v133, v133, v123
    v_add_f32 v132, v132, v124
    v_add_f32 v133, v133, v125
    v_add_f32 v132, v132, v126
    v_add_f32 v133, v133, v127
    v_add_f32 v132, v132, v128
    v_add_f32 v133, v133, v129
    v_add_f32 v132, v132, v130
    v_add_f32 v133, v133, v131
    v_add_f32 v132, v132, v133
    s_nop 1
    v_add_f32_dpp v132, v132, v132 quad_perm:[1,0,3,2] row_mask:0xf bank_mask:0xf
    s_nop 1
    v_add_f32_dpp v132, v132, v132 quad_perm:[2,3,0,1] row_mask:0xf bank_mask:0xf
    s_nop 1
    v_add_f32_dpp v132, v132, v132 row_half_mirror row_mask:0xf bank_mask:0xf
    s_nop 1
    v_add_f32_dpp v132, v132, v132 row_mirror row_mask:0xf bank_mask:0xf
    v_mul_f32 v132, 0x3ae38e39, v132
    v_mov_b32 v133, 0
    v_mov_b32 v134, 0
    v_sub_f32 v158, v96, v132
    v_sub_f32 v159, v97, v132
    v_fmac_f32 v133, v158, v158
    v_fmac_f32 v134, v159, v159
    v_sub_f32 v158, v98, v132
    v_sub_f32 v159, v99, v132
    v_fmac_f32 v133, v158, v158
    v_fmac_f32 v134, v159, v159
    v_sub_f32 v158, v100, v132
    v_sub_f32 v159, v101, v132
    v_fmac_f32 v133, v158, v158
    v_fmac_f32 v134, v159, v159
    v_sub_f32 v158, v102, v132
    v_sub_f32 v159, v103, v132
    v_fmac_f32 v133, v158, v158
    v_fmac_f32 v134, v159, v159
    v_sub_f32 v158, v104, v132
    v_sub_f32 v159, v105, v132
    v_fmac_f32 v133, v158, v158
    v_fmac_f32 v134, v159, v159
    v_sub_f32 v158, v106, v132
    v_sub_f32 v159, v107, v132
    v_fmac_f32 v133, v158, v158
    v_fmac_f32 v134, v159, v159
    v_sub_f32 v158, v108, v132
    v_sub_f32 v159, v109, v132
    v_fmac_f32 v133, v158, v158
    v_fmac_f32 v134, v159, v159
    v_sub_f32 v158, v110, v132
    v_sub_f32 v159, v111, v132
    v_fmac_f32 v133, v158, v158
    v_fmac_f32 v134, v159, v159
    v_sub_f32 v158, v112, v132
    v_sub_f32 v159, v113, v132
    v_fmac_f32 v133, v158, v158
    v_fmac_f32 v134, v159, v159
    v_sub_f32 v158, v114, v132
    v_sub_f32 v159, v115, v132
    v_fmac_f32 v133, v158, v158
    v_fmac_f32 v134, v159, v159
    v_sub_f32 v158, v116, v132
    v_sub_f32 v159, v117, v132
    v_fmac_f32 v133, v158, v158
    v_fmac_f32 v134, v159, v159
    v_sub_f32 v158, v118, v132
    v_sub_f32 v159, v119, v132
    v_fmac_f32 v133, v158, v158
    v_fmac_f32 v134, v159, v159
    v_sub_f32 v158, v120, v132
    v_sub_f32 v159, v121, v132
    v_fmac_f32 v133, v158, v158
    v_fmac_f32 v134, v159, v159
    v_sub_f32 v158, v122, v132
    v_sub_f32 v159, v123, v132
    v_fmac_f32 v133, v158, v158
    v_fmac_f32 v134, v159, v159
    v_sub_f32 v158, v124, v132
    v_sub_f32 v159, v125, v132
    v_fmac_f32 v133, v158, v158
    v_fmac_f32 v134, v159, v159
    v_sub_f32 v158, v126, v132
    v_sub_f32 v159, v127, v132
    v_fmac_f32 v133, v158, v158
    v_fmac_f32 v134, v159, v159
    v_sub_f32 v158, v128, v132
    v_sub_f32 v159, v129, v132
    v_fmac_f32 v133, v158, v158
    v_fmac_f32 v134, v159, v159
    v_sub_f32 v158, v130, v132
    v_sub_f32 v159, v131, v132
    v_fmac_f32 v133, v158, v158
    v_fmac_f32 v134, v159, v159
    v_add_f32 v133, v133, v134
    s_nop 1
    v_add_f32_dpp v133, v133, v133 quad_perm:[1,0,3,2] row_mask:0xf bank_mask:0xf
    s_nop 1
    v_add_f32_dpp v133, v133, v133 quad_perm:[2,3,0,1] row_mask:0xf bank_mask:0xf
    s_nop 1
    v_add_f32_dpp v133, v133, v133 row_half_mirror row_mask:0xf bank_mask:0xf
    s_nop 1
    v_add_f32_dpp v133, v133, v133 row_mirror row_mask:0xf bank_mask:0xf
    v_mul_f32 v133, 0x3ae38e39, v133
    v_cvt_pk_bf16_f32 v132, v132, v132
    v_lshlrev_b32 v132, 16, v132
    v_cvt_pk_bf16_f32 v133, v133, v133
    v_lshlrev_b32 v133, 16, v133
    v_add_f32 v133, 0x3727c5ac, v133
    v_cvt_pk_bf16_f32 v133, v133, v133
    v_lshlrev_b32 v133, 16, v133
    v_sqrt_f32 v133, v133
    s_nop 0
    v_cvt_pk_bf16_f32 v133, v133, v133
    v_lshlrev_b32 v133, 16, v133
    v_rcp_f32 v133, v133
    v_sub_f32 v96, v96, v132
    v_sub_f32 v97, v97, v132
    v_cvt_pk_bf16_f32 v158, v96, v97
    v_lshlrev_b32 v96, 16, v158
    v_and_b32 v97, 0xffff0000, v158
    v_mul_f32 v96, v96, v133
    v_mul_f32 v97, v97, v133
    v_cvt_pk_bf16_f32 v140, v96, v97
    v_sub_f32 v98, v98, v132
    v_sub_f32 v99, v99, v132
    v_cvt_pk_bf16_f32 v158, v98, v99
    v_lshlrev_b32 v98, 16, v158
    v_and_b32 v99, 0xffff0000, v158
    v_mul_f32 v98, v98, v133
    v_mul_f32 v99, v99, v133
    v_cvt_pk_bf16_f32 v141, v98, v99
    buffer_store_dwordx2 v[140:141], v4, s[36:39], s90 offen offset:0 sc1
    v_sub_f32 v100, v100, v132
    v_sub_f32 v101, v101, v132
    v_cvt_pk_bf16_f32 v158, v100, v101
    v_lshlrev_b32 v100, 16, v158
    v_and_b32 v101, 0xffff0000, v158
    v_mul_f32 v100, v100, v133
    v_mul_f32 v101, v101, v133
    v_cvt_pk_bf16_f32 v142, v100, v101
    v_sub_f32 v102, v102, v132
    v_sub_f32 v103, v103, v132
    v_cvt_pk_bf16_f32 v158, v102, v103
    v_lshlrev_b32 v102, 16, v158
    v_and_b32 v103, 0xffff0000, v158
    v_mul_f32 v102, v102, v133
    v_mul_f32 v103, v103, v133
    v_cvt_pk_bf16_f32 v143, v102, v103
    buffer_store_dwordx2 v[142:143], v4, s[36:39], s90 offen offset:2048 sc1
    v_sub_f32 v104, v104, v132
    v_sub_f32 v105, v105, v132
    v_cvt_pk_bf16_f32 v158, v104, v105
    v_lshlrev_b32 v104, 16, v158
    v_and_b32 v105, 0xffff0000, v158
    v_mul_f32 v104, v104, v133
    v_mul_f32 v105, v105, v133
    v_cvt_pk_bf16_f32 v144, v104, v105
    v_sub_f32 v106, v106, v132
    v_sub_f32 v107, v107, v132
    v_cvt_pk_bf16_f32 v158, v106, v107
    v_lshlrev_b32 v106, 16, v158
    v_and_b32 v107, 0xffff0000, v158
    v_mul_f32 v106, v106, v133
    v_mul_f32 v107, v107, v133
    v_cvt_pk_bf16_f32 v145, v106, v107
    buffer_store_dwordx2 v[144:145], v5, s[36:39], s90 offen offset:0 sc1
    v_sub_f32 v108, v108, v132
    v_sub_f32 v109, v109, v132
    v_cvt_pk_bf16_f32 v158, v108, v109
    v_lshlrev_b32 v108, 16, v158
    v_and_b32 v109, 0xffff0000, v158
    v_mul_f32 v108, v108, v133
    v_mul_f32 v109, v109, v133
    v_cvt_pk_bf16_f32 v146, v108, v109
    v_sub_f32 v110, v110, v132
    v_sub_f32 v111, v111, v132
    v_cvt_pk_bf16_f32 v158, v110, v111
    v_lshlrev_b32 v110, 16, v158
    v_and_b32 v111, 0xffff0000, v158
    v_mul_f32 v110, v110, v133
    v_mul_f32 v111, v111, v133
    v_cvt_pk_bf16_f32 v147, v110, v111
    buffer_store_dwordx2 v[146:147], v5, s[36:39], s90 offen offset:2048 sc1
    v_sub_f32 v112, v112, v132
    v_sub_f32 v113, v113, v132
    v_cvt_pk_bf16_f32 v158, v112, v113
    v_lshlrev_b32 v112, 16, v158
    v_and_b32 v113, 0xffff0000, v158
    v_mul_f32 v112, v112, v133
    v_mul_f32 v113, v113, v133
    v_cvt_pk_bf16_f32 v148, v112, v113
    v_sub_f32 v114, v114, v132
    v_sub_f32 v115, v115, v132
    v_cvt_pk_bf16_f32 v158, v114, v115
    v_lshlrev_b32 v114, 16, v158
    v_and_b32 v115, 0xffff0000, v158
    v_mul_f32 v114, v114, v133
    v_mul_f32 v115, v115, v133
    v_cvt_pk_bf16_f32 v149, v114, v115
    buffer_store_dwordx2 v[148:149], v6, s[36:39], s90 offen offset:0 sc1
    v_sub_f32 v116, v116, v132
    v_sub_f32 v117, v117, v132
    v_cvt_pk_bf16_f32 v158, v116, v117
    v_lshlrev_b32 v116, 16, v158
    v_and_b32 v117, 0xffff0000, v158
    v_mul_f32 v116, v116, v133
    v_mul_f32 v117, v117, v133
    v_cvt_pk_bf16_f32 v150, v116, v117
    v_sub_f32 v118, v118, v132
    v_sub_f32 v119, v119, v132
    v_cvt_pk_bf16_f32 v158, v118, v119
    v_lshlrev_b32 v118, 16, v158
    v_and_b32 v119, 0xffff0000, v158
    v_mul_f32 v118, v118, v133
    v_mul_f32 v119, v119, v133
    v_cvt_pk_bf16_f32 v151, v118, v119
    buffer_store_dwordx2 v[150:151], v6, s[36:39], s90 offen offset:2048 sc1
    v_sub_f32 v120, v120, v132
    v_sub_f32 v121, v121, v132
    v_cvt_pk_bf16_f32 v158, v120, v121
    v_lshlrev_b32 v120, 16, v158
    v_and_b32 v121, 0xffff0000, v158
    v_mul_f32 v120, v120, v133
    v_mul_f32 v121, v121, v133
    v_cvt_pk_bf16_f32 v152, v120, v121
    v_sub_f32 v122, v122, v132
    v_sub_f32 v123, v123, v132
    v_cvt_pk_bf16_f32 v158, v122, v123
    v_lshlrev_b32 v122, 16, v158
    v_and_b32 v123, 0xffff0000, v158
    v_mul_f32 v122, v122, v133
    v_mul_f32 v123, v123, v133
    v_cvt_pk_bf16_f32 v153, v122, v123
    buffer_store_dwordx2 v[152:153], v7, s[36:39], s90 offen offset:0 sc1
    v_sub_f32 v124, v124, v132
    v_sub_f32 v125, v125, v132
    v_cvt_pk_bf16_f32 v158, v124, v125
    v_lshlrev_b32 v124, 16, v158
    v_and_b32 v125, 0xffff0000, v158
    v_mul_f32 v124, v124, v133
    v_mul_f32 v125, v125, v133
    v_cvt_pk_bf16_f32 v154, v124, v125
    v_sub_f32 v126, v126, v132
    v_sub_f32 v127, v127, v132
    v_cvt_pk_bf16_f32 v158, v126, v127
    v_lshlrev_b32 v126, 16, v158
    v_and_b32 v127, 0xffff0000, v158
    v_mul_f32 v126, v126, v133
    v_mul_f32 v127, v127, v133
    v_cvt_pk_bf16_f32 v155, v126, v127
    buffer_store_dwordx2 v[154:155], v7, s[36:39], s90 offen offset:2048 sc1
    v_sub_f32 v128, v128, v132
    v_sub_f32 v129, v129, v132
    v_cvt_pk_bf16_f32 v158, v128, v129
    v_lshlrev_b32 v128, 16, v158
    v_and_b32 v129, 0xffff0000, v158
    v_mul_f32 v128, v128, v133
    v_mul_f32 v129, v129, v133
    v_cvt_pk_bf16_f32 v156, v128, v129
    v_sub_f32 v130, v130, v132
    v_sub_f32 v131, v131, v132
    v_cvt_pk_bf16_f32 v158, v130, v131
    v_lshlrev_b32 v130, 16, v158
    v_and_b32 v131, 0xffff0000, v158
    v_mul_f32 v130, v130, v133
    v_mul_f32 v131, v131, v133
    v_cvt_pk_bf16_f32 v157, v130, v131
    buffer_store_dwordx2 v[156:157], v3, s[36:39], s90 offen offset:0 sc1
    s_waitcnt vmcnt(18)
    s_branch L_lnskip_4
L_tag_6:
    buffer_load_dwordx2 v[136:137], v138, s[40:43], 0 offen sc1
    s_waitcnt vmcnt(0)
L_lnskip_4:
    v_readfirstlane_b32 s62, v136
    v_readfirstlane_b32 s63, v137
    s_sub_u32 s3, s3, 1
    s_cbranch_scc1 L_tagok_7
    s_cmp_eq_u32 s62, 0
    s_cbranch_scc1 L_tag_6
L_tagok_7:
    s_waitcnt vmcnt(0) lgkmcnt(0)
    s_barrier
    s_cmp_lg_u32 s4, 0
    s_cbranch_scc1 L_fs_8
    s_lshl_b32 s3, s2, 7
    s_mov_b64 exec, 1
    v_mov_b32 v2, s62
    v_mov_b32 v3, s63
    v_mov_b32 v1, 163840
    buffer_store_dwordx2 v[2:3], v1, s[44:47], s3 offen sc1
    s_mov_b64 exec, -1
L_fs_8:
    s_cmp_lt_u32 s2, 192
    s_cbranch_scc1 L_csskip_5
    s_mov_b32 s40, s80
    s_mov_b32 s41, s81
    s_mov_b32 s42, 0x510000
    s_mov_b32 s43, 0x20000
    s_add_u32 s36, s88, 0x980000
    s_addc_u32 s37, s89, 0
    s_mov_b32 s38, 0x24000
    s_mov_b32 s39, 0x20000
    s_sub_u32 s3, s2, 192
    s_mul_i32 s90, s3, 144
    v_mul_u32_u24 v4, 7282, v0
    v_lshrrev_b32 v4, 16, v4
    v_mul_u32_u24 v5, 9, v4
    v_sub_u32 v5, v0, v5
    v_min_u32 v6, 23, v4
    v_mul_u32_u24 v3, 9216, v6
    v_lshl_add_u32 v3, v5, 4, v3
    s_mov_b32 s91, s90
    buffer_load_dwordx4 v[64:67], v3, s[40:43], s91 offen
    s_add_u32 s91, s91, 221184
    buffer_load_dwordx4 v[68:71], v3, s[40:43], s91 offen
    s_add_u32 s91, s91, 221184
    buffer_load_dwordx4 v[72:75], v3, s[40:43], s91 offen
    s_add_u32 s91, s91, 221184
    buffer_load_dwordx4 v[76:79], v3, s[40:43], s91 offen
    s_add_u32 s91, s91, 221184
    buffer_load_dwordx4 v[80:83], v3, s[40:43], s91 offen
    s_add_u32 s91, s91, 221184
    buffer_load_dwordx4 v[84:87], v3, s[40:43], s91 offen
    s_add_u32 s91, s91, 221184
    buffer_load_dwordx4 v[88:91], v3, s[40:43], s91 offen
    s_add_u32 s91, s91, 221184
    buffer_load_dwordx4 v[92:95], v3, s[40:43], s91 offen
    s_add_u32 s91, s91, 221184
    buffer_load_dwordx4 v[96:99], v3, s[40:43], s91 offen
    s_add_u32 s91, s91, 221184
    buffer_load_dwordx4 v[100:103], v3, s[40:43], s91 offen
    s_add_u32 s91, s91, 221184
    buffer_load_dwordx4 v[104:107], v3, s[40:43], s91 offen
    s_add_u32 s91, s91, 221184
    buffer_load_dwordx4 v[108:111], v3, s[40:43], s91 offen
    s_add_u32 s91, s91, 221184
    buffer_load_dwordx4 v[112:115], v3, s[40:43], s91 offen
    s_add_u32 s91, s91, 221184
    buffer_load_dwordx4 v[116:119], v3, s[40:43], s91 offen
    s_add_u32 s91, s91, 221184
    buffer_load_dwordx4 v[120:123], v3, s[40:43], s91 offen
    s_add_u32 s91, s91, 221184
    buffer_load_dwordx4 v[124:127], v3, s[40:43], s91 offen
    s_add_u32 s91, s91, 221184
    buffer_load_dwordx4 v[128:131], v3, s[40:43], s91 offen
    s_add_u32 s91, s91, 221184
    buffer_load_dwordx4 v[132:135], v3, s[40:43], s91 offen
    s_add_u32 s91, s91, 221184
    buffer_load_dwordx4 v[136:139], v3, s[40:43], s91 offen
    s_add_u32 s91, s91, 221184
    buffer_load_dwordx4 v[140:143], v3, s[40:43], s91 offen
    s_add_u32 s91, s91, 221184
    buffer_load_dwordx4 v[144:147], v3, s[40:43], s91 offen
    s_add_u32 s91, s91, 221184
    buffer_load_dwordx4 v[148:151], v3, s[40:43], s91 offen
    s_add_u32 s91, s91, 221184
    buffer_load_dwordx4 v[152:155], v3, s[40:43], s91 offen
    s_add_u32 s91, s91, 221184
    buffer_load_dwordx4 v[156:159], v3, s[40:43], s91 offen
    s_add_u32 s91, s91, 221184
    v_mov_b32 v160, 0
    v_mov_b32 v161, 0
    v_mov_b32 v162, 0
    v_mov_b32 v163, 0
    v_mov_b32 v164, 0
    v_mov_b32 v165, 0
    v_mov_b32 v166, 0
    v_mov_b32 v167, 0
    s_waitcnt vmcnt(23)
    v_lshlrev_b32 v168, 16, v64
    v_and_b32 v169, 0xffff0000, v64
    v_add_f32 v160, v160, v168
    v_add_f32 v161, v161, v169
    v_lshlrev_b32 v168, 16, v65
    v_and_b32 v169, 0xffff0000, v65
    v_add_f32 v162, v162, v168
    v_add_f32 v163, v163, v169
    v_lshlrev_b32 v168, 16, v66
    v_and_b32 v169, 0xffff0000, v66
    v_add_f32 v164, v164, v168
    v_add_f32 v165, v165, v169
    v_lshlrev_b32 v168, 16, v67
    v_and_b32 v169, 0xffff0000, v67
    v_add_f32 v166, v166, v168
    v_add_f32 v167, v167, v169
    s_waitcnt vmcnt(22)
    v_lshlrev_b32 v168, 16, v68
    v_and_b32 v169, 0xffff0000, v68
    v_add_f32 v160, v160, v168
    v_add_f32 v161, v161, v169
    v_lshlrev_b32 v168, 16, v69
    v_and_b32 v169, 0xffff0000, v69
    v_add_f32 v162, v162, v168
    v_add_f32 v163, v163, v169
    v_lshlrev_b32 v168, 16, v70
    v_and_b32 v169, 0xffff0000, v70
    v_add_f32 v164, v164, v168
    v_add_f32 v165, v165, v169
    v_lshlrev_b32 v168, 16, v71
    v_and_b32 v169, 0xffff0000, v71
    v_add_f32 v166, v166, v168
    v_add_f32 v167, v167, v169
    s_waitcnt vmcnt(21)
    v_lshlrev_b32 v168, 16, v72
    v_and_b32 v169, 0xffff0000, v72
    v_add_f32 v160, v160, v168
    v_add_f32 v161, v161, v169
    v_lshlrev_b32 v168, 16, v73
    v_and_b32 v169, 0xffff0000, v73
    v_add_f32 v162, v162, v168
    v_add_f32 v163, v163, v169
    v_lshlrev_b32 v168, 16, v74
    v_and_b32 v169, 0xffff0000, v74
    v_add_f32 v164, v164, v168
    v_add_f32 v165, v165, v169
    v_lshlrev_b32 v168, 16, v75
    v_and_b32 v169, 0xffff0000, v75
    v_add_f32 v166, v166, v168
    v_add_f32 v167, v167, v169
    s_waitcnt vmcnt(20)
    v_lshlrev_b32 v168, 16, v76
    v_and_b32 v169, 0xffff0000, v76
    v_add_f32 v160, v160, v168
    v_add_f32 v161, v161, v169
    v_lshlrev_b32 v168, 16, v77
    v_and_b32 v169, 0xffff0000, v77
    v_add_f32 v162, v162, v168
    v_add_f32 v163, v163, v169
    v_lshlrev_b32 v168, 16, v78
    v_and_b32 v169, 0xffff0000, v78
    v_add_f32 v164, v164, v168
    v_add_f32 v165, v165, v169
    v_lshlrev_b32 v168, 16, v79
    v_and_b32 v169, 0xffff0000, v79
    v_add_f32 v166, v166, v168
    v_add_f32 v167, v167, v169
    s_waitcnt vmcnt(19)
    v_lshlrev_b32 v168, 16, v80
    v_and_b32 v169, 0xffff0000, v80
    v_add_f32 v160, v160, v168
    v_add_f32 v161, v161, v169
    v_lshlrev_b32 v168, 16, v81
    v_and_b32 v169, 0xffff0000, v81
    v_add_f32 v162, v162, v168
    v_add_f32 v163, v163, v169
    v_lshlrev_b32 v168, 16, v82
    v_and_b32 v169, 0xffff0000, v82
    v_add_f32 v164, v164, v168
    v_add_f32 v165, v165, v169
    v_lshlrev_b32 v168, 16, v83
    v_and_b32 v169, 0xffff0000, v83
    v_add_f32 v166, v166, v168
    v_add_f32 v167, v167, v169
    s_waitcnt vmcnt(18)
    v_lshlrev_b32 v168, 16, v84
    v_and_b32 v169, 0xffff0000, v84
    v_add_f32 v160, v160, v168
    v_add_f32 v161, v161, v169
    v_lshlrev_b32 v168, 16, v85
    v_and_b32 v169, 0xffff0000, v85
    v_add_f32 v162, v162, v168
    v_add_f32 v163, v163, v169
    v_lshlrev_b32 v168, 16, v86
    v_and_b32 v169, 0xffff0000, v86
    v_add_f32 v164, v164, v168
    v_add_f32 v165, v165, v169
    v_lshlrev_b32 v168, 16, v87
    v_and_b32 v169, 0xffff0000, v87
    v_add_f32 v166, v166, v168
    v_add_f32 v167, v167, v169
    s_waitcnt vmcnt(17)
    v_lshlrev_b32 v168, 16, v88
    v_and_b32 v169, 0xffff0000, v88
    v_add_f32 v160, v160, v168
    v_add_f32 v161, v161, v169
    v_lshlrev_b32 v168, 16, v89
    v_and_b32 v169, 0xffff0000, v89
    v_add_f32 v162, v162, v168
    v_add_f32 v163, v163, v169
    v_lshlrev_b32 v168, 16, v90
    v_and_b32 v169, 0xffff0000, v90
    v_add_f32 v164, v164, v168
    v_add_f32 v165, v165, v169
    v_lshlrev_b32 v168, 16, v91
    v_and_b32 v169, 0xffff0000, v91
    v_add_f32 v166, v166, v168
    v_add_f32 v167, v167, v169
    s_waitcnt vmcnt(16)
    v_lshlrev_b32 v168, 16, v92
    v_and_b32 v169, 0xffff0000, v92
    v_add_f32 v160, v160, v168
    v_add_f32 v161, v161, v169
    v_lshlrev_b32 v168, 16, v93
    v_and_b32 v169, 0xffff0000, v93
    v_add_f32 v162, v162, v168
    v_add_f32 v163, v163, v169
    v_lshlrev_b32 v168, 16, v94
    v_and_b32 v169, 0xffff0000, v94
    v_add_f32 v164, v164, v168
    v_add_f32 v165, v165, v169
    v_lshlrev_b32 v168, 16, v95
    v_and_b32 v169, 0xffff0000, v95
    v_add_f32 v166, v166, v168
    v_add_f32 v167, v167, v169
    s_waitcnt vmcnt(15)
    v_lshlrev_b32 v168, 16, v96
    v_and_b32 v169, 0xffff0000, v96
    v_add_f32 v160, v160, v168
    v_add_f32 v161, v161, v169
    v_lshlrev_b32 v168, 16, v97
    v_and_b32 v169, 0xffff0000, v97
    v_add_f32 v162, v162, v168
    v_add_f32 v163, v163, v169
    v_lshlrev_b32 v168, 16, v98
    v_and_b32 v169, 0xffff0000, v98
    v_add_f32 v164, v164, v168
    v_add_f32 v165, v165, v169
    v_lshlrev_b32 v168, 16, v99
    v_and_b32 v169, 0xffff0000, v99
    v_add_f32 v166, v166, v168
    v_add_f32 v167, v167, v169
    s_waitcnt vmcnt(14)
    v_lshlrev_b32 v168, 16, v100
    v_and_b32 v169, 0xffff0000, v100
    v_add_f32 v160, v160, v168
    v_add_f32 v161, v161, v169
    v_lshlrev_b32 v168, 16, v101
    v_and_b32 v169, 0xffff0000, v101
    v_add_f32 v162, v162, v168
    v_add_f32 v163, v163, v169
    v_lshlrev_b32 v168, 16, v102
    v_and_b32 v169, 0xffff0000, v102
    v_add_f32 v164, v164, v168
    v_add_f32 v165, v165, v169
    v_lshlrev_b32 v168, 16, v103
    v_and_b32 v169, 0xffff0000, v103
    v_add_f32 v166, v166, v168
    v_add_f32 v167, v167, v169
    s_waitcnt vmcnt(13)
    v_lshlrev_b32 v168, 16, v104
    v_and_b32 v169, 0xffff0000, v104
    v_add_f32 v160, v160, v168
    v_add_f32 v161, v161, v169
    v_lshlrev_b32 v168, 16, v105
    v_and_b32 v169, 0xffff0000, v105
    v_add_f32 v162, v162, v168
    v_add_f32 v163, v163, v169
    v_lshlrev_b32 v168, 16, v106
    v_and_b32 v169, 0xffff0000, v106
    v_add_f32 v164, v164, v168
    v_add_f32 v165, v165, v169
    v_lshlrev_b32 v168, 16, v107
    v_and_b32 v169, 0xffff0000, v107
    v_add_f32 v166, v166, v168
    v_add_f32 v167, v167, v169
    s_waitcnt vmcnt(12)
    v_lshlrev_b32 v168, 16, v108
    v_and_b32 v169, 0xffff0000, v108
    v_add_f32 v160, v160, v168
    v_add_f32 v161, v161, v169
    v_lshlrev_b32 v168, 16, v109
    v_and_b32 v169, 0xffff0000, v109
    v_add_f32 v162, v162, v168
    v_add_f32 v163, v163, v169
    v_lshlrev_b32 v168, 16, v110
    v_and_b32 v169, 0xffff0000, v110
    v_add_f32 v164, v164, v168
    v_add_f32 v165, v165, v169
    v_lshlrev_b32 v168, 16, v111
    v_and_b32 v169, 0xffff0000, v111
    v_add_f32 v166, v166, v168
    v_add_f32 v167, v167, v169
    s_waitcnt vmcnt(11)
    v_lshlrev_b32 v168, 16, v112
    v_and_b32 v169, 0xffff0000, v112
    v_add_f32 v160, v160, v168
    v_add_f32 v161, v161, v169
    v_lshlrev_b32 v168, 16, v113
    v_and_b32 v169, 0xffff0000, v113
    v_add_f32 v162, v162, v168
    v_add_f32 v163, v163, v169
    v_lshlrev_b32 v168, 16, v114
    v_and_b32 v169, 0xffff0000, v114
    v_add_f32 v164, v164, v168
    v_add_f32 v165, v165, v169
    v_lshlrev_b32 v168, 16, v115
    v_and_b32 v169, 0xffff0000, v115
    v_add_f32 v166, v166, v168
    v_add_f32 v167, v167, v169
    s_waitcnt vmcnt(10)
    v_lshlrev_b32 v168, 16, v116
    v_and_b32 v169, 0xffff0000, v116
    v_add_f32 v160, v160, v168
    v_add_f32 v161, v161, v169
    v_lshlrev_b32 v168, 16, v117
    v_and_b32 v169, 0xffff0000, v117
    v_add_f32 v162, v162, v168
    v_add_f32 v163, v163, v169
    v_lshlrev_b32 v168, 16, v118
    v_and_b32 v169, 0xffff0000, v118
    v_add_f32 v164, v164, v168
    v_add_f32 v165, v165, v169
    v_lshlrev_b32 v168, 16, v119
    v_and_b32 v169, 0xffff0000, v119
    v_add_f32 v166, v166, v168
    v_add_f32 v167, v167, v169
    s_waitcnt vmcnt(9)
    v_lshlrev_b32 v168, 16, v120
    v_and_b32 v169, 0xffff0000, v120
    v_add_f32 v160, v160, v168
    v_add_f32 v161, v161, v169
    v_lshlrev_b32 v168, 16, v121
    v_and_b32 v169, 0xffff0000, v121
    v_add_f32 v162, v162, v168
    v_add_f32 v163, v163, v169
    v_lshlrev_b32 v168, 16, v122
    v_and_b32 v169, 0xffff0000, v122
    v_add_f32 v164, v164, v168
    v_add_f32 v165, v165, v169
    v_lshlrev_b32 v168, 16, v123
    v_and_b32 v169, 0xffff0000, v123
    v_add_f32 v166, v166, v168
    v_add_f32 v167, v167, v169
    s_waitcnt vmcnt(8)
    v_lshlrev_b32 v168, 16, v124
    v_and_b32 v169, 0xffff0000, v124
    v_add_f32 v160, v160, v168
    v_add_f32 v161, v161, v169
    v_lshlrev_b32 v168, 16, v125
    v_and_b32 v169, 0xffff0000, v125
    v_add_f32 v162, v162, v168
    v_add_f32 v163, v163, v169
    v_lshlrev_b32 v168, 16, v126
    v_and_b32 v169, 0xffff0000, v126
    v_add_f32 v164, v164, v168
    v_add_f32 v165, v165, v169
    v_lshlrev_b32 v168, 16, v127
    v_and_b32 v169, 0xffff0000, v127
    v_add_f32 v166, v166, v168
    v_add_f32 v167, v167, v169
    s_waitcnt vmcnt(7)
    v_lshlrev_b32 v168, 16, v128
    v_and_b32 v169, 0xffff0000, v128
    v_add_f32 v160, v160, v168
    v_add_f32 v161, v161, v169
    v_lshlrev_b32 v168, 16, v129
    v_and_b32 v169, 0xffff0000, v129
    v_add_f32 v162, v162, v168
    v_add_f32 v163, v163, v169
    v_lshlrev_b32 v168, 16, v130
    v_and_b32 v169, 0xffff0000, v130
    v_add_f32 v164, v164, v168
    v_add_f32 v165, v165, v169
    v_lshlrev_b32 v168, 16, v131
    v_and_b32 v169, 0xffff0000, v131
    v_add_f32 v166, v166, v168
    v_add_f32 v167, v167, v169
    s_waitcnt vmcnt(6)
    v_lshlrev_b32 v168, 16, v132
    v_and_b32 v169, 0xffff0000, v132
    v_add_f32 v160, v160, v168
    v_add_f32 v161, v161, v169
    v_lshlrev_b32 v168, 16, v133
    v_and_b32 v169, 0xffff0000, v133
    v_add_f32 v162, v162, v168
    v_add_f32 v163, v163, v169
    v_lshlrev_b32 v168, 16, v134
    v_and_b32 v169, 0xffff0000, v134
    v_add_f32 v164, v164, v168
    v_add_f32 v165, v165, v169
    v_lshlrev_b32 v168, 16, v135
    v_and_b32 v169, 0xffff0000, v135
    v_add_f32 v166, v166, v168
    v_add_f32 v167, v167, v169
    s_waitcnt vmcnt(5)
    v_lshlrev_b32 v168, 16, v136
    v_and_b32 v169, 0xffff0000, v136
    v_add_f32 v160, v160, v168
    v_add_f32 v161, v161, v169
    v_lshlrev_b32 v168, 16, v137
    v_and_b32 v169, 0xffff0000, v137
    v_add_f32 v162, v162, v168
    v_add_f32 v163, v163, v169
    v_lshlrev_b32 v168, 16, v138
    v_and_b32 v169, 0xffff0000, v138
    v_add_f32 v164, v164, v168
    v_add_f32 v165, v165, v169
    v_lshlrev_b32 v168, 16, v139
    v_and_b32 v169, 0xffff0000, v139
    v_add_f32 v166, v166, v168
    v_add_f32 v167, v167, v169
    s_waitcnt vmcnt(4)
    v_lshlrev_b32 v168, 16, v140
    v_and_b32 v169, 0xffff0000, v140
    v_add_f32 v160, v160, v168
    v_add_f32 v161, v161, v169
    v_lshlrev_b32 v168, 16, v141
    v_and_b32 v169, 0xffff0000, v141
    v_add_f32 v162, v162, v168
    v_add_f32 v163, v163, v169
    v_lshlrev_b32 v168, 16, v142
    v_and_b32 v169, 0xffff0000, v142
    v_add_f32 v164, v164, v168
    v_add_f32 v165, v165, v169
    v_lshlrev_b32 v168, 16, v143
    v_and_b32 v169, 0xffff0000, v143
    v_add_f32 v166, v166, v168
    v_add_f32 v167, v167, v169
    s_waitcnt vmcnt(3)
    v_lshlrev_b32 v168, 16, v144
    v_and_b32 v169, 0xffff0000, v144
    v_add_f32 v160, v160, v168
    v_add_f32 v161, v161, v169
    v_lshlrev_b32 v168, 16, v145
    v_and_b32 v169, 0xffff0000, v145
    v_add_f32 v162, v162, v168
    v_add_f32 v163, v163, v169
    v_lshlrev_b32 v168, 16, v146
    v_and_b32 v169, 0xffff0000, v146
    v_add_f32 v164, v164, v168
    v_add_f32 v165, v165, v169
    v_lshlrev_b32 v168, 16, v147
    v_and_b32 v169, 0xffff0000, v147
    v_add_f32 v166, v166, v168
    v_add_f32 v167, v167, v169
    s_waitcnt vmcnt(2)
    v_lshlrev_b32 v168, 16, v148
    v_and_b32 v169, 0xffff0000, v148
    v_add_f32 v160, v160, v168
    v_add_f32 v161, v161, v169
    v_lshlrev_b32 v168, 16, v149
    v_and_b32 v169, 0xffff0000, v149
    v_add_f32 v162, v162, v168
    v_add_f32 v163, v163, v169
    v_lshlrev_b32 v168, 16, v150
    v_and_b32 v169, 0xffff0000, v150
    v_add_f32 v164, v164, v168
    v_add_f32 v165, v165, v169
    v_lshlrev_b32 v168, 16, v151
    v_and_b32 v169, 0xffff0000, v151
    v_add_f32 v166, v166, v168
    v_add_f32 v167, v167, v169
    s_waitcnt vmcnt(1)
    v_lshlrev_b32 v168, 16, v152
    v_and_b32 v169, 0xffff0000, v152
    v_add_f32 v160, v160, v168
    v_add_f32 v161, v161, v169
    v_lshlrev_b32 v168, 16, v153
    v_and_b32 v169, 0xffff0000, v153
    v_add_f32 v162, v162, v168
    v_add_f32 v163, v163, v169
    v_lshlrev_b32 v168, 16, v154
    v_and_b32 v169, 0xffff0000, v154
    v_add_f32 v164, v164, v168
    v_add_f32 v165, v165, v169
    v_lshlrev_b32 v168, 16, v155
    v_and_b32 v169, 0xffff0000, v155
    v_add_f32 v166, v166, v168
    v_add_f32 v167, v167, v169
    s_waitcnt vmcnt(0)
    v_lshlrev_b32 v168, 16, v156
    v_and_b32 v169, 0xffff0000, v156
    v_add_f32 v160, v160, v168
    v_add_f32 v161, v161, v169
    v_lshlrev_b32 v168, 16, v157
    v_and_b32 v169, 0xffff0000, v157
    v_add_f32 v162, v162, v168
    v_add_f32 v163, v163, v169
    v_lshlrev_b32 v168, 16, v158
    v_and_b32 v169, 0xffff0000, v158
    v_add_f32 v164, v164, v168
    v_add_f32 v165, v165, v169
    v_lshlrev_b32 v168, 16, v159
    v_and_b32 v169, 0xffff0000, v159
    v_add_f32 v166, v166, v168
    v_add_f32 v167, v167, v169
    v_lshlrev_b32 v7, 5, v0
    ds_write_b128 v7, v[160:163] offset:57344
    ds_write_b128 v7, v[164:167] offset:57360
    v_add_u32 v6, 2, v4
    v_mul_u32_u24 v6, 9216, v6
    v_lshl_add_u32 v6, v5, 4, v6
    v_mov_b32 v168, 0
    v_mov_b32 v169, 0
    v_mov_b32 v170, 0
    v_mov_b32 v171, 0
    buffer_store_dwordx4 v[168:171], v6, s[36:39], s90 offen sc1
    s_waitcnt lgkmcnt(0)
    s_barrier
    v_min_u32 v6, 71, v0
    v_lshlrev_b32 v7, 2, v6
    ds_read_b32 v64, v7 offset:57344
    ds_read_b32 v65, v7 offset:57632
    ds_read_b32 v66, v7 offset:57920
    ds_read_b32 v67, v7 offset:58208
    ds_read_b32 v68, v7 offset:58496
    ds_read_b32 v69, v7 offset:58784
    ds_read_b32 v70, v7 offset:59072
    ds_read_b32 v71, v7 offset:59360
    ds_read_b32 v72, v7 offset:59648
    ds_read_b32 v73, v7 offset:59936
    ds_read_b32 v74, v7 offset:60224
    ds_read_b32 v75, v7 offset:60512
    ds_read_b32 v76, v7 offset:60800
    ds_read_b32 v77, v7 offset:61088
    ds_read_b32 v78, v7 offset:61376
    ds_read_b32 v79, v7 offset:61664
    ds_read_b32 v80, v7 offset:61952
    ds_read_b32 v81, v7 offset:62240
    ds_read_b32 v82, v7 offset:62528
    ds_read_b32 v83, v7 offset:62816
    ds_read_b32 v84, v7 offset:63104
    ds_read_b32 v85, v7 offset:63392
    ds_read_b32 v86, v7 offset:63680
    ds_read_b32 v87, v7 offset:63968
    s_waitcnt lgkmcnt(0)
    v_add_f32 v64, v64, v80
    v_add_f32 v65, v65, v81
    v_add_f32 v66, v66, v82
    v_add_f32 v67, v67, v83
    v_add_f32 v68, v68, v84
    v_add_f32 v69, v69, v85
    v_add_f32 v70, v70, v86
    v_add_f32 v71, v71, v87
    v_add_f32 v64, v64, v72
    v_add_f32 v65, v65, v73
    v_add_f32 v66, v66, v74
    v_add_f32 v67, v67, v75
    v_add_f32 v68, v68, v76
    v_add_f32 v69, v69, v77
    v_add_f32 v70, v70, v78
    v_add_f32 v71, v71, v79
    v_add_f32 v64, v64, v68
    v_add_f32 v65, v65, v69
    v_add_f32 v66, v66, v70
    v_add_f32 v67, v67, v71
    v_add_f32 v64, v64, v66
    v_add_f32 v65, v65, v67
    v_add_f32 v64, v64, v65
    v_cvt_pk_bf16_f32 v65, v64, v64
    v_lshlrev_b32 v66, 16, v65
    v_sub_f32 v66, v64, v66
    v_cvt_pk_bf16_f32 v66, v66, v66
    v_lshlrev_b32 v6, 1, v6
    s_add_u32 s91, s90, 9216
    buffer_store_short v65, v6, s[36:39], s90 offen sc1
    buffer_store_short v66, v6, s[36:39], s91 offen sc1
    s_waitcnt vmcnt(0) lgkmcnt(0)
    s_barrier
    s_cmp_lg_u32 s4, 0
    s_cbranch_scc1 L_fs_9
    s_lshl_b32 s3, s2, 7
    s_mov_b64 exec, 1
    v_mov_b32 v2, s62
    v_mov_b32 v3, s63
    v_mov_b32 v1, 196608
    buffer_store_dwordx2 v[2:3], v1, s[44:47], s3 offen sc1
    s_mov_b64 exec, -1
L_fs_9:
L_csskip_5:
    s_cmp_lt_u32 s2, 192
    s_cselect_b32 s92, 0x240000, 0
    s_cselect_b32 s91, 196608, 0
    s_add_u32 s40, s88, 0x6c0000
    s_addc_u32 s41, s89, 0
    s_mov_b32 s42, s92
    s_mov_b32 s43, 0x20000
    s_add_u32 s36, s88, 0x900000
    s_addc_u32 s37, s89, 0
    s_mov_b32 s38, s91
    s_mov_b32 s39, 0x20000
    v_lshlrev_b32 v61, 7, v61
    s_mov_b32 s3, 0x40000
    s_mov_b32 s5, 163840
L_fw_10:
    buffer_load_dwordx2 v[24:25], v61, s[44:47], s5 offen sc1
    s_sub_u32 s3, s3, 1
    s_cbranch_scc1 L_fd_11
    s_waitcnt vmcnt(0)
    v_cmp_eq_u64 vcc, s[62:63], v[24:25]
    s_nop 1
    s_cmp_eq_u64 vcc, exec
    s_cbranch_scc0 L_fw_10
L_fd_11:
    s_waitcnt vmcnt(0)
    s_mov_b32 s31, 0
    buffer_load_dwordx4 a[0:3], v11, s[16:19], s31 offen offset:0 sc1
    buffer_load_dwordx4 a[4:7], v12, s[16:19], s31 offen offset:0 sc1
    s_mov_b32 s31, 0
    buffer_load_dwordx4 a[8:11], v11, s[16:19], s31 offen offset:1024 sc1
    buffer_load_dwordx4 a[12:15], v12, s[16:19], s31 offen offset:1024 sc1
    s_mov_b32 s31, 0
    buffer_load_dwordx4 a[16:19], v11, s[16:19], s31 offen offset:2048 sc1
    buffer_load_dwordx4 a[20:23], v12, s[16:19], s31 offen offset:2048 sc1
    s_mov_b32 s31, 0
    buffer_load_dwordx4 a[24:27], v11, s[16:19], s31 offen offset:3072 sc1
    buffer_load_dwordx4 a[28:31], v12, s[16:19], s31 offen offset:3072 sc1
    s_mov_b32 s31, 4096
    buffer_load_dwordx4 a[32:35], v11, s[16:19], s31 offen offset:0 sc1
    buffer_load_dwordx4 a[36:39], v12, s[16:19], s31 offen offset:0 sc1
    s_mov_b32 s31, 4096
    buffer_load_dwordx4 a[40:43], v11, s[16:19], s31 offen offset:1024 sc1
    buffer_load_dwordx4 a[44:47], v12, s[16:19], s31 offen offset:1024 sc1
    s_mov_b32 s31, 4096
    buffer_load_dwordx4 a[48:51], v11, s[16:19], s31 offen offset:2048 sc1
    buffer_load_dwordx4 a[52:55], v12, s[16:19], s31 offen offset:2048 sc1
    s_mov_b32 s31, 4096
    buffer_load_dwordx4 a[56:59], v11, s[16:19], s31 offen offset:3072 sc1
    buffer_load_dwordx4 a[60:63], v12, s[16:19], s31 offen offset:3072 sc1
    s_mov_b32 s31, 8192
    buffer_load_dwordx4 a[64:67], v11, s[16:19], s31 offen offset:0 sc1
    buffer_load_dwordx4 a[68:71], v12, s[16:19], s31 offen offset:0 sc1
    s_mov_b32 s31, 8192
    buffer_load_dwordx4 a[72:75], v11, s[16:19], s31 offen offset:1024 sc1
    buffer_load_dwordx4 a[76:79], v12, s[16:19], s31 offen offset:1024 sc1
    s_mov_b32 s31, 8192
    buffer_load_dwordx4 a[80:83], v11, s[16:19], s31 offen offset:2048 sc1
    buffer_load_dwordx4 a[84:87], v12, s[16:19], s31 offen offset:2048 sc1
    s_mov_b32 s31, 8192
    buffer_load_dwordx4 a[88:91], v11, s[16:19], s31 offen offset:3072 sc1
    buffer_load_dwordx4 a[92:95], v12, s[16:19], s31 offen offset:3072 sc1
    s_mov_b32 s31, 12288
    buffer_load_dwordx4 a[96:99], v11, s[16:19], s31 offen offset:0 sc1
    buffer_load_dwordx4 a[100:103], v12, s[16:19], s31 offen offset:0 sc1
    s_mov_b32 s31, 12288
    buffer_load_dwordx4 a[104:107], v11, s[16:19], s31 offen offset:1024 sc1
    buffer_load_dwordx4 a[108:111], v12, s[16:19], s31 offen offset:1024 sc1
    s_mov_b32 s31, 12288
    buffer_load_dwordx4 a[112:115], v11, s[16:19], s31 offen offset:2048 sc1
    buffer_load_dwordx4 a[116:119], v12, s[16:19], s31 offen offset:2048 sc1
    s_mov_b32 s31, 12288
    buffer_load_dwordx4 a[120:123], v11, s[16:19], s31 offen offset:3072 sc1
    buffer_load_dwordx4 a[124:127], v12, s[16:19], s31 offen offset:3072 sc1
    s_mov_b32 s31, 16384
    buffer_load_dwordx4 a[128:131], v11, s[16:19], s31 offen offset:0 sc1
    buffer_load_dwordx4 a[132:135], v12, s[16:19], s31 offen offset:0 sc1
    s_mov_b32 s31, 16384
    buffer_load_dwordx4 a[136:139], v11, s[16:19], s31 offen offset:1024 sc1
    buffer_load_dwordx4 a[140:143], v12, s[16:19], s31 offen offset:1024 sc1
    s_add_u32 s95, s93, 0
    s_sub_u32 s3, s95, 9
    s_cselect_b32 s95, s95, s3
    s_lshl_b32 s95, s95, 11
    buffer_load_dwordx4 a[144:147], v30, s[20:23], s95 offen offset:0 sc1
    buffer_load_dwordx4 a[148:151], v31, s[20:23], s95 offen offset:0 sc1
    buffer_load_dwordx4 a[152:155], v32, s[20:23], s95 offen offset:0 sc1
    buffer_load_dwordx4 a[156:159], v33, s[20:23], s95 offen offset:0 sc1
    s_add_u32 s95, s93, 0
    s_sub_u32 s3, s95, 9
    s_cselect_b32 s95, s95, s3
    s_lshl_b32 s95, s95, 11
    buffer_load_dwordx4 a[160:163], v30, s[20:23], s95 offen offset:1024 sc1
    buffer_load_dwordx4 a[164:167], v31, s[20:23], s95 offen offset:1024 sc1
    buffer_load_dwordx4 a[168:171], v32, s[20:23], s95 offen offset:1024 sc1
    buffer_load_dwordx4 a[172:175], v33, s[20:23], s95 offen offset:1024 sc1
    s_add_u32 s95, s93, 1
    s_sub_u32 s3, s95, 9
    s_cselect_b32 s95, s95, s3
    s_lshl_b32 s95, s95, 11
    buffer_load_dwordx4 a[176:179], v30, s[20:23], s95 offen offset:0 sc1
    buffer_load_dwordx4 a[180:183], v31, s[20:23], s95 offen offset:0 sc1
    buffer_load_dwordx4 a[184:187], v32, s[20:23], s95 offen offset:0 sc1
    buffer_load_dwordx4 a[188:191], v33, s[20:23], s95 offen offset:0 sc1
    s_add_u32 s95, s93, 1
    s_sub_u32 s3, s95, 9
    s_cselect_b32 s95, s95, s3
    s_lshl_b32 s95, s95, 11
    buffer_load_dwordx4 a[192:195], v30, s[20:23], s95 offen offset:1024 sc1
    buffer_load_dwordx4 a[196:199], v31, s[20:23], s95 offen offset:1024 sc1
    buffer_load_dwordx4 a[200:203], v32, s[20:23], s95 offen offset:1024 sc1
    buffer_load_dwordx4 a[204:207], v33, s[20:23], s95 offen offset:1024 sc1
    s_waitcnt vmcnt(40)
    ds_read_b64_tr_b16 v[216:217], v13 offset:0
    ds_read_b64_tr_b16 v[218:219], v13 offset:1536
    ds_read_b64_tr_b16 v[220:221], v13 offset:32
    ds_read_b64_tr_b16 v[222:223], v13 offset:1568
    ds_read_b64_tr_b16 v[224:225], v13 offset:64
    ds_read_b64_tr_b16 v[226:227], v13 offset:1600
    ds_read_b64_tr_b16 v[228:229], v13 offset:3072
    ds_read_b64_tr_b16 v[230:231], v13 offset:4608
    ds_read_b64_tr_b16 v[232:233], v13 offset:3104
    ds_read_b64_tr_b16 v[234:235], v13 offset:4640
    ds_read_b64_tr_b16 v[236:237], v13 offset:3136
    ds_read_b64_tr_b16 v[238:239], v13 offset:4672
    s_waitcnt lgkmcnt(6)
    v_mfma_f32_16x16x32_bf16 v[192:195], v[216:219], a[0:3], 0
    v_mfma_f32_16x16x32_bf16 v[196:199], v[216:219], a[4:7], 0
    ds_read_b64_tr_b16 v[240:241], v13 offset:6144
    ds_read_b64_tr_b16 v[242:243], v13 offset:7680
    ds_read_b64_tr_b16 v[244:245], v13 offset:6176
    ds_read_b64_tr_b16 v[246:247], v13 offset:7712
    ds_read_b64_tr_b16 v[248:249], v13 offset:6208
    ds_read_b64_tr_b16 v[250:251], v13 offset:7744
    s_add_u32 s95, s93, 2
    s_sub_u32 s3, s95, 9
    s_cselect_b32 s95, s95, s3
    s_lshl_b32 s95, s95, 11
    buffer_load_dwordx4 a[208:211], v30, s[20:23], s95 offen offset:0 sc1
    v_mfma_f32_16x16x32_bf16 v[200:203], v[220:223], a[0:3], 0
    v_mfma_f32_16x16x32_bf16 v[204:207], v[220:223], a[4:7], 0
    buffer_load_dwordx4 a[212:215], v31, s[20:23], s95 offen offset:0 sc1
    v_mfma_f32_16x16x32_bf16 v[208:211], v[224:227], a[0:3], 0
    v_mfma_f32_16x16x32_bf16 v[212:215], v[224:227], a[4:7], 0
    buffer_load_dwordx4 a[216:219], v32, s[20:23], s95 offen offset:0 sc1
    s_waitcnt lgkmcnt(6)
    v_mfma_f32_16x16x32_bf16 v[192:195], v[228:231], a[8:11], v[192:195]
    v_mfma_f32_16x16x32_bf16 v[196:199], v[228:231], a[12:15], v[196:199]
    ds_read_b64_tr_b16 v[216:217], v13 offset:9216
    ds_read_b64_tr_b16 v[218:219], v13 offset:10752
    ds_read_b64_tr_b16 v[220:221], v13 offset:9248
    ds_read_b64_tr_b16 v[222:223], v13 offset:10784
    ds_read_b64_tr_b16 v[224:225], v13 offset:9280
    ds_read_b64_tr_b16 v[226:227], v13 offset:10816
    buffer_load_dwordx4 a[220:223], v33, s[20:23], s95 offen offset:0 sc1
    v_mfma_f32_16x16x32_bf16 v[200:203], v[232:235], a[8:11], v[200:203]
    v_mfma_f32_16x16x32_bf16 v[204:207], v[232:235], a[12:15], v[204:207]
    s_add_u32 s95, s93, 2
    s_sub_u32 s3, s95, 9
    s_cselect_b32 s95, s95, s3
    s_lshl_b32 s95, s95, 11
    buffer_load_dwordx4 a[224:227], v30, s[20:23], s95 offen offset:1024 sc1
    v_mfma_f32_16x16x32_bf16 v[208:211], v[236:239], a[8:11], v[208:211]
    v_mfma_f32_16x16x32_bf16 v[212:215], v[236:239], a[12:15], v[212:215]
    buffer_load_dwordx4 a[228:231], v31, s[20:23], s95 offen offset:1024 sc1
    s_waitcnt lgkmcnt(6)
    v_mfma_f32_16x16x32_bf16 v[192:195], v[240:243], a[16:19], v[192:195]
    v_mfma_f32_16x16x32_bf16 v[196:199], v[240:243], a[20:23], v[196:199]
    ds_read_b64_tr_b16 v[228:229], v13 offset:12288
    ds_read_b64_tr_b16 v[230:231], v13 offset:13824
    ds_read_b64_tr_b16 v[232:233], v13 offset:12320
    ds_read_b64_tr_b16 v[234:235], v13 offset:13856
    ds_read_b64_tr_b16 v[236:237], v13 offset:12352
    ds_read_b64_tr_b16 v[238:239], v13 offset:13888
    buffer_load_dwordx4 a[232:235], v32, s[20:23], s95 offen offset:1024 sc1
    v_mfma_f32_16x16x32_bf16 v[200:203], v[244:247], a[16:19], v[200:203]
    v_mfma_f32_16x16x32_bf16 v[204:207], v[244:247], a[20:23], v[204:207]
    buffer_load_dwordx4 a[236:239], v33, s[20:23], s95 offen offset:1024 sc1
    v_mfma_f32_16x16x32_bf16 v[208:211], v[248:251], a[16:19], v[208:211]
    v_mfma_f32_16x16x32_bf16 v[212:215], v[248:251], a[20:23], v[212:215]
    s_add_u32 s95, s93, 3
    s_sub_u32 s3, s95, 9
    s_cselect_b32 s95, s95, s3
    s_lshl_b32 s95, s95, 11
    buffer_load_dwordx4 a[240:243], v30, s[20:23], s95 offen offset:0 sc1
    s_waitcnt lgkmcnt(6)
    v_mfma_f32_16x16x32_bf16 v[192:195], v[216:219], a[24:27], v[192:195]
    v_mfma_f32_16x16x32_bf16 v[196:199], v[216:219], a[28:31], v[196:199]
    ds_read_b64_tr_b16 v[240:241], v13 offset:15360
    ds_read_b64_tr_b16 v[242:243], v13 offset:16896
    ds_read_b64_tr_b16 v[244:245], v13 offset:15392
    ds_read_b64_tr_b16 v[246:247], v13 offset:16928
    ds_read_b64_tr_b16 v[248:249], v13 offset:15424
    ds_read_b64_tr_b16 v[250:251], v13 offset:16960
    buffer_load_dwordx4 a[244:247], v31, s[20:23], s95 offen offset:0 sc1
    v_mfma_f32_16x16x32_bf16 v[200:203], v[220:223], a[24:27], v[200:203]
    v_mfma_f32_16x16x32_bf16 v[204:207], v[220:223], a[28:31], v[204:207]
    buffer_load_dwordx4 a[248:251], v32, s[20:23], s95 offen offset:0 sc1
    v_mfma_f32_16x16x32_bf16 v[208:211], v[224:227], a[24:27], v[208:211]
    v_mfma_f32_16x16x32_bf16 v[212:215], v[224:227], a[28:31], v[212:215]
    buffer_load_dwordx4 a[252:255], v33, s[20:23], s95 offen offset:0 sc1
    s_waitcnt lgkmcnt(6)
    v_mfma_f32_16x16x32_bf16 v[192:195], v[228:231], a[32:35], v[192:195]
    v_mfma_f32_16x16x32_bf16 v[196:199], v[228:231], a[36:39], v[196:199]
    ds_read_b64_tr_b16 v[216:217], v13 offset:18432
    ds_read_b64_tr_b16 v[218:219], v13 offset:19968
    ds_read_b64_tr_b16 v[220:221], v13 offset:18464
    ds_read_b64_tr_b16 v[222:223], v13 offset:20000
    ds_read_b64_tr_b16 v[224:225], v13 offset:18496
    ds_read_b64_tr_b16 v[226:227], v13 offset:20032
    v_mfma_f32_16x16x32_bf16 v[200:203], v[232:235], a[32:35], v[200:203]
    v_mfma_f32_16x16x32_bf16 v[204:207], v[232:235], a[36:39], v[204:207]
    v_mfma_f32_16x16x32_bf16 v[208:211], v[236:239], a[32:35], v[208:211]
    v_mfma_f32_16x16x32_bf16 v[212:215], v[236:239], a[36:39], v[212:215]
    s_waitcnt lgkmcnt(6)
    v_mfma_f32_16x16x32_bf16 v[192:195], v[240:243], a[40:43], v[192:195]
    v_mfma_f32_16x16x32_bf16 v[196:199], v[240:243], a[44:47], v[196:199]
    ds_read_b64_tr_b16 v[228:229], v13 offset:21504
    ds_read_b64_tr_b16 v[230:231], v13 offset:23040
    ds_read_b64_tr_b16 v[232:233], v13 offset:21536
    ds_read_b64_tr_b16 v[234:235], v13 offset:23072
    ds_read_b64_tr_b16 v[236:237], v13 offset:21568
    ds_read_b64_tr_b16 v[238:239], v13 offset:23104
    v_mfma_f32_16x16x32_bf16 v[200:203], v[244:247], a[40:43], v[200:203]
    v_mfma_f32_16x16x32_bf16 v[204:207], v[244:247], a[44:47], v[204:207]
    v_mfma_f32_16x16x32_bf16 v[208:211], v[248:251], a[40:43], v[208:211]
    v_mfma_f32_16x16x32_bf16 v[212:215], v[248:251], a[44:47], v[212:215]
    s_waitcnt vmcnt(40)
    s_waitcnt lgkmcnt(6)
    v_mfma_f32_16x16x32_bf16 v[192:195], v[216:219], a[48:51], v[192:195]
    v_mfma_f32_16x16x32_bf16 v[196:199], v[216:219], a[52:55], v[196:199]
    ds_read_b64_tr_b16 v[240:241], v13 offset:24576
    ds_read_b64_tr_b16 v[242:243], v13 offset:26112
    ds_read_b64_tr_b16 v[244:245], v13 offset:24608
    ds_read_b64_tr_b16 v[246:247], v13 offset:26144
    ds_read_b64_tr_b16 v[248:249], v13 offset:24640
    ds_read_b64_tr_b16 v[250:251], v13 offset:26176
    v_mfma_f32_16x16x32_bf16 v[200:203], v[220:223], a[48:51], v[200:203]
    v_mfma_f32_16x16x32_bf16 v[204:207], v[220:223], a[52:55], v[204:207]
    v_mfma_f32_16x16x32_bf16 v[208:211], v[224:227], a[48:51], v[208:211]
    v_mfma_f32_16x16x32_bf16 v[212:215], v[224:227], a[52:55], v[212:215]
    s_waitcnt lgkmcnt(6)
    v_mfma_f32_16x16x32_bf16 v[192:195], v[228:231], a[56:59], v[192:195]
    v_mfma_f32_16x16x32_bf16 v[196:199], v[228:231], a[60:63], v[196:199]
    ds_read_b64_tr_b16 v[216:217], v13 offset:27648
    ds_read_b64_tr_b16 v[218:219], v13 offset:29184
    ds_read_b64_tr_b16 v[220:221], v13 offset:27680
    ds_read_b64_tr_b16 v[222:223], v13 offset:29216
    ds_read_b64_tr_b16 v[224:225], v13 offset:27712
    ds_read_b64_tr_b16 v[226:227], v13 offset:29248
    v_mfma_f32_16x16x32_bf16 v[200:203], v[232:235], a[56:59], v[200:203]
    v_mfma_f32_16x16x32_bf16 v[204:207], v[232:235], a[60:63], v[204:207]
    v_mfma_f32_16x16x32_bf16 v[208:211], v[236:239], a[56:59], v[208:211]
    v_mfma_f32_16x16x32_bf16 v[212:215], v[236:239], a[60:63], v[212:215]
    s_waitcnt lgkmcnt(6)
    v_mfma_f32_16x16x32_bf16 v[192:195], v[240:243], a[64:67], v[192:195]
    v_mfma_f32_16x16x32_bf16 v[196:199], v[240:243], a[68:71], v[196:199]
    ds_read_b64_tr_b16 v[228:229], v13 offset:30720
    ds_read_b64_tr_b16 v[230:231], v13 offset:32256
    ds_read_b64_tr_b16 v[232:233], v13 offset:30752
    ds_read_b64_tr_b16 v[234:235], v13 offset:32288
    ds_read_b64_tr_b16 v[236:237], v13 offset:30784
    ds_read_b64_tr_b16 v[238:239], v13 offset:32320
    v_mfma_f32_16x16x32_bf16 v[200:203], v[244:247], a[64:67], v[200:203]
    v_mfma_f32_16x16x32_bf16 v[204:207], v[244:247], a[68:71], v[204:207]
    v_mfma_f32_16x16x32_bf16 v[208:211], v[248:251], a[64:67], v[208:211]
    v_mfma_f32_16x16x32_bf16 v[212:215], v[248:251], a[68:71], v[212:215]
    s_waitcnt lgkmcnt(6)
    v_mfma_f32_16x16x32_bf16 v[192:195], v[216:219], a[72:75], v[192:195]
    v_mfma_f32_16x16x32_bf16 v[196:199], v[216:219], a[76:79], v[196:199]
    ds_read_b64_tr_b16 v[240:241], v13 offset:33792
    ds_read_b64_tr_b16 v[242:243], v13 offset:35328
    ds_read_b64_tr_b16 v[244:245], v13 offset:33824
    ds_read_b64_tr_b16 v[246:247], v13 offset:35360
    ds_read_b64_tr_b16 v[248:249], v13 offset:33856
    ds_read_b64_tr_b16 v[250:251], v13 offset:35392
    v_mfma_f32_16x16x32_bf16 v[200:203], v[220:223], a[72:75], v[200:203]
    v_mfma_f32_16x16x32_bf16 v[204:207], v[220:223], a[76:79], v[204:207]
    v_mfma_f32_16x16x32_bf16 v[208:211], v[224:227], a[72:75], v[208:211]
    v_mfma_f32_16x16x32_bf16 v[212:215], v[224:227], a[76:79], v[212:215]
    s_waitcnt lgkmcnt(6)
    v_mfma_f32_16x16x32_bf16 v[192:195], v[228:231], a[80:83], v[192:195]
    v_mfma_f32_16x16x32_bf16 v[196:199], v[228:231], a[84:87], v[196:199]
    ds_read_b64_tr_b16 v[216:217], v13 offset:36864
    ds_read_b64_tr_b16 v[218:219], v13 offset:38400
    ds_read_b64_tr_b16 v[220:221], v13 offset:36896
    ds_read_b64_tr_b16 v[222:223], v13 offset:38432
    ds_read_b64_tr_b16 v[224:225], v13 offset:36928
    ds_read_b64_tr_b16 v[226:227], v13 offset:38464
    v_mfma_f32_16x16x32_bf16 v[200:203], v[232:235], a[80:83], v[200:203]
    v_mfma_f32_16x16x32_bf16 v[204:207], v[232:235], a[84:87], v[204:207]
    v_mfma_f32_16x16x32_bf16 v[208:211], v[236:239], a[80:83], v[208:211]
    v_mfma_f32_16x16x32_bf16 v[212:215], v[236:239], a[84:87], v[212:215]
    s_waitcnt lgkmcnt(6)
    v_mfma_f32_16x16x32_bf16 v[192:195], v[240:243], a[88:91], v[192:195]
    v_mfma_f32_16x16x32_bf16 v[196:199], v[240:243], a[92:95], v[196:199]
    ds_read_b64_tr_b16 v[228:229], v13 offset:39936
    ds_read_b64_tr_b16 v[230:231], v13 offset:41472
    ds_read_b64_tr_b16 v[232:233], v13 offset:39968
    ds_read_b64_tr_b16 v[234:235], v13 offset:41504
    ds_read_b64_tr_b16 v[236:237], v13 offset:40000
    ds_read_b64_tr_b16 v[238:239], v13 offset:41536
    v_mfma_f32_16x16x32_bf16 v[200:203], v[244:247], a[88:91], v[200:203]
    v_mfma_f32_16x16x32_bf16 v[204:207], v[244:247], a[92:95], v[204:207]
    v_mfma_f32_16x16x32_bf16 v[208:211], v[248:251], a[88:91], v[208:211]
    v_mfma_f32_16x16x32_bf16 v[212:215], v[248:251], a[92:95], v[212:215]
    s_waitcnt vmcnt(32)
    s_waitcnt lgkmcnt(6)
    v_mfma_f32_16x16x32_bf16 v[192:195], v[216:219], a[96:99], v[192:195]
    v_mfma_f32_16x16x32_bf16 v[196:199], v[216:219], a[100:103], v[196:199]
    ds_read_b64_tr_b16 v[240:241], v13 offset:43008
    ds_read_b64_tr_b16 v[242:243], v13 offset:44544
    ds_read_b64_tr_b16 v[244:245], v13 offset:43040
    ds_read_b64_tr_b16 v[246:247], v13 offset:44576
    ds_read_b64_tr_b16 v[248:249], v13 offset:43072
    ds_read_b64_tr_b16 v[250:251], v13 offset:44608
    v_mfma_f32_16x16x32_bf16 v[200:203], v[220:223], a[96:99], v[200:203]
    v_mfma_f32_16x16x32_bf16 v[204:207], v[220:223], a[100:103], v[204:207]
    v_mfma_f32_16x16x32_bf16 v[208:211], v[224:227], a[96:99], v[208:211]
    v_mfma_f32_16x16x32_bf16 v[212:215], v[224:227], a[100:103], v[212:215]
    s_waitcnt lgkmcnt(6)
    v_mfma_f32_16x16x32_bf16 v[192:195], v[228:231], a[104:107], v[192:195]
    v_mfma_f32_16x16x32_bf16 v[196:199], v[228:231], a[108:111], v[196:199]
    ds_read_b64_tr_b16 v[216:217], v13 offset:46080
    ds_read_b64_tr_b16 v[218:219], v13 offset:47616
    ds_read_b64_tr_b16 v[220:221], v13 offset:46112
    ds_read_b64_tr_b16 v[222:223], v13 offset:47648
    ds_read_b64_tr_b16 v[224:225], v13 offset:46144
    ds_read_b64_tr_b16 v[226:227], v13 offset:47680
    v_mfma_f32_16x16x32_bf16 v[200:203], v[232:235], a[104:107], v[200:203]
    v_mfma_f32_16x16x32_bf16 v[204:207], v[232:235], a[108:111], v[204:207]
    v_mfma_f32_16x16x32_bf16 v[208:211], v[236:239], a[104:107], v[208:211]
    v_mfma_f32_16x16x32_bf16 v[212:215], v[236:239], a[108:111], v[212:215]
    s_waitcnt lgkmcnt(6)
    v_mfma_f32_16x16x32_bf16 v[192:195], v[240:243], a[112:115], v[192:195]
    v_mfma_f32_16x16x32_bf16 v[196:199], v[240:243], a[116:119], v[196:199]
    ds_read_b64_tr_b16 v[228:229], v13 offset:49152
    ds_read_b64_tr_b16 v[230:231], v13 offset:50688
    ds_read_b64_tr_b16 v[232:233], v13 offset:49184
    ds_read_b64_tr_b16 v[234:235], v13 offset:50720
    ds_read_b64_tr_b16 v[236:237], v13 offset:49216
    ds_read_b64_tr_b16 v[238:239], v13 offset:50752
    v_mfma_f32_16x16x32_bf16 v[200:203], v[244:247], a[112:115], v[200:203]
    v_mfma_f32_16x16x32_bf16 v[204:207], v[244:247], a[116:119], v[204:207]
    v_mfma_f32_16x16x32_bf16 v[208:211], v[248:251], a[112:115], v[208:211]
    v_mfma_f32_16x16x32_bf16 v[212:215], v[248:251], a[116:119], v[212:215]
    s_waitcnt lgkmcnt(6)
    v_mfma_f32_16x16x32_bf16 v[192:195], v[216:219], a[120:123], v[192:195]
    v_mfma_f32_16x16x32_bf16 v[196:199], v[216:219], a[124:127], v[196:199]
    ds_read_b64_tr_b16 v[240:241], v13 offset:52224
    ds_read_b64_tr_b16 v[242:243], v13 offset:53760
    ds_read_b64_tr_b16 v[244:245], v13 offset:52256
    ds_read_b64_tr_b16 v[246:247], v13 offset:53792
    ds_read_b64_tr_b16 v[248:249], v13 offset:52288
    ds_read_b64_tr_b16 v[250:251], v13 offset:53824
    v_mfma_f32_16x16x32_bf16 v[200:203], v[220:223], a[120:123], v[200:203]
    v_mfma_f32_16x16x32_bf16 v[204:207], v[220:223], a[124:127], v[204:207]
    v_mfma_f32_16x16x32_bf16 v[208:211], v[224:227], a[120:123], v[208:211]
    v_mfma_f32_16x16x32_bf16 v[212:215], v[224:227], a[124:127], v[212:215]
    s_waitcnt vmcnt(28)
    s_waitcnt lgkmcnt(6)
    v_mfma_f32_16x16x32_bf16 v[192:195], v[228:231], a[128:131], v[192:195]
    v_mfma_f32_16x16x32_bf16 v[196:199], v[228:231], a[132:135], v[196:199]
    v_mfma_f32_16x16x32_bf16 v[200:203], v[232:235], a[128:131], v[200:203]
    v_mfma_f32_16x16x32_bf16 v[204:207], v[232:235], a[132:135], v[204:207]
    v_mfma_f32_16x16x32_bf16 v[208:211], v[236:239], a[128:131], v[208:211]
    v_mfma_f32_16x16x32_bf16 v[212:215], v[236:239], a[132:135], v[212:215]
    s_waitcnt lgkmcnt(0)
    v_mfma_f32_16x16x32_bf16 v[192:195], v[240:243], a[136:139], v[192:195]
    v_mfma_f32_16x16x32_bf16 v[196:199], v[240:243], a[140:143], v[196:199]
    v_mfma_f32_16x16x32_bf16 v[200:203], v[244:247], a[136:139], v[200:203]
    v_mfma_f32_16x16x32_bf16 v[204:207], v[244:247], a[140:143], v[204:207]
    v_mfma_f32_16x16x32_bf16 v[208:211], v[248:251], a[136:139], v[208:211]
    v_mfma_f32_16x16x32_bf16 v[212:215], v[248:251], a[140:143], v[212:215]
    s_nop 7
    s_barrier
    v_mul_f32 v216, v192, v192
    v_mul_f32 v217, v193, v193
    v_mul_f32 v218, v194, v194
    v_mul_f32 v219, v195, v195
    v_mul_f32 v220, v196, v196
    v_mul_f32 v221, v197, v197
    v_mul_f32 v222, v198, v198
    v_mul_f32 v223, v199, v199
    v_mul_f32 v224, v200, v200
    v_mul_f32 v225, v201, v201
    v_mul_f32 v226, v202, v202
    v_mul_f32 v227, v203, v203
    v_mul_f32 v228, v204, v204
    v_mul_f32 v229, v205, v205
    v_mul_f32 v230, v206, v206
    v_mul_f32 v231, v207, v207
    v_mul_f32 v232, v208, v208
    v_mul_f32 v233, v209, v209
    v_mul_f32 v234, v210, v210
    v_mul_f32 v235, v211, v211
    v_mul_f32 v236, v212, v212
    v_mul_f32 v237, v213, v213
    v_mul_f32 v238, v214, v214
    v_mul_f32 v239, v215, v215
    v_fmaak_f32 v216, v18, v216, 0xc0135761
    v_fmaak_f32 v217, v18, v217, 0xc0135761
    v_fmaak_f32 v218, v18, v218, 0xc0135761
    v_fmaak_f32 v219, v18, v219, 0xc0135761
    v_fmaak_f32 v220, v18, v220, 0xc0135761
    v_fmaak_f32 v221, v18, v221, 0xc0135761
    v_fmaak_f32 v222, v18, v222, 0xc0135761
    v_fmaak_f32 v223, v18, v223, 0xc0135761
    v_fmaak_f32 v224, v18, v224, 0xc0135761
    v_fmaak_f32 v225, v18, v225, 0xc0135761
    v_fmaak_f32 v226, v18, v226, 0xc0135761
    v_fmaak_f32 v227, v18, v227, 0xc0135761
    v_fmaak_f32 v228, v18, v228, 0xc0135761
    v_fmaak_f32 v229, v18, v229, 0xc0135761
    v_fmaak_f32 v230, v18, v230, 0xc0135761
    v_fmaak_f32 v231, v18, v231, 0xc0135761
    v_fmaak_f32 v232, v18, v232, 0xc0135761
    v_fmaak_f32 v233, v18, v233, 0xc0135761
    v_fmaak_f32 v234, v18, v234, 0xc0135761
    v_fmaak_f32 v235, v18, v235, 0xc0135761
    v_fmaak_f32 v236, v18, v236, 0xc0135761
    v_fmaak_f32 v237, v18, v237, 0xc0135761
    v_fmaak_f32 v238, v18, v238, 0xc0135761
    v_fmaak_f32 v239, v18, v239, 0xc0135761
    v_mul_f32 v216, v216, v192
    v_mul_f32 v217, v217, v193
    v_mul_f32 v218, v218, v194
    v_mul_f32 v219, v219, v195
    v_mul_f32 v220, v220, v196
    v_mul_f32 v221, v221, v197
    v_mul_f32 v222, v222, v198
    v_mul_f32 v223, v223, v199
    v_mul_f32 v224, v224, v200
    v_mul_f32 v225, v225, v201
    v_mul_f32 v226, v226, v202
    v_mul_f32 v227, v227, v203
    v_mul_f32 v228, v228, v204
    v_mul_f32 v229, v229, v205
    v_mul_f32 v230, v230, v206
    v_mul_f32 v231, v231, v207
    v_mul_f32 v232, v232, v208
    v_mul_f32 v233, v233, v209
    v_mul_f32 v234, v234, v210
    v_mul_f32 v235, v235, v211
    v_mul_f32 v236, v236, v212
    v_mul_f32 v237, v237, v213
    v_mul_f32 v238, v238, v214
    v_mul_f32 v239, v239, v215
    v_exp_f32 v216, v216
    v_exp_f32 v217, v217
    v_exp_f32 v218, v218
    v_exp_f32 v219, v219
    v_exp_f32 v220, v220
    v_exp_f32 v221, v221
    v_exp_f32 v222, v222
    v_exp_f32 v223, v223
    v_exp_f32 v224, v224
    v_exp_f32 v225, v225
    v_exp_f32 v226, v226
    v_exp_f32 v227, v227
    v_exp_f32 v228, v228
    v_exp_f32 v229, v229
    v_exp_f32 v230, v230
    v_exp_f32 v231, v231
    v_exp_f32 v232, v232
    v_exp_f32 v233, v233
    v_exp_f32 v234, v234
    v_exp_f32 v235, v235
    v_exp_f32 v236, v236
    v_exp_f32 v237, v237
    v_exp_f32 v238, v238
    v_exp_f32 v239, v239
    v_add_f32 v216, 1.0, v216
    v_add_f32 v217, 1.0, v217
    v_add_f32 v218, 1.0, v218
    v_add_f32 v219, 1.0, v219
    v_add_f32 v220, 1.0, v220
    v_add_f32 v221, 1.0, v221
    v_add_f32 v222, 1.0, v222
    v_add_f32 v223, 1.0, v223
    v_add_f32 v224, 1.0, v224
    v_add_f32 v225, 1.0, v225
    v_add_f32 v226, 1.0, v226
    v_add_f32 v227, 1.0, v227
    v_add_f32 v228, 1.0, v228
    v_add_f32 v229, 1.0, v229
    v_add_f32 v230, 1.0, v230
    v_add_f32 v231, 1.0, v231
    v_add_f32 v232, 1.0, v232
    v_add_f32 v233, 1.0, v233
    v_add_f32 v234, 1.0, v234
    v_add_f32 v235, 1.0, v235
    v_add_f32 v236, 1.0, v236
    v_add_f32 v237, 1.0, v237
    v_add_f32 v238, 1.0, v238
    v_add_f32 v239, 1.0, v239
    v_rcp_f32 v216, v216
    v_rcp_f32 v217, v217
    v_rcp_f32 v218, v218
    v_rcp_f32 v219, v219
    v_rcp_f32 v220, v220
    v_rcp_f32 v221, v221
    v_rcp_f32 v222, v222
    v_rcp_f32 v223, v223
    v_rcp_f32 v224, v224
    v_rcp_f32 v225, v225
    v_rcp_f32 v226, v226
    v_rcp_f32 v227, v227
    v_rcp_f32 v228, v228
    v_rcp_f32 v229, v229
    v_rcp_f32 v230, v230
    v_rcp_f32 v231, v231
    v_rcp_f32 v232, v232
    v_rcp_f32 v233, v233
    v_rcp_f32 v234, v234
    v_rcp_f32 v235, v235
    v_rcp_f32 v236, v236
    v_rcp_f32 v237, v237
    v_rcp_f32 v238, v238
    v_rcp_f32 v239, v239
    v_mul_f32 v192, v192, v216
    v_mul_f32 v193, v193, v217
    v_mul_f32 v194, v194, v218
    v_mul_f32 v195, v195, v219
    v_mul_f32 v196, v196, v220
    v_mul_f32 v197, v197, v221
    v_mul_f32 v198, v198, v222
    v_mul_f32 v199, v199, v223
    v_mul_f32 v200, v200, v224
    v_mul_f32 v201, v201, v225
    v_mul_f32 v202, v202, v226
    v_mul_f32 v203, v203, v227
    v_mul_f32 v204, v204, v228
    v_mul_f32 v205, v205, v229
    v_mul_f32 v206, v206, v230
    v_mul_f32 v207, v207, v231
    v_mul_f32 v208, v208, v232
    v_mul_f32 v209, v209, v233
    v_mul_f32 v210, v210, v234
    v_mul_f32 v211, v211, v235
    v_mul_f32 v212, v212, v236
    v_mul_f32 v213, v213, v237
    v_mul_f32 v214, v214, v238
    v_mul_f32 v215, v215, v239
    v_cvt_pk_bf16_f32 v240, v192, v193
    v_cvt_pk_bf16_f32 v241, v194, v195
    v_cvt_pk_bf16_f32 v242, v196, v197
    v_cvt_pk_bf16_f32 v243, v198, v199
    v_cvt_pk_bf16_f32 v244, v200, v201
    v_cvt_pk_bf16_f32 v245, v202, v203
    v_cvt_pk_bf16_f32 v246, v204, v205
    v_cvt_pk_bf16_f32 v247, v206, v207
    v_cvt_pk_bf16_f32 v248, v208, v209
    v_cvt_pk_bf16_f32 v249, v210, v211
    v_cvt_pk_bf16_f32 v250, v212, v213
    v_cvt_pk_bf16_f32 v251, v214, v215
    v_permlane16_swap_b32 v240, v242
    v_permlane16_swap_b32 v241, v243
    v_and_b32 v240, v240, v20
    v_and_b32 v241, v241, v20
    v_and_b32 v242, v242, v20
    v_and_b32 v243, v243, v20
    buffer_store_dwordx4 v[240:243], v15, s[24:27], s101 offen offset:0 sc1
    v_permlane16_swap_b32 v244, v246
    v_permlane16_swap_b32 v245, v247
    v_and_b32 v244, v244, v20
    v_and_b32 v245, v245, v20
    v_and_b32 v246, v246, v20
    v_and_b32 v247, v247, v20
    buffer_store_dwordx4 v[244:247], v15, s[24:27], s101 offen offset:512 sc1
    v_permlane16_swap_b32 v248, v250
    v_permlane16_swap_b32 v249, v251
    v_and_b32 v248, v248, v20
    v_and_b32 v249, v249, v20
    v_and_b32 v250, v250, v20
    v_and_b32 v251, v251, v20
    buffer_store_dwordx4 v[248:251], v15, s[24:27], s101 offen offset:1024 sc1
    s_add_u32 s94, s93, 3
    s_sub_u32 s3, s94, 9
    s_cselect_b32 s94, s94, s3
    s_add_u32 m0, s100, 0
    s_lshl_b32 s94, s94, 19
    buffer_load_dwordx4 v26, s[96:99], s94 offen offset:0 lds
    buffer_load_dwordx4 v27, s[96:99], s94 offen offset:1024 lds
    buffer_load_dwordx4 v28, s[96:99], s94 offen offset:2048 lds
    buffer_load_dwordx4 v29, s[96:99], s94 offen offset:3072 lds
    s_add_u32 s94, s93, 4
    s_sub_u32 s3, s94, 9
    s_cselect_b32 s94, s94, s3
    s_add_u32 m0, s100, 16384
    s_lshl_b32 s94, s94, 19
    buffer_load_dwordx4 v26, s[96:99], s94 offen offset:0 lds
    buffer_load_dwordx4 v27, s[96:99], s94 offen offset:1024 lds
    buffer_load_dwordx4 v28, s[96:99], s94 offen offset:2048 lds
    buffer_load_dwordx4 v29, s[96:99], s94 offen offset:3072 lds
    s_add_u32 s94, s93, 5
    s_sub_u32 s3, s94, 9
    s_cselect_b32 s94, s94, s3
    s_add_u32 m0, s100, 32768
    s_lshl_b32 s94, s94, 19
    buffer_load_dwordx4 v26, s[96:99], s94 offen offset:0 lds
    buffer_load_dwordx4 v27, s[96:99], s94 offen offset:1024 lds
    buffer_load_dwordx4 v28, s[96:99], s94 offen offset:2048 lds
    buffer_load_dwordx4 v29, s[96:99], s94 offen offset:3072 lds
    s_lshr_b32 s90, s2, 3
    s_mul_i32 s91, s90, 165888
    s_bfe_u32 s3, s2, 0x20001
    s_mul_i32 s3, s3, 2304
    s_add_u32 s91, s91, s3
    s_mov_b32 s8, s80
    s_mov_b32 s9, s81
    s_mov_b32 s10, 0x510000
    s_mov_b32 s11, 0x20000
    v_add_u32 v252, 0, v0
    v_min_u32 v252, 323, v252
    v_mul_u32_u24 v253, 58255, v252
    v_lshrrev_b32 v253, 20, v253
    v_mul_u32_u24 v253, 6912, v253
    v_lshl_add_u32 v252, v252, 7, v253
    buffer_load_dword v253, v252, s[8:11], s91 offen
    v_add_u32 v252, 256, v0
    v_min_u32 v252, 323, v252
    v_mul_u32_u24 v253, 58255, v252
    v_lshrrev_b32 v253, 20, v253
    v_mul_u32_u24 v253, 6912, v253
    v_lshl_add_u32 v252, v252, 7, v253
    buffer_load_dword v253, v252, s[8:11], s91 offen
    s_waitcnt vmcnt(63)
    s_barrier
    ds_read_b64_tr_b16 v[192:193], v34 offset:0
    ds_read_b64_tr_b16 v[194:195], v34 offset:4096
    ds_read_b64_tr_b16 v[196:197], v34 offset:8
    ds_read_b64_tr_b16 v[198:199], v34 offset:4104
    ds_read_b64_tr_b16 v[200:201], v35 offset:0
    ds_read_b64_tr_b16 v[202:203], v35 offset:4096
    ds_read_b64_tr_b16 v[204:205], v35 offset:8
    ds_read_b64_tr_b16 v[206:207], v35 offset:4104
    s_waitcnt vmcnt(41) lgkmcnt(6)
    v_mfma_f32_16x16x32_bf16 v[64:67], v[192:195], a[144:147], 0
    ds_read_b64_tr_b16 v[208:209], v36 offset:0
    v_mfma_f32_16x16x32_bf16 v[68:71], v[192:195], a[148:151], 0
    ds_read_b64_tr_b16 v[210:211], v36 offset:4096
    v_mfma_f32_16x16x32_bf16 v[72:75], v[192:195], a[152:155], 0
    v_mfma_f32_16x16x32_bf16 v[76:79], v[192:195], a[156:159], 0
    s_waitcnt lgkmcnt(6)
    v_mfma_f32_16x16x32_bf16 v[80:83], v[196:199], a[144:147], 0
    ds_read_b64_tr_b16 v[212:213], v36 offset:8
    v_mfma_f32_16x16x32_bf16 v[84:87], v[196:199], a[148:151], 0
    ds_read_b64_tr_b16 v[214:215], v36 offset:4104
    v_mfma_f32_16x16x32_bf16 v[88:91], v[196:199], a[152:155], 0
    v_mfma_f32_16x16x32_bf16 v[92:95], v[196:199], a[156:159], 0
    s_waitcnt lgkmcnt(6)
    v_mfma_f32_16x16x32_bf16 v[96:99], v[200:203], a[144:147], 0
    ds_read_b64_tr_b16 v[216:217], v37 offset:0
    v_mfma_f32_16x16x32_bf16 v[100:103], v[200:203], a[148:151], 0
    ds_read_b64_tr_b16 v[218:219], v37 offset:4096
    v_mfma_f32_16x16x32_bf16 v[104:107], v[200:203], a[152:155], 0
    v_mfma_f32_16x16x32_bf16 v[108:111], v[200:203], a[156:159], 0
    s_waitcnt lgkmcnt(6)
    v_mfma_f32_16x16x32_bf16 v[112:115], v[204:207], a[144:147], 0
    ds_read_b64_tr_b16 v[220:221], v37 offset:8
    v_mfma_f32_16x16x32_bf16 v[116:119], v[204:207], a[148:151], 0
    ds_read_b64_tr_b16 v[222:223], v37 offset:4104
    v_mfma_f32_16x16x32_bf16 v[120:123], v[204:207], a[152:155], 0
    v_mfma_f32_16x16x32_bf16 v[124:127], v[204:207], a[156:159], 0
    s_waitcnt lgkmcnt(6)
    v_mfma_f32_16x16x32_bf16 v[128:131], v[208:211], a[144:147], 0
    ds_read_b64_tr_b16 v[192:193], v34 offset:8192
    v_mfma_f32_16x16x32_bf16 v[132:135], v[208:211], a[148:151], 0
    ds_read_b64_tr_b16 v[194:195], v34 offset:12288
    v_mfma_f32_16x16x32_bf16 v[136:139], v[208:211], a[152:155], 0
    v_mfma_f32_16x16x32_bf16 v[140:143], v[208:211], a[156:159], 0
    s_waitcnt lgkmcnt(6)
    v_mfma_f32_16x16x32_bf16 v[144:147], v[212:215], a[144:147], 0
    ds_read_b64_tr_b16 v[196:197], v34 offset:8200
    v_mfma_f32_16x16x32_bf16 v[148:151], v[212:215], a[148:151], 0
    ds_read_b64_tr_b16 v[198:199], v34 offset:12296
    v_mfma_f32_16x16x32_bf16 v[152:155], v[212:215], a[152:155], 0
    v_mfma_f32_16x16x32_bf16 v[156:159], v[212:215], a[156:159], 0
    s_waitcnt lgkmcnt(6)
    v_mfma_f32_16x16x32_bf16 v[160:163], v[216:219], a[144:147], 0
    ds_read_b64_tr_b16 v[200:201], v35 offset:8192
    v_mfma_f32_16x16x32_bf16 v[164:167], v[216:219], a[148:151], 0
    ds_read_b64_tr_b16 v[202:203], v35 offset:12288
    v_mfma_f32_16x16x32_bf16 v[168:171], v[216:219], a[152:155], 0
    v_mfma_f32_16x16x32_bf16 v[172:175], v[216:219], a[156:159], 0
    s_waitcnt lgkmcnt(6)
    v_mfma_f32_16x16x32_bf16 v[176:179], v[220:223], a[144:147], 0
    ds_read_b64_tr_b16 v[204:205], v35 offset:8200
    v_mfma_f32_16x16x32_bf16 v[180:183], v[220:223], a[148:151], 0
    ds_read_b64_tr_b16 v[206:207], v35 offset:12296
    v_mfma_f32_16x16x32_bf16 v[184:187], v[220:223], a[152:155], 0
    v_mfma_f32_16x16x32_bf16 v[188:191], v[220:223], a[156:159], 0
    s_waitcnt vmcnt(37) lgkmcnt(6)
    v_mfma_f32_16x16x32_bf16 v[64:67], v[192:195], a[160:163], v[64:67]
    ds_read_b64_tr_b16 v[208:209], v36 offset:8192
    v_mfma_f32_16x16x32_bf16 v[68:71], v[192:195], a[164:167], v[68:71]
    ds_read_b64_tr_b16 v[210:211], v36 offset:12288
    v_mfma_f32_16x16x32_bf16 v[72:75], v[192:195], a[168:171], v[72:75]
    s_add_u32 s95, s93, 3
    s_sub_u32 s3, s95, 9
    s_cselect_b32 s95, s95, s3
    s_lshl_b32 s95, s95, 11
    buffer_load_dwordx4 a[144:147], v30, s[20:23], s95 offen offset:1024 sc1
    v_mfma_f32_16x16x32_bf16 v[76:79], v[192:195], a[172:175], v[76:79]
    buffer_load_dwordx4 a[148:151], v31, s[20:23], s95 offen offset:1024 sc1
    s_waitcnt lgkmcnt(6)
    v_mfma_f32_16x16x32_bf16 v[80:83], v[196:199], a[160:163], v[80:83]
    ds_read_b64_tr_b16 v[212:213], v36 offset:8200
    v_mfma_f32_16x16x32_bf16 v[84:87], v[196:199], a[164:167], v[84:87]
    ds_read_b64_tr_b16 v[214:215], v36 offset:12296
    v_mfma_f32_16x16x32_bf16 v[88:91], v[196:199], a[168:171], v[88:91]
    buffer_load_dwordx4 a[152:155], v32, s[20:23], s95 offen offset:1024 sc1
    v_mfma_f32_16x16x32_bf16 v[92:95], v[196:199], a[172:175], v[92:95]
    buffer_load_dwordx4 a[156:159], v33, s[20:23], s95 offen offset:1024 sc1
    s_waitcnt lgkmcnt(6)
    v_mfma_f32_16x16x32_bf16 v[96:99], v[200:203], a[160:163], v[96:99]
    ds_read_b64_tr_b16 v[216:217], v37 offset:8192
    v_mfma_f32_16x16x32_bf16 v[100:103], v[200:203], a[164:167], v[100:103]
    ds_read_b64_tr_b16 v[218:219], v37 offset:12288
    v_mfma_f32_16x16x32_bf16 v[104:107], v[200:203], a[168:171], v[104:107]
    buffer_load_dwordx2 v[46:47], v11, s[20:23], s33 offen sc1
    v_mfma_f32_16x16x32_bf16 v[108:111], v[200:203], a[172:175], v[108:111]
    buffer_load_dwordx2 v[48:49], v12, s[20:23], s33 offen sc1
    s_waitcnt lgkmcnt(6)
    v_mfma_f32_16x16x32_bf16 v[112:115], v[204:207], a[160:163], v[112:115]
    ds_read_b64_tr_b16 v[220:221], v37 offset:8200
    v_mfma_f32_16x16x32_bf16 v[116:119], v[204:207], a[164:167], v[116:119]
    ds_read_b64_tr_b16 v[222:223], v37 offset:12296
    v_mfma_f32_16x16x32_bf16 v[120:123], v[204:207], a[168:171], v[120:123]
    buffer_load_dwordx2 v[50:51], v11, s[20:23], s34 offen sc1
    v_mfma_f32_16x16x32_bf16 v[124:127], v[204:207], a[172:175], v[124:127]
    buffer_load_dwordx2 v[52:53], v12, s[20:23], s34 offen sc1
    s_waitcnt lgkmcnt(6)
    v_mfma_f32_16x16x32_bf16 v[128:131], v[208:211], a[160:163], v[128:131]
    s_waitcnt vmcnt(63)
    s_barrier
    ds_read_b64_tr_b16 v[192:193], v34 offset:16384
    v_mfma_f32_16x16x32_bf16 v[132:135], v[208:211], a[164:167], v[132:135]
    ds_read_b64_tr_b16 v[194:195], v34 offset:20480
    v_mfma_f32_16x16x32_bf16 v[136:139], v[208:211], a[168:171], v[136:139]
    buffer_load_dwordx2 v[54:55], v11, s[20:23], s35 offen sc1
    v_mfma_f32_16x16x32_bf16 v[140:143], v[208:211], a[172:175], v[140:143]
    buffer_load_dwordx2 v[56:57], v12, s[20:23], s35 offen sc1
    s_waitcnt lgkmcnt(6)
    v_mfma_f32_16x16x32_bf16 v[144:147], v[212:215], a[160:163], v[144:147]
    ds_read_b64_tr_b16 v[196:197], v34 offset:16392
    v_mfma_f32_16x16x32_bf16 v[148:151], v[212:215], a[164:167], v[148:151]
    ds_read_b64_tr_b16 v[198:199], v34 offset:20488
    v_mfma_f32_16x16x32_bf16 v[152:155], v[212:215], a[168:171], v[152:155]
    v_mfma_f32_16x16x32_bf16 v[156:159], v[212:215], a[172:175], v[156:159]
    s_waitcnt lgkmcnt(6)
    v_mfma_f32_16x16x32_bf16 v[160:163], v[216:219], a[160:163], v[160:163]
    ds_read_b64_tr_b16 v[200:201], v35 offset:16384
    v_mfma_f32_16x16x32_bf16 v[164:167], v[216:219], a[164:167], v[164:167]
    ds_read_b64_tr_b16 v[202:203], v35 offset:20480
    v_mfma_f32_16x16x32_bf16 v[168:171], v[216:219], a[168:171], v[168:171]
    v_mfma_f32_16x16x32_bf16 v[172:175], v[216:219], a[172:175], v[172:175]
    s_waitcnt lgkmcnt(6)
    v_mfma_f32_16x16x32_bf16 v[176:179], v[220:223], a[160:163], v[176:179]
    ds_read_b64_tr_b16 v[204:205], v35 offset:16392
    v_mfma_f32_16x16x32_bf16 v[180:183], v[220:223], a[164:167], v[180:183]
    ds_read_b64_tr_b16 v[206:207], v35 offset:20488
    v_mfma_f32_16x16x32_bf16 v[184:187], v[220:223], a[168:171], v[184:187]
    v_mfma_f32_16x16x32_bf16 v[188:191], v[220:223], a[172:175], v[188:191]
    s_waitcnt vmcnt(43) lgkmcnt(6)
    v_mfma_f32_16x16x32_bf16 v[64:67], v[192:195], a[176:179], v[64:67]
    ds_read_b64_tr_b16 v[208:209], v36 offset:16384
    v_mfma_f32_16x16x32_bf16 v[68:71], v[192:195], a[180:183], v[68:71]
    ds_read_b64_tr_b16 v[210:211], v36 offset:20480
    v_mfma_f32_16x16x32_bf16 v[72:75], v[192:195], a[184:187], v[72:75]
    s_add_u32 s95, s93, 4
    s_sub_u32 s3, s95, 9
    s_cselect_b32 s95, s95, s3
    s_lshl_b32 s95, s95, 11
    buffer_load_dwordx4 a[160:163], v30, s[20:23], s95 offen offset:0 sc1
    v_mfma_f32_16x16x32_bf16 v[76:79], v[192:195], a[188:191], v[76:79]
    buffer_load_dwordx4 a[164:167], v31, s[20:23], s95 offen offset:0 sc1
    s_waitcnt lgkmcnt(6)
    v_mfma_f32_16x16x32_bf16 v[80:83], v[196:199], a[176:179], v[80:83]
    ds_read_b64_tr_b16 v[212:213], v36 offset:16392
    v_mfma_f32_16x16x32_bf16 v[84:87], v[196:199], a[180:183], v[84:87]
    ds_read_b64_tr_b16 v[214:215], v36 offset:20488
    v_mfma_f32_16x16x32_bf16 v[88:91], v[196:199], a[184:187], v[88:91]
    buffer_load_dwordx4 a[168:171], v32, s[20:23], s95 offen offset:0 sc1
    v_mfma_f32_16x16x32_bf16 v[92:95], v[196:199], a[188:191], v[92:95]
    buffer_load_dwordx4 a[172:175], v33, s[20:23], s95 offen offset:0 sc1
    s_waitcnt lgkmcnt(6)
    v_mfma_f32_16x16x32_bf16 v[96:99], v[200:203], a[176:179], v[96:99]
    ds_read_b64_tr_b16 v[216:217], v37 offset:16384
    v_mfma_f32_16x16x32_bf16 v[100:103], v[200:203], a[180:183], v[100:103]
    ds_read_b64_tr_b16 v[218:219], v37 offset:20480
    v_mfma_f32_16x16x32_bf16 v[104:107], v[200:203], a[184:187], v[104:107]
    v_mfma_f32_16x16x32_bf16 v[108:111], v[200:203], a[188:191], v[108:111]
    s_waitcnt lgkmcnt(6)
    v_mfma_f32_16x16x32_bf16 v[112:115], v[204:207], a[176:179], v[112:115]
    ds_read_b64_tr_b16 v[220:221], v37 offset:16392
    v_mfma_f32_16x16x32_bf16 v[116:119], v[204:207], a[180:183], v[116:119]
    ds_read_b64_tr_b16 v[222:223], v37 offset:20488
    v_mfma_f32_16x16x32_bf16 v[120:123], v[204:207], a[184:187], v[120:123]
    v_mfma_f32_16x16x32_bf16 v[124:127], v[204:207], a[188:191], v[124:127]
    s_waitcnt lgkmcnt(6)
    v_mfma_f32_16x16x32_bf16 v[128:131], v[208:211], a[176:179], v[128:131]
    ds_read_b64_tr_b16 v[192:193], v34 offset:24576
    v_mfma_f32_16x16x32_bf16 v[132:135], v[208:211], a[180:183], v[132:135]
    ds_read_b64_tr_b16 v[194:195], v34 offset:28672
    v_mfma_f32_16x16x32_bf16 v[136:139], v[208:211], a[184:187], v[136:139]
    v_mfma_f32_16x16x32_bf16 v[140:143], v[208:211], a[188:191], v[140:143]
    s_waitcnt lgkmcnt(6)
    v_mfma_f32_16x16x32_bf16 v[144:147], v[212:215], a[176:179], v[144:147]
    ds_read_b64_tr_b16 v[196:197], v34 offset:24584
    v_mfma_f32_16x16x32_bf16 v[148:151], v[212:215], a[180:183], v[148:151]
    ds_read_b64_tr_b16 v[198:199], v34 offset:28680
    v_mfma_f32_16x16x32_bf16 v[152:155], v[212:215], a[184:187], v[152:155]
    v_mfma_f32_16x16x32_bf16 v[156:159], v[212:215], a[188:191], v[156:159]
    s_waitcnt lgkmcnt(6)
    v_mfma_f32_16x16x32_bf16 v[160:163], v[216:219], a[176:179], v[160:163]
    ds_read_b64_tr_b16 v[200:201], v35 offset:24576
    v_mfma_f32_16x16x32_bf16 v[164:167], v[216:219], a[180:183], v[164:167]
    ds_read_b64_tr_b16 v[202:203], v35 offset:28672
    v_mfma_f32_16x16x32_bf16 v[168:171], v[216:219], a[184:187], v[168:171]
    v_mfma_f32_16x16x32_bf16 v[172:175], v[216:219], a[188:191], v[172:175]
    s_waitcnt lgkmcnt(6)
    v_mfma_f32_16x16x32_bf16 v[176:179], v[220:223], a[176:179], v[176:179]
    ds_read_b64_tr_b16 v[204:205], v35 offset:24584
    v_mfma_f32_16x16x32_bf16 v[180:183], v[220:223], a[180:183], v[180:183]
    ds_read_b64_tr_b16 v[206:207], v35 offset:28680
    v_mfma_f32_16x16x32_bf16 v[184:187], v[220:223], a[184:187], v[184:187]
    v_mfma_f32_16x16x32_bf16 v[188:191], v[220:223], a[188:191], v[188:191]
    s_waitcnt vmcnt(43) lgkmcnt(6)
    v_mfma_f32_16x16x32_bf16 v[64:67], v[192:195], a[192:195], v[64:67]
    ds_read_b64_tr_b16 v[208:209], v36 offset:24576
    v_mfma_f32_16x16x32_bf16 v[68:71], v[192:195], a[196:199], v[68:71]
    ds_read_b64_tr_b16 v[210:211], v36 offset:28672
    v_mfma_f32_16x16x32_bf16 v[72:75], v[192:195], a[200:203], v[72:75]
    s_add_u32 s95, s93, 4
    s_sub_u32 s3, s95, 9
    s_cselect_b32 s95, s95, s3
    s_lshl_b32 s95, s95, 11
    buffer_load_dwordx4 a[176:179], v30, s[20:23], s95 offen offset:1024 sc1
    v_mfma_f32_16x16x32_bf16 v[76:79], v[192:195], a[204:207], v[76:79]
    buffer_load_dwordx4 a[180:183], v31, s[20:23], s95 offen offset:1024 sc1
    s_waitcnt lgkmcnt(6)
    v_mfma_f32_16x16x32_bf16 v[80:83], v[196:199], a[192:195], v[80:83]
    ds_read_b64_tr_b16 v[212:213], v36 offset:24584
    v_mfma_f32_16x16x32_bf16 v[84:87], v[196:199], a[196:199], v[84:87]
    ds_read_b64_tr_b16 v[214:215], v36 offset:28680
    v_mfma_f32_16x16x32_bf16 v[88:91], v[196:199], a[200:203], v[88:91]
    buffer_load_dwordx4 a[184:187], v32, s[20:23], s95 offen offset:1024 sc1
    v_mfma_f32_16x16x32_bf16 v[92:95], v[196:199], a[204:207], v[92:95]
    buffer_load_dwordx4 a[188:191], v33, s[20:23], s95 offen offset:1024 sc1
    s_waitcnt lgkmcnt(6)
    v_mfma_f32_16x16x32_bf16 v[96:99], v[200:203], a[192:195], v[96:99]
    ds_read_b64_tr_b16 v[216:217], v37 offset:24576
    v_mfma_f32_16x16x32_bf16 v[100:103], v[200:203], a[196:199], v[100:103]
    ds_read_b64_tr_b16 v[218:219], v37 offset:28672
    v_mfma_f32_16x16x32_bf16 v[104:107], v[200:203], a[200:203], v[104:107]
    v_mfma_f32_16x16x32_bf16 v[108:111], v[200:203], a[204:207], v[108:111]
    s_waitcnt lgkmcnt(6)
    v_mfma_f32_16x16x32_bf16 v[112:115], v[204:207], a[192:195], v[112:115]
    ds_read_b64_tr_b16 v[220:221], v37 offset:24584
    v_mfma_f32_16x16x32_bf16 v[116:119], v[204:207], a[196:199], v[116:119]
    ds_read_b64_tr_b16 v[222:223], v37 offset:28680
    v_mfma_f32_16x16x32_bf16 v[120:123], v[204:207], a[200:203], v[120:123]
    v_mfma_f32_16x16x32_bf16 v[124:127], v[204:207], a[204:207], v[124:127]
    s_waitcnt lgkmcnt(6)
    v_mfma_f32_16x16x32_bf16 v[128:131], v[208:211], a[192:195], v[128:131]
    s_waitcnt vmcnt(32)
    s_barrier
    s_cmp_lg_u32 s4, 0
    s_cbranch_scc1 L_fs_12
    s_lshl_b32 s3, s2, 7
    s_mov_b64 exec, 1
    v_mov_b32 v2, s62
    v_mov_b32 v3, s63
    v_mov_b32 v1, 0
    buffer_store_dwordx2 v[2:3], v1, s[44:47], s3 offen sc1
    s_mov_b64 exec, -1
L_fs_12:
    ds_read_b64_tr_b16 v[192:193], v34 offset:32768
    v_mfma_f32_16x16x32_bf16 v[132:135], v[208:211], a[196:199], v[132:135]
    ds_read_b64_tr_b16 v[194:195], v34 offset:36864
    v_mfma_f32_16x16x32_bf16 v[136:139], v[208:211], a[200:203], v[136:139]
    s_add_u32 s94, s93, 6
    s_sub_u32 s3, s94, 9
    s_cselect_b32 s94, s94, s3
    s_add_u32 m0, s100, 114688
    s_lshl_b32 s94, s94, 19
    buffer_load_dwordx4 v26, s[96:99], s94 offen offset:0 lds
    v_mfma_f32_16x16x32_bf16 v[140:143], v[208:211], a[204:207], v[140:143]
    buffer_load_dwordx4 v27, s[96:99], s94 offen offset:1024 lds
    s_waitcnt lgkmcnt(6)
    v_mfma_f32_16x16x32_bf16 v[144:147], v[212:215], a[192:195], v[144:147]
    ds_read_b64_tr_b16 v[196:197], v34 offset:32776
    v_mfma_f32_16x16x32_bf16 v[148:151], v[212:215], a[196:199], v[148:151]
    ds_read_b64_tr_b16 v[198:199], v34 offset:36872
    v_mfma_f32_16x16x32_bf16 v[152:155], v[212:215], a[200:203], v[152:155]
    buffer_load_dwordx4 v28, s[96:99], s94 offen offset:2048 lds
    v_mfma_f32_16x16x32_bf16 v[156:159], v[212:215], a[204:207], v[156:159]
    buffer_load_dwordx4 v29, s[96:99], s94 offen offset:3072 lds
    s_waitcnt lgkmcnt(6)
    v_mfma_f32_16x16x32_bf16 v[160:163], v[216:219], a[192:195], v[160:163]
    ds_read_b64_tr_b16 v[200:201], v35 offset:32768
    v_mfma_f32_16x16x32_bf16 v[164:167], v[216:219], a[196:199], v[164:167]
    ds_read_b64_tr_b16 v[202:203], v35 offset:36864
    v_mfma_f32_16x16x32_bf16 v[168:171], v[216:219], a[200:203], v[168:171]
    s_add_u32 m0, s32, 57344
    s_mov_b32 s30, 0
    buffer_load_dwordx4 v58, s[12:15], s30 offen lds
    v_mfma_f32_16x16x32_bf16 v[172:175], v[216:219], a[204:207], v[172:175]
    s_add_u32 m0, s32, 61440
    s_mov_b32 s30, 0
    buffer_load_dwordx4 v59, s[12:15], s30 offen lds
    s_waitcnt lgkmcnt(6)
    v_mfma_f32_16x16x32_bf16 v[176:179], v[220:223], a[192:195], v[176:179]
    ds_read_b64_tr_b16 v[204:205], v35 offset:32776
    v_mfma_f32_16x16x32_bf16 v[180:183], v[220:223], a[196:199], v[180:183]
    ds_read_b64_tr_b16 v[206:207], v35 offset:36872
    v_mfma_f32_16x16x32_bf16 v[184:187], v[220:223], a[200:203], v[184:187]
    s_add_u32 m0, s32, 65536
    s_mov_b32 s30, 0
    buffer_load_dwordx4 v60, s[12:15], s30 offen lds
    v_mfma_f32_16x16x32_bf16 v[188:191], v[220:223], a[204:207], v[188:191]
    s_add_u32 m0, s32, 69632
    s_mov_b32 s30, 147456
    buffer_load_dwordx4 v58, s[12:15], s30 offen lds
    s_waitcnt vmcnt(63) lgkmcnt(6)
    v_mfma_f32_16x16x32_bf16 v[64:67], v[192:195], a[208:211], v[64:67]
    ds_read_b64_tr_b16 v[208:209], v36 offset:32768
    v_mfma_f32_16x16x32_bf16 v[68:71], v[192:195], a[212:215], v[68:71]
    ds_read_b64_tr_b16 v[210:211], v36 offset:36864
    v_mfma_f32_16x16x32_bf16 v[72:75], v[192:195], a[216:219], v[72:75]
    s_add_u32 s95, s93, 5
    s_sub_u32 s3, s95, 9
    s_cselect_b32 s95, s95, s3
    s_lshl_b32 s95, s95, 11
    buffer_load_dwordx4 a[192:195], v30, s[20:23], s95 offen offset:0 sc1
    v_mfma_f32_16x16x32_bf16 v[76:79], v[192:195], a[220:223], v[76:79]
    buffer_load_dwordx4 a[196:199], v31, s[20:23], s95 offen offset:0 sc1
    s_waitcnt lgkmcnt(6)
    v_mfma_f32_16x16x32_bf16 v[80:83], v[196:199], a[208:211], v[80:83]
    ds_read_b64_tr_b16 v[212:213], v36 offset:32776
    v_mfma_f32_16x16x32_bf16 v[84:87], v[196:199], a[212:215], v[84:87]
    ds_read_b64_tr_b16 v[214:215], v36 offset:36872
    v_mfma_f32_16x16x32_bf16 v[88:91], v[196:199], a[216:219], v[88:91]
    buffer_load_dwordx4 a[200:203], v32, s[20:23], s95 offen offset:0 sc1
    v_mfma_f32_16x16x32_bf16 v[92:95], v[196:199], a[220:223], v[92:95]
    buffer_load_dwordx4 a[204:207], v33, s[20:23], s95 offen offset:0 sc1
    s_waitcnt lgkmcnt(6)
    v_mfma_f32_16x16x32_bf16 v[96:99], v[200:203], a[208:211], v[96:99]
    ds_read_b64_tr_b16 v[216:217], v37 offset:32768
    v_mfma_f32_16x16x32_bf16 v[100:103], v[200:203], a[212:215], v[100:103]
    ds_read_b64_tr_b16 v[218:219], v37 offset:36864
    v_mfma_f32_16x16x32_bf16 v[104:107], v[200:203], a[216:219], v[104:107]
    s_add_u32 m0, s32, 73728
    s_mov_b32 s30, 147456
    buffer_load_dwordx4 v59, s[12:15], s30 offen lds
    v_mfma_f32_16x16x32_bf16 v[108:111], v[200:203], a[220:223], v[108:111]
    s_add_u32 m0, s32, 77824
    s_mov_b32 s30, 147456
    buffer_load_dwordx4 v60, s[12:15], s30 offen lds
    s_waitcnt lgkmcnt(6)
    v_mfma_f32_16x16x32_bf16 v[112:115], v[204:207], a[208:211], v[112:115]
    ds_read_b64_tr_b16 v[220:221], v37 offset:32776
    v_mfma_f32_16x16x32_bf16 v[116:119], v[204:207], a[212:215], v[116:119]
    ds_read_b64_tr_b16 v[222:223], v37 offset:36872
    v_mfma_f32_16x16x32_bf16 v[120:123], v[204:207], a[216:219], v[120:123]
    s_add_u32 m0, s32, 81920
    s_mov_b32 s30, 294912
    buffer_load_dwordx4 v58, s[12:15], s30 offen lds
    v_mfma_f32_16x16x32_bf16 v[124:127], v[204:207], a[220:223], v[124:127]
    s_add_u32 m0, s32, 86016
    s_mov_b32 s30, 294912
    buffer_load_dwordx4 v59, s[12:15], s30 offen lds
    s_waitcnt lgkmcnt(6)
    v_mfma_f32_16x16x32_bf16 v[128:131], v[208:211], a[208:211], v[128:131]
    ds_read_b64_tr_b16 v[192:193], v34 offset:40960
    v_mfma_f32_16x16x32_bf16 v[132:135], v[208:211], a[212:215], v[132:135]
    ds_read_b64_tr_b16 v[194:195], v34 offset:45056
    v_mfma_f32_16x16x32_bf16 v[136:139], v[208:211], a[216:219], v[136:139]
    s_add_u32 m0, s32, 90112
    s_mov_b32 s30, 294912
    buffer_load_dwordx4 v60, s[12:15], s30 offen lds
    v_mfma_f32_16x16x32_bf16 v[140:143], v[208:211], a[220:223], v[140:143]
    s_add_u32 m0, s32, 94208
    s_mov_b32 s30, 442368
    buffer_load_dwordx4 v58, s[12:15], s30 offen lds
    s_waitcnt lgkmcnt(6)
    v_mfma_f32_16x16x32_bf16 v[144:147], v[212:215], a[208:211], v[144:147]
    ds_read_b64_tr_b16 v[196:197], v34 offset:40968
    v_mfma_f32_16x16x32_bf16 v[148:151], v[212:215], a[212:215], v[148:151]
    ds_read_b64_tr_b16 v[198:199], v34 offset:45064
    v_mfma_f32_16x16x32_bf16 v[152:155], v[212:215], a[216:219], v[152:155]
    s_add_u32 m0, s32, 98304
    s_mov_b32 s30, 442368
    buffer_load_dwordx4 v59, s[12:15], s30 offen lds
    v_mfma_f32_16x16x32_bf16 v[156:159], v[212:215], a[220:223], v[156:159]
    s_add_u32 m0, s32, 102400
    s_mov_b32 s30, 442368
    buffer_load_dwordx4 v60, s[12:15], s30 offen lds
    s_waitcnt lgkmcnt(6)
    v_mfma_f32_16x16x32_bf16 v[160:163], v[216:219], a[208:211], v[160:163]
    ds_read_b64_tr_b16 v[200:201], v35 offset:40960
    v_mfma_f32_16x16x32_bf16 v[164:167], v[216:219], a[212:215], v[164:167]
    ds_read_b64_tr_b16 v[202:203], v35 offset:45056
    v_mfma_f32_16x16x32_bf16 v[168:171], v[216:219], a[216:219], v[168:171]
    s_add_u32 m0, s32, 106496
    s_mov_b32 s30, 589824
    buffer_load_dwordx4 v58, s[12:15], s30 offen lds
    v_mfma_f32_16x16x32_bf16 v[172:175], v[216:219], a[220:223], v[172:175]
    s_add_u32 m0, s32, 110592
    s_mov_b32 s30, 589824
    buffer_load_dwordx4 v59, s[12:15], s30 offen lds
    s_waitcnt lgkmcnt(6)
    v_mfma_f32_16x16x32_bf16 v[176:179], v[220:223], a[208:211], v[176:179]
    ds_read_b64_tr_b16 v[204:205], v35 offset:40968
    v_mfma_f32_16x16x32_bf16 v[180:183], v[220:223], a[212:215], v[180:183]
    ds_read_b64_tr_b16 v[206:207], v35 offset:45064
    v_mfma_f32_16x16x32_bf16 v[184:187], v[220:223], a[216:219], v[184:187]
    v_mfma_f32_16x16x32_bf16 v[188:191], v[220:223], a[220:223], v[188:191]
    s_waitcnt vmcnt(63) lgkmcnt(6)
    v_mfma_f32_16x16x32_bf16 v[64:67], v[192:195], a[224:227], v[64:67]
    ds_read_b64_tr_b16 v[208:209], v36 offset:40960
    v_mfma_f32_16x16x32_bf16 v[68:71], v[192:195], a[228:231], v[68:71]
    ds_read_b64_tr_b16 v[210:211], v36 offset:45056
    v_mfma_f32_16x16x32_bf16 v[72:75], v[192:195], a[232:235], v[72:75]
    s_add_u32 s95, s93, 5
    s_sub_u32 s3, s95, 9
    s_cselect_b32 s95, s95, s3
    s_lshl_b32 s95, s95, 11
    buffer_load_dwordx4 a[208:211], v30, s[20:23], s95 offen offset:1024 sc1
    v_mfma_f32_16x16x32_bf16 v[76:79], v[192:195], a[236:239], v[76:79]
    buffer_load_dwordx4 a[212:215], v31, s[20:23], s95 offen offset:1024 sc1
    s_waitcnt lgkmcnt(6)
    v_mfma_f32_16x16x32_bf16 v[80:83], v[196:199], a[224:227], v[80:83]
    ds_read_b64_tr_b16 v[212:213], v36 offset:40968
    v_mfma_f32_16x16x32_bf16 v[84:87], v[196:199], a[228:231], v[84:87]
    ds_read_b64_tr_b16 v[214:215], v36 offset:45064
    v_mfma_f32_16x16x32_bf16 v[88:91], v[196:199], a[232:235], v[88:91]
    buffer_load_dwordx4 a[216:219], v32, s[20:23], s95 offen offset:1024 sc1
    v_mfma_f32_16x16x32_bf16 v[92:95], v[196:199], a[236:239], v[92:95]
    buffer_load_dwordx4 a[220:223], v33, s[20:23], s95 offen offset:1024 sc1
    s_waitcnt lgkmcnt(6)
    v_mfma_f32_16x16x32_bf16 v[96:99], v[200:203], a[224:227], v[96:99]
    ds_read_b64_tr_b16 v[216:217], v37 offset:40960
    v_mfma_f32_16x16x32_bf16 v[100:103], v[200:203], a[228:231], v[100:103]
    ds_read_b64_tr_b16 v[218:219], v37 offset:45056
    v_mfma_f32_16x16x32_bf16 v[104:107], v[200:203], a[232:235], v[104:107]
    v_mfma_f32_16x16x32_bf16 v[108:111], v[200:203], a[236:239], v[108:111]
    s_waitcnt lgkmcnt(6)
    v_mfma_f32_16x16x32_bf16 v[112:115], v[204:207], a[224:227], v[112:115]
    ds_read_b64_tr_b16 v[220:221], v37 offset:40968
    v_mfma_f32_16x16x32_bf16 v[116:119], v[204:207], a[228:231], v[116:119]
    ds_read_b64_tr_b16 v[222:223], v37 offset:45064
    v_mfma_f32_16x16x32_bf16 v[120:123], v[204:207], a[232:235], v[120:123]
    v_mfma_f32_16x16x32_bf16 v[124:127], v[204:207], a[236:239], v[124:127]
    s_waitcnt lgkmcnt(6)
    v_mfma_f32_16x16x32_bf16 v[128:131], v[208:211], a[224:227], v[128:131]
    s_waitcnt vmcnt(54)
    s_barrier
    ds_read_b64_tr_b16 v[192:193], v38 offset:0
    v_mfma_f32_16x16x32_bf16 v[132:135], v[208:211], a[228:231], v[132:135]
    ds_read_b64_tr_b16 v[194:195], v38 offset:4096
    v_mfma_f32_16x16x32_bf16 v[136:139], v[208:211], a[232:235], v[136:139]
    s_add_u32 s94, s93, 7
    s_sub_u32 s3, s94, 9
    s_cselect_b32 s94, s94, s3
    s_add_u32 m0, s100, 131072
    s_lshl_b32 s94, s94, 19
    buffer_load_dwordx4 v26, s[96:99], s94 offen offset:0 lds
    v_mfma_f32_16x16x32_bf16 v[140:143], v[208:211], a[236:239], v[140:143]
    buffer_load_dwordx4 v27, s[96:99], s94 offen offset:1024 lds
    s_waitcnt lgkmcnt(6)
    v_mfma_f32_16x16x32_bf16 v[144:147], v[212:215], a[224:227], v[144:147]
    ds_read_b64_tr_b16 v[196:197], v38 offset:8
    v_mfma_f32_16x16x32_bf16 v[148:151], v[212:215], a[228:231], v[148:151]
    ds_read_b64_tr_b16 v[198:199], v38 offset:4104
    v_mfma_f32_16x16x32_bf16 v[152:155], v[212:215], a[232:235], v[152:155]
    buffer_load_dwordx4 v28, s[96:99], s94 offen offset:2048 lds
    v_mfma_f32_16x16x32_bf16 v[156:159], v[212:215], a[236:239], v[156:159]
    buffer_load_dwordx4 v29, s[96:99], s94 offen offset:3072 lds
    s_waitcnt lgkmcnt(6)
    v_mfma_f32_16x16x32_bf16 v[160:163], v[216:219], a[224:227], v[160:163]
    ds_read_b64_tr_b16 v[200:201], v39 offset:0
    v_mfma_f32_16x16x32_bf16 v[164:167], v[216:219], a[228:231], v[164:167]
    ds_read_b64_tr_b16 v[202:203], v39 offset:4096
    v_mfma_f32_16x16x32_bf16 v[168:171], v[216:219], a[232:235], v[168:171]
    v_mfma_f32_16x16x32_bf16 v[172:175], v[216:219], a[236:239], v[172:175]
    s_waitcnt lgkmcnt(6)
    v_mfma_f32_16x16x32_bf16 v[176:179], v[220:223], a[224:227], v[176:179]
    ds_read_b64_tr_b16 v[204:205], v39 offset:8
    v_mfma_f32_16x16x32_bf16 v[180:183], v[220:223], a[228:231], v[180:183]
    ds_read_b64_tr_b16 v[206:207], v39 offset:4104
    v_mfma_f32_16x16x32_bf16 v[184:187], v[220:223], a[232:235], v[184:187]
    v_mfma_f32_16x16x32_bf16 v[188:191], v[220:223], a[236:239], v[188:191]
    s_mov_b32 s5, 0
    buffer_load_dwordx2 v[24:25], v23, s[44:47], s5 offen sc1
    s_waitcnt vmcnt(63) lgkmcnt(6)
    v_mfma_f32_16x16x32_bf16 v[64:67], v[192:195], a[240:243], v[64:67]
    ds_read_b64_tr_b16 v[208:209], v40 offset:0
    v_mfma_f32_16x16x32_bf16 v[68:71], v[192:195], a[244:247], v[68:71]
    ds_read_b64_tr_b16 v[210:211], v40 offset:4096
    v_mfma_f32_16x16x32_bf16 v[72:75], v[192:195], a[248:251], v[72:75]
    s_add_u32 s95, s93, 6
    s_sub_u32 s3, s95, 9
    s_cselect_b32 s95, s95, s3
    s_lshl_b32 s95, s95, 11
    buffer_load_dwordx4 a[224:227], v30, s[20:23], s95 offen offset:0 sc1
    v_mfma_f32_16x16x32_bf16 v[76:79], v[192:195], a[252:255], v[76:79]
    buffer_load_dwordx4 a[228:231], v31, s[20:23], s95 offen offset:0 sc1
    s_waitcnt lgkmcnt(6)
    v_mfma_f32_16x16x32_bf16 v[80:83], v[196:199], a[240:243], v[80:83]
    ds_read_b64_tr_b16 v[212:213], v40 offset:8
    v_mfma_f32_16x16x32_bf16 v[84:87], v[196:199], a[244:247], v[84:87]
    ds_read_b64_tr_b16 v[214:215], v40 offset:4104
    v_mfma_f32_16x16x32_bf16 v[88:91], v[196:199], a[248:251], v[88:91]
    buffer_load_dwordx4 a[232:235], v32, s[20:23], s95 offen offset:0 sc1
    v_mfma_f32_16x16x32_bf16 v[92:95], v[196:199], a[252:255], v[92:95]
    s_waitcnt vmcnt(54)
    buffer_load_dwordx4 a[236:239], v33, s[20:23], s95 offen offset:0 sc1
    s_waitcnt lgkmcnt(6)
    v_mfma_f32_16x16x32_bf16 v[96:99], v[200:203], a[240:243], v[96:99]
    ds_read_b64_tr_b16 v[216:217], v41 offset:0
    v_mfma_f32_16x16x32_bf16 v[100:103], v[200:203], a[244:247], v[100:103]
    ds_read_b64_tr_b16 v[218:219], v41 offset:4096
    v_mfma_f32_16x16x32_bf16 v[104:107], v[200:203], a[248:251], v[104:107]
    v_mfma_f32_16x16x32_bf16 v[108:111], v[200:203], a[252:255], v[108:111]
    s_waitcnt lgkmcnt(6)
    v_mfma_f32_16x16x32_bf16 v[112:115], v[204:207], a[240:243], v[112:115]
    ds_read_b64_tr_b16 v[220:221], v41 offset:8
    v_mfma_f32_16x16x32_bf16 v[116:119], v[204:207], a[244:247], v[116:119]
    ds_read_b64_tr_b16 v[222:223], v41 offset:4104
    v_mfma_f32_16x16x32_bf16 v[120:123], v[204:207], a[248:251], v[120:123]
    v_mfma_f32_16x16x32_bf16 v[124:127], v[204:207], a[252:255], v[124:127]
    s_waitcnt lgkmcnt(6)
    v_mfma_f32_16x16x32_bf16 v[128:131], v[208:211], a[240:243], v[128:131]
    ds_read_b64_tr_b16 v[192:193], v38 offset:8192
    v_mfma_f32_16x16x32_bf16 v[132:135], v[208:211], a[244:247], v[132:135]
    ds_read_b64_tr_b16 v[194:195], v38 offset:12288
    v_mfma_f32_16x16x32_bf16 v[136:139], v[208:211], a[248:251], v[136:139]
    v_mfma_f32_16x16x32_bf16 v[140:143], v[208:211], a[252:255], v[140:143]
    s_waitcnt lgkmcnt(6)
    v_mfma_f32_16x16x32_bf16 v[144:147], v[212:215], a[240:243], v[144:147]
    ds_read_b64_tr_b16 v[196:197], v38 offset:8200
    v_mfma_f32_16x16x32_bf16 v[148:151], v[212:215], a[244:247], v[148:151]
    ds_read_b64_tr_b16 v[198:199], v38 offset:12296
    v_mfma_f32_16x16x32_bf16 v[152:155], v[212:215], a[248:251], v[152:155]
    v_mfma_f32_16x16x32_bf16 v[156:159], v[212:215], a[252:255], v[156:159]
    s_waitcnt lgkmcnt(6)
    v_mfma_f32_16x16x32_bf16 v[160:163], v[216:219], a[240:243], v[160:163]
    ds_read_b64_tr_b16 v[200:201], v39 offset:8192
    v_mfma_f32_16x16x32_bf16 v[164:167], v[216:219], a[244:247], v[164:167]
    ds_read_b64_tr_b16 v[202:203], v39 offset:12288
    v_mfma_f32_16x16x32_bf16 v[168:171], v[216:219], a[248:251], v[168:171]
    v_mfma_f32_16x16x32_bf16 v[172:175], v[216:219], a[252:255], v[172:175]
    s_waitcnt lgkmcnt(6)
    v_mfma_f32_16x16x32_bf16 v[176:179], v[220:223], a[240:243], v[176:179]
    ds_read_b64_tr_b16 v[204:205], v39 offset:8200
    v_mfma_f32_16x16x32_bf16 v[180:183], v[220:223], a[244:247], v[180:183]
    ds_read_b64_tr_b16 v[206:207], v39 offset:12296
    v_mfma_f32_16x16x32_bf16 v[184:187], v[220:223], a[248:251], v[184:187]
    v_mfma_f32_16x16x32_bf16 v[188:191], v[220:223], a[252:255], v[188:191]
    s_waitcnt vmcnt(4)
    v_cmp_eq_u64 vcc, s[62:63], v[24:25]
    s_nop 1
    s_cmp_eq_u64 vcc, exec
    s_cbranch_scc1 L_pk_13
    s_mov_b32 s3, 0x40000
    s_mov_b32 s5, 0
L_fw_14:
    buffer_load_dwordx2 v[24:25], v23, s[44:47], s5 offen sc1
    s_sub_u32 s3, s3, 1
    s_cbranch_scc1 L_fd_15
    s_waitcnt vmcnt(0)
    v_cmp_eq_u64 vcc, s[62:63], v[24:25]
    s_nop 1
    s_cmp_eq_u64 vcc, exec
    s_cbranch_scc0 L_fw_14
L_fd_15:
    s_waitcnt vmcnt(0)
L_pk_13:
    s_waitcnt vmcnt(63) lgkmcnt(6)
    v_mfma_f32_16x16x32_bf16 v[64:67], v[192:195], a[144:147], v[64:67]
    ds_read_b64_tr_b16 v[208:209], v40 offset:8192
    v_mfma_f32_16x16x32_bf16 v[68:71], v[192:195], a[148:151], v[68:71]
    ds_read_b64_tr_b16 v[210:211], v40 offset:12288
    v_mfma_f32_16x16x32_bf16 v[72:75], v[192:195], a[152:155], v[72:75]
    s_add_u32 s95, s93, 6
    s_sub_u32 s3, s95, 9
    s_cselect_b32 s95, s95, s3
    s_lshl_b32 s95, s95, 11
    buffer_load_dwordx4 a[240:243], v30, s[20:23], s95 offen offset:1024 sc1
    v_mfma_f32_16x16x32_bf16 v[76:79], v[192:195], a[156:159], v[76:79]
    buffer_load_dwordx4 a[244:247], v31, s[20:23], s95 offen offset:1024 sc1
    s_waitcnt lgkmcnt(6)
    v_mfma_f32_16x16x32_bf16 v[80:83], v[196:199], a[144:147], v[80:83]
    ds_read_b64_tr_b16 v[212:213], v40 offset:8200
    v_mfma_f32_16x16x32_bf16 v[84:87], v[196:199], a[148:151], v[84:87]
    ds_read_b64_tr_b16 v[214:215], v40 offset:12296
    v_mfma_f32_16x16x32_bf16 v[88:91], v[196:199], a[152:155], v[88:91]
    buffer_load_dwordx4 a[248:251], v32, s[20:23], s95 offen offset:1024 sc1
    v_mfma_f32_16x16x32_bf16 v[92:95], v[196:199], a[156:159], v[92:95]
    buffer_load_dwordx4 a[252:255], v33, s[20:23], s95 offen offset:1024 sc1
    s_waitcnt lgkmcnt(6)
    v_mfma_f32_16x16x32_bf16 v[96:99], v[200:203], a[144:147], v[96:99]
    ds_read_b64_tr_b16 v[216:217], v41 offset:8192
    v_mfma_f32_16x16x32_bf16 v[100:103], v[200:203], a[148:151], v[100:103]
    ds_read_b64_tr_b16 v[218:219], v41 offset:12288
    v_mfma_f32_16x16x32_bf16 v[104:107], v[200:203], a[152:155], v[104:107]
    s_mov_b32 s31, 0
    buffer_load_dwordx4 a[0:3], v11, s[24:27], s31 offen offset:0 sc1
    v_mfma_f32_16x16x32_bf16 v[108:111], v[200:203], a[156:159], v[108:111]
    buffer_load_dwordx4 a[4:7], v12, s[24:27], s31 offen offset:0 sc1
    s_waitcnt lgkmcnt(6)
    v_mfma_f32_16x16x32_bf16 v[112:115], v[204:207], a[144:147], v[112:115]
    ds_read_b64_tr_b16 v[220:221], v41 offset:8200
    v_mfma_f32_16x16x32_bf16 v[116:119], v[204:207], a[148:151], v[116:119]
    ds_read_b64_tr_b16 v[222:223], v41 offset:12296
    v_mfma_f32_16x16x32_bf16 v[120:123], v[204:207], a[152:155], v[120:123]
    s_mov_b32 s31, 0
    buffer_load_dwordx4 a[8:11], v11, s[24:27], s31 offen offset:1024 sc1
    v_mfma_f32_16x16x32_bf16 v[124:127], v[204:207], a[156:159], v[124:127]
    buffer_load_dwordx4 a[12:15], v12, s[24:27], s31 offen offset:1024 sc1
    s_waitcnt lgkmcnt(6)
    v_mfma_f32_16x16x32_bf16 v[128:131], v[208:211], a[144:147], v[128:131]
    s_waitcnt vmcnt(63)
    s_barrier
    ds_read_b64_tr_b16 v[192:193], v38 offset:16384
    v_mfma_f32_16x16x32_bf16 v[132:135], v[208:211], a[148:151], v[132:135]
    ds_read_b64_tr_b16 v[194:195], v38 offset:20480
    v_mfma_f32_16x16x32_bf16 v[136:139], v[208:211], a[152:155], v[136:139]
    s_mov_b32 s31, 0
    buffer_load_dwordx4 a[16:19], v11, s[24:27], s31 offen offset:2048 sc1
    v_mfma_f32_16x16x32_bf16 v[140:143], v[208:211], a[156:159], v[140:143]
    buffer_load_dwordx4 a[20:23], v12, s[24:27], s31 offen offset:2048 sc1
    s_waitcnt lgkmcnt(6)
    v_mfma_f32_16x16x32_bf16 v[144:147], v[212:215], a[144:147], v[144:147]
    ds_read_b64_tr_b16 v[196:197], v38 offset:16392
    v_mfma_f32_16x16x32_bf16 v[148:151], v[212:215], a[148:151], v[148:151]
    ds_read_b64_tr_b16 v[198:199], v38 offset:20488
    v_mfma_f32_16x16x32_bf16 v[152:155], v[212:215], a[152:155], v[152:155]
    s_mov_b32 s31, 0
    buffer_load_dwordx4 a[24:27], v11, s[24:27], s31 offen offset:3072 sc1
    v_mfma_f32_16x16x32_bf16 v[156:159], v[212:215], a[156:159], v[156:159]
    buffer_load_dwordx4 a[28:31], v12, s[24:27], s31 offen offset:3072 sc1
    s_waitcnt lgkmcnt(6)
    v_mfma_f32_16x16x32_bf16 v[160:163], v[216:219], a[144:147], v[160:163]
    ds_read_b64_tr_b16 v[200:201], v39 offset:16384
    v_mfma_f32_16x16x32_bf16 v[164:167], v[216:219], a[148:151], v[164:167]
    ds_read_b64_tr_b16 v[202:203], v39 offset:20480
    v_mfma_f32_16x16x32_bf16 v[168:171], v[216:219], a[152:155], v[168:171]
    s_mov_b32 s31, 4096
    buffer_load_dwordx4 a[32:35], v11, s[24:27], s31 offen offset:0 sc1
    v_mfma_f32_16x16x32_bf16 v[172:175], v[216:219], a[156:159], v[172:175]
    buffer_load_dwordx4 a[36:39], v12, s[24:27], s31 offen offset:0 sc1
    s_waitcnt lgkmcnt(6)
    v_mfma_f32_16x16x32_bf16 v[176:179], v[220:223], a[144:147], v[176:179]
    ds_read_b64_tr_b16 v[204:205], v39 offset:16392
    v_mfma_f32_16x16x32_bf16 v[180:183], v[220:223], a[148:151], v[180:183]
    ds_read_b64_tr_b16 v[206:207], v39 offset:20488
    v_mfma_f32_16x16x32_bf16 v[184:187], v[220:223], a[152:155], v[184:187]
    s_mov_b32 s31, 4096
    buffer_load_dwordx4 a[40:43], v11, s[24:27], s31 offen offset:1024 sc1
    v_mfma_f32_16x16x32_bf16 v[188:191], v[220:223], a[156:159], v[188:191]
    buffer_load_dwordx4 a[44:47], v12, s[24:27], s31 offen offset:1024 sc1
    s_waitcnt vmcnt(63) lgkmcnt(6)
    v_mfma_f32_16x16x32_bf16 v[64:67], v[192:195], a[160:163], v[64:67]
    ds_read_b64_tr_b16 v[208:209], v40 offset:16384
    v_mfma_f32_16x16x32_bf16 v[68:71], v[192:195], a[164:167], v[68:71]
    ds_read_b64_tr_b16 v[210:211], v40 offset:20480
    v_mfma_f32_16x16x32_bf16 v[72:75], v[192:195], a[168:171], v[72:75]
    s_add_u32 s95, s93, 7
    s_sub_u32 s3, s95, 9
    s_cselect_b32 s95, s95, s3
    s_lshl_b32 s95, s95, 11
    buffer_load_dwordx4 a[144:147], v30, s[20:23], s95 offen offset:0 sc1
    v_mfma_f32_16x16x32_bf16 v[76:79], v[192:195], a[172:175], v[76:79]
    buffer_load_dwordx4 a[148:151], v31, s[20:23], s95 offen offset:0 sc1
    s_waitcnt lgkmcnt(6)
    v_mfma_f32_16x16x32_bf16 v[80:83], v[196:199], a[160:163], v[80:83]
    ds_read_b64_tr_b16 v[212:213], v40 offset:16392
    v_mfma_f32_16x16x32_bf16 v[84:87], v[196:199], a[164:167], v[84:87]
    ds_read_b64_tr_b16 v[214:215], v40 offset:20488
    v_mfma_f32_16x16x32_bf16 v[88:91], v[196:199], a[168:171], v[88:91]
    buffer_load_dwordx4 a[152:155], v32, s[20:23], s95 offen offset:0 sc1
    v_mfma_f32_16x16x32_bf16 v[92:95], v[196:199], a[172:175], v[92:95]
    buffer_load_dwordx4 a[156:159], v33, s[20:23], s95 offen offset:0 sc1
    s_waitcnt lgkmcnt(6)
    v_mfma_f32_16x16x32_bf16 v[96:99], v[200:203], a[160:163], v[96:99]
    ds_read_b64_tr_b16 v[216:217], v41 offset:16384
    v_mfma_f32_16x16x32_bf16 v[100:103], v[200:203], a[164:167], v[100:103]
    ds_read_b64_tr_b16 v[218:219], v41 offset:20480
    v_mfma_f32_16x16x32_bf16 v[104:107], v[200:203], a[168:171], v[104:107]
    s_mov_b32 s31, 4096
    buffer_load_dwordx4 a[48:51], v11, s[24:27], s31 offen offset:2048 sc1
    v_mfma_f32_16x16x32_bf16 v[108:111], v[200:203], a[172:175], v[108:111]
    buffer_load_dwordx4 a[52:55], v12, s[24:27], s31 offen offset:2048 sc1
    s_waitcnt lgkmcnt(6)
    v_mfma_f32_16x16x32_bf16 v[112:115], v[204:207], a[160:163], v[112:115]
    ds_read_b64_tr_b16 v[220:221], v41 offset:16392
    v_mfma_f32_16x16x32_bf16 v[116:119], v[204:207], a[164:167], v[116:119]
    ds_read_b64_tr_b16 v[222:223], v41 offset:20488
    v_mfma_f32_16x16x32_bf16 v[120:123], v[204:207], a[168:171], v[120:123]
    s_mov_b32 s31, 4096
    buffer_load_dwordx4 a[56:59], v11, s[24:27], s31 offen offset:3072 sc1
    v_mfma_f32_16x16x32_bf16 v[124:127], v[204:207], a[172:175], v[124:127]
    buffer_load_dwordx4 a[60:63], v12, s[24:27], s31 offen offset:3072 sc1
    s_waitcnt lgkmcnt(6)
    v_mfma_f32_16x16x32_bf16 v[128:131], v[208:211], a[160:163], v[128:131]
    ds_read_b64_tr_b16 v[192:193], v38 offset:24576
    v_mfma_f32_16x16x32_bf16 v[132:135], v[208:211], a[164:167], v[132:135]
    ds_read_b64_tr_b16 v[194:195], v38 offset:28672
    v_mfma_f32_16x16x32_bf16 v[136:139], v[208:211], a[168:171], v[136:139]
    s_mov_b32 s31, 8192
    buffer_load_dwordx4 a[64:67], v11, s[24:27], s31 offen offset:0 sc1
    v_mfma_f32_16x16x32_bf16 v[140:143], v[208:211], a[172:175], v[140:143]
    buffer_load_dwordx4 a[68:71], v12, s[24:27], s31 offen offset:0 sc1
    s_waitcnt lgkmcnt(6)
    v_mfma_f32_16x16x32_bf16 v[144:147], v[212:215], a[160:163], v[144:147]
    ds_read_b64_tr_b16 v[196:197], v38 offset:24584
    v_mfma_f32_16x16x32_bf16 v[148:151], v[212:215], a[164:167], v[148:151]
    ds_read_b64_tr_b16 v[198:199], v38 offset:28680
    v_mfma_f32_16x16x32_bf16 v[152:155], v[212:215], a[168:171], v[152:155]
    s_mov_b32 s31, 8192
    buffer_load_dwordx4 a[72:75], v11, s[24:27], s31 offen offset:1024 sc1
    v_mfma_f32_16x16x32_bf16 v[156:159], v[212:215], a[172:175], v[156:159]
    buffer_load_dwordx4 a[76:79], v12, s[24:27], s31 offen offset:1024 sc1
    s_waitcnt lgkmcnt(6)
    v_mfma_f32_16x16x32_bf16 v[160:163], v[216:219], a[160:163], v[160:163]
    ds_read_b64_tr_b16 v[200:201], v39 offset:24576
    v_mfma_f32_16x16x32_bf16 v[164:167], v[216:219], a[164:167], v[164:167]
    ds_read_b64_tr_b16 v[202:203], v39 offset:28672
    v_mfma_f32_16x16x32_bf16 v[168:171], v[216:219], a[168:171], v[168:171]
    s_mov_b32 s31, 8192
    buffer_load_dwordx4 a[80:83], v11, s[24:27], s31 offen offset:2048 sc1
    v_mfma_f32_16x16x32_bf16 v[172:175], v[216:219], a[172:175], v[172:175]
    buffer_load_dwordx4 a[84:87], v12, s[24:27], s31 offen offset:2048 sc1
    s_waitcnt lgkmcnt(6)
    v_mfma_f32_16x16x32_bf16 v[176:179], v[220:223], a[160:163], v[176:179]
    ds_read_b64_tr_b16 v[204:205], v39 offset:24584
    v_mfma_f32_16x16x32_bf16 v[180:183], v[220:223], a[164:167], v[180:183]
    ds_read_b64_tr_b16 v[206:207], v39 offset:28680
    v_mfma_f32_16x16x32_bf16 v[184:187], v[220:223], a[168:171], v[184:187]
    s_mov_b32 s31, 8192
    buffer_load_dwordx4 a[88:91], v11, s[24:27], s31 offen offset:3072 sc1
    v_mfma_f32_16x16x32_bf16 v[188:191], v[220:223], a[172:175], v[188:191]
    buffer_load_dwordx4 a[92:95], v12, s[24:27], s31 offen offset:3072 sc1
    s_waitcnt vmcnt(63) lgkmcnt(6)
    v_mfma_f32_16x16x32_bf16 v[64:67], v[192:195], a[176:179], v[64:67]
    ds_read_b64_tr_b16 v[208:209], v40 offset:24576
    v_mfma_f32_16x16x32_bf16 v[68:71], v[192:195], a[180:183], v[68:71]
    ds_read_b64_tr_b16 v[210:211], v40 offset:28672
    v_mfma_f32_16x16x32_bf16 v[72:75], v[192:195], a[184:187], v[72:75]
    s_add_u32 s95, s93, 7
    s_sub_u32 s3, s95, 9
    s_cselect_b32 s95, s95, s3
    s_lshl_b32 s95, s95, 11
    buffer_load_dwordx4 a[160:163], v30, s[20:23], s95 offen offset:1024 sc1
    v_mfma_f32_16x16x32_bf16 v[76:79], v[192:195], a[188:191], v[76:79]
    buffer_load_dwordx4 a[164:167], v31, s[20:23], s95 offen offset:1024 sc1
    s_waitcnt lgkmcnt(6)
    v_mfma_f32_16x16x32_bf16 v[80:83], v[196:199], a[176:179], v[80:83]
    ds_read_b64_tr_b16 v[212:213], v40 offset:24584
    v_mfma_f32_16x16x32_bf16 v[84:87], v[196:199], a[180:183], v[84:87]
    ds_read_b64_tr_b16 v[214:215], v40 offset:28680
    v_mfma_f32_16x16x32_bf16 v[88:91], v[196:199], a[184:187], v[88:91]
    buffer_load_dwordx4 a[168:171], v32, s[20:23], s95 offen offset:1024 sc1
    v_mfma_f32_16x16x32_bf16 v[92:95], v[196:199], a[188:191], v[92:95]
    buffer_load_dwordx4 a[172:175], v33, s[20:23], s95 offen offset:1024 sc1
    s_waitcnt lgkmcnt(6)
    v_mfma_f32_16x16x32_bf16 v[96:99], v[200:203], a[176:179], v[96:99]
    ds_read_b64_tr_b16 v[216:217], v41 offset:24576
    v_mfma_f32_16x16x32_bf16 v[100:103], v[200:203], a[180:183], v[100:103]
    ds_read_b64_tr_b16 v[218:219], v41 offset:28672
    v_mfma_f32_16x16x32_bf16 v[104:107], v[200:203], a[184:187], v[104:107]
    s_mov_b32 s31, 12288
    buffer_load_dwordx4 a[96:99], v11, s[24:27], s31 offen offset:0 sc1
    v_mfma_f32_16x16x32_bf16 v[108:111], v[200:203], a[188:191], v[108:111]
    buffer_load_dwordx4 a[100:103], v12, s[24:27], s31 offen offset:0 sc1
    s_waitcnt lgkmcnt(6)
    v_mfma_f32_16x16x32_bf16 v[112:115], v[204:207], a[176:179], v[112:115]
    ds_read_b64_tr_b16 v[220:221], v41 offset:24584
    v_mfma_f32_16x16x32_bf16 v[116:119], v[204:207], a[180:183], v[116:119]
    ds_read_b64_tr_b16 v[222:223], v41 offset:28680
    v_mfma_f32_16x16x32_bf16 v[120:123], v[204:207], a[184:187], v[120:123]
    s_mov_b32 s31, 12288
    buffer_load_dwordx4 a[104:107], v11, s[24:27], s31 offen offset:1024 sc1
    v_mfma_f32_16x16x32_bf16 v[124:127], v[204:207], a[188:191], v[124:127]
    buffer_load_dwordx4 a[108:111], v12, s[24:27], s31 offen offset:1024 sc1
    s_waitcnt lgkmcnt(6)
    v_mfma_f32_16x16x32_bf16 v[128:131], v[208:211], a[176:179], v[128:131]
    v_mfma_f32_16x16x32_bf16 v[132:135], v[208:211], a[180:183], v[132:135]
    v_mfma_f32_16x16x32_bf16 v[136:139], v[208:211], a[184:187], v[136:139]
    s_mov_b32 s31, 12288
    buffer_load_dwordx4 a[112:115], v11, s[24:27], s31 offen offset:2048 sc1
    v_mfma_f32_16x16x32_bf16 v[140:143], v[208:211], a[188:191], v[140:143]
    buffer_load_dwordx4 a[116:119], v12, s[24:27], s31 offen offset:2048 sc1
    s_waitcnt lgkmcnt(4)
    v_mfma_f32_16x16x32_bf16 v[144:147], v[212:215], a[176:179], v[144:147]
    v_mfma_f32_16x16x32_bf16 v[148:151], v[212:215], a[180:183], v[148:151]
    v_mfma_f32_16x16x32_bf16 v[152:155], v[212:215], a[184:187], v[152:155]
    s_mov_b32 s31, 12288
    buffer_load_dwordx4 a[120:123], v11, s[24:27], s31 offen offset:3072 sc1
    v_mfma_f32_16x16x32_bf16 v[156:159], v[212:215], a[188:191], v[156:159]
    buffer_load_dwordx4 a[124:127], v12, s[24:27], s31 offen offset:3072 sc1
    s_waitcnt lgkmcnt(2)
    v_mfma_f32_16x16x32_bf16 v[160:163], v[216:219], a[176:179], v[160:163]
    v_mfma_f32_16x16x32_bf16 v[164:167], v[216:219], a[180:183], v[164:167]
    v_mfma_f32_16x16x32_bf16 v[168:171], v[216:219], a[184:187], v[168:171]
    s_mov_b32 s31, 16384
    buffer_load_dwordx4 a[128:131], v11, s[24:27], s31 offen offset:0 sc1
    v_mfma_f32_16x16x32_bf16 v[172:175], v[216:219], a[188:191], v[172:175]
    buffer_load_dwordx4 a[132:135], v12, s[24:27], s31 offen offset:0 sc1
    s_waitcnt lgkmcnt(0)
    v_mfma_f32_16x16x32_bf16 v[176:179], v[220:223], a[176:179], v[176:179]
    v_mfma_f32_16x16x32_bf16 v[180:183], v[220:223], a[180:183], v[180:183]
    v_mfma_f32_16x16x32_bf16 v[184:187], v[220:223], a[184:187], v[184:187]
    s_mov_b32 s31, 16384
    buffer_load_dwordx4 a[136:139], v11, s[24:27], s31 offen offset:1024 sc1
    v_mfma_f32_16x16x32_bf16 v[188:191], v[220:223], a[188:191], v[188:191]
    buffer_load_dwordx4 a[140:143], v12, s[24:27], s31 offen offset:1024 sc1
    s_add_u32 s94, s93, 8
    s_sub_u32 s3, s94, 9
    s_cselect_b32 s94, s94, s3
    s_add_u32 m0, s100, 147456
    s_lshl_b32 s94, s94, 19
    buffer_load_dwordx4 v26, s[96:99], s94 offen offset:0 lds
    buffer_load_dwordx4 v27, s[96:99], s94 offen offset:1024 lds
    buffer_load_dwordx4 v28, s[96:99], s94 offen offset:2048 lds
    buffer_load_dwordx4 v29, s[96:99], s94 offen offset:3072 lds
    s_waitcnt vmcnt(63)
    s_barrier
    s_waitcnt vmcnt(36)
    ds_read_b64_tr_b16 v[216:217], v14 offset:0
    ds_read_b64_tr_b16 v[218:219], v14 offset:1536
    ds_read_b64_tr_b16 v[220:221], v14 offset:32
    ds_read_b64_tr_b16 v[222:223], v14 offset:1568
    ds_read_b64_tr_b16 v[224:225], v14 offset:64
    ds_read_b64_tr_b16 v[226:227], v14 offset:1600
    ds_read_b64_tr_b16 v[228:229], v14 offset:3072
    ds_read_b64_tr_b16 v[230:231], v14 offset:4608
    ds_read_b64_tr_b16 v[232:233], v14 offset:3104
    ds_read_b64_tr_b16 v[234:235], v14 offset:4640
    ds_read_b64_tr_b16 v[236:237], v14 offset:3136
    ds_read_b64_tr_b16 v[238:239], v14 offset:4672
    s_waitcnt lgkmcnt(6)
    v_mfma_f32_16x16x32_bf16 v[192:195], v[216:219], a[0:3], 0
    v_mfma_f32_16x16x32_bf16 v[196:199], v[216:219], a[4:7], 0
    ds_read_b64_tr_b16 v[240:241], v14 offset:6144
    ds_read_b64_tr_b16 v[242:243], v14 offset:7680
    ds_read_b64_tr_b16 v[244:245], v14 offset:6176
    ds_read_b64_tr_b16 v[246:247], v14 offset:7712
    ds_read_b64_tr_b16 v[248:249], v14 offset:6208
    ds_read_b64_tr_b16 v[250:251], v14 offset:7744
    v_mfma_f32_16x16x32_bf16 v[200:203], v[220:223], a[0:3], 0
    v_mfma_f32_16x16x32_bf16 v[204:207], v[220:223], a[4:7], 0
    v_mfma_f32_16x16x32_bf16 v[208:211], v[224:227], a[0:3], 0
    v_mfma_f32_16x16x32_bf16 v[212:215], v[224:227], a[4:7], 0
    s_waitcnt lgkmcnt(6)
    v_mfma_f32_16x16x32_bf16 v[192:195], v[228:231], a[8:11], v[192:195]
    v_mfma_f32_16x16x32_bf16 v[196:199], v[228:231], a[12:15], v[196:199]
    ds_read_b64_tr_b16 v[216:217], v14 offset:9216
    ds_read_b64_tr_b16 v[218:219], v14 offset:10752
    ds_read_b64_tr_b16 v[220:221], v14 offset:9248
    ds_read_b64_tr_b16 v[222:223], v14 offset:10784
    ds_read_b64_tr_b16 v[224:225], v14 offset:9280
    ds_read_b64_tr_b16 v[226:227], v14 offset:10816
    v_mfma_f32_16x16x32_bf16 v[200:203], v[232:235], a[8:11], v[200:203]
    v_mfma_f32_16x16x32_bf16 v[204:207], v[232:235], a[12:15], v[204:207]
    v_mfma_f32_16x16x32_bf16 v[208:211], v[236:239], a[8:11], v[208:211]
    v_mfma_f32_16x16x32_bf16 v[212:215], v[236:239], a[12:15], v[212:215]
    s_waitcnt lgkmcnt(6)
    v_mfma_f32_16x16x32_bf16 v[192:195], v[240:243], a[16:19], v[192:195]
    v_mfma_f32_16x16x32_bf16 v[196:199], v[240:243], a[20:23], v[196:199]
    ds_read_b64_tr_b16 v[228:229], v14 offset:12288
    ds_read_b64_tr_b16 v[230:231], v14 offset:13824
    ds_read_b64_tr_b16 v[232:233], v14 offset:12320
    ds_read_b64_tr_b16 v[234:235], v14 offset:13856
    ds_read_b64_tr_b16 v[236:237], v14 offset:12352
    ds_read_b64_tr_b16 v[238:239], v14 offset:13888
    v_mfma_f32_16x16x32_bf16 v[200:203], v[244:247], a[16:19], v[200:203]
    v_mfma_f32_16x16x32_bf16 v[204:207], v[244:247], a[20:23], v[204:207]
    v_mfma_f32_16x16x32_bf16 v[208:211], v[248:251], a[16:19], v[208:211]
    v_mfma_f32_16x16x32_bf16 v[212:215], v[248:251], a[20:23], v[212:215]
    s_waitcnt lgkmcnt(6)
    v_mfma_f32_16x16x32_bf16 v[192:195], v[216:219], a[24:27], v[192:195]
    v_mfma_f32_16x16x32_bf16 v[196:199], v[216:219], a[28:31], v[196:199]
    ds_read_b64_tr_b16 v[240:241], v14 offset:15360
    ds_read_b64_tr_b16 v[242:243], v14 offset:16896
    ds_read_b64_tr_b16 v[244:245], v14 offset:15392
    ds_read_b64_tr_b16 v[246:247], v14 offset:16928
    ds_read_b64_tr_b16 v[248:249], v14 offset:15424
    ds_read_b64_tr_b16 v[250:251], v14 offset:16960
    v_mfma_f32_16x16x32_bf16 v[200:203], v[220:223], a[24:27], v[200:203]
    v_mfma_f32_16x16x32_bf16 v[204:207], v[220:223], a[28:31], v[204:207]
    v_mfma_f32_16x16x32_bf16 v[208:211], v[224:227], a[24:27], v[208:211]
    v_mfma_f32_16x16x32_bf16 v[212:215], v[224:227], a[28:31], v[212:215]
    s_waitcnt lgkmcnt(6)
    v_mfma_f32_16x16x32_bf16 v[192:195], v[228:231], a[32:35], v[192:195]
    v_mfma_f32_16x16x32_bf16 v[196:199], v[228:231], a[36:39], v[196:199]
    ds_read_b64_tr_b16 v[216:217], v14 offset:18432
    ds_read_b64_tr_b16 v[218:219], v14 offset:19968
    ds_read_b64_tr_b16 v[220:221], v14 offset:18464
    ds_read_b64_tr_b16 v[222:223], v14 offset:20000
    ds_read_b64_tr_b16 v[224:225], v14 offset:18496
    ds_read_b64_tr_b16 v[226:227], v14 offset:20032
    v_mfma_f32_16x16x32_bf16 v[200:203], v[232:235], a[32:35], v[200:203]
    v_mfma_f32_16x16x32_bf16 v[204:207], v[232:235], a[36:39], v[204:207]
    v_mfma_f32_16x16x32_bf16 v[208:211], v[236:239], a[32:35], v[208:211]
    v_mfma_f32_16x16x32_bf16 v[212:215], v[236:239], a[36:39], v[212:215]
    s_waitcnt lgkmcnt(6)
    v_mfma_f32_16x16x32_bf16 v[192:195], v[240:243], a[40:43], v[192:195]
    v_mfma_f32_16x16x32_bf16 v[196:199], v[240:243], a[44:47], v[196:199]
    ds_read_b64_tr_b16 v[228:229], v14 offset:21504
    ds_read_b64_tr_b16 v[230:231], v14 offset:23040
    ds_read_b64_tr_b16 v[232:233], v14 offset:21536
    ds_read_b64_tr_b16 v[234:235], v14 offset:23072
    ds_read_b64_tr_b16 v[236:237], v14 offset:21568
    ds_read_b64_tr_b16 v[238:239], v14 offset:23104
    v_mfma_f32_16x16x32_bf16 v[200:203], v[244:247], a[40:43], v[200:203]
    v_mfma_f32_16x16x32_bf16 v[204:207], v[244:247], a[44:47], v[204:207]
    v_mfma_f32_16x16x32_bf16 v[208:211], v[248:251], a[40:43], v[208:211]
    v_mfma_f32_16x16x32_bf16 v[212:215], v[248:251], a[44:47], v[212:215]
    s_waitcnt vmcnt(20)
    s_waitcnt lgkmcnt(6)
    v_mfma_f32_16x16x32_bf16 v[192:195], v[216:219], a[48:51], v[192:195]
    v_mfma_f32_16x16x32_bf16 v[196:199], v[216:219], a[52:55], v[196:199]
    ds_read_b64_tr_b16 v[240:241], v14 offset:24576
    ds_read_b64_tr_b16 v[242:243], v14 offset:26112
    ds_read_b64_tr_b16 v[244:245], v14 offset:24608
    ds_read_b64_tr_b16 v[246:247], v14 offset:26144
    ds_read_b64_tr_b16 v[248:249], v14 offset:24640
    ds_read_b64_tr_b16 v[250:251], v14 offset:26176
    v_mfma_f32_16x16x32_bf16 v[200:203], v[220:223], a[48:51], v[200:203]
    v_mfma_f32_16x16x32_bf16 v[204:207], v[220:223], a[52:55], v[204:207]
    v_mfma_f32_16x16x32_bf16 v[208:211], v[224:227], a[48:51], v[208:211]
    v_mfma_f32_16x16x32_bf16 v[212:215], v[224:227], a[52:55], v[212:215]
    s_waitcnt lgkmcnt(6)
    v_mfma_f32_16x16x32_bf16 v[192:195], v[228:231], a[56:59], v[192:195]
    v_mfma_f32_16x16x32_bf16 v[196:199], v[228:231], a[60:63], v[196:199]
    ds_read_b64_tr_b16 v[216:217], v14 offset:27648
    ds_read_b64_tr_b16 v[218:219], v14 offset:29184
    ds_read_b64_tr_b16 v[220:221], v14 offset:27680
    ds_read_b64_tr_b16 v[222:223], v14 offset:29216
    ds_read_b64_tr_b16 v[224:225], v14 offset:27712
    ds_read_b64_tr_b16 v[226:227], v14 offset:29248
    v_mfma_f32_16x16x32_bf16 v[200:203], v[232:235], a[56:59], v[200:203]
    v_mfma_f32_16x16x32_bf16 v[204:207], v[232:235], a[60:63], v[204:207]
    v_mfma_f32_16x16x32_bf16 v[208:211], v[236:239], a[56:59], v[208:211]
    v_mfma_f32_16x16x32_bf16 v[212:215], v[236:239], a[60:63], v[212:215]
    s_waitcnt lgkmcnt(6)
    v_mfma_f32_16x16x32_bf16 v[192:195], v[240:243], a[64:67], v[192:195]
    v_mfma_f32_16x16x32_bf16 v[196:199], v[240:243], a[68:71], v[196:199]
    ds_read_b64_tr_b16 v[228:229], v14 offset:30720
    ds_read_b64_tr_b16 v[230:231], v14 offset:32256
    ds_read_b64_tr_b16 v[232:233], v14 offset:30752
    ds_read_b64_tr_b16 v[234:235], v14 offset:32288
    ds_read_b64_tr_b16 v[236:237], v14 offset:30784
    ds_read_b64_tr_b16 v[238:239], v14 offset:32320
    v_mfma_f32_16x16x32_bf16 v[200:203], v[244:247], a[64:67], v[200:203]
    v_mfma_f32_16x16x32_bf16 v[204:207], v[244:247], a[68:71], v[204:207]
    v_mfma_f32_16x16x32_bf16 v[208:211], v[248:251], a[64:67], v[208:211]
    v_mfma_f32_16x16x32_bf16 v[212:215], v[248:251], a[68:71], v[212:215]
    s_waitcnt lgkmcnt(6)
    v_mfma_f32_16x16x32_bf16 v[192:195], v[216:219], a[72:75], v[192:195]
    v_mfma_f32_16x16x32_bf16 v[196:199], v[216:219], a[76:79], v[196:199]
    ds_read_b64_tr_b16 v[240:241], v14 offset:33792
    ds_read_b64_tr_b16 v[242:243], v14 offset:35328
    ds_read_b64_tr_b16 v[244:245], v14 offset:33824
    ds_read_b64_tr_b16 v[246:247], v14 offset:35360
    ds_read_b64_tr_b16 v[248:249], v14 offset:33856
    ds_read_b64_tr_b16 v[250:251], v14 offset:35392
    v_mfma_f32_16x16x32_bf16 v[200:203], v[220:223], a[72:75], v[200:203]
    v_mfma_f32_16x16x32_bf16 v[204:207], v[220:223], a[76:79], v[204:207]
    v_mfma_f32_16x16x32_bf16 v[208:211], v[224:227], a[72:75], v[208:211]
    v_mfma_f32_16x16x32_bf16 v[212:215], v[224:227], a[76:79], v[212:215]
    s_waitcnt lgkmcnt(6)
    v_mfma_f32_16x16x32_bf16 v[192:195], v[228:231], a[80:83], v[192:195]
    v_mfma_f32_16x16x32_bf16 v[196:199], v[228:231], a[84:87], v[196:199]
    ds_read_b64_tr_b16 v[216:217], v14 offset:36864
    ds_read_b64_tr_b16 v[218:219], v14 offset:38400
    ds_read_b64_tr_b16 v[220:221], v14 offset:36896
    ds_read_b64_tr_b16 v[222:223], v14 offset:38432
    ds_read_b64_tr_b16 v[224:225], v14 offset:36928
    ds_read_b64_tr_b16 v[226:227], v14 offset:38464
    v_mfma_f32_16x16x32_bf16 v[200:203], v[232:235], a[80:83], v[200:203]
    v_mfma_f32_16x16x32_bf16 v[204:207], v[232:235], a[84:87], v[204:207]
    v_mfma_f32_16x16x32_bf16 v[208:211], v[236:239], a[80:83], v[208:211]
    v_mfma_f32_16x16x32_bf16 v[212:215], v[236:239], a[84:87], v[212:215]
    s_waitcnt lgkmcnt(6)
    v_mfma_f32_16x16x32_bf16 v[192:195], v[240:243], a[88:91], v[192:195]
    v_mfma_f32_16x16x32_bf16 v[196:199], v[240:243], a[92:95], v[196:199]
    ds_read_b64_tr_b16 v[228:229], v14 offset:39936
    ds_read_b64_tr_b16 v[230:231], v14 offset:41472
    ds_read_b64_tr_b16 v[232:233], v14 offset:39968
    ds_read_b64_tr_b16 v[234:235], v14 offset:41504
    ds_read_b64_tr_b16 v[236:237], v14 offset:40000
    ds_read_b64_tr_b16 v[238:239], v14 offset:41536
    v_mfma_f32_16x16x32_bf16 v[200:203], v[244:247], a[88:91], v[200:203]
    v_mfma_f32_16x16x32_bf16 v[204:207], v[244:247], a[92:95], v[204:207]
    v_mfma_f32_16x16x32_bf16 v[208:211], v[248:251], a[88:91], v[208:211]
    v_mfma_f32_16x16x32_bf16 v[212:215], v[248:251], a[92:95], v[212:215]
    s_waitcnt vmcnt(8)
    s_waitcnt lgkmcnt(6)
    v_mfma_f32_16x16x32_bf16 v[192:195], v[216:219], a[96:99], v[192:195]
    v_mfma_f32_16x16x32_bf16 v[196:199], v[216:219], a[100:103], v[196:199]
    ds_read_b64_tr_b16 v[240:241], v14 offset:43008
    ds_read_b64_tr_b16 v[242:243], v14 offset:44544
    ds_read_b64_tr_b16 v[244:245], v14 offset:43040
    ds_read_b64_tr_b16 v[246:247], v14 offset:44576
    ds_read_b64_tr_b16 v[248:249], v14 offset:43072
    ds_read_b64_tr_b16 v[250:251], v14 offset:44608
    v_mfma_f32_16x16x32_bf16 v[200:203], v[220:223], a[96:99], v[200:203]
    v_mfma_f32_16x16x32_bf16 v[204:207], v[220:223], a[100:103], v[204:207]
    v_mfma_f32_16x16x32_bf16 v[208:211], v[224:227], a[96:99], v[208:211]
    v_mfma_f32_16x16x32_bf16 v[212:215], v[224:227], a[100:103], v[212:215]
    s_waitcnt lgkmcnt(6)
    v_mfma_f32_16x16x32_bf16 v[192:195], v[228:231], a[104:107], v[192:195]
    v_mfma_f32_16x16x32_bf16 v[196:199], v[228:231], a[108:111], v[196:199]
    ds_read_b64_tr_b16 v[216:217], v14 offset:46080
    ds_read_b64_tr_b16 v[218:219], v14 offset:47616
    ds_read_b64_tr_b16 v[220:221], v14 offset:46112
    ds_read_b64_tr_b16 v[222:223], v14 offset:47648
    ds_read_b64_tr_b16 v[224:225], v14 offset:46144
    ds_read_b64_tr_b16 v[226:227], v14 offset:47680
    v_mfma_f32_16x16x32_bf16 v[200:203], v[232:235], a[104:107], v[200:203]
    v_mfma_f32_16x16x32_bf16 v[204:207], v[232:235], a[108:111], v[204:207]
    v_mfma_f32_16x16x32_bf16 v[208:211], v[236:239], a[104:107], v[208:211]
    v_mfma_f32_16x16x32_bf16 v[212:215], v[236:239], a[108:111], v[212:215]
    s_waitcnt lgkmcnt(6)
    v_mfma_f32_16x16x32_bf16 v[192:195], v[240:243], a[112:115], v[192:195]
    v_mfma_f32_16x16x32_bf16 v[196:199], v[240:243], a[116:119], v[196:199]
    ds_read_b64_tr_b16 v[228:229], v14 offset:49152
    ds_read_b64_tr_b16 v[230:231], v14 offset:50688
    ds_read_b64_tr_b16 v[232:233], v14 offset:49184
    ds_read_b64_tr_b16 v[234:235], v14 offset:50720
    ds_read_b64_tr_b16 v[236:237], v14 offset:49216
    ds_read_b64_tr_b16 v[238:239], v14 offset:50752
    v_mfma_f32_16x16x32_bf16 v[200:203], v[244:247], a[112:115], v[200:203]
    v_mfma_f32_16x16x32_bf16 v[204:207], v[244:247], a[116:119], v[204:207]
    v_mfma_f32_16x16x32_bf16 v[208:211], v[248:251], a[112:115], v[208:211]
    v_mfma_f32_16x16x32_bf16 v[212:215], v[248:251], a[116:119], v[212:215]
    s_waitcnt lgkmcnt(6)
    v_mfma_f32_16x16x32_bf16 v[192:195], v[216:219], a[120:123], v[192:195]
    v_mfma_f32_16x16x32_bf16 v[196:199], v[216:219], a[124:127], v[196:199]
    ds_read_b64_tr_b16 v[240:241], v14 offset:52224
    ds_read_b64_tr_b16 v[242:243], v14 offset:53760
    ds_read_b64_tr_b16 v[244:245], v14 offset:52256
    ds_read_b64_tr_b16 v[246:247], v14 offset:53792
    ds_read_b64_tr_b16 v[248:249], v14 offset:52288
    ds_read_b64_tr_b16 v[250:251], v14 offset:53824
    v_mfma_f32_16x16x32_bf16 v[200:203], v[220:223], a[120:123], v[200:203]
    v_mfma_f32_16x16x32_bf16 v[204:207], v[220:223], a[124:127], v[204:207]
    v_mfma_f32_16x16x32_bf16 v[208:211], v[224:227], a[120:123], v[208:211]
    v_mfma_f32_16x16x32_bf16 v[212:215], v[224:227], a[124:127], v[212:215]
    s_waitcnt vmcnt(4)
    s_waitcnt lgkmcnt(6)
    v_mfma_f32_16x16x32_bf16 v[192:195], v[228:231], a[128:131], v[192:195]
    v_mfma_f32_16x16x32_bf16 v[196:199], v[228:231], a[132:135], v[196:199]
    v_mfma_f32_16x16x32_bf16 v[200:203], v[232:235], a[128:131], v[200:203]
    v_mfma_f32_16x16x32_bf16 v[204:207], v[232:235], a[132:135], v[204:207]
    v_mfma_f32_16x16x32_bf16 v[208:211], v[236:239], a[128:131], v[208:211]
    v_mfma_f32_16x16x32_bf16 v[212:215], v[236:239], a[132:135], v[212:215]
    s_waitcnt lgkmcnt(0)
    v_mfma_f32_16x16x32_bf16 v[192:195], v[240:243], a[136:139], v[192:195]
    v_mfma_f32_16x16x32_bf16 v[196:199], v[240:243], a[140:143], v[196:199]
    v_mfma_f32_16x16x32_bf16 v[200:203], v[244:247], a[136:139], v[200:203]
    v_mfma_f32_16x16x32_bf16 v[204:207], v[244:247], a[140:143], v[204:207]
    v_mfma_f32_16x16x32_bf16 v[208:211], v[248:251], a[136:139], v[208:211]
    v_mfma_f32_16x16x32_bf16 v[212:215], v[248:251], a[140:143], v[212:215]
    s_nop 7
    v_lshlrev_b32 v216, 16, v46
    v_and_b32 v217, 0xffff0000, v46
    v_add_f32 v192, v192, v216
    v_add_f32 v193, v193, v217
    v_cvt_pk_bf16_f32 v240, v192, v193
    v_lshlrev_b32 v192, 16, v240
    v_and_b32 v193, 0xffff0000, v240
    v_lshlrev_b32 v216, 16, v47
    v_and_b32 v217, 0xffff0000, v47
    v_add_f32 v194, v194, v216
    v_add_f32 v195, v195, v217
    v_cvt_pk_bf16_f32 v241, v194, v195
    v_lshlrev_b32 v194, 16, v241
    v_and_b32 v195, 0xffff0000, v241
    v_lshlrev_b32 v216, 16, v48
    v_and_b32 v217, 0xffff0000, v48
    v_add_f32 v196, v196, v216
    v_add_f32 v197, v197, v217
    v_cvt_pk_bf16_f32 v242, v196, v197
    v_lshlrev_b32 v196, 16, v242
    v_and_b32 v197, 0xffff0000, v242
    v_lshlrev_b32 v216, 16, v49
    v_and_b32 v217, 0xffff0000, v49
    v_add_f32 v198, v198, v216
    v_add_f32 v199, v199, v217
    v_cvt_pk_bf16_f32 v243, v198, v199
    v_lshlrev_b32 v198, 16, v243
    v_and_b32 v199, 0xffff0000, v243
    v_permlane16_swap_b32 v240, v242
    v_permlane16_swap_b32 v241, v243
    buffer_store_dwordx4 v[240:243], v16, s[40:43], s101 offen offset:0 sc1
    v_lshlrev_b32 v216, 16, v50
    v_and_b32 v217, 0xffff0000, v50
    v_add_f32 v200, v200, v216
    v_add_f32 v201, v201, v217
    v_cvt_pk_bf16_f32 v244, v200, v201
    v_lshlrev_b32 v200, 16, v244
    v_and_b32 v201, 0xffff0000, v244
    v_lshlrev_b32 v216, 16, v51
    v_and_b32 v217, 0xffff0000, v51
    v_add_f32 v202, v202, v216
    v_add_f32 v203, v203, v217
    v_cvt_pk_bf16_f32 v245, v202, v203
    v_lshlrev_b32 v202, 16, v245
    v_and_b32 v203, 0xffff0000, v245
    v_lshlrev_b32 v216, 16, v52
    v_and_b32 v217, 0xffff0000, v52
    v_add_f32 v204, v204, v216
    v_add_f32 v205, v205, v217
    v_cvt_pk_bf16_f32 v246, v204, v205
    v_lshlrev_b32 v204, 16, v246
    v_and_b32 v205, 0xffff0000, v246
    v_lshlrev_b32 v216, 16, v53
    v_and_b32 v217, 0xffff0000, v53
    v_add_f32 v206, v206, v216
    v_add_f32 v207, v207, v217
    v_cvt_pk_bf16_f32 v247, v206, v207
    v_lshlrev_b32 v206, 16, v247
    v_and_b32 v207, 0xffff0000, v247
    v_permlane16_swap_b32 v244, v246
    v_permlane16_swap_b32 v245, v247
    buffer_store_dwordx4 v[244:247], v16, s[40:43], s101 offen offset:512 sc1
    v_lshlrev_b32 v216, 16, v54
    v_and_b32 v217, 0xffff0000, v54
    v_add_f32 v208, v208, v216
    v_add_f32 v209, v209, v217
    v_cvt_pk_bf16_f32 v248, v208, v209
    v_lshlrev_b32 v208, 16, v248
    v_and_b32 v209, 0xffff0000, v248
    v_lshlrev_b32 v216, 16, v55
    v_and_b32 v217, 0xffff0000, v55
    v_add_f32 v210, v210, v216
    v_add_f32 v211, v211, v217
    v_cvt_pk_bf16_f32 v249, v210, v211
    v_lshlrev_b32 v210, 16, v249
    v_and_b32 v211, 0xffff0000, v249
    v_lshlrev_b32 v216, 16, v56
    v_and_b32 v217, 0xffff0000, v56
    v_add_f32 v212, v212, v216
    v_add_f32 v213, v213, v217
    v_cvt_pk_bf16_f32 v250, v212, v213
    v_lshlrev_b32 v212, 16, v250
    v_and_b32 v213, 0xffff0000, v250
    v_lshlrev_b32 v216, 16, v57
    v_and_b32 v217, 0xffff0000, v57
    v_add_f32 v214, v214, v216
    v_add_f32 v215, v215, v217
    v_cvt_pk_bf16_f32 v251, v214, v215
    v_lshlrev_b32 v214, 16, v251
    v_and_b32 v215, 0xffff0000, v251
    v_permlane16_swap_b32 v248, v250
    v_permlane16_swap_b32 v249, v251
    buffer_store_dwordx4 v[248:251], v16, s[40:43], s101 offen offset:1024 sc1
    v_add_f32 v220, v192, v193
    v_add_f32 v220, v220, v194
    v_add_f32 v220, v220, v195
    v_add_f32 v220, v220, v200
    v_add_f32 v220, v220, v201
    v_add_f32 v220, v220, v202
    v_add_f32 v220, v220, v203
    v_add_f32 v220, v220, v208
    v_add_f32 v220, v220, v209
    v_add_f32 v220, v220, v210
    v_add_f32 v220, v220, v211
    v_add_f32 v222, v196, v197
    v_add_f32 v222, v222, v198
    v_add_f32 v222, v222, v199
    v_add_f32 v222, v222, v204
    v_add_f32 v222, v222, v205
    v_add_f32 v222, v222, v206
    v_add_f32 v222, v222, v207
    v_add_f32 v222, v222, v212
    v_add_f32 v222, v222, v213
    v_add_f32 v222, v222, v214
    v_add_f32 v222, v222, v215
    v_mov_b32 v226, v220
    v_mov_b32 v227, v222
    s_nop 1
    v_permlane16_swap_b32 v220, v226
    v_permlane16_swap_b32 v222, v227
    v_add_f32 v220, v220, v226
    v_add_f32 v222, v222, v227
    v_mov_b32 v226, v220
    v_mov_b32 v227, v222
    s_nop 1
    v_permlane32_swap_b32 v220, v226
    v_permlane32_swap_b32 v222, v227
    v_add_f32 v220, v220, v226
    v_add_f32 v222, v222, v227
    v_mul_f32 v228, 0x3caaaaab, v220
    v_mov_b32 v221, 0
    v_sub_f32 v229, v192, v228
    v_fmac_f32 v221, v229, v229
    v_sub_f32 v229, v193, v228
    v_fmac_f32 v221, v229, v229
    v_sub_f32 v229, v194, v228
    v_fmac_f32 v221, v229, v229
    v_sub_f32 v229, v195, v228
    v_fmac_f32 v221, v229, v229
    v_sub_f32 v229, v200, v228
    v_fmac_f32 v221, v229, v229
    v_sub_f32 v229, v201, v228
    v_fmac_f32 v221, v229, v229
    v_sub_f32 v229, v202, v228
    v_fmac_f32 v221, v229, v229
    v_sub_f32 v229, v203, v228
    v_fmac_f32 v221, v229, v229
    v_sub_f32 v229, v208, v228
    v_fmac_f32 v221, v229, v229
    v_sub_f32 v229, v209, v228
    v_fmac_f32 v221, v229, v229
    v_sub_f32 v229, v210, v228
    v_fmac_f32 v221, v229, v229
    v_sub_f32 v229, v211, v228
    v_fmac_f32 v221, v229, v229
    v_mul_f32 v228, 0x3caaaaab, v222
    v_mov_b32 v223, 0
    v_sub_f32 v229, v196, v228
    v_fmac_f32 v223, v229, v229
    v_sub_f32 v229, v197, v228
    v_fmac_f32 v223, v229, v229
    v_sub_f32 v229, v198, v228
    v_fmac_f32 v223, v229, v229
    v_sub_f32 v229, v199, v228
    v_fmac_f32 v223, v229, v229
    v_sub_f32 v229, v204, v228
    v_fmac_f32 v223, v229, v229
    v_sub_f32 v229, v205, v228
    v_fmac_f32 v223, v229, v229
    v_sub_f32 v229, v206, v228
    v_fmac_f32 v223, v229, v229
    v_sub_f32 v229, v207, v228
    v_fmac_f32 v223, v229, v229
    v_sub_f32 v229, v212, v228
    v_fmac_f32 v223, v229, v229
    v_sub_f32 v229, v213, v228
    v_fmac_f32 v223, v229, v229
    v_sub_f32 v229, v214, v228
    v_fmac_f32 v223, v229, v229
    v_sub_f32 v229, v215, v228
    v_fmac_f32 v223, v229, v229
    v_mov_b32 v226, v221
    v_mov_b32 v227, v223
    s_nop 1
    v_permlane16_swap_b32 v221, v226
    v_permlane16_swap_b32 v223, v227
    v_add_f32 v221, v221, v226
    v_add_f32 v223, v223, v227
    v_mov_b32 v226, v221
    v_mov_b32 v227, v223
    s_nop 1
    v_permlane32_swap_b32 v221, v226
    v_permlane32_swap_b32 v223, v227
    v_add_f32 v221, v221, v226
    v_add_f32 v223, v223, v227
    s_lshl_b32 s30, s29, 14
    buffer_store_dwordx2 v[220:221], v22, s[36:39], s30 offen sc1
    buffer_store_dwordx2 v[222:223], v22, s[36:39], s30 offen offset:128 sc1
    s_bfe_u32 s90, s2, 0x20001
    s_lshl_b32 s90, s90, 3
    s_bfe_u32 s3, s2, 0x30003
    s_add_u32 s90, s90, s3
    s_and_b32 s91, s2, 1
    s_lshl_b32 s91, s91, 2
    s_lshr_b32 s3, s2, 6
    s_add_u32 s91, s91, s3
    s_lshl_b32 s90, s90, 19
    s_and_b32 s91, s91, 3
    s_mul_i32 s91, s91, 12288
    s_add_u32 s8, s66, s90
    s_addc_u32 s9, s67, 0
    s_mov_b32 s10, 0x80000
    s_mov_b32 s11, 0x20000
    v_add_u32 v252, 0, v0
    v_min_u32 v252, 95, v252
    v_lshlrev_b32 v252, 7, v252
    buffer_load_dword v253, v252, s[8:11], s91 offen
    s_add_u32 s8, s68, s90
    s_addc_u32 s9, s69, 0
    s_mov_b32 s10, 0x80000
    s_mov_b32 s11, 0x20000
    v_add_u32 v254, 0, v0
    v_min_u32 v254, 95, v254
    v_lshlrev_b32 v254, 7, v254
    buffer_load_dword v255, v254, s[8:11], s91 offen
    s_waitcnt vmcnt(63)
    s_barrier
    ds_read_b64_tr_b16 v[192:193], v38 offset:32768
    ds_read_b64_tr_b16 v[194:195], v38 offset:36864
    ds_read_b64_tr_b16 v[196:197], v38 offset:32776
    ds_read_b64_tr_b16 v[198:199], v38 offset:36872
    ds_read_b64_tr_b16 v[200:201], v39 offset:32768
    ds_read_b64_tr_b16 v[202:203], v39 offset:36864
    ds_read_b64_tr_b16 v[204:205], v39 offset:32776
    ds_read_b64_tr_b16 v[206:207], v39 offset:36872
    s_and_b32 s29, s2, 1
    s_lshl_b32 s29, s29, 3
    s_bfe_u32 s31, s2, 0x30003
    s_add_u32 s29, s29, s31
    s_bfe_u32 s30, s2, 0x20001
    s_lshl_b32 s30, s30, 2
    s_lshr_b32 s31, s2, 6
    s_add_u32 s30, s30, s31
    v_lshrrev_b32 v1, 6, v0
    v_and_b32 v2, 63, v0
    v_lshrrev_b32 v3, 2, v2
    v_and_b32 v4, 3, v2
    v_mul_u32_u24 v5, 144, v1
    v_add_u32 v5, v5, v3
    v_mul_u32_u24 v5, 9216, v5
    v_lshl_add_u32 v8, v4, 4, v5
    v_add_u32 v9, 146432, v8
    v_add_u32 v10, 292864, v8
    v_add_u32 v11, 439296, v8
    v_lshl_add_u32 v5, v1, 4, v3
    v_mul_u32_u24 v5, 9216, v5
    v_lshl_add_u32 v12, v4, 4, v5
    s_mul_i32 s33, s4, 9216
    s_lshl_b32 s28, s4, 10
    v_bfe_u32 v5, v2, 4, 1
    v_lshlrev_b32 v5, 2, v5
    v_and_b32 v6, 7, v2
    v_xor_b32 v6, v6, v5
    v_lshrrev_b32 v5, 3, v2
    v_mul_u32_u24 v7, 72, v1
    v_add_u32 v7, v7, v5
    v_mul_u32_u24 v7, 9216, v7
    v_lshl_add_u32 v236, v6, 4, v7
    v_add_u32 v237, 72704, v236
    v_add_u32 v238, 145408, v236
    v_add_u32 v239, 218112, v236
    v_lshl_add_u32 v7, v1, 3, v5
    v_mul_u32_u24 v7, 9216, v7
    v_lshl_add_u32 v240, v6, 4, v7
    s_mul_i32 s34, s30, 576
    s_mul_i32 s35, s30, 9216
    s_bitcmp1_b32 s30, 0
    s_cselect_b32 s101, 0, 512
    s_cselect_b32 s31, 0, 8192
    s_cselect_b32 s32, 64, 0
    s_add_u32 s101, s101, s34
    s_add_u32 s34, s34, s32
    s_add_u32 s92, s35, s31
    v_mov_b32 v55, s92
    s_lshl_b32 s32, s32, 4
    s_add_u32 s35, s35, s32
    s_mov_b32 s8, s80
    s_mov_b32 s9, s81
    s_mov_b32 s10, 0x510000
    s_mov_b32 s11, 0x20000
    s_add_u32 s24, s88, 0x980000
    s_addc_u32 s25, s89, 0
    s_mov_b32 s26, 0x24000
    s_mov_b32 s27, 0x20000
    s_lshl_b32 s31, s29, 3
    v_lshl_add_u32 v5, v1, 1, s31
    v_bfe_u32 v6, v2, 4, 1
    v_add_u32 v5, v5, v6
    v_lshrrev_b32 v6, 5, v2
    v_and_b32 v7, 15, v2
    v_lshlrev_b32 v22, 4, v7
    v_lshl_add_u32 v22, v6, 8, v22
    v_mul_u32_u24 v13, 18432, v5
    v_add_u32 v13, v13, v22
    v_mul_u32_u24 v19, 147456, v5
    v_add_u32 v19, v19, v22
    v_lshl_add_u32 v7, v5, 4, v7
    v_lshlrev_b32 v18, 2, v7
    v_mul_u32_u24 v23, 98304, v6
    v_lshl_add_u32 v17, v7, 3, v23
    v_and_b32 v3, 3, v3
    v_bfe_u32 v5, v2, 4, 1
    v_lshlrev_b32 v4, 5, v5
    v_and_b32 v5, 1, v2
    v_lshl_or_b32 v4, v5, 4, v4
    v_bfe_u32 v5, v2, 1, 1
    v_lshl_or_b32 v4, v5, 3, v4
    v_lshrrev_b32 v5, 1, v3
    v_lshl_add_u32 v3, v6, 3, v3
    v_lshl_or_b32 v54, v3, 6, v4
    v_lshl_or_b32 v4, v3, 7, v4
    v_lshl_or_b32 v46, v5, 6, v4
    v_xor_b32 v47, 64, v46
    v_add_u32 v48, 40960, v46
    v_add_u32 v49, 40960, v47
    v_add_u32 v50, 81920, v46
    v_add_u32 v51, 81920, v47
    v_add_u32 v52, 122880, v46
    v_add_u32 v53, 122880, v47
    s_add_u32 s12, s88, 0x6c0000
    s_addc_u32 s13, s89, 0
    s_mov_b32 s14, 0x240000
    s_mov_b32 s15, 0x20000
    s_add_u32 s36, s88, 0x900000
    s_addc_u32 s37, s89, 0
    s_mov_b32 s38, 0x30000
    s_mov_b32 s39, 0x20000
    s_add_u32 s16, s88, 0x1000000
    s_addc_u32 s17, s89, 0
    s_mov_b32 s18, 0x1200000
    s_mov_b32 s19, 0x20000
    s_add_u32 s40, s88, 0x9c0000
    s_addc_u32 s41, s89, 0
    s_mov_b32 s42, 0x2000
    s_mov_b32 s43, 0x20000
    v_mov_b32 v22, 0x3caaaaab
    v_mov_b32 v23, 0x42400000
    v_lshlrev_b32 v16, 31, v6
    v_ashrrev_i32 v16, 31, v16
    v_not_b32 v16, v16
    v_min_u32 v3, 11, v2
    s_lshr_b32 s31, s29, 1
    s_and_b32 s32, s29, 1
    s_lshl_b32 s32, s32, 3
    s_add_u32 s31, s31, s32
    v_lshl_add_u32 v3, v3, 4, s31
    v_and_b32 v4, 3, v2
    s_lshl_b32 s31, s30, 2
    s_add_u32 s31, s31, 1472
    v_add_u32 v4, s31, v4
    v_cmp_gt_u32 vcc, 12, v2
    s_nop 1
    v_cndmask_b32 v3, v4, v3, vcc
    v_lshlrev_b32 v14, 7, v3
    s_waitcnt vmcnt(63) lgkmcnt(6)
    v_mfma_f32_16x16x32_bf16 v[64:67], v[192:195], a[192:195], v[64:67]
    ds_read_b64_tr_b16 v[208:209], v40 offset:32768
    v_mfma_f32_16x16x32_bf16 v[68:71], v[192:195], a[196:199], v[68:71]
    ds_read_b64_tr_b16 v[210:211], v40 offset:36864
    v_mfma_f32_16x16x32_bf16 v[72:75], v[192:195], a[200:203], v[72:75]
    s_add_u32 s95, s93, 8
    s_sub_u32 s3, s95, 9
    s_cselect_b32 s95, s95, s3
    s_lshl_b32 s95, s95, 11
    buffer_load_dwordx4 a[176:179], v30, s[20:23], s95 offen offset:0 sc1
    v_mfma_f32_16x16x32_bf16 v[76:79], v[192:195], a[204:207], v[76:79]
    buffer_load_dwordx4 a[180:183], v31, s[20:23], s95 offen offset:0 sc1
    s_waitcnt lgkmcnt(6)
    v_mfma_f32_16x16x32_bf16 v[80:83], v[196:199], a[192:195], v[80:83]
    ds_read_b64_tr_b16 v[212:213], v40 offset:32776
    v_mfma_f32_16x16x32_bf16 v[84:87], v[196:199], a[196:199], v[84:87]
    ds_read_b64_tr_b16 v[214:215], v40 offset:36872
    v_mfma_f32_16x16x32_bf16 v[88:91], v[196:199], a[200:203], v[88:91]
    buffer_load_dwordx4 a[184:187], v32, s[20:23], s95 offen offset:0 sc1
    v_mfma_f32_16x16x32_bf16 v[92:95], v[196:199], a[204:207], v[92:95]
    buffer_load_dwordx4 a[188:191], v33, s[20:23], s95 offen offset:0 sc1
    s_waitcnt lgkmcnt(6)
    v_mfma_f32_16x16x32_bf16 v[96:99], v[200:203], a[192:195], v[96:99]
    ds_read_b64_tr_b16 v[216:217], v41 offset:32768
    v_mfma_f32_16x16x32_bf16 v[100:103], v[200:203], a[196:199], v[100:103]
    ds_read_b64_tr_b16 v[218:219], v41 offset:36864
    v_mfma_f32_16x16x32_bf16 v[104:107], v[200:203], a[200:203], v[104:107]
    v_mfma_f32_16x16x32_bf16 v[108:111], v[200:203], a[204:207], v[108:111]
    s_waitcnt lgkmcnt(6)
    v_mfma_f32_16x16x32_bf16 v[112:115], v[204:207], a[192:195], v[112:115]
    ds_read_b64_tr_b16 v[220:221], v41 offset:32776
    v_mfma_f32_16x16x32_bf16 v[116:119], v[204:207], a[196:199], v[116:119]
    ds_read_b64_tr_b16 v[222:223], v41 offset:36872
    v_mfma_f32_16x16x32_bf16 v[120:123], v[204:207], a[200:203], v[120:123]
    v_mfma_f32_16x16x32_bf16 v[124:127], v[204:207], a[204:207], v[124:127]
    s_waitcnt lgkmcnt(6)
    v_mfma_f32_16x16x32_bf16 v[128:131], v[208:211], a[192:195], v[128:131]
    ds_read_b64_tr_b16 v[192:193], v38 offset:40960
    v_mfma_f32_16x16x32_bf16 v[132:135], v[208:211], a[196:199], v[132:135]
    ds_read_b64_tr_b16 v[194:195], v38 offset:45056
    v_mfma_f32_16x16x32_bf16 v[136:139], v[208:211], a[200:203], v[136:139]
    v_mfma_f32_16x16x32_bf16 v[140:143], v[208:211], a[204:207], v[140:143]
    s_waitcnt lgkmcnt(6)
    v_mfma_f32_16x16x32_bf16 v[144:147], v[212:215], a[192:195], v[144:147]
    ds_read_b64_tr_b16 v[196:197], v38 offset:40968
    v_mfma_f32_16x16x32_bf16 v[148:151], v[212:215], a[196:199], v[148:151]
    ds_read_b64_tr_b16 v[198:199], v38 offset:45064
    v_mfma_f32_16x16x32_bf16 v[152:155], v[212:215], a[200:203], v[152:155]
    v_mfma_f32_16x16x32_bf16 v[156:159], v[212:215], a[204:207], v[156:159]
    s_waitcnt lgkmcnt(6)
    v_mfma_f32_16x16x32_bf16 v[160:163], v[216:219], a[192:195], v[160:163]
    ds_read_b64_tr_b16 v[200:201], v39 offset:40960
    v_mfma_f32_16x16x32_bf16 v[164:167], v[216:219], a[196:199], v[164:167]
    ds_read_b64_tr_b16 v[202:203], v39 offset:45056
    v_mfma_f32_16x16x32_bf16 v[168:171], v[216:219], a[200:203], v[168:171]
    v_mfma_f32_16x16x32_bf16 v[172:175], v[216:219], a[204:207], v[172:175]
    s_waitcnt lgkmcnt(6)
    v_mfma_f32_16x16x32_bf16 v[176:179], v[220:223], a[192:195], v[176:179]
    ds_read_b64_tr_b16 v[204:205], v39 offset:40968
    v_mfma_f32_16x16x32_bf16 v[180:183], v[220:223], a[196:199], v[180:183]
    ds_read_b64_tr_b16 v[206:207], v39 offset:45064
    v_mfma_f32_16x16x32_bf16 v[184:187], v[220:223], a[200:203], v[184:187]
    v_mfma_f32_16x16x32_bf16 v[188:191], v[220:223], a[204:207], v[188:191]
    s_waitcnt vmcnt(63) lgkmcnt(6)
    v_mfma_f32_16x16x32_bf16 v[64:67], v[192:195], a[208:211], v[64:67]
    ds_read_b64_tr_b16 v[208:209], v40 offset:40960
    v_mfma_f32_16x16x32_bf16 v[68:71], v[192:195], a[212:215], v[68:71]
    ds_read_b64_tr_b16 v[210:211], v40 offset:45056
    v_mfma_f32_16x16x32_bf16 v[72:75], v[192:195], a[216:219], v[72:75]
    s_add_u32 s95, s93, 8
    s_sub_u32 s3, s95, 9
    s_cselect_b32 s95, s95, s3
    s_lshl_b32 s95, s95, 11
    buffer_load_dwordx4 a[192:195], v30, s[20:23], s95 offen offset:1024 sc1
    v_mfma_f32_16x16x32_bf16 v[76:79], v[192:195], a[220:223], v[76:79]
    buffer_load_dwordx4 a[196:199], v31, s[20:23], s95 offen offset:1024 sc1
    s_waitcnt lgkmcnt(6)
    v_mfma_f32_16x16x32_bf16 v[80:83], v[196:199], a[208:211], v[80:83]
    ds_read_b64_tr_b16 v[212:213], v40 offset:40968
    v_mfma_f32_16x16x32_bf16 v[84:87], v[196:199], a[212:215], v[84:87]
    ds_read_b64_tr_b16 v[214:215], v40 offset:45064
    v_mfma_f32_16x16x32_bf16 v[88:91], v[196:199], a[216:219], v[88:91]
    buffer_load_dwordx4 a[200:203], v32, s[20:23], s95 offen offset:1024 sc1
    v_mfma_f32_16x16x32_bf16 v[92:95], v[196:199], a[220:223], v[92:95]
    buffer_load_dwordx4 a[204:207], v33, s[20:23], s95 offen offset:1024 sc1
    s_waitcnt lgkmcnt(6)
    v_mfma_f32_16x16x32_bf16 v[96:99], v[200:203], a[208:211], v[96:99]
    ds_read_b64_tr_b16 v[216:217], v41 offset:40960
    v_mfma_f32_16x16x32_bf16 v[100:103], v[200:203], a[212:215], v[100:103]
    ds_read_b64_tr_b16 v[218:219], v41 offset:45056
    v_mfma_f32_16x16x32_bf16 v[104:107], v[200:203], a[216:219], v[104:107]
    v_mfma_f32_16x16x32_bf16 v[108:111], v[200:203], a[220:223], v[108:111]
    s_waitcnt lgkmcnt(6)
    v_mfma_f32_16x16x32_bf16 v[112:115], v[204:207], a[208:211], v[112:115]
    ds_read_b64_tr_b16 v[220:221], v41 offset:40968
    v_mfma_f32_16x16x32_bf16 v[116:119], v[204:207], a[212:215], v[116:119]
    ds_read_b64_tr_b16 v[222:223], v41 offset:45064
    v_mfma_f32_16x16x32_bf16 v[120:123], v[204:207], a[216:219], v[120:123]
    v_mfma_f32_16x16x32_bf16 v[124:127], v[204:207], a[220:223], v[124:127]
    s_waitcnt lgkmcnt(6)
    v_mfma_f32_16x16x32_bf16 v[128:131], v[208:211], a[208:211], v[128:131]
    s_waitcnt vmcnt(63)
    s_barrier
    ds_read_b64_tr_b16 v[192:193], v34 offset:0
    v_mfma_f32_16x16x32_bf16 v[132:135], v[208:211], a[212:215], v[132:135]
    ds_read_b64_tr_b16 v[194:195], v34 offset:4096
    v_mfma_f32_16x16x32_bf16 v[136:139], v[208:211], a[216:219], v[136:139]
    v_mfma_f32_16x16x32_bf16 v[140:143], v[208:211], a[220:223], v[140:143]
    s_waitcnt lgkmcnt(6)
    v_mfma_f32_16x16x32_bf16 v[144:147], v[212:215], a[208:211], v[144:147]
    ds_read_b64_tr_b16 v[196:197], v34 offset:8
    v_mfma_f32_16x16x32_bf16 v[148:151], v[212:215], a[212:215], v[148:151]
    ds_read_b64_tr_b16 v[198:199], v34 offset:4104
    v_mfma_f32_16x16x32_bf16 v[152:155], v[212:215], a[216:219], v[152:155]
    v_mfma_f32_16x16x32_bf16 v[156:159], v[212:215], a[220:223], v[156:159]
    s_waitcnt lgkmcnt(6)
    v_mfma_f32_16x16x32_bf16 v[160:163], v[216:219], a[208:211], v[160:163]
    ds_read_b64_tr_b16 v[200:201], v35 offset:0
    v_mfma_f32_16x16x32_bf16 v[164:167], v[216:219], a[212:215], v[164:167]
    ds_read_b64_tr_b16 v[202:203], v35 offset:4096
    v_mfma_f32_16x16x32_bf16 v[168:171], v[216:219], a[216:219], v[168:171]
    v_mfma_f32_16x16x32_bf16 v[172:175], v[216:219], a[220:223], v[172:175]
    s_waitcnt lgkmcnt(6)
    v_mfma_f32_16x16x32_bf16 v[176:179], v[220:223], a[208:211], v[176:179]
    ds_read_b64_tr_b16 v[204:205], v35 offset:8
    v_mfma_f32_16x16x32_bf16 v[180:183], v[220:223], a[212:215], v[180:183]
    ds_read_b64_tr_b16 v[206:207], v35 offset:4104
    v_mfma_f32_16x16x32_bf16 v[184:187], v[220:223], a[216:219], v[184:187]
    v_mfma_f32_16x16x32_bf16 v[188:191], v[220:223], a[220:223], v[188:191]
    s_waitcnt vmcnt(63) lgkmcnt(6)
    v_mfma_f32_16x16x32_bf16 v[64:67], v[192:195], a[224:227], v[64:67]
    ds_read_b64_tr_b16 v[208:209], v36 offset:0
    v_mfma_f32_16x16x32_bf16 v[68:71], v[192:195], a[228:231], v[68:71]
    ds_read_b64_tr_b16 v[210:211], v36 offset:4096
    v_mfma_f32_16x16x32_bf16 v[72:75], v[192:195], a[232:235], v[72:75]
    v_mfma_f32_16x16x32_bf16 v[76:79], v[192:195], a[236:239], v[76:79]
    s_waitcnt lgkmcnt(6)
    v_mfma_f32_16x16x32_bf16 v[80:83], v[196:199], a[224:227], v[80:83]
    ds_read_b64_tr_b16 v[212:213], v36 offset:8
    v_mfma_f32_16x16x32_bf16 v[84:87], v[196:199], a[228:231], v[84:87]
    ds_read_b64_tr_b16 v[214:215], v36 offset:4104
    v_mfma_f32_16x16x32_bf16 v[88:91], v[196:199], a[232:235], v[88:91]
    v_mfma_f32_16x16x32_bf16 v[92:95], v[196:199], a[236:239], v[92:95]
    s_waitcnt lgkmcnt(6)
    v_mfma_f32_16x16x32_bf16 v[96:99], v[200:203], a[224:227], v[96:99]
    ds_read_b64_tr_b16 v[216:217], v37 offset:0
    v_mfma_f32_16x16x32_bf16 v[100:103], v[200:203], a[228:231], v[100:103]
    ds_read_b64_tr_b16 v[218:219], v37 offset:4096
    v_mfma_f32_16x16x32_bf16 v[104:107], v[200:203], a[232:235], v[104:107]
    v_mfma_f32_16x16x32_bf16 v[108:111], v[200:203], a[236:239], v[108:111]
    s_waitcnt lgkmcnt(6)
    v_mfma_f32_16x16x32_bf16 v[112:115], v[204:207], a[224:227], v[112:115]
    ds_read_b64_tr_b16 v[220:221], v37 offset:8
    v_mfma_f32_16x16x32_bf16 v[116:119], v[204:207], a[228:231], v[116:119]
    ds_read_b64_tr_b16 v[222:223], v37 offset:4104
    v_mfma_f32_16x16x32_bf16 v[120:123], v[204:207], a[232:235], v[120:123]
    v_mfma_f32_16x16x32_bf16 v[124:127], v[204:207], a[236:239], v[124:127]
    s_waitcnt lgkmcnt(6)
    v_mfma_f32_16x16x32_bf16 v[128:131], v[208:211], a[224:227], v[128:131]
    ds_read_b64_tr_b16 v[192:193], v34 offset:8192
    v_mfma_f32_16x16x32_bf16 v[132:135], v[208:211], a[228:231], v[132:135]
    ds_read_b64_tr_b16 v[194:195], v34 offset:12288
    v_mfma_f32_16x16x32_bf16 v[136:139], v[208:211], a[232:235], v[136:139]
    v_mfma_f32_16x16x32_bf16 v[140:143], v[208:211], a[236:239], v[140:143]
    s_waitcnt lgkmcnt(6)
    v_mfma_f32_16x16x32_bf16 v[144:147], v[212:215], a[224:227], v[144:147]
    ds_read_b64_tr_b16 v[196:197], v34 offset:8200
    v_mfma_f32_16x16x32_bf16 v[148:151], v[212:215], a[228:231], v[148:151]
    ds_read_b64_tr_b16 v[198:199], v34 offset:12296
    v_mfma_f32_16x16x32_bf16 v[152:155], v[212:215], a[232:235], v[152:155]
    v_mfma_f32_16x16x32_bf16 v[156:159], v[212:215], a[236:239], v[156:159]
    s_waitcnt lgkmcnt(6)
    v_mfma_f32_16x16x32_bf16 v[160:163], v[216:219], a[224:227], v[160:163]
    ds_read_b64_tr_b16 v[200:201], v35 offset:8192
    v_mfma_f32_16x16x32_bf16 v[164:167], v[216:219], a[228:231], v[164:167]
    ds_read_b64_tr_b16 v[202:203], v35 offset:12288
    v_mfma_f32_16x16x32_bf16 v[168:171], v[216:219], a[232:235], v[168:171]
    v_mfma_f32_16x16x32_bf16 v[172:175], v[216:219], a[236:239], v[172:175]
    s_waitcnt lgkmcnt(6)
    v_mfma_f32_16x16x32_bf16 v[176:179], v[220:223], a[224:227], v[176:179]
    ds_read_b64_tr_b16 v[204:205], v35 offset:8200
    v_mfma_f32_16x16x32_bf16 v[180:183], v[220:223], a[228:231], v[180:183]
    ds_read_b64_tr_b16 v[206:207], v35 offset:12296
    v_mfma_f32_16x16x32_bf16 v[184:187], v[220:223], a[232:235], v[184:187]
    v_mfma_f32_16x16x32_bf16 v[188:191], v[220:223], a[236:239], v[188:191]
    s_waitcnt vmcnt(63) lgkmcnt(6)
    v_mfma_f32_16x16x32_bf16 v[64:67], v[192:195], a[240:243], v[64:67]
    ds_read_b64_tr_b16 v[208:209], v36 offset:8192
    v_mfma_f32_16x16x32_bf16 v[68:71], v[192:195], a[244:247], v[68:71]
    ds_read_b64_tr_b16 v[210:211], v36 offset:12288
    v_mfma_f32_16x16x32_bf16 v[72:75], v[192:195], a[248:251], v[72:75]
    v_mfma_f32_16x16x32_bf16 v[76:79], v[192:195], a[252:255], v[76:79]
    s_waitcnt lgkmcnt(6)
    v_mfma_f32_16x16x32_bf16 v[80:83], v[196:199], a[240:243], v[80:83]
    ds_read_b64_tr_b16 v[212:213], v36 offset:8200
    v_mfma_f32_16x16x32_bf16 v[84:87], v[196:199], a[244:247], v[84:87]
    ds_read_b64_tr_b16 v[214:215], v36 offset:12296
    v_mfma_f32_16x16x32_bf16 v[88:91], v[196:199], a[248:251], v[88:91]
    v_mfma_f32_16x16x32_bf16 v[92:95], v[196:199], a[252:255], v[92:95]
    s_waitcnt lgkmcnt(6)
    v_mfma_f32_16x16x32_bf16 v[96:99], v[200:203], a[240:243], v[96:99]
    ds_read_b64_tr_b16 v[216:217], v37 offset:8192
    v_mfma_f32_16x16x32_bf16 v[100:103], v[200:203], a[244:247], v[100:103]
    ds_read_b64_tr_b16 v[218:219], v37 offset:12288
    v_mfma_f32_16x16x32_bf16 v[104:107], v[200:203], a[248:251], v[104:107]
    v_mfma_f32_16x16x32_bf16 v[108:111], v[200:203], a[252:255], v[108:111]
    s_waitcnt lgkmcnt(6)
    v_mfma_f32_16x16x32_bf16 v[112:115], v[204:207], a[240:243], v[112:115]
    ds_read_b64_tr_b16 v[220:221], v37 offset:8200
    v_mfma_f32_16x16x32_bf16 v[116:119], v[204:207], a[244:247], v[116:119]
    ds_read_b64_tr_b16 v[222:223], v37 offset:12296
    v_mfma_f32_16x16x32_bf16 v[120:123], v[204:207], a[248:251], v[120:123]
    v_mfma_f32_16x16x32_bf16 v[124:127], v[204:207], a[252:255], v[124:127]
    s_waitcnt lgkmcnt(6)
    v_mfma_f32_16x16x32_bf16 v[128:131], v[208:211], a[240:243], v[128:131]
    s_waitcnt vmcnt(10)
    s_barrier
    s_cmp_lg_u32 s4, 0
    s_cbranch_scc1 L_fs_16
    s_lshl_b32 s3, s2, 7
    s_mov_b64 exec, 1
    v_mov_b32 v2, s62
    v_mov_b32 v3, s63
    v_mov_b32 v1, 32768
    buffer_store_dwordx2 v[2:3], v1, s[44:47], s3 offen sc1
    s_mov_b64 exec, -1
L_fs_16:
    ds_read_b64_tr_b16 v[192:193], v34 offset:16384
    v_mfma_f32_16x16x32_bf16 v[132:135], v[208:211], a[244:247], v[132:135]
    ds_read_b64_tr_b16 v[194:195], v34 offset:20480
    v_mfma_f32_16x16x32_bf16 v[136:139], v[208:211], a[248:251], v[136:139]
    v_mfma_f32_16x16x32_bf16 v[140:143], v[208:211], a[252:255], v[140:143]
    s_waitcnt lgkmcnt(6)
    v_mfma_f32_16x16x32_bf16 v[144:147], v[212:215], a[240:243], v[144:147]
    ds_read_b64_tr_b16 v[196:197], v34 offset:16392
    v_mfma_f32_16x16x32_bf16 v[148:151], v[212:215], a[244:247], v[148:151]
    ds_read_b64_tr_b16 v[198:199], v34 offset:20488
    v_mfma_f32_16x16x32_bf16 v[152:155], v[212:215], a[248:251], v[152:155]
    v_mfma_f32_16x16x32_bf16 v[156:159], v[212:215], a[252:255], v[156:159]
    s_waitcnt lgkmcnt(6)
    v_mfma_f32_16x16x32_bf16 v[160:163], v[216:219], a[240:243], v[160:163]
    ds_read_b64_tr_b16 v[200:201], v35 offset:16384
    v_mfma_f32_16x16x32_bf16 v[164:167], v[216:219], a[244:247], v[164:167]
    ds_read_b64_tr_b16 v[202:203], v35 offset:20480
    v_mfma_f32_16x16x32_bf16 v[168:171], v[216:219], a[248:251], v[168:171]
    s_add_u32 m0, s33, 0
    s_add_u32 s31, s34, 0
    buffer_load_dwordx4 v236, s[8:11], s31 offen offset:0 lds
    v_mfma_f32_16x16x32_bf16 v[172:175], v[216:219], a[252:255], v[172:175]
    buffer_load_dwordx4 v237, s[8:11], s31 offen offset:1024 lds
    s_waitcnt lgkmcnt(6)
    v_mfma_f32_16x16x32_bf16 v[176:179], v[220:223], a[240:243], v[176:179]
    ds_read_b64_tr_b16 v[204:205], v35 offset:16392
    v_mfma_f32_16x16x32_bf16 v[180:183], v[220:223], a[244:247], v[180:183]
    ds_read_b64_tr_b16 v[206:207], v35 offset:20488
    v_mfma_f32_16x16x32_bf16 v[184:187], v[220:223], a[248:251], v[184:187]
    buffer_load_dwordx4 v238, s[8:11], s31 offen offset:2048 lds
    v_mfma_f32_16x16x32_bf16 v[188:191], v[220:223], a[252:255], v[188:191]
    buffer_load_dwordx4 v239, s[8:11], s31 offen offset:3072 lds
    s_waitcnt vmcnt(63) lgkmcnt(6)
    v_mfma_f32_16x16x32_bf16 v[64:67], v[192:195], a[144:147], v[64:67]
    ds_read_b64_tr_b16 v[208:209], v36 offset:16384
    v_mfma_f32_16x16x32_bf16 v[68:71], v[192:195], a[148:151], v[68:71]
    ds_read_b64_tr_b16 v[210:211], v36 offset:20480
    v_mfma_f32_16x16x32_bf16 v[72:75], v[192:195], a[152:155], v[72:75]
    s_add_u32 m0, s33, 4096
    s_add_u32 s31, s34, 294912
    buffer_load_dwordx4 v236, s[8:11], s31 offen offset:0 lds
    v_mfma_f32_16x16x32_bf16 v[76:79], v[192:195], a[156:159], v[76:79]
    buffer_load_dwordx4 v237, s[8:11], s31 offen offset:1024 lds
    s_waitcnt lgkmcnt(6)
    v_mfma_f32_16x16x32_bf16 v[80:83], v[196:199], a[144:147], v[80:83]
    ds_read_b64_tr_b16 v[212:213], v36 offset:16392
    v_mfma_f32_16x16x32_bf16 v[84:87], v[196:199], a[148:151], v[84:87]
    ds_read_b64_tr_b16 v[214:215], v36 offset:20488
    v_mfma_f32_16x16x32_bf16 v[88:91], v[196:199], a[152:155], v[88:91]
    buffer_load_dwordx4 v238, s[8:11], s31 offen offset:2048 lds
    v_mfma_f32_16x16x32_bf16 v[92:95], v[196:199], a[156:159], v[92:95]
    buffer_load_dwordx4 v239, s[8:11], s31 offen offset:3072 lds
    s_waitcnt lgkmcnt(6)
    v_mfma_f32_16x16x32_bf16 v[96:99], v[200:203], a[144:147], v[96:99]
    ds_read_b64_tr_b16 v[216:217], v37 offset:16384
    v_mfma_f32_16x16x32_bf16 v[100:103], v[200:203], a[148:151], v[100:103]
    ds_read_b64_tr_b16 v[218:219], v37 offset:20480
    v_mfma_f32_16x16x32_bf16 v[104:107], v[200:203], a[152:155], v[104:107]
    s_add_u32 m0, s33, 8192
    s_add_u32 s31, s34, 589824
    buffer_load_dwordx4 v236, s[8:11], s31 offen offset:0 lds
    v_mfma_f32_16x16x32_bf16 v[108:111], v[200:203], a[156:159], v[108:111]
    s_add_u32 m0, s33, 40960
    s_add_u32 s31, s34, 2654208
    buffer_load_dwordx4 v236, s[8:11], s31 offen offset:0 lds
    s_waitcnt lgkmcnt(6)
    v_mfma_f32_16x16x32_bf16 v[112:115], v[204:207], a[144:147], v[112:115]
    ds_read_b64_tr_b16 v[220:221], v37 offset:16392
    v_mfma_f32_16x16x32_bf16 v[116:119], v[204:207], a[148:151], v[116:119]
    ds_read_b64_tr_b16 v[222:223], v37 offset:20488
    v_mfma_f32_16x16x32_bf16 v[120:123], v[204:207], a[152:155], v[120:123]
    buffer_load_dwordx4 v237, s[8:11], s31 offen offset:1024 lds
    v_mfma_f32_16x16x32_bf16 v[124:127], v[204:207], a[156:159], v[124:127]
    buffer_load_dwordx4 v238, s[8:11], s31 offen offset:2048 lds
    s_waitcnt lgkmcnt(6)
    v_mfma_f32_16x16x32_bf16 v[128:131], v[208:211], a[144:147], v[128:131]
    ds_read_b64_tr_b16 v[192:193], v34 offset:24576
    v_mfma_f32_16x16x32_bf16 v[132:135], v[208:211], a[148:151], v[132:135]
    ds_read_b64_tr_b16 v[194:195], v34 offset:28672
    v_mfma_f32_16x16x32_bf16 v[136:139], v[208:211], a[152:155], v[136:139]
    buffer_load_dwordx4 v239, s[8:11], s31 offen offset:3072 lds
    v_mfma_f32_16x16x32_bf16 v[140:143], v[208:211], a[156:159], v[140:143]
    s_add_u32 m0, s33, 45056
    s_add_u32 s31, s34, 2949120
    buffer_load_dwordx4 v236, s[8:11], s31 offen offset:0 lds
    s_waitcnt lgkmcnt(6)
    v_mfma_f32_16x16x32_bf16 v[144:147], v[212:215], a[144:147], v[144:147]
    ds_read_b64_tr_b16 v[196:197], v34 offset:24584
    v_mfma_f32_16x16x32_bf16 v[148:151], v[212:215], a[148:151], v[148:151]
    ds_read_b64_tr_b16 v[198:199], v34 offset:28680
    v_mfma_f32_16x16x32_bf16 v[152:155], v[212:215], a[152:155], v[152:155]
    buffer_load_dwordx4 v237, s[8:11], s31 offen offset:1024 lds
    v_mfma_f32_16x16x32_bf16 v[156:159], v[212:215], a[156:159], v[156:159]
    buffer_load_dwordx4 v238, s[8:11], s31 offen offset:2048 lds
    s_waitcnt lgkmcnt(6)
    v_mfma_f32_16x16x32_bf16 v[160:163], v[216:219], a[144:147], v[160:163]
    ds_read_b64_tr_b16 v[200:201], v35 offset:24576
    v_mfma_f32_16x16x32_bf16 v[164:167], v[216:219], a[148:151], v[164:167]
    ds_read_b64_tr_b16 v[202:203], v35 offset:28672
    v_mfma_f32_16x16x32_bf16 v[168:171], v[216:219], a[152:155], v[168:171]
    buffer_load_dwordx4 v239, s[8:11], s31 offen offset:3072 lds
    v_mfma_f32_16x16x32_bf16 v[172:175], v[216:219], a[156:159], v[172:175]
    s_add_u32 m0, s33, 49152
    s_add_u32 s31, s34, 3244032
    buffer_load_dwordx4 v236, s[8:11], s31 offen offset:0 lds
    s_waitcnt lgkmcnt(6)
    v_mfma_f32_16x16x32_bf16 v[176:179], v[220:223], a[144:147], v[176:179]
    ds_read_b64_tr_b16 v[204:205], v35 offset:24584
    v_mfma_f32_16x16x32_bf16 v[180:183], v[220:223], a[148:151], v[180:183]
    ds_read_b64_tr_b16 v[206:207], v35 offset:28680
    v_mfma_f32_16x16x32_bf16 v[184:187], v[220:223], a[152:155], v[184:187]
    v_mfma_f32_16x16x32_bf16 v[188:191], v[220:223], a[156:159], v[188:191]
    s_waitcnt vmcnt(63) lgkmcnt(6)
    v_mfma_f32_16x16x32_bf16 v[64:67], v[192:195], a[160:163], v[64:67]
    ds_read_b64_tr_b16 v[208:209], v36 offset:24576
    v_mfma_f32_16x16x32_bf16 v[68:71], v[192:195], a[164:167], v[68:71]
    ds_read_b64_tr_b16 v[210:211], v36 offset:28672
    v_mfma_f32_16x16x32_bf16 v[72:75], v[192:195], a[168:171], v[72:75]
    v_mfma_f32_16x16x32_bf16 v[76:79], v[192:195], a[172:175], v[76:79]
    s_waitcnt lgkmcnt(6)
    v_mfma_f32_16x16x32_bf16 v[80:83], v[196:199], a[160:163], v[80:83]
    ds_read_b64_tr_b16 v[212:213], v36 offset:24584
    v_mfma_f32_16x16x32_bf16 v[84:87], v[196:199], a[164:167], v[84:87]
    ds_read_b64_tr_b16 v[214:215], v36 offset:28680
    v_mfma_f32_16x16x32_bf16 v[88:91], v[196:199], a[168:171], v[88:91]
    v_mfma_f32_16x16x32_bf16 v[92:95], v[196:199], a[172:175], v[92:95]
    s_mov_b32 s5, 32768
    buffer_load_dwordx2 v[24:25], v14, s[44:47], s5 offen sc1
    s_waitcnt lgkmcnt(6)
    v_mfma_f32_16x16x32_bf16 v[96:99], v[200:203], a[160:163], v[96:99]
    ds_read_b64_tr_b16 v[216:217], v37 offset:24576
    v_mfma_f32_16x16x32_bf16 v[100:103], v[200:203], a[164:167], v[100:103]
    ds_read_b64_tr_b16 v[218:219], v37 offset:28672
    v_mfma_f32_16x16x32_bf16 v[104:107], v[200:203], a[168:171], v[104:107]
    v_mfma_f32_16x16x32_bf16 v[108:111], v[200:203], a[172:175], v[108:111]
    s_waitcnt lgkmcnt(6)
    v_mfma_f32_16x16x32_bf16 v[112:115], v[204:207], a[160:163], v[112:115]
    ds_read_b64_tr_b16 v[220:221], v37 offset:24584
    v_mfma_f32_16x16x32_bf16 v[116:119], v[204:207], a[164:167], v[116:119]
    ds_read_b64_tr_b16 v[222:223], v37 offset:28680
    v_mfma_f32_16x16x32_bf16 v[120:123], v[204:207], a[168:171], v[120:123]
    v_mfma_f32_16x16x32_bf16 v[124:127], v[204:207], a[172:175], v[124:127]
    s_waitcnt lgkmcnt(6)
    v_mfma_f32_16x16x32_bf16 v[128:131], v[208:211], a[160:163], v[128:131]
    s_waitcnt vmcnt(63)
    s_barrier
    ds_read_b64_tr_b16 v[192:193], v34 offset:32768
    v_mfma_f32_16x16x32_bf16 v[132:135], v[208:211], a[164:167], v[132:135]
    ds_read_b64_tr_b16 v[194:195], v34 offset:36864
    v_mfma_f32_16x16x32_bf16 v[136:139], v[208:211], a[168:171], v[136:139]
    v_mfma_f32_16x16x32_bf16 v[140:143], v[208:211], a[172:175], v[140:143]
    s_waitcnt lgkmcnt(6)
    v_mfma_f32_16x16x32_bf16 v[144:147], v[212:215], a[160:163], v[144:147]
    ds_read_b64_tr_b16 v[196:197], v34 offset:32776
    v_mfma_f32_16x16x32_bf16 v[148:151], v[212:215], a[164:167], v[148:151]
    ds_read_b64_tr_b16 v[198:199], v34 offset:36872
    v_mfma_f32_16x16x32_bf16 v[152:155], v[212:215], a[168:171], v[152:155]
    v_mfma_f32_16x16x32_bf16 v[156:159], v[212:215], a[172:175], v[156:159]
    s_waitcnt lgkmcnt(6)
    v_mfma_f32_16x16x32_bf16 v[160:163], v[216:219], a[160:163], v[160:163]
    ds_read_b64_tr_b16 v[200:201], v35 offset:32768
    v_mfma_f32_16x16x32_bf16 v[164:167], v[216:219], a[164:167], v[164:167]
    ds_read_b64_tr_b16 v[202:203], v35 offset:36864
    v_mfma_f32_16x16x32_bf16 v[168:171], v[216:219], a[168:171], v[168:171]
    v_mfma_f32_16x16x32_bf16 v[172:175], v[216:219], a[172:175], v[172:175]
    s_waitcnt lgkmcnt(6)
    v_mfma_f32_16x16x32_bf16 v[176:179], v[220:223], a[160:163], v[176:179]
    ds_read_b64_tr_b16 v[204:205], v35 offset:32776
    v_mfma_f32_16x16x32_bf16 v[180:183], v[220:223], a[164:167], v[180:183]
    ds_read_b64_tr_b16 v[206:207], v35 offset:36872
    v_mfma_f32_16x16x32_bf16 v[184:187], v[220:223], a[168:171], v[184:187]
    v_mfma_f32_16x16x32_bf16 v[188:191], v[220:223], a[172:175], v[188:191]
    s_waitcnt vmcnt(0)
    v_cmp_eq_u64 vcc, s[62:63], v[24:25]
    s_nop 1
    s_cmp_eq_u64 vcc, exec
    s_cbranch_scc1 L_pk_17
    s_mov_b32 s3, 0x40000
    s_mov_b32 s5, 32768
L_fw_18:
    buffer_load_dwordx2 v[24:25], v14, s[44:47], s5 offen sc1
    s_sub_u32 s3, s3, 1
    s_cbranch_scc1 L_fd_19
    s_waitcnt vmcnt(0)
    v_cmp_eq_u64 vcc, s[62:63], v[24:25]
    s_nop 1
    s_cmp_eq_u64 vcc, exec
    s_cbranch_scc0 L_fw_18
L_fd_19:
    s_waitcnt vmcnt(0)
L_pk_17:
    s_waitcnt vmcnt(63) lgkmcnt(6)
    v_mfma_f32_16x16x32_bf16 v[64:67], v[192:195], a[176:179], v[64:67]
    ds_read_b64_tr_b16 v[208:209], v36 offset:32768
    v_mfma_f32_16x16x32_bf16 v[68:71], v[192:195], a[180:183], v[68:71]
    ds_read_b64_tr_b16 v[210:211], v36 offset:36864
    v_mfma_f32_16x16x32_bf16 v[72:75], v[192:195], a[184:187], v[72:75]
    v_mfma_f32_16x16x32_bf16 v[76:79], v[192:195], a[188:191], v[76:79]
    s_waitcnt lgkmcnt(6)
    v_mfma_f32_16x16x32_bf16 v[80:83], v[196:199], a[176:179], v[80:83]
    ds_read_b64_tr_b16 v[212:213], v36 offset:32776
    v_mfma_f32_16x16x32_bf16 v[84:87], v[196:199], a[180:183], v[84:87]
    ds_read_b64_tr_b16 v[214:215], v36 offset:36872
    v_mfma_f32_16x16x32_bf16 v[88:91], v[196:199], a[184:187], v[88:91]
    s_add_u32 m0, s28, 77824
    s_add_u32 s31, s34, 0
    buffer_load_dwordx4 v240, s[24:27], s31 offen sc1 lds
    v_mfma_f32_16x16x32_bf16 v[92:95], v[196:199], a[188:191], v[92:95]
    s_mov_b32 s32, 0
    buffer_load_dwordx2 v[224:225], v17, s[36:39], s32 offen sc1
    s_waitcnt lgkmcnt(6)
    v_mfma_f32_16x16x32_bf16 v[96:99], v[200:203], a[176:179], v[96:99]
    ds_read_b64_tr_b16 v[216:217], v37 offset:32768
    v_mfma_f32_16x16x32_bf16 v[100:103], v[200:203], a[180:183], v[100:103]
    ds_read_b64_tr_b16 v[218:219], v37 offset:36864
    v_mfma_f32_16x16x32_bf16 v[104:107], v[200:203], a[184:187], v[104:107]
    s_mov_b32 s32, 16384
    buffer_load_dwordx2 v[226:227], v17, s[36:39], s32 offen sc1
    v_mfma_f32_16x16x32_bf16 v[108:111], v[200:203], a[188:191], v[108:111]
    s_mov_b32 s32, 32768
    buffer_load_dwordx2 v[228:229], v17, s[36:39], s32 offen sc1
    s_waitcnt lgkmcnt(6)
    v_mfma_f32_16x16x32_bf16 v[112:115], v[204:207], a[176:179], v[112:115]
    ds_read_b64_tr_b16 v[220:221], v37 offset:32776
    v_mfma_f32_16x16x32_bf16 v[116:119], v[204:207], a[180:183], v[116:119]
    ds_read_b64_tr_b16 v[222:223], v37 offset:36872
    v_mfma_f32_16x16x32_bf16 v[120:123], v[204:207], a[184:187], v[120:123]
    s_mov_b32 s32, 49152
    buffer_load_dwordx2 v[230:231], v17, s[36:39], s32 offen sc1
    v_mfma_f32_16x16x32_bf16 v[124:127], v[204:207], a[188:191], v[124:127]
    s_mov_b32 s32, 65536
    buffer_load_dwordx2 v[232:233], v17, s[36:39], s32 offen sc1
    s_waitcnt lgkmcnt(6)
    v_mfma_f32_16x16x32_bf16 v[128:131], v[208:211], a[176:179], v[128:131]
    ds_read_b64_tr_b16 v[192:193], v34 offset:40960
    v_mfma_f32_16x16x32_bf16 v[132:135], v[208:211], a[180:183], v[132:135]
    ds_read_b64_tr_b16 v[194:195], v34 offset:45056
    v_mfma_f32_16x16x32_bf16 v[136:139], v[208:211], a[184:187], v[136:139]
    s_mov_b32 s32, 81920
    buffer_load_dwordx2 v[234:235], v17, s[36:39], s32 offen sc1
    v_mfma_f32_16x16x32_bf16 v[140:143], v[208:211], a[188:191], v[140:143]
    s_mov_b32 s32, 0
    buffer_load_dwordx4 a[0:3], v13, s[12:15], s32 offen offset:0 sc1
    s_waitcnt lgkmcnt(6)
    v_mfma_f32_16x16x32_bf16 v[144:147], v[212:215], a[176:179], v[144:147]
    ds_read_b64_tr_b16 v[196:197], v34 offset:40968
    v_mfma_f32_16x16x32_bf16 v[148:151], v[212:215], a[180:183], v[148:151]
    ds_read_b64_tr_b16 v[198:199], v34 offset:45064
    v_mfma_f32_16x16x32_bf16 v[152:155], v[212:215], a[184:187], v[152:155]
    buffer_load_dwordx4 a[4:7], v13, s[12:15], s32 offen offset:512 sc1
    v_mfma_f32_16x16x32_bf16 v[156:159], v[212:215], a[188:191], v[156:159]
    buffer_load_dwordx4 a[8:11], v13, s[12:15], s32 offen offset:1024 sc1
    s_waitcnt lgkmcnt(6)
    v_mfma_f32_16x16x32_bf16 v[160:163], v[216:219], a[176:179], v[160:163]
    ds_read_b64_tr_b16 v[200:201], v35 offset:40960
    v_mfma_f32_16x16x32_bf16 v[164:167], v[216:219], a[180:183], v[164:167]
    ds_read_b64_tr_b16 v[202:203], v35 offset:45056
    v_mfma_f32_16x16x32_bf16 v[168:171], v[216:219], a[184:187], v[168:171]
    buffer_load_dwordx4 a[12:15], v13, s[12:15], s32 offen offset:1536 sc1
    v_mfma_f32_16x16x32_bf16 v[172:175], v[216:219], a[188:191], v[172:175]
    buffer_load_dwordx4 a[16:19], v13, s[12:15], s32 offen offset:2048 sc1
    s_waitcnt lgkmcnt(6)
    v_mfma_f32_16x16x32_bf16 v[176:179], v[220:223], a[176:179], v[176:179]
    ds_read_b64_tr_b16 v[204:205], v35 offset:40968
    v_mfma_f32_16x16x32_bf16 v[180:183], v[220:223], a[180:183], v[180:183]
    ds_read_b64_tr_b16 v[206:207], v35 offset:45064
    v_mfma_f32_16x16x32_bf16 v[184:187], v[220:223], a[184:187], v[184:187]
    buffer_load_dwordx4 a[20:23], v13, s[12:15], s32 offen offset:2560 sc1
    v_mfma_f32_16x16x32_bf16 v[188:191], v[220:223], a[188:191], v[188:191]
    buffer_load_dwordx4 a[24:27], v13, s[12:15], s32 offen offset:3072 sc1
    s_waitcnt vmcnt(63) lgkmcnt(6)
    v_mfma_f32_16x16x32_bf16 v[64:67], v[192:195], a[192:195], v[64:67]
    ds_read_b64_tr_b16 v[208:209], v36 offset:40960
    v_mfma_f32_16x16x32_bf16 v[68:71], v[192:195], a[196:199], v[68:71]
    ds_read_b64_tr_b16 v[210:211], v36 offset:45056
    v_mfma_f32_16x16x32_bf16 v[72:75], v[192:195], a[200:203], v[72:75]
    buffer_load_dwordx4 a[28:31], v13, s[12:15], s32 offen offset:3584 sc1
    v_mfma_f32_16x16x32_bf16 v[76:79], v[192:195], a[204:207], v[76:79]
    s_mov_b32 s32, 4096
    buffer_load_dwordx4 a[32:35], v13, s[12:15], s32 offen offset:0 sc1
    s_waitcnt lgkmcnt(6)
    v_mfma_f32_16x16x32_bf16 v[80:83], v[196:199], a[192:195], v[80:83]
    ds_read_b64_tr_b16 v[212:213], v36 offset:40968
    v_mfma_f32_16x16x32_bf16 v[84:87], v[196:199], a[196:199], v[84:87]
    ds_read_b64_tr_b16 v[214:215], v36 offset:45064
    v_mfma_f32_16x16x32_bf16 v[88:91], v[196:199], a[200:203], v[88:91]
    buffer_load_dwordx4 a[36:39], v13, s[12:15], s32 offen offset:512 sc1
    v_mfma_f32_16x16x32_bf16 v[92:95], v[196:199], a[204:207], v[92:95]
    buffer_load_dwordx4 a[40:43], v13, s[12:15], s32 offen offset:1024 sc1
    s_waitcnt lgkmcnt(6)
    v_mfma_f32_16x16x32_bf16 v[96:99], v[200:203], a[192:195], v[96:99]
    ds_read_b64_tr_b16 v[216:217], v37 offset:40960
    v_mfma_f32_16x16x32_bf16 v[100:103], v[200:203], a[196:199], v[100:103]
    ds_read_b64_tr_b16 v[218:219], v37 offset:45056
    v_mfma_f32_16x16x32_bf16 v[104:107], v[200:203], a[200:203], v[104:107]
    buffer_load_dwordx4 a[44:47], v13, s[12:15], s32 offen offset:1536 sc1
    v_mfma_f32_16x16x32_bf16 v[108:111], v[200:203], a[204:207], v[108:111]
    buffer_load_dwordx4 a[48:51], v13, s[12:15], s32 offen offset:2048 sc1
    s_waitcnt lgkmcnt(6)
    v_mfma_f32_16x16x32_bf16 v[112:115], v[204:207], a[192:195], v[112:115]
    ds_read_b64_tr_b16 v[220:221], v37 offset:40968
    v_mfma_f32_16x16x32_bf16 v[116:119], v[204:207], a[196:199], v[116:119]
    ds_read_b64_tr_b16 v[222:223], v37 offset:45064
    v_mfma_f32_16x16x32_bf16 v[120:123], v[204:207], a[200:203], v[120:123]
    buffer_load_dwordx4 a[52:55], v13, s[12:15], s32 offen offset:2560 sc1
    v_mfma_f32_16x16x32_bf16 v[124:127], v[204:207], a[204:207], v[124:127]
    buffer_load_dwordx4 a[56:59], v13, s[12:15], s32 offen offset:3072 sc1
    s_waitcnt lgkmcnt(6)
    v_mfma_f32_16x16x32_bf16 v[128:131], v[208:211], a[192:195], v[128:131]
    v_mfma_f32_16x16x32_bf16 v[132:135], v[208:211], a[196:199], v[132:135]
    v_mfma_f32_16x16x32_bf16 v[136:139], v[208:211], a[200:203], v[136:139]
    buffer_load_dwordx4 a[60:63], v13, s[12:15], s32 offen offset:3584 sc1
    v_mfma_f32_16x16x32_bf16 v[140:143], v[208:211], a[204:207], v[140:143]
    s_mov_b32 s32, 8192
    buffer_load_dwordx4 a[64:67], v13, s[12:15], s32 offen offset:0 sc1
    s_waitcnt lgkmcnt(4)
    v_mfma_f32_16x16x32_bf16 v[144:147], v[212:215], a[192:195], v[144:147]
    v_mfma_f32_16x16x32_bf16 v[148:151], v[212:215], a[196:199], v[148:151]
    v_mfma_f32_16x16x32_bf16 v[152:155], v[212:215], a[200:203], v[152:155]
    buffer_load_dwordx4 a[68:71], v13, s[12:15], s32 offen offset:512 sc1
    v_mfma_f32_16x16x32_bf16 v[156:159], v[212:215], a[204:207], v[156:159]
    buffer_load_dwordx4 a[72:75], v13, s[12:15], s32 offen offset:1024 sc1
    s_waitcnt lgkmcnt(2)
    v_mfma_f32_16x16x32_bf16 v[160:163], v[216:219], a[192:195], v[160:163]
    v_mfma_f32_16x16x32_bf16 v[164:167], v[216:219], a[196:199], v[164:167]
    v_mfma_f32_16x16x32_bf16 v[168:171], v[216:219], a[200:203], v[168:171]
    buffer_load_dwordx4 a[76:79], v13, s[12:15], s32 offen offset:1536 sc1
    v_mfma_f32_16x16x32_bf16 v[172:175], v[216:219], a[204:207], v[172:175]
    buffer_load_dwordx4 a[80:83], v13, s[12:15], s32 offen offset:2048 sc1
    s_waitcnt lgkmcnt(0)
    v_mfma_f32_16x16x32_bf16 v[176:179], v[220:223], a[192:195], v[176:179]
    v_mfma_f32_16x16x32_bf16 v[180:183], v[220:223], a[196:199], v[180:183]
    v_mfma_f32_16x16x32_bf16 v[184:187], v[220:223], a[200:203], v[184:187]
    buffer_load_dwordx4 a[84:87], v13, s[12:15], s32 offen offset:2560 sc1
    v_mfma_f32_16x16x32_bf16 v[188:191], v[220:223], a[204:207], v[188:191]
    buffer_load_dwordx4 a[88:91], v13, s[12:15], s32 offen offset:3072 sc1
    buffer_load_dwordx4 a[92:95], v13, s[12:15], s32 offen offset:3584 sc1
    s_mov_b32 s32, 12288
    buffer_load_dwordx4 a[96:99], v13, s[12:15], s32 offen offset:0 sc1
    buffer_load_dwordx4 a[100:103], v13, s[12:15], s32 offen offset:512 sc1
    buffer_load_dwordx4 a[104:107], v13, s[12:15], s32 offen offset:1024 sc1
    buffer_load_dwordx4 a[108:111], v13, s[12:15], s32 offen offset:1536 sc1
    buffer_load_dwordx4 a[112:115], v13, s[12:15], s32 offen offset:2048 sc1
    buffer_load_dwordx4 a[116:119], v13, s[12:15], s32 offen offset:2560 sc1
    buffer_load_dwordx4 a[120:123], v13, s[12:15], s32 offen offset:3072 sc1
    buffer_load_dwordx4 a[124:127], v13, s[12:15], s32 offen offset:3584 sc1
    s_mov_b32 s32, 16384
    buffer_load_dwordx4 a[128:131], v13, s[12:15], s32 offen offset:0 sc1
    buffer_load_dwordx4 a[132:135], v13, s[12:15], s32 offen offset:512 sc1
    buffer_load_dwordx4 a[136:139], v13, s[12:15], s32 offen offset:1024 sc1
    buffer_load_dwordx4 a[140:143], v13, s[12:15], s32 offen offset:1536 sc1
    s_mov_b32 s100, 0x3e0293ee
    s_barrier
    s_add_u32 m0, s33, 81920
    s_add_u32 s31, s34, 128
    buffer_load_dwordx4 v236, s[8:11], s31 offen offset:0 lds
    buffer_load_dwordx4 v237, s[8:11], s31 offen offset:1024 lds
    buffer_load_dwordx4 v238, s[8:11], s31 offen offset:2048 lds
    buffer_load_dwordx4 v239, s[8:11], s31 offen offset:3072 lds
    s_add_u32 m0, s33, 86016
    s_add_u32 s31, s34, 295040
    buffer_load_dwordx4 v236, s[8:11], s31 offen offset:0 lds
    buffer_load_dwordx4 v237, s[8:11], s31 offen offset:1024 lds
    buffer_load_dwordx4 v238, s[8:11], s31 offen offset:2048 lds
    buffer_load_dwordx4 v239, s[8:11], s31 offen offset:3072 lds
    s_add_u32 m0, s33, 90112
    s_add_u32 s31, s34, 589952
    buffer_load_dwordx4 v236, s[8:11], s31 offen offset:0 lds
    s_add_u32 m0, s33, 122880
    s_add_u32 s31, s34, 2654336
    buffer_load_dwordx4 v236, s[8:11], s31 offen offset:0 lds
    buffer_load_dwordx4 v237, s[8:11], s31 offen offset:1024 lds
    buffer_load_dwordx4 v238, s[8:11], s31 offen offset:2048 lds
    buffer_load_dwordx4 v239, s[8:11], s31 offen offset:3072 lds
    s_add_u32 m0, s33, 126976
    s_add_u32 s31, s34, 2949248
    buffer_load_dwordx4 v236, s[8:11], s31 offen offset:0 lds
    buffer_load_dwordx4 v237, s[8:11], s31 offen offset:1024 lds
    buffer_load_dwordx4 v238, s[8:11], s31 offen offset:2048 lds
    buffer_load_dwordx4 v239, s[8:11], s31 offen offset:3072 lds
    s_add_u32 m0, s33, 131072
    s_add_u32 s31, s34, 3244160
    buffer_load_dwordx4 v236, s[8:11], s31 offen offset:0 lds
    s_add_u32 m0, s28, 159744
    s_add_u32 s31, s34, 128
    buffer_load_dwordx4 v240, s[24:27], s31 offen sc1 lds
    s_waitcnt vmcnt(55)
    s_barrier
    ds_read_b64_tr_b16 a[144:145], v46 offset:0
    ds_read_b64_tr_b16 a[146:147], v46 offset:512
    ds_read_b64_tr_b16 a[148:149], v47 offset:0
    ds_read_b64_tr_b16 a[150:151], v47 offset:512
    ds_read_b64_tr_b16 a[152:153], v46 offset:2048
    ds_read_b64_tr_b16 a[154:155], v46 offset:2560
    ds_read_b64_tr_b16 a[156:157], v47 offset:2048
    ds_read_b64_tr_b16 a[158:159], v47 offset:2560
    v_add_f32 v241, v224, v226
    v_add_f32 v241, v241, v228
    v_add_f32 v241, v241, v230
    v_add_f32 v241, v241, v232
    v_add_f32 v241, v241, v234
    v_mov_b32 v243, v241
    s_nop 1
    v_permlane32_swap_b32 v241, v243
    v_add_f32 v241, v241, v243
    v_mul_f32 v241, 0x3ae38e39, v241
    v_add_f32 v242, v225, v227
    v_add_f32 v242, v242, v229
    v_add_f32 v242, v242, v231
    v_add_f32 v242, v242, v233
    v_add_f32 v242, v242, v235
    v_fma_f32 v243, v224, v22, -v241
    v_mul_f32 v244, v23, v243
    v_fmac_f32 v242, v243, v244
    v_fma_f32 v243, v226, v22, -v241
    v_mul_f32 v244, v23, v243
    v_fmac_f32 v242, v243, v244
    v_fma_f32 v243, v228, v22, -v241
    v_mul_f32 v244, v23, v243
    v_fmac_f32 v242, v243, v244
    v_fma_f32 v243, v230, v22, -v241
    v_mul_f32 v244, v23, v243
    v_fmac_f32 v242, v243, v244
    v_fma_f32 v243, v232, v22, -v241
    v_mul_f32 v244, v23, v243
    v_fmac_f32 v242, v243, v244
    v_fma_f32 v243, v234, v22, -v241
    v_mul_f32 v244, v23, v243
    v_fmac_f32 v242, v243, v244
    v_mov_b32 v243, v242
    s_nop 1
    v_permlane32_swap_b32 v242, v243
    v_add_f32 v242, v242, v243
    v_mul_f32 v242, 0x3ae38e39, v242
    v_cvt_pk_bf16_f32 v241, v241, v241
    v_lshlrev_b32 v241, 16, v241
    v_cvt_pk_bf16_f32 v242, v242, v242
    v_lshlrev_b32 v242, 16, v242
    v_add_f32 v242, 0x3727c5ac, v242
    v_cvt_pk_bf16_f32 v242, v242, v242
    v_lshlrev_b32 v242, 16, v242
    v_sqrt_f32 v242, v242
    v_xor_b32 v241, 0x80000000, v241
    v_cvt_pk_bf16_f32 v242, v242, v242
    v_lshlrev_b32 v242, 16, v242
    v_rcp_f32 v242, v242
    v_lshrrev_b32 v243, 16, v241
    v_or_b32 v241, v241, v243
    v_and_b32 v56, v241, v16
    v_mov_b32 v57, 0
    v_mov_b32 v58, 0
    v_mov_b32 v59, 0
    v_mul_f32 v60, 0xc0135761, v242
    v_mul_f32 v243, v242, v242
    v_mul_f32 v243, 0x3d372713, v243
    v_mul_f32 v61, v243, v60
    buffer_store_dword v242, v18, s[40:43], 0 offen sc1
    s_waitcnt vmcnt(52) lgkmcnt(4)
    v_mfma_f32_32x32x16_bf16 v[192:207], a[144:147], a[0:3], 0
    ds_read_b64_tr_b16 a[160:161], v46 offset:4096
    ds_read_b64_tr_b16 a[162:163], v46 offset:4608
    v_mfma_f32_32x32x16_bf16 v[208:223], a[148:151], a[0:3], 0
    ds_read_b64_tr_b16 a[164:165], v47 offset:4096
    ds_read_b64_tr_b16 a[166:167], v47 offset:4608
    s_waitcnt lgkmcnt(4)
    v_mfma_f32_32x32x16_bf16 v[192:207], a[152:155], a[4:7], v[192:207]
    ds_read_b64_tr_b16 a[168:169], v46 offset:6144
    ds_read_b64_tr_b16 a[170:171], v46 offset:6656
    v_mul_f32 v64, s100, v64
    v_mul_f32 v65, s100, v65
    v_mul_f32 v66, s100, v66
    v_mul_f32 v67, s100, v67
    v_mfma_f32_32x32x16_bf16 v[208:223], a[156:159], a[4:7], v[208:223]
    ds_read_b64_tr_b16 a[172:173], v47 offset:6144
    ds_read_b64_tr_b16 a[174:175], v47 offset:6656
    v_cvt_pk_bf16_f32 v64, v64, v65
    v_cvt_pk_bf16_f32 v65, v66, v67
    v_accvgpr_write_b32 a192, v64
    v_accvgpr_write_b32 a193, v65
    s_waitcnt lgkmcnt(4)
    v_mfma_f32_32x32x16_bf16 v[192:207], a[160:163], a[8:11], v[192:207]
    ds_read_b64_tr_b16 a[144:145], v46 offset:8192
    ds_read_b64_tr_b16 a[146:147], v46 offset:8704
    v_mul_f32 v68, s100, v68
    v_mul_f32 v69, s100, v69
    v_mul_f32 v70, s100, v70
    v_mul_f32 v71, s100, v71
    v_mfma_f32_32x32x16_bf16 v[208:223], a[164:167], a[8:11], v[208:223]
    ds_read_b64_tr_b16 a[148:149], v47 offset:8192
    ds_read_b64_tr_b16 a[150:151], v47 offset:8704
    v_cvt_pk_bf16_f32 v68, v68, v69
    v_cvt_pk_bf16_f32 v69, v70, v71
    v_accvgpr_write_b32 a208, v68
    v_accvgpr_write_b32 a209, v69
    s_waitcnt lgkmcnt(4)
    v_mfma_f32_32x32x16_bf16 v[192:207], a[168:171], a[12:15], v[192:207]
    ds_read_b64_tr_b16 a[152:153], v46 offset:10240
    ds_read_b64_tr_b16 a[154:155], v46 offset:10752
    v_mul_f32 v72, s100, v72
    v_mul_f32 v73, s100, v73
    v_mul_f32 v74, s100, v74
    v_mul_f32 v75, s100, v75
    v_mfma_f32_32x32x16_bf16 v[208:223], a[172:175], a[12:15], v[208:223]
    ds_read_b64_tr_b16 a[156:157], v47 offset:10240
    ds_read_b64_tr_b16 a[158:159], v47 offset:10752
    v_cvt_pk_bf16_f32 v72, v72, v73
    v_cvt_pk_bf16_f32 v73, v74, v75
    v_accvgpr_write_b32 a224, v72
    v_accvgpr_write_b32 a225, v73
    s_waitcnt vmcnt(48) lgkmcnt(4)
    v_mfma_f32_32x32x16_bf16 v[192:207], a[144:147], a[16:19], v[192:207]
    ds_read_b64_tr_b16 a[160:161], v46 offset:12288
    ds_read_b64_tr_b16 a[162:163], v46 offset:12800
    v_mul_f32 v76, s100, v76
    v_mul_f32 v77, s100, v77
    v_mul_f32 v78, s100, v78
    v_mul_f32 v79, s100, v79
    v_mfma_f32_32x32x16_bf16 v[208:223], a[148:151], a[16:19], v[208:223]
    ds_read_b64_tr_b16 a[164:165], v47 offset:12288
    ds_read_b64_tr_b16 a[166:167], v47 offset:12800
    v_cvt_pk_bf16_f32 v76, v76, v77
    v_cvt_pk_bf16_f32 v77, v78, v79
    v_accvgpr_write_b32 a240, v76
    v_accvgpr_write_b32 a241, v77
    s_waitcnt lgkmcnt(4)
    v_mfma_f32_32x32x16_bf16 v[192:207], a[152:155], a[20:23], v[192:207]
    ds_read_b64_tr_b16 a[168:169], v46 offset:14336
    ds_read_b64_tr_b16 a[170:171], v46 offset:14848
    v_mul_f32 v80, s100, v80
    v_mul_f32 v81, s100, v81
    v_mul_f32 v82, s100, v82
    v_mul_f32 v83, s100, v83
    v_mfma_f32_32x32x16_bf16 v[208:223], a[156:159], a[20:23], v[208:223]
    ds_read_b64_tr_b16 a[172:173], v47 offset:14336
    ds_read_b64_tr_b16 a[174:175], v47 offset:14848
    v_cvt_pk_bf16_f32 v80, v80, v81
    v_cvt_pk_bf16_f32 v81, v82, v83
    v_accvgpr_write_b32 a194, v80
    v_accvgpr_write_b32 a195, v81
    s_waitcnt lgkmcnt(4)
    v_mfma_f32_32x32x16_bf16 v[192:207], a[160:163], a[24:27], v[192:207]
    ds_read_b64_tr_b16 a[144:145], v46 offset:16384
    ds_read_b64_tr_b16 a[146:147], v46 offset:16896
    v_mul_f32 v84, s100, v84
    v_mul_f32 v85, s100, v85
    v_mul_f32 v86, s100, v86
    v_mul_f32 v87, s100, v87
    v_mfma_f32_32x32x16_bf16 v[208:223], a[164:167], a[24:27], v[208:223]
    ds_read_b64_tr_b16 a[148:149], v47 offset:16384
    ds_read_b64_tr_b16 a[150:151], v47 offset:16896
    v_cvt_pk_bf16_f32 v84, v84, v85
    v_cvt_pk_bf16_f32 v85, v86, v87
    v_accvgpr_write_b32 a210, v84
    v_accvgpr_write_b32 a211, v85
    s_waitcnt lgkmcnt(4)
    v_mfma_f32_32x32x16_bf16 v[192:207], a[168:171], a[28:31], v[192:207]
    ds_read_b64_tr_b16 a[152:153], v46 offset:18432
    ds_read_b64_tr_b16 a[154:155], v46 offset:18944
    v_mul_f32 v88, s100, v88
    v_mul_f32 v89, s100, v89
    v_mul_f32 v90, s100, v90
    v_mul_f32 v91, s100, v91
    v_mfma_f32_32x32x16_bf16 v[208:223], a[172:175], a[28:31], v[208:223]
    ds_read_b64_tr_b16 a[156:157], v47 offset:18432
    ds_read_b64_tr_b16 a[158:159], v47 offset:18944
    v_cvt_pk_bf16_f32 v88, v88, v89
    v_cvt_pk_bf16_f32 v89, v90, v91
    v_accvgpr_write_b32 a226, v88
    v_accvgpr_write_b32 a227, v89
    s_waitcnt vmcnt(44) lgkmcnt(4)
    v_mfma_f32_32x32x16_bf16 v[192:207], a[144:147], a[32:35], v[192:207]
    ds_read_b64_tr_b16 a[160:161], v46 offset:20480
    ds_read_b64_tr_b16 a[162:163], v46 offset:20992
    v_mul_f32 v92, s100, v92
    v_mul_f32 v93, s100, v93
    v_mul_f32 v94, s100, v94
    v_mul_f32 v95, s100, v95
    v_mfma_f32_32x32x16_bf16 v[208:223], a[148:151], a[32:35], v[208:223]
    ds_read_b64_tr_b16 a[164:165], v47 offset:20480
    ds_read_b64_tr_b16 a[166:167], v47 offset:20992
    v_cvt_pk_bf16_f32 v92, v92, v93
    v_cvt_pk_bf16_f32 v93, v94, v95
    v_accvgpr_write_b32 a242, v92
    v_accvgpr_write_b32 a243, v93
    s_waitcnt lgkmcnt(4)
    v_mfma_f32_32x32x16_bf16 v[192:207], a[152:155], a[36:39], v[192:207]
    ds_read_b64_tr_b16 a[168:169], v46 offset:22528
    ds_read_b64_tr_b16 a[170:171], v46 offset:23040
    v_mul_f32 v96, s100, v96
    v_mul_f32 v97, s100, v97
    v_mul_f32 v98, s100, v98
    v_mul_f32 v99, s100, v99
    v_mfma_f32_32x32x16_bf16 v[208:223], a[156:159], a[36:39], v[208:223]
    ds_read_b64_tr_b16 a[172:173], v47 offset:22528
    ds_read_b64_tr_b16 a[174:175], v47 offset:23040
    v_cvt_pk_bf16_f32 v96, v96, v97
    v_cvt_pk_bf16_f32 v97, v98, v99
    v_accvgpr_write_b32 a196, v96
    v_accvgpr_write_b32 a197, v97
    s_waitcnt lgkmcnt(4)
    v_mfma_f32_32x32x16_bf16 v[192:207], a[160:163], a[40:43], v[192:207]
    ds_read_b64_tr_b16 a[144:145], v46 offset:24576
    ds_read_b64_tr_b16 a[146:147], v46 offset:25088
    v_mul_f32 v100, s100, v100
    v_mul_f32 v101, s100, v101
    v_mul_f32 v102, s100, v102
    v_mul_f32 v103, s100, v103
    v_mfma_f32_32x32x16_bf16 v[208:223], a[164:167], a[40:43], v[208:223]
    ds_read_b64_tr_b16 a[148:149], v47 offset:24576
    ds_read_b64_tr_b16 a[150:151], v47 offset:25088
    v_cvt_pk_bf16_f32 v100, v100, v101
    v_cvt_pk_bf16_f32 v101, v102, v103
    v_accvgpr_write_b32 a212, v100
    v_accvgpr_write_b32 a213, v101
    s_waitcnt lgkmcnt(4)
    v_mfma_f32_32x32x16_bf16 v[192:207], a[168:171], a[44:47], v[192:207]
    ds_read_b64_tr_b16 a[152:153], v46 offset:26624
    ds_read_b64_tr_b16 a[154:155], v46 offset:27136
    v_mul_f32 v104, s100, v104
    v_mul_f32 v105, s100, v105
    v_mul_f32 v106, s100, v106
    v_mul_f32 v107, s100, v107
    v_mfma_f32_32x32x16_bf16 v[208:223], a[172:175], a[44:47], v[208:223]
    ds_read_b64_tr_b16 a[156:157], v47 offset:26624
    ds_read_b64_tr_b16 a[158:159], v47 offset:27136
    v_cvt_pk_bf16_f32 v104, v104, v105
    v_cvt_pk_bf16_f32 v105, v106, v107
    v_accvgpr_write_b32 a228, v104
    v_accvgpr_write_b32 a229, v105
    s_waitcnt vmcnt(40) lgkmcnt(4)
    v_mfma_f32_32x32x16_bf16 v[192:207], a[144:147], a[48:51], v[192:207]
    ds_read_b64_tr_b16 a[160:161], v46 offset:28672
    ds_read_b64_tr_b16 a[162:163], v46 offset:29184
    v_mul_f32 v108, s100, v108
    v_mul_f32 v109, s100, v109
    v_mul_f32 v110, s100, v110
    v_mul_f32 v111, s100, v111
    v_mfma_f32_32x32x16_bf16 v[208:223], a[148:151], a[48:51], v[208:223]
    ds_read_b64_tr_b16 a[164:165], v47 offset:28672
    ds_read_b64_tr_b16 a[166:167], v47 offset:29184
    v_cvt_pk_bf16_f32 v108, v108, v109
    v_cvt_pk_bf16_f32 v109, v110, v111
    v_accvgpr_write_b32 a244, v108
    v_accvgpr_write_b32 a245, v109
    s_waitcnt lgkmcnt(4)
    v_mfma_f32_32x32x16_bf16 v[192:207], a[152:155], a[52:55], v[192:207]
    ds_read_b64_tr_b16 a[168:169], v46 offset:30720
    ds_read_b64_tr_b16 a[170:171], v46 offset:31232
    v_mul_f32 v112, s100, v112
    v_mul_f32 v113, s100, v113
    v_mul_f32 v114, s100, v114
    v_mul_f32 v115, s100, v115
    v_mfma_f32_32x32x16_bf16 v[208:223], a[156:159], a[52:55], v[208:223]
    ds_read_b64_tr_b16 a[172:173], v47 offset:30720
    ds_read_b64_tr_b16 a[174:175], v47 offset:31232
    v_cvt_pk_bf16_f32 v112, v112, v113
    v_cvt_pk_bf16_f32 v113, v114, v115
    v_accvgpr_write_b32 a198, v112
    v_accvgpr_write_b32 a199, v113
    s_waitcnt lgkmcnt(4)
    v_mfma_f32_32x32x16_bf16 v[192:207], a[160:163], a[56:59], v[192:207]
    ds_read_b64_tr_b16 a[144:145], v46 offset:32768
    ds_read_b64_tr_b16 a[146:147], v46 offset:33280
    v_mul_f32 v116, s100, v116
    v_mul_f32 v117, s100, v117
    v_mul_f32 v118, s100, v118
    v_mul_f32 v119, s100, v119
    v_mfma_f32_32x32x16_bf16 v[208:223], a[164:167], a[56:59], v[208:223]
    ds_read_b64_tr_b16 a[148:149], v47 offset:32768
    ds_read_b64_tr_b16 a[150:151], v47 offset:33280
    v_cvt_pk_bf16_f32 v116, v116, v117
    v_cvt_pk_bf16_f32 v117, v118, v119
    v_accvgpr_write_b32 a214, v116
    v_accvgpr_write_b32 a215, v117
    s_waitcnt lgkmcnt(4)
    v_mfma_f32_32x32x16_bf16 v[192:207], a[168:171], a[60:63], v[192:207]
    ds_read_b64_tr_b16 a[152:153], v46 offset:34816
    ds_read_b64_tr_b16 a[154:155], v46 offset:35328
    v_mul_f32 v120, s100, v120
    v_mul_f32 v121, s100, v121
    v_mul_f32 v122, s100, v122
    v_mul_f32 v123, s100, v123
    v_mfma_f32_32x32x16_bf16 v[208:223], a[172:175], a[60:63], v[208:223]
    ds_read_b64_tr_b16 a[156:157], v47 offset:34816
    ds_read_b64_tr_b16 a[158:159], v47 offset:35328
    v_cvt_pk_bf16_f32 v120, v120, v121
    v_cvt_pk_bf16_f32 v121, v122, v123
    v_accvgpr_write_b32 a230, v120
    v_accvgpr_write_b32 a231, v121
    s_waitcnt vmcnt(36) lgkmcnt(4)
    v_mfma_f32_32x32x16_bf16 v[192:207], a[144:147], a[64:67], v[192:207]
    s_waitcnt vmcnt(63)
    s_barrier
    ds_read_b64_tr_b16 a[160:161], v48 offset:0
    ds_read_b64_tr_b16 a[162:163], v48 offset:512
    v_mul_f32 v124, s100, v124
    v_mul_f32 v125, s100, v125
    v_mul_f32 v126, s100, v126
    v_mul_f32 v127, s100, v127
    v_mfma_f32_32x32x16_bf16 v[208:223], a[148:151], a[64:67], v[208:223]
    ds_read_b64_tr_b16 a[164:165], v49 offset:0
    ds_read_b64_tr_b16 a[166:167], v49 offset:512
    v_cvt_pk_bf16_f32 v124, v124, v125
    v_cvt_pk_bf16_f32 v125, v126, v127
    v_accvgpr_write_b32 a246, v124
    v_accvgpr_write_b32 a247, v125
    s_waitcnt lgkmcnt(4)
    v_mfma_f32_32x32x16_bf16 v[192:207], a[152:155], a[68:71], v[192:207]
    ds_read_b64_tr_b16 a[168:169], v48 offset:2048
    ds_read_b64_tr_b16 a[170:171], v48 offset:2560
    v_mul_f32 v128, s100, v128
    v_mul_f32 v129, s100, v129
    v_mul_f32 v130, s100, v130
    v_mul_f32 v131, s100, v131
    v_mfma_f32_32x32x16_bf16 v[208:223], a[156:159], a[68:71], v[208:223]
    ds_read_b64_tr_b16 a[172:173], v49 offset:2048
    ds_read_b64_tr_b16 a[174:175], v49 offset:2560
    v_cvt_pk_bf16_f32 v128, v128, v129
    v_cvt_pk_bf16_f32 v129, v130, v131
    v_accvgpr_write_b32 a200, v128
    v_accvgpr_write_b32 a201, v129
    s_waitcnt lgkmcnt(4)
    v_mfma_f32_32x32x16_bf16 v[192:207], a[160:163], a[72:75], v[192:207]
    ds_read_b64_tr_b16 a[144:145], v48 offset:4096
    ds_read_b64_tr_b16 a[146:147], v48 offset:4608
    v_mul_f32 v132, s100, v132
    v_mul_f32 v133, s100, v133
    v_mul_f32 v134, s100, v134
    v_mul_f32 v135, s100, v135
    v_mfma_f32_32x32x16_bf16 v[208:223], a[164:167], a[72:75], v[208:223]
    ds_read_b64_tr_b16 a[148:149], v49 offset:4096
    ds_read_b64_tr_b16 a[150:151], v49 offset:4608
    v_cvt_pk_bf16_f32 v132, v132, v133
    v_cvt_pk_bf16_f32 v133, v134, v135
    v_accvgpr_write_b32 a216, v132
    v_accvgpr_write_b32 a217, v133
    s_waitcnt lgkmcnt(4)
    v_mfma_f32_32x32x16_bf16 v[192:207], a[168:171], a[76:79], v[192:207]
    ds_read_b64_tr_b16 a[152:153], v48 offset:6144
    ds_read_b64_tr_b16 a[154:155], v48 offset:6656
    v_mul_f32 v136, s100, v136
    v_mul_f32 v137, s100, v137
    v_mul_f32 v138, s100, v138
    v_mul_f32 v139, s100, v139
    v_mfma_f32_32x32x16_bf16 v[208:223], a[172:175], a[76:79], v[208:223]
    ds_read_b64_tr_b16 a[156:157], v49 offset:6144
    ds_read_b64_tr_b16 a[158:159], v49 offset:6656
    v_cvt_pk_bf16_f32 v136, v136, v137
    v_cvt_pk_bf16_f32 v137, v138, v139
    v_accvgpr_write_b32 a232, v136
    v_accvgpr_write_b32 a233, v137
    s_waitcnt vmcnt(32) lgkmcnt(4)
    v_mfma_f32_32x32x16_bf16 v[192:207], a[144:147], a[80:83], v[192:207]
    ds_read_b64_tr_b16 a[160:161], v48 offset:8192
    ds_read_b64_tr_b16 a[162:163], v48 offset:8704
    v_mul_f32 v140, s100, v140
    v_mul_f32 v141, s100, v141
    v_mul_f32 v142, s100, v142
    v_mul_f32 v143, s100, v143
    v_mfma_f32_32x32x16_bf16 v[208:223], a[148:151], a[80:83], v[208:223]
    ds_read_b64_tr_b16 a[164:165], v49 offset:8192
    ds_read_b64_tr_b16 a[166:167], v49 offset:8704
    v_cvt_pk_bf16_f32 v140, v140, v141
    v_cvt_pk_bf16_f32 v141, v142, v143
    v_accvgpr_write_b32 a248, v140
    v_accvgpr_write_b32 a249, v141
    s_waitcnt lgkmcnt(4)
    v_mfma_f32_32x32x16_bf16 v[192:207], a[152:155], a[84:87], v[192:207]
    ds_read_b64_tr_b16 a[168:169], v48 offset:10240
    ds_read_b64_tr_b16 a[170:171], v48 offset:10752
    v_mul_f32 v144, s100, v144
    v_mul_f32 v145, s100, v145
    v_mul_f32 v146, s100, v146
    v_mfma_f32_32x32x16_bf16 v[208:223], a[156:159], a[84:87], v[208:223]
    ds_read_b64_tr_b16 a[172:173], v49 offset:10240
    ds_read_b64_tr_b16 a[174:175], v49 offset:10752
    v_mul_f32 v147, s100, v147
    v_cvt_pk_bf16_f32 v144, v144, v145
    v_cvt_pk_bf16_f32 v145, v146, v147
    s_waitcnt lgkmcnt(4)
    v_mfma_f32_32x32x16_bf16 v[192:207], a[160:163], a[88:91], v[192:207]
    ds_read_b64_tr_b16 a[144:145], v48 offset:12288
    ds_read_b64_tr_b16 a[146:147], v48 offset:12800
    v_accvgpr_write_b32 a202, v144
    v_accvgpr_write_b32 a203, v145
    v_mul_f32 v148, s100, v148
    v_mfma_f32_32x32x16_bf16 v[208:223], a[164:167], a[88:91], v[208:223]
    ds_read_b64_tr_b16 a[148:149], v49 offset:12288
    ds_read_b64_tr_b16 a[150:151], v49 offset:12800
    v_mul_f32 v149, s100, v149
    v_mul_f32 v150, s100, v150
    v_mul_f32 v151, s100, v151
    s_waitcnt lgkmcnt(4)
    v_mfma_f32_32x32x16_bf16 v[192:207], a[168:171], a[92:95], v[192:207]
    ds_read_b64_tr_b16 a[152:153], v48 offset:14336
    ds_read_b64_tr_b16 a[154:155], v48 offset:14848
    v_cvt_pk_bf16_f32 v148, v148, v149
    v_cvt_pk_bf16_f32 v149, v150, v151
    v_accvgpr_write_b32 a218, v148
    v_mfma_f32_32x32x16_bf16 v[208:223], a[172:175], a[92:95], v[208:223]
    ds_read_b64_tr_b16 a[156:157], v49 offset:14336
    ds_read_b64_tr_b16 a[158:159], v49 offset:14848
    v_accvgpr_write_b32 a219, v149
    v_mul_f32 v152, s100, v152
    v_mul_f32 v153, s100, v153
    s_waitcnt vmcnt(28) lgkmcnt(4)
    v_mfma_f32_32x32x16_bf16 v[192:207], a[144:147], a[96:99], v[192:207]
    ds_read_b64_tr_b16 a[160:161], v48 offset:16384
    ds_read_b64_tr_b16 a[162:163], v48 offset:16896
    v_mul_f32 v154, s100, v154
    v_mul_f32 v155, s100, v155
    v_cvt_pk_bf16_f32 v152, v152, v153
    v_mfma_f32_32x32x16_bf16 v[208:223], a[148:151], a[96:99], v[208:223]
    ds_read_b64_tr_b16 a[164:165], v49 offset:16384
    ds_read_b64_tr_b16 a[166:167], v49 offset:16896
    v_cvt_pk_bf16_f32 v153, v154, v155
    v_accvgpr_write_b32 a234, v152
    v_accvgpr_write_b32 a235, v153
    s_waitcnt lgkmcnt(4)
    v_mfma_f32_32x32x16_bf16 v[192:207], a[152:155], a[100:103], v[192:207]
    ds_read_b64_tr_b16 a[168:169], v48 offset:18432
    ds_read_b64_tr_b16 a[170:171], v48 offset:18944
    v_mul_f32 v156, s100, v156
    v_mul_f32 v157, s100, v157
    v_mul_f32 v158, s100, v158
    v_mfma_f32_32x32x16_bf16 v[208:223], a[156:159], a[100:103], v[208:223]
    ds_read_b64_tr_b16 a[172:173], v49 offset:18432
    ds_read_b64_tr_b16 a[174:175], v49 offset:18944
    v_mul_f32 v159, s100, v159
    v_cvt_pk_bf16_f32 v156, v156, v157
    v_cvt_pk_bf16_f32 v157, v158, v159
    s_waitcnt lgkmcnt(4)
    v_mfma_f32_32x32x16_bf16 v[192:207], a[160:163], a[104:107], v[192:207]
    ds_read_b64_tr_b16 a[144:145], v48 offset:20480
    ds_read_b64_tr_b16 a[146:147], v48 offset:20992
    v_accvgpr_write_b32 a250, v156
    v_accvgpr_write_b32 a251, v157
    v_mul_f32 v160, s100, v160
    v_mfma_f32_32x32x16_bf16 v[208:223], a[164:167], a[104:107], v[208:223]
    ds_read_b64_tr_b16 a[148:149], v49 offset:20480
    ds_read_b64_tr_b16 a[150:151], v49 offset:20992
    v_mul_f32 v161, s100, v161
    v_mul_f32 v162, s100, v162
    v_mul_f32 v163, s100, v163
    s_waitcnt lgkmcnt(4)
    v_mfma_f32_32x32x16_bf16 v[192:207], a[168:171], a[108:111], v[192:207]
    ds_read_b64_tr_b16 a[152:153], v48 offset:22528
    ds_read_b64_tr_b16 a[154:155], v48 offset:23040
    v_cvt_pk_bf16_f32 v160, v160, v161
    v_cvt_pk_bf16_f32 v161, v162, v163
    v_accvgpr_write_b32 a204, v160
    v_mfma_f32_32x32x16_bf16 v[208:223], a[172:175], a[108:111], v[208:223]
    ds_read_b64_tr_b16 a[156:157], v49 offset:22528
    ds_read_b64_tr_b16 a[158:159], v49 offset:23040
    v_accvgpr_write_b32 a205, v161
    v_mul_f32 v164, s100, v164
    v_mul_f32 v165, s100, v165
    s_waitcnt vmcnt(24) lgkmcnt(4)
    v_mfma_f32_32x32x16_bf16 v[192:207], a[144:147], a[112:115], v[192:207]
    ds_read_b64_tr_b16 a[160:161], v48 offset:24576
    ds_read_b64_tr_b16 a[162:163], v48 offset:25088
    v_mul_f32 v166, s100, v166
    v_mul_f32 v167, s100, v167
    v_cvt_pk_bf16_f32 v164, v164, v165
    v_mfma_f32_32x32x16_bf16 v[208:223], a[148:151], a[112:115], v[208:223]
    ds_read_b64_tr_b16 a[164:165], v49 offset:24576
    ds_read_b64_tr_b16 a[166:167], v49 offset:25088
    v_cvt_pk_bf16_f32 v165, v166, v167
    v_accvgpr_write_b32 a220, v164
    v_accvgpr_write_b32 a221, v165
    s_waitcnt lgkmcnt(4)
    v_mfma_f32_32x32x16_bf16 v[192:207], a[152:155], a[116:119], v[192:207]
    ds_read_b64_tr_b16 a[168:169], v48 offset:26624
    ds_read_b64_tr_b16 a[170:171], v48 offset:27136
    v_mul_f32 v168, s100, v168
    v_mul_f32 v169, s100, v169
    v_mul_f32 v170, s100, v170
    v_mfma_f32_32x32x16_bf16 v[208:223], a[156:159], a[116:119], v[208:223]
    ds_read_b64_tr_b16 a[172:173], v49 offset:26624
    ds_read_b64_tr_b16 a[174:175], v49 offset:27136
    v_mul_f32 v171, s100, v171
    v_cvt_pk_bf16_f32 v168, v168, v169
    v_cvt_pk_bf16_f32 v169, v170, v171
    s_waitcnt lgkmcnt(4)
    v_mfma_f32_32x32x16_bf16 v[192:207], a[160:163], a[120:123], v[192:207]
    ds_read_b64_tr_b16 a[144:145], v48 offset:28672
    ds_read_b64_tr_b16 a[146:147], v48 offset:29184
    v_accvgpr_write_b32 a236, v168
    v_accvgpr_write_b32 a237, v169
    v_mul_f32 v172, s100, v172
    v_mfma_f32_32x32x16_bf16 v[208:223], a[164:167], a[120:123], v[208:223]
    ds_read_b64_tr_b16 a[148:149], v49 offset:28672
    ds_read_b64_tr_b16 a[150:151], v49 offset:29184
    v_mul_f32 v173, s100, v173
    v_mul_f32 v174, s100, v174
    v_mul_f32 v175, s100, v175
    s_waitcnt lgkmcnt(4)
    v_mfma_f32_32x32x16_bf16 v[192:207], a[168:171], a[124:127], v[192:207]
    ds_read_b64_tr_b16 a[152:153], v48 offset:30720
    ds_read_b64_tr_b16 a[154:155], v48 offset:31232
    v_cvt_pk_bf16_f32 v172, v172, v173
    v_cvt_pk_bf16_f32 v173, v174, v175
    v_accvgpr_write_b32 a252, v172
    v_mfma_f32_32x32x16_bf16 v[208:223], a[172:175], a[124:127], v[208:223]
    ds_read_b64_tr_b16 a[156:157], v49 offset:30720
    ds_read_b64_tr_b16 a[158:159], v49 offset:31232
    v_accvgpr_write_b32 a253, v173
    v_mul_f32 v176, s100, v176
    v_mul_f32 v177, s100, v177
    s_waitcnt vmcnt(20) lgkmcnt(4)
    v_mfma_f32_32x32x16_bf16 v[192:207], a[144:147], a[128:131], v[192:207]
    ds_read_b64_tr_b16 a[160:161], v48 offset:32768
    ds_read_b64_tr_b16 a[162:163], v48 offset:33280
    v_mul_f32 v178, s100, v178
    v_mul_f32 v179, s100, v179
    v_cvt_pk_bf16_f32 v176, v176, v177
    v_mfma_f32_32x32x16_bf16 v[208:223], a[148:151], a[128:131], v[208:223]
    ds_read_b64_tr_b16 a[164:165], v49 offset:32768
    ds_read_b64_tr_b16 a[166:167], v49 offset:33280
    v_cvt_pk_bf16_f32 v177, v178, v179
    v_accvgpr_write_b32 a206, v176
    v_accvgpr_write_b32 a207, v177
    s_waitcnt lgkmcnt(4)
    v_mfma_f32_32x32x16_bf16 v[192:207], a[152:155], a[132:135], v[192:207]
    ds_read_b64_tr_b16 a[168:169], v48 offset:34816
    ds_read_b64_tr_b16 a[170:171], v48 offset:35328
    v_mul_f32 v180, s100, v180
    v_mul_f32 v181, s100, v181
    v_mul_f32 v182, s100, v182
    v_mfma_f32_32x32x16_bf16 v[208:223], a[156:159], a[132:135], v[208:223]
    ds_read_b64_tr_b16 a[172:173], v49 offset:34816
    ds_read_b64_tr_b16 a[174:175], v49 offset:35328
    v_mul_f32 v183, s100, v183
    v_cvt_pk_bf16_f32 v180, v180, v181
    v_cvt_pk_bf16_f32 v181, v182, v183
    s_waitcnt lgkmcnt(4)
    v_mfma_f32_32x32x16_bf16 v[192:207], a[160:163], a[136:139], v[192:207]
    ds_read_b64_tr_b16 a[144:145], v48 offset:36864
    ds_read_b64_tr_b16 a[146:147], v48 offset:37376
    v_accvgpr_write_b32 a222, v180
    v_accvgpr_write_b32 a223, v181
    v_mul_f32 v184, s100, v184
    v_mfma_f32_32x32x16_bf16 v[208:223], a[164:167], a[136:139], v[208:223]
    ds_read_b64_tr_b16 a[148:149], v49 offset:36864
    ds_read_b64_tr_b16 a[150:151], v49 offset:37376
    v_mul_f32 v185, s100, v185
    v_mul_f32 v186, s100, v186
    v_mul_f32 v187, s100, v187
    s_waitcnt lgkmcnt(4)
    v_mfma_f32_32x32x16_bf16 v[192:207], a[168:171], a[140:143], v[192:207]
    s_waitcnt vmcnt(11)
    s_barrier
    ds_read_b64_tr_b16 a[152:153], v50 offset:0
    ds_read_b64_tr_b16 a[154:155], v50 offset:512
    s_add_u32 m0, s33, 0
    s_add_u32 s31, s34, 256
    buffer_load_dwordx4 v236, s[8:11], s31 offen offset:0 lds
    v_cvt_pk_bf16_f32 v184, v184, v185
    v_cvt_pk_bf16_f32 v185, v186, v187
    v_accvgpr_write_b32 a238, v184
    v_mfma_f32_32x32x16_bf16 v[208:223], a[172:175], a[140:143], v[208:223]
    ds_read_b64_tr_b16 a[156:157], v51 offset:0
    ds_read_b64_tr_b16 a[158:159], v51 offset:512
    buffer_load_dwordx4 v237, s[8:11], s31 offen offset:1024 lds
    v_accvgpr_write_b32 a239, v185
    v_mul_f32 v188, s100, v188
    v_mul_f32 v189, s100, v189
    s_waitcnt lgkmcnt(4)
    v_mfma_f32_32x32x16_bf16 v[192:207], a[144:147], v[56:59], v[192:207]
    ds_read_b64_tr_b16 a[160:161], v50 offset:2048
    ds_read_b64_tr_b16 a[162:163], v50 offset:2560
    buffer_load_dwordx4 v238, s[8:11], s31 offen offset:2048 lds
    v_mul_f32 v190, s100, v190
    v_mul_f32 v191, s100, v191
    v_cvt_pk_bf16_f32 v188, v188, v189
    v_mfma_f32_32x32x16_bf16 v[208:223], a[148:151], v[56:59], v[208:223]
    ds_read_b64_tr_b16 a[164:165], v51 offset:2048
    ds_read_b64_tr_b16 a[166:167], v51 offset:2560
    buffer_load_dwordx4 v239, s[8:11], s31 offen offset:3072 lds
    v_cvt_pk_bf16_f32 v189, v190, v191
    v_accvgpr_write_b32 a254, v188
    v_accvgpr_write_b32 a255, v189
    s_waitcnt lgkmcnt(4)
    v_mfma_f32_32x32x16_bf16 v[96:111], a[152:155], a[0:3], 0
    ds_read_b64_tr_b16 a[168:169], v50 offset:4096
    ds_read_b64_tr_b16 a[170:171], v50 offset:4608
    s_add_u32 m0, s33, 4096
    s_add_u32 s31, s34, 295168
    buffer_load_dwordx4 v236, s[8:11], s31 offen offset:0 lds
    v_mfma_f32_32x32x16_bf16 v[112:127], a[156:159], a[0:3], 0
    ds_read_b64_tr_b16 a[172:173], v51 offset:4096
    ds_read_b64_tr_b16 a[174:175], v51 offset:4608
    buffer_load_dwordx4 v237, s[8:11], s31 offen offset:1024 lds
    s_waitcnt lgkmcnt(4)
    v_mfma_f32_32x32x16_bf16 v[96:111], a[160:163], a[4:7], v[96:111]
    ds_read_b64_tr_b16 a[144:145], v50 offset:6144
    ds_read_b64_tr_b16 a[146:147], v50 offset:6656
    buffer_load_dwordx4 v238, s[8:11], s31 offen offset:2048 lds
    v_mul_f32 v128, v192, v192
    v_mul_f32 v129, v193, v193
    v_mul_f32 v130, v194, v194
    v_mul_f32 v131, v195, v195
    v_mul_f32 v132, v196, v196
    v_mfma_f32_32x32x16_bf16 v[112:127], a[164:167], a[4:7], v[112:127]
    ds_read_b64_tr_b16 a[148:149], v51 offset:6144
    ds_read_b64_tr_b16 a[150:151], v51 offset:6656
    buffer_load_dwordx4 v239, s[8:11], s31 offen offset:3072 lds
    v_mul_f32 v133, v197, v197
    v_mul_f32 v134, v198, v198
    v_mul_f32 v135, v199, v199
    v_fma_f32 v128, v128, v61, v60
    v_fma_f32 v129, v129, v61, v60
    s_waitcnt lgkmcnt(4)
    v_mfma_f32_32x32x16_bf16 v[96:111], a[168:171], a[8:11], v[96:111]
    ds_read_b64_tr_b16 a[152:153], v50 offset:8192
    ds_read_b64_tr_b16 a[154:155], v50 offset:8704
    s_add_u32 m0, s33, 8192
    s_add_u32 s31, s34, 590080
    buffer_load_dwordx4 v236, s[8:11], s31 offen offset:0 lds
    v_fma_f32 v130, v130, v61, v60
    v_fma_f32 v131, v131, v61, v60
    v_fma_f32 v132, v132, v61, v60
    v_fma_f32 v133, v133, v61, v60
    v_fma_f32 v134, v134, v61, v60
    v_mfma_f32_32x32x16_bf16 v[112:127], a[172:175], a[8:11], v[112:127]
    ds_read_b64_tr_b16 a[156:157], v51 offset:8192
    ds_read_b64_tr_b16 a[158:159], v51 offset:8704
    v_fma_f32 v135, v135, v61, v60
    v_mul_f32 v128, v128, v192
    v_mul_f32 v129, v129, v193
    v_mul_f32 v130, v130, v194
    v_mul_f32 v131, v131, v195
    s_waitcnt lgkmcnt(4)
    v_mfma_f32_32x32x16_bf16 v[96:111], a[144:147], a[12:15], v[96:111]
    ds_read_b64_tr_b16 a[160:161], v50 offset:10240
    ds_read_b64_tr_b16 a[162:163], v50 offset:10752
    v_mul_f32 v132, v132, v196
    v_mul_f32 v133, v133, v197
    v_mul_f32 v134, v134, v198
    v_mul_f32 v135, v135, v199
    v_exp_f32 v128, v128
    v_mfma_f32_32x32x16_bf16 v[112:127], a[148:151], a[12:15], v[112:127]
    ds_read_b64_tr_b16 a[164:165], v51 offset:10240
    ds_read_b64_tr_b16 a[166:167], v51 offset:10752
    v_exp_f32 v129, v129
    v_exp_f32 v130, v130
    v_exp_f32 v131, v131
    s_waitcnt lgkmcnt(4)
    v_mfma_f32_32x32x16_bf16 v[96:111], a[152:155], a[16:19], v[96:111]
    ds_read_b64_tr_b16 a[168:169], v50 offset:12288
    ds_read_b64_tr_b16 a[170:171], v50 offset:12800
    v_exp_f32 v132, v132
    v_exp_f32 v133, v133
    v_exp_f32 v134, v134
    v_mfma_f32_32x32x16_bf16 v[112:127], a[156:159], a[16:19], v[112:127]
    ds_read_b64_tr_b16 a[172:173], v51 offset:12288
    ds_read_b64_tr_b16 a[174:175], v51 offset:12800
    v_exp_f32 v135, v135
    v_add_f32 v128, 1.0, v128
    v_add_f32 v129, 1.0, v129
    v_add_f32 v130, 1.0, v130
    s_waitcnt lgkmcnt(4)
    v_mfma_f32_32x32x16_bf16 v[96:111], a[160:163], a[20:23], v[96:111]
    ds_read_b64_tr_b16 a[144:145], v50 offset:14336
    ds_read_b64_tr_b16 a[146:147], v50 offset:14848
    v_add_f32 v131, 1.0, v131
    v_add_f32 v132, 1.0, v132
    v_add_f32 v133, 1.0, v133
    v_add_f32 v134, 1.0, v134
    v_add_f32 v135, 1.0, v135
    v_mfma_f32_32x32x16_bf16 v[112:127], a[164:167], a[20:23], v[112:127]
    ds_read_b64_tr_b16 a[148:149], v51 offset:14336
    ds_read_b64_tr_b16 a[150:151], v51 offset:14848
    v_rcp_f32 v128, v128
    v_rcp_f32 v129, v129
    v_rcp_f32 v130, v130
    s_waitcnt lgkmcnt(4)
    v_mfma_f32_32x32x16_bf16 v[96:111], a[168:171], a[24:27], v[96:111]
    ds_read_b64_tr_b16 a[152:153], v50 offset:16384
    ds_read_b64_tr_b16 a[154:155], v50 offset:16896
    v_rcp_f32 v131, v131
    v_rcp_f32 v132, v132
    v_rcp_f32 v133, v133
    v_mfma_f32_32x32x16_bf16 v[112:127], a[172:175], a[24:27], v[112:127]
    ds_read_b64_tr_b16 a[156:157], v51 offset:16384
    ds_read_b64_tr_b16 a[158:159], v51 offset:16896
    v_rcp_f32 v134, v134
    v_rcp_f32 v135, v135
    v_mul_f32 v192, v192, v128
    s_waitcnt lgkmcnt(4)
    v_mfma_f32_32x32x16_bf16 v[96:111], a[144:147], a[28:31], v[96:111]
    ds_read_b64_tr_b16 a[160:161], v50 offset:18432
    ds_read_b64_tr_b16 a[162:163], v50 offset:18944
    v_mul_f32 v193, v193, v129
    v_mul_f32 v194, v194, v130
    v_mul_f32 v195, v195, v131
    v_mul_f32 v196, v196, v132
    v_mul_f32 v197, v197, v133
    v_mfma_f32_32x32x16_bf16 v[112:127], a[148:151], a[28:31], v[112:127]
    ds_read_b64_tr_b16 a[164:165], v51 offset:18432
    ds_read_b64_tr_b16 a[166:167], v51 offset:18944
    v_mul_f32 v198, v198, v134
    v_mul_f32 v199, v199, v135
    v_cvt_pk_bf16_f32 v144, v192, v193
    v_cvt_pk_bf16_f32 v145, v194, v195
    v_cvt_pk_bf16_f32 v146, v196, v197
    s_waitcnt lgkmcnt(4)
    v_mfma_f32_32x32x16_bf16 v[96:111], a[152:155], a[32:35], v[96:111]
    ds_read_b64_tr_b16 a[168:169], v50 offset:20480
    ds_read_b64_tr_b16 a[170:171], v50 offset:20992
    v_cvt_pk_bf16_f32 v147, v198, v199
    s_add_u32 s32, s35, 0
    buffer_store_dwordx4 v[144:147], v19, s[16:19], s32 offen offset:0 sc1
    v_mul_f32 v136, v200, v200
    v_mul_f32 v137, v201, v201
    v_mfma_f32_32x32x16_bf16 v[112:127], a[156:159], a[32:35], v[112:127]
    ds_read_b64_tr_b16 a[172:173], v51 offset:20480
    ds_read_b64_tr_b16 a[174:175], v51 offset:20992
    v_mul_f32 v138, v202, v202
    v_mul_f32 v139, v203, v203
    v_mul_f32 v140, v204, v204
    v_mul_f32 v141, v205, v205
    v_mul_f32 v142, v206, v206
    s_waitcnt lgkmcnt(4)
    v_mfma_f32_32x32x16_bf16 v[96:111], a[160:163], a[36:39], v[96:111]
    ds_read_b64_tr_b16 a[144:145], v50 offset:22528
    ds_read_b64_tr_b16 a[146:147], v50 offset:23040
    v_mul_f32 v143, v207, v207
    v_fma_f32 v136, v136, v61, v60
    v_fma_f32 v137, v137, v61, v60
    v_fma_f32 v138, v138, v61, v60
    v_fma_f32 v139, v139, v61, v60
    v_mfma_f32_32x32x16_bf16 v[112:127], a[164:167], a[36:39], v[112:127]
    ds_read_b64_tr_b16 a[148:149], v51 offset:22528
    ds_read_b64_tr_b16 a[150:151], v51 offset:23040
    v_fma_f32 v140, v140, v61, v60
    v_fma_f32 v141, v141, v61, v60
    v_fma_f32 v142, v142, v61, v60
    v_fma_f32 v143, v143, v61, v60
    v_mul_f32 v136, v136, v200
    s_waitcnt lgkmcnt(4)
    v_mfma_f32_32x32x16_bf16 v[96:111], a[168:171], a[40:43], v[96:111]
    ds_read_b64_tr_b16 a[152:153], v50 offset:24576
    ds_read_b64_tr_b16 a[154:155], v50 offset:25088
    v_mul_f32 v137, v137, v201
    v_mul_f32 v138, v138, v202
    v_mul_f32 v139, v139, v203
    v_mul_f32 v140, v140, v204
    v_mul_f32 v141, v141, v205
    v_mfma_f32_32x32x16_bf16 v[112:127], a[172:175], a[40:43], v[112:127]
    ds_read_b64_tr_b16 a[156:157], v51 offset:24576
    ds_read_b64_tr_b16 a[158:159], v51 offset:25088
    v_mul_f32 v142, v142, v206
    v_mul_f32 v143, v143, v207
    v_exp_f32 v136, v136
    s_waitcnt lgkmcnt(4)
    v_mfma_f32_32x32x16_bf16 v[96:111], a[144:147], a[44:47], v[96:111]
    ds_read_b64_tr_b16 a[160:161], v50 offset:26624
    ds_read_b64_tr_b16 a[162:163], v50 offset:27136
    v_exp_f32 v137, v137
    v_exp_f32 v138, v138
    v_mfma_f32_32x32x16_bf16 v[112:127], a[148:151], a[44:47], v[112:127]
    ds_read_b64_tr_b16 a[164:165], v51 offset:26624
    ds_read_b64_tr_b16 a[166:167], v51 offset:27136
    v_exp_f32 v139, v139
    v_exp_f32 v140, v140
    s_waitcnt lgkmcnt(4)
    v_mfma_f32_32x32x16_bf16 v[96:111], a[152:155], a[48:51], v[96:111]
    ds_read_b64_tr_b16 a[168:169], v50 offset:28672
    ds_read_b64_tr_b16 a[170:171], v50 offset:29184
    v_exp_f32 v141, v141
    v_exp_f32 v142, v142
    v_mfma_f32_32x32x16_bf16 v[112:127], a[156:159], a[48:51], v[112:127]
    ds_read_b64_tr_b16 a[172:173], v51 offset:28672
    ds_read_b64_tr_b16 a[174:175], v51 offset:29184
    v_exp_f32 v143, v143
    v_add_f32 v136, 1.0, v136
    v_add_f32 v137, 1.0, v137
    s_waitcnt lgkmcnt(4)
    v_mfma_f32_32x32x16_bf16 v[96:111], a[160:163], a[52:55], v[96:111]
    ds_read_b64_tr_b16 a[144:145], v50 offset:30720
    ds_read_b64_tr_b16 a[146:147], v50 offset:31232
    v_add_f32 v138, 1.0, v138
    v_add_f32 v139, 1.0, v139
    v_add_f32 v140, 1.0, v140
    v_add_f32 v141, 1.0, v141
    v_mfma_f32_32x32x16_bf16 v[112:127], a[164:167], a[52:55], v[112:127]
    ds_read_b64_tr_b16 a[148:149], v51 offset:30720
    ds_read_b64_tr_b16 a[150:151], v51 offset:31232
    v_add_f32 v142, 1.0, v142
    v_add_f32 v143, 1.0, v143
    v_rcp_f32 v136, v136
    s_waitcnt lgkmcnt(4)
    v_mfma_f32_32x32x16_bf16 v[96:111], a[168:171], a[56:59], v[96:111]
    ds_read_b64_tr_b16 a[152:153], v50 offset:32768
    ds_read_b64_tr_b16 a[154:155], v50 offset:33280
    v_rcp_f32 v137, v137
    v_rcp_f32 v138, v138
    v_mfma_f32_32x32x16_bf16 v[112:127], a[172:175], a[56:59], v[112:127]
    ds_read_b64_tr_b16 a[156:157], v51 offset:32768
    ds_read_b64_tr_b16 a[158:159], v51 offset:33280
    v_rcp_f32 v139, v139
    v_rcp_f32 v140, v140
    s_waitcnt lgkmcnt(4)
    v_mfma_f32_32x32x16_bf16 v[96:111], a[144:147], a[60:63], v[96:111]
    ds_read_b64_tr_b16 a[160:161], v50 offset:34816
    ds_read_b64_tr_b16 a[162:163], v50 offset:35328
    v_rcp_f32 v141, v141
    v_rcp_f32 v142, v142
    v_mfma_f32_32x32x16_bf16 v[112:127], a[148:151], a[60:63], v[112:127]
    ds_read_b64_tr_b16 a[164:165], v51 offset:34816
    ds_read_b64_tr_b16 a[166:167], v51 offset:35328
    v_rcp_f32 v143, v143
    v_mul_f32 v200, v200, v136
    v_mul_f32 v201, v201, v137
    s_waitcnt lgkmcnt(4)
    v_mfma_f32_32x32x16_bf16 v[96:111], a[152:155], a[64:67], v[96:111]
    s_waitcnt vmcnt(11)
    s_barrier
    ds_read_b64_tr_b16 a[168:169], v52 offset:0
    ds_read_b64_tr_b16 a[170:171], v52 offset:512
    s_add_u32 m0, s33, 40960
    s_add_u32 s31, s34, 2654464
    buffer_load_dwordx4 v236, s[8:11], s31 offen offset:0 lds
    v_mul_f32 v202, v202, v138
    v_mul_f32 v203, v203, v139
    v_mul_f32 v204, v204, v140
    v_mul_f32 v205, v205, v141
    v_mfma_f32_32x32x16_bf16 v[112:127], a[156:159], a[64:67], v[112:127]
    ds_read_b64_tr_b16 a[172:173], v53 offset:0
    ds_read_b64_tr_b16 a[174:175], v53 offset:512
    buffer_load_dwordx4 v237, s[8:11], s31 offen offset:1024 lds
    v_mul_f32 v206, v206, v142
    v_mul_f32 v207, v207, v143
    v_cvt_pk_bf16_f32 v148, v200, v201
    v_cvt_pk_bf16_f32 v149, v202, v203
    s_waitcnt lgkmcnt(4)
    v_mfma_f32_32x32x16_bf16 v[96:111], a[160:163], a[68:71], v[96:111]
    ds_read_b64_tr_b16 a[144:145], v52 offset:2048
    ds_read_b64_tr_b16 a[146:147], v52 offset:2560
    buffer_load_dwordx4 v238, s[8:11], s31 offen offset:2048 lds
    v_cvt_pk_bf16_f32 v150, v204, v205
    v_cvt_pk_bf16_f32 v151, v206, v207
    s_add_u32 s32, s35, 0
    buffer_store_dwordx4 v[148:151], v19, s[16:19], s32 offen offset:512 sc1
    v_mfma_f32_32x32x16_bf16 v[112:127], a[164:167], a[68:71], v[112:127]
    ds_read_b64_tr_b16 a[148:149], v53 offset:2048
    ds_read_b64_tr_b16 a[150:151], v53 offset:2560
    buffer_load_dwordx4 v239, s[8:11], s31 offen offset:3072 lds
    v_mul_f32 v128, v208, v208
    v_mul_f32 v129, v209, v209
    v_mul_f32 v130, v210, v210
    v_mul_f32 v131, v211, v211
    s_waitcnt lgkmcnt(4)
    v_mfma_f32_32x32x16_bf16 v[96:111], a[168:171], a[72:75], v[96:111]
    ds_read_b64_tr_b16 a[152:153], v52 offset:4096
    ds_read_b64_tr_b16 a[154:155], v52 offset:4608
    s_add_u32 m0, s33, 45056
    s_add_u32 s31, s34, 2949376
    buffer_load_dwordx4 v236, s[8:11], s31 offen offset:0 lds
    v_mul_f32 v132, v212, v212
    v_mul_f32 v133, v213, v213
    v_mul_f32 v134, v214, v214
    v_mul_f32 v135, v215, v215
    v_mfma_f32_32x32x16_bf16 v[112:127], a[172:175], a[72:75], v[112:127]
    ds_read_b64_tr_b16 a[156:157], v53 offset:4096
    ds_read_b64_tr_b16 a[158:159], v53 offset:4608
    buffer_load_dwordx4 v237, s[8:11], s31 offen offset:1024 lds
    v_fma_f32 v128, v128, v61, v60
    v_fma_f32 v129, v129, v61, v60
    v_fma_f32 v130, v130, v61, v60
    v_fma_f32 v131, v131, v61, v60
    s_waitcnt lgkmcnt(4)
    v_mfma_f32_32x32x16_bf16 v[96:111], a[144:147], a[76:79], v[96:111]
    ds_read_b64_tr_b16 a[160:161], v52 offset:6144
    ds_read_b64_tr_b16 a[162:163], v52 offset:6656
    buffer_load_dwordx4 v238, s[8:11], s31 offen offset:2048 lds
    v_fma_f32 v132, v132, v61, v60
    v_fma_f32 v133, v133, v61, v60
    v_fma_f32 v134, v134, v61, v60
    v_fma_f32 v135, v135, v61, v60
    v_mfma_f32_32x32x16_bf16 v[112:127], a[148:151], a[76:79], v[112:127]
    ds_read_b64_tr_b16 a[164:165], v53 offset:6144
    ds_read_b64_tr_b16 a[166:167], v53 offset:6656
    buffer_load_dwordx4 v239, s[8:11], s31 offen offset:3072 lds
    v_mul_f32 v128, v128, v208
    v_mul_f32 v129, v129, v209
    v_mul_f32 v130, v130, v210
    v_mul_f32 v131, v131, v211
    s_waitcnt lgkmcnt(4)
    v_mfma_f32_32x32x16_bf16 v[96:111], a[152:155], a[80:83], v[96:111]
    ds_read_b64_tr_b16 a[168:169], v52 offset:8192
    ds_read_b64_tr_b16 a[170:171], v52 offset:8704
    s_add_u32 m0, s33, 49152
    s_add_u32 s31, s34, 3244288
    buffer_load_dwordx4 v236, s[8:11], s31 offen offset:0 lds
    v_mul_f32 v132, v132, v212
    v_mul_f32 v133, v133, v213
    v_mul_f32 v134, v134, v214
    v_mul_f32 v135, v135, v215
    v_mfma_f32_32x32x16_bf16 v[112:127], a[156:159], a[80:83], v[112:127]
    ds_read_b64_tr_b16 a[172:173], v53 offset:8192
    ds_read_b64_tr_b16 a[174:175], v53 offset:8704
    s_add_u32 m0, s28, 77824
    s_add_u32 s31, s34, 256
    buffer_load_dwordx4 v240, s[24:27], s31 offen sc1 lds
    v_exp_f32 v128, v128
    v_exp_f32 v129, v129
    s_waitcnt lgkmcnt(4)
    v_mfma_f32_32x32x16_bf16 v[96:111], a[160:163], a[84:87], v[96:111]
    ds_read_b64_tr_b16 a[144:145], v52 offset:10240
    ds_read_b64_tr_b16 a[146:147], v52 offset:10752
    v_exp_f32 v130, v130
    v_exp_f32 v131, v131
    v_mfma_f32_32x32x16_bf16 v[112:127], a[164:167], a[84:87], v[112:127]
    ds_read_b64_tr_b16 a[148:149], v53 offset:10240
    ds_read_b64_tr_b16 a[150:151], v53 offset:10752
    v_exp_f32 v132, v132
    v_exp_f32 v133, v133
    s_waitcnt lgkmcnt(4)
    v_mfma_f32_32x32x16_bf16 v[96:111], a[168:171], a[88:91], v[96:111]
    ds_read_b64_tr_b16 a[152:153], v52 offset:12288
    ds_read_b64_tr_b16 a[154:155], v52 offset:12800
    v_exp_f32 v134, v134
    v_exp_f32 v135, v135
    v_mfma_f32_32x32x16_bf16 v[112:127], a[172:175], a[88:91], v[112:127]
    ds_read_b64_tr_b16 a[156:157], v53 offset:12288
    ds_read_b64_tr_b16 a[158:159], v53 offset:12800
    v_add_f32 v128, 1.0, v128
    v_add_f32 v129, 1.0, v129
    v_add_f32 v130, 1.0, v130
    v_add_f32 v131, 1.0, v131
    s_waitcnt lgkmcnt(4)
    v_mfma_f32_32x32x16_bf16 v[96:111], a[144:147], a[92:95], v[96:111]
    ds_read_b64_tr_b16 a[160:161], v52 offset:14336
    ds_read_b64_tr_b16 a[162:163], v52 offset:14848
    v_add_f32 v132, 1.0, v132
    v_add_f32 v133, 1.0, v133
    v_add_f32 v134, 1.0, v134
    v_add_f32 v135, 1.0, v135
    v_mfma_f32_32x32x16_bf16 v[112:127], a[148:151], a[92:95], v[112:127]
    ds_read_b64_tr_b16 a[164:165], v53 offset:14336
    ds_read_b64_tr_b16 a[166:167], v53 offset:14848
    v_rcp_f32 v128, v128
    v_rcp_f32 v129, v129
    s_waitcnt lgkmcnt(4)
    v_mfma_f32_32x32x16_bf16 v[96:111], a[152:155], a[96:99], v[96:111]
    ds_read_b64_tr_b16 a[168:169], v52 offset:16384
    ds_read_b64_tr_b16 a[170:171], v52 offset:16896
    v_rcp_f32 v130, v130
    v_rcp_f32 v131, v131
    v_mfma_f32_32x32x16_bf16 v[112:127], a[156:159], a[96:99], v[112:127]
    ds_read_b64_tr_b16 a[172:173], v53 offset:16384
    ds_read_b64_tr_b16 a[174:175], v53 offset:16896
    v_rcp_f32 v132, v132
    v_rcp_f32 v133, v133
    s_waitcnt lgkmcnt(4)
    v_mfma_f32_32x32x16_bf16 v[96:111], a[160:163], a[100:103], v[96:111]
    ds_read_b64_tr_b16 a[144:145], v52 offset:18432
    ds_read_b64_tr_b16 a[146:147], v52 offset:18944
    v_rcp_f32 v134, v134
    v_rcp_f32 v135, v135
    v_mfma_f32_32x32x16_bf16 v[112:127], a[164:167], a[100:103], v[112:127]
    ds_read_b64_tr_b16 a[148:149], v53 offset:18432
    ds_read_b64_tr_b16 a[150:151], v53 offset:18944
    v_mul_f32 v208, v208, v128
    v_mul_f32 v209, v209, v129
    v_mul_f32 v210, v210, v130
    v_mul_f32 v211, v211, v131
    s_waitcnt lgkmcnt(4)
    v_mfma_f32_32x32x16_bf16 v[96:111], a[168:171], a[104:107], v[96:111]
    ds_read_b64_tr_b16 a[152:153], v52 offset:20480
    ds_read_b64_tr_b16 a[154:155], v52 offset:20992
    v_mul_f32 v212, v212, v132
    v_mul_f32 v213, v213, v133
    v_mul_f32 v214, v214, v134
    v_mul_f32 v215, v215, v135
    v_mfma_f32_32x32x16_bf16 v[112:127], a[172:175], a[104:107], v[112:127]
    ds_read_b64_tr_b16 a[156:157], v53 offset:20480
    ds_read_b64_tr_b16 a[158:159], v53 offset:20992
    v_cvt_pk_bf16_f32 v152, v208, v209
    v_cvt_pk_bf16_f32 v153, v210, v211
    v_cvt_pk_bf16_f32 v154, v212, v213
    v_cvt_pk_bf16_f32 v155, v214, v215
    s_waitcnt lgkmcnt(4)
    v_mfma_f32_32x32x16_bf16 v[96:111], a[144:147], a[108:111], v[96:111]
    ds_read_b64_tr_b16 a[160:161], v52 offset:22528
    ds_read_b64_tr_b16 a[162:163], v52 offset:23040
    s_add_u32 s32, s35, 1024
    buffer_store_dwordx4 v[152:155], v19, s[16:19], s32 offen offset:0 sc1
    v_mul_f32 v136, v216, v216
    v_mul_f32 v137, v217, v217
    v_mfma_f32_32x32x16_bf16 v[112:127], a[148:151], a[108:111], v[112:127]
    ds_read_b64_tr_b16 a[164:165], v53 offset:22528
    ds_read_b64_tr_b16 a[166:167], v53 offset:23040
    v_mul_f32 v138, v218, v218
    v_mul_f32 v139, v219, v219
    v_mul_f32 v140, v220, v220
    v_mul_f32 v141, v221, v221
    s_waitcnt lgkmcnt(4)
    v_mfma_f32_32x32x16_bf16 v[96:111], a[152:155], a[112:115], v[96:111]
    ds_read_b64_tr_b16 a[168:169], v52 offset:24576
    ds_read_b64_tr_b16 a[170:171], v52 offset:25088
    v_mul_f32 v142, v222, v222
    v_mul_f32 v143, v223, v223
    v_fma_f32 v136, v136, v61, v60
    v_fma_f32 v137, v137, v61, v60
    v_mfma_f32_32x32x16_bf16 v[112:127], a[156:159], a[112:115], v[112:127]
    ds_read_b64_tr_b16 a[172:173], v53 offset:24576
    ds_read_b64_tr_b16 a[174:175], v53 offset:25088
    v_fma_f32 v138, v138, v61, v60
    v_fma_f32 v139, v139, v61, v60
    v_fma_f32 v140, v140, v61, v60
    v_fma_f32 v141, v141, v61, v60
    s_waitcnt lgkmcnt(4)
    v_mfma_f32_32x32x16_bf16 v[96:111], a[160:163], a[116:119], v[96:111]
    ds_read_b64_tr_b16 a[144:145], v52 offset:26624
    ds_read_b64_tr_b16 a[146:147], v52 offset:27136
    v_fma_f32 v142, v142, v61, v60
    v_fma_f32 v143, v143, v61, v60
    v_mul_f32 v136, v136, v216
    v_mul_f32 v137, v137, v217
    v_mfma_f32_32x32x16_bf16 v[112:127], a[164:167], a[116:119], v[112:127]
    ds_read_b64_tr_b16 a[148:149], v53 offset:26624
    ds_read_b64_tr_b16 a[150:151], v53 offset:27136
    v_mul_f32 v138, v138, v218
    v_mul_f32 v139, v139, v219
    v_mul_f32 v140, v140, v220
    v_mul_f32 v141, v141, v221
    s_waitcnt lgkmcnt(4)
    v_mfma_f32_32x32x16_bf16 v[96:111], a[168:171], a[120:123], v[96:111]
    ds_read_b64_tr_b16 a[152:153], v52 offset:28672
    ds_read_b64_tr_b16 a[154:155], v52 offset:29184
    v_mul_f32 v142, v142, v222
    v_mul_f32 v143, v143, v223
    v_exp_f32 v136, v136
    v_mfma_f32_32x32x16_bf16 v[112:127], a[172:175], a[120:123], v[112:127]
    ds_read_b64_tr_b16 a[156:157], v53 offset:28672
    ds_read_b64_tr_b16 a[158:159], v53 offset:29184
    v_exp_f32 v137, v137
    v_exp_f32 v138, v138
    s_waitcnt lgkmcnt(4)
    v_mfma_f32_32x32x16_bf16 v[96:111], a[144:147], a[124:127], v[96:111]
    ds_read_b64_tr_b16 a[160:161], v52 offset:30720
    ds_read_b64_tr_b16 a[162:163], v52 offset:31232
    v_exp_f32 v139, v139
    v_exp_f32 v140, v140
    v_mfma_f32_32x32x16_bf16 v[112:127], a[148:151], a[124:127], v[112:127]
    ds_read_b64_tr_b16 a[164:165], v53 offset:30720
    ds_read_b64_tr_b16 a[166:167], v53 offset:31232
    v_exp_f32 v141, v141
    v_exp_f32 v142, v142
    s_waitcnt lgkmcnt(4)
    v_mfma_f32_32x32x16_bf16 v[96:111], a[152:155], a[128:131], v[96:111]
    ds_read_b64_tr_b16 a[168:169], v52 offset:32768
    ds_read_b64_tr_b16 a[170:171], v52 offset:33280
    v_exp_f32 v143, v143
    v_add_f32 v136, 1.0, v136
    v_add_f32 v137, 1.0, v137
    v_mfma_f32_32x32x16_bf16 v[112:127], a[156:159], a[128:131], v[112:127]
    ds_read_b64_tr_b16 a[172:173], v53 offset:32768
    ds_read_b64_tr_b16 a[174:175], v53 offset:33280
    v_add_f32 v138, 1.0, v138
    v_add_f32 v139, 1.0, v139
    v_add_f32 v140, 1.0, v140
    v_add_f32 v141, 1.0, v141
    s_waitcnt lgkmcnt(4)
    v_mfma_f32_32x32x16_bf16 v[96:111], a[160:163], a[132:135], v[96:111]
    ds_read_b64_tr_b16 a[144:145], v52 offset:34816
    ds_read_b64_tr_b16 a[146:147], v52 offset:35328
    v_add_f32 v142, 1.0, v142
    v_add_f32 v143, 1.0, v143
    v_rcp_f32 v136, v136
    v_mfma_f32_32x32x16_bf16 v[112:127], a[164:167], a[132:135], v[112:127]
    ds_read_b64_tr_b16 a[148:149], v53 offset:34816
    ds_read_b64_tr_b16 a[150:151], v53 offset:35328
    v_rcp_f32 v137, v137
    v_rcp_f32 v138, v138
    s_waitcnt lgkmcnt(4)
    v_mfma_f32_32x32x16_bf16 v[96:111], a[168:171], a[136:139], v[96:111]
    ds_read_b64_tr_b16 a[152:153], v52 offset:36864
    ds_read_b64_tr_b16 a[154:155], v52 offset:37376
    v_rcp_f32 v139, v139
    v_rcp_f32 v140, v140
    v_mfma_f32_32x32x16_bf16 v[112:127], a[172:175], a[136:139], v[112:127]
    ds_read_b64_tr_b16 a[156:157], v53 offset:36864
    ds_read_b64_tr_b16 a[158:159], v53 offset:37376
    v_rcp_f32 v141, v141
    v_rcp_f32 v142, v142
    s_waitcnt lgkmcnt(4)
    v_mfma_f32_32x32x16_bf16 v[96:111], a[144:147], a[140:143], v[96:111]
    s_waitcnt vmcnt(13)
    s_barrier
    ds_read_b64_tr_b16 a[160:161], v46 offset:0
    ds_read_b64_tr_b16 a[162:163], v46 offset:512
    s_add_u32 m0, s33, 81920
    s_add_u32 s31, s34, 384
    buffer_load_dwordx4 v236, s[8:11], s31 offen offset:0 lds
    v_rcp_f32 v143, v143
    v_mul_f32 v216, v216, v136
    v_mul_f32 v217, v217, v137
    v_mfma_f32_32x32x16_bf16 v[112:127], a[148:151], a[140:143], v[112:127]
    ds_read_b64_tr_b16 a[164:165], v47 offset:0
    ds_read_b64_tr_b16 a[166:167], v47 offset:512
    buffer_load_dwordx4 v237, s[8:11], s31 offen offset:1024 lds
    v_mul_f32 v218, v218, v138
    v_mul_f32 v219, v219, v139
    v_mul_f32 v220, v220, v140
    v_mul_f32 v221, v221, v141
    s_waitcnt lgkmcnt(4)
    v_mfma_f32_32x32x16_bf16 v[96:111], a[152:155], v[56:59], v[96:111]
    ds_read_b64_tr_b16 a[168:169], v46 offset:2048
    ds_read_b64_tr_b16 a[170:171], v46 offset:2560
    buffer_load_dwordx4 v238, s[8:11], s31 offen offset:2048 lds
    v_mul_f32 v222, v222, v142
    v_mul_f32 v223, v223, v143
    v_cvt_pk_bf16_f32 v156, v216, v217
    v_cvt_pk_bf16_f32 v157, v218, v219
    v_mfma_f32_32x32x16_bf16 v[112:127], a[156:159], v[56:59], v[112:127]
    ds_read_b64_tr_b16 a[172:173], v47 offset:2048
    ds_read_b64_tr_b16 a[174:175], v47 offset:2560
    buffer_load_dwordx4 v239, s[8:11], s31 offen offset:3072 lds
    v_cvt_pk_bf16_f32 v158, v220, v221
    v_cvt_pk_bf16_f32 v159, v222, v223
    s_add_u32 s32, s35, 1024
    buffer_store_dwordx4 v[156:159], v19, s[16:19], s32 offen offset:512 sc1
    s_waitcnt lgkmcnt(4)
    v_mfma_f32_32x32x16_bf16 v[64:79], a[160:163], a[0:3], 0
    ds_read_b64_tr_b16 a[144:145], v46 offset:4096
    ds_read_b64_tr_b16 a[146:147], v46 offset:4608
    s_add_u32 m0, s33, 86016
    s_add_u32 s31, s34, 295296
    buffer_load_dwordx4 v236, s[8:11], s31 offen offset:0 lds
    v_mfma_f32_32x32x16_bf16 v[80:95], a[164:167], a[0:3], 0
    ds_read_b64_tr_b16 a[148:149], v47 offset:4096
    ds_read_b64_tr_b16 a[150:151], v47 offset:4608
    buffer_load_dwordx4 v237, s[8:11], s31 offen offset:1024 lds
    s_waitcnt lgkmcnt(4)
    v_mfma_f32_32x32x16_bf16 v[64:79], a[168:171], a[4:7], v[64:79]
    ds_read_b64_tr_b16 a[152:153], v46 offset:6144
    ds_read_b64_tr_b16 a[154:155], v46 offset:6656
    buffer_load_dwordx4 v238, s[8:11], s31 offen offset:2048 lds
    v_mul_f32 v128, v96, v96
    v_mul_f32 v129, v97, v97
    v_mul_f32 v130, v98, v98
    v_mul_f32 v131, v99, v99
    v_mul_f32 v132, v100, v100
    v_mfma_f32_32x32x16_bf16 v[80:95], a[172:175], a[4:7], v[80:95]
    ds_read_b64_tr_b16 a[156:157], v47 offset:6144
    ds_read_b64_tr_b16 a[158:159], v47 offset:6656
    buffer_load_dwordx4 v239, s[8:11], s31 offen offset:3072 lds
    v_mul_f32 v133, v101, v101
    v_mul_f32 v134, v102, v102
    v_mul_f32 v135, v103, v103
    v_fma_f32 v128, v128, v61, v60
    v_fma_f32 v129, v129, v61, v60
    s_waitcnt lgkmcnt(4)
    v_mfma_f32_32x32x16_bf16 v[64:79], a[144:147], a[8:11], v[64:79]
    ds_read_b64_tr_b16 a[160:161], v46 offset:8192
    ds_read_b64_tr_b16 a[162:163], v46 offset:8704
    s_add_u32 m0, s33, 90112
    s_add_u32 s31, s34, 590208
    buffer_load_dwordx4 v236, s[8:11], s31 offen offset:0 lds
    v_fma_f32 v130, v130, v61, v60
    v_fma_f32 v131, v131, v61, v60
    v_fma_f32 v132, v132, v61, v60
    v_fma_f32 v133, v133, v61, v60
    v_fma_f32 v134, v134, v61, v60
    v_mfma_f32_32x32x16_bf16 v[80:95], a[148:151], a[8:11], v[80:95]
    ds_read_b64_tr_b16 a[164:165], v47 offset:8192
    ds_read_b64_tr_b16 a[166:167], v47 offset:8704
    v_fma_f32 v135, v135, v61, v60
    v_mul_f32 v128, v128, v96
    v_mul_f32 v129, v129, v97
    v_mul_f32 v130, v130, v98
    v_mul_f32 v131, v131, v99
    s_waitcnt lgkmcnt(4)
    v_mfma_f32_32x32x16_bf16 v[64:79], a[152:155], a[12:15], v[64:79]
    ds_read_b64_tr_b16 a[168:169], v46 offset:10240
    ds_read_b64_tr_b16 a[170:171], v46 offset:10752
    v_mul_f32 v132, v132, v100
    v_mul_f32 v133, v133, v101
    v_mul_f32 v134, v134, v102
    v_mul_f32 v135, v135, v103
    v_exp_f32 v128, v128
    v_mfma_f32_32x32x16_bf16 v[80:95], a[156:159], a[12:15], v[80:95]
    ds_read_b64_tr_b16 a[172:173], v47 offset:10240
    ds_read_b64_tr_b16 a[174:175], v47 offset:10752
    v_exp_f32 v129, v129
    v_exp_f32 v130, v130
    v_exp_f32 v131, v131
    s_waitcnt lgkmcnt(4)
    v_mfma_f32_32x32x16_bf16 v[64:79], a[160:163], a[16:19], v[64:79]
    ds_read_b64_tr_b16 a[144:145], v46 offset:12288
    ds_read_b64_tr_b16 a[146:147], v46 offset:12800
    v_exp_f32 v132, v132
    v_exp_f32 v133, v133
    v_exp_f32 v134, v134
    v_mfma_f32_32x32x16_bf16 v[80:95], a[164:167], a[16:19], v[80:95]
    ds_read_b64_tr_b16 a[148:149], v47 offset:12288
    ds_read_b64_tr_b16 a[150:151], v47 offset:12800
    v_exp_f32 v135, v135
    v_add_f32 v128, 1.0, v128
    v_add_f32 v129, 1.0, v129
    v_add_f32 v130, 1.0, v130
    s_waitcnt lgkmcnt(4)
    v_mfma_f32_32x32x16_bf16 v[64:79], a[168:171], a[20:23], v[64:79]
    ds_read_b64_tr_b16 a[152:153], v46 offset:14336
    ds_read_b64_tr_b16 a[154:155], v46 offset:14848
    v_add_f32 v131, 1.0, v131
    v_add_f32 v132, 1.0, v132
    v_add_f32 v133, 1.0, v133
    v_add_f32 v134, 1.0, v134
    v_add_f32 v135, 1.0, v135
    v_mfma_f32_32x32x16_bf16 v[80:95], a[172:175], a[20:23], v[80:95]
    ds_read_b64_tr_b16 a[156:157], v47 offset:14336
    ds_read_b64_tr_b16 a[158:159], v47 offset:14848
    v_rcp_f32 v128, v128
    v_rcp_f32 v129, v129
    v_rcp_f32 v130, v130
    s_waitcnt lgkmcnt(4)
    v_mfma_f32_32x32x16_bf16 v[64:79], a[144:147], a[24:27], v[64:79]
    ds_read_b64_tr_b16 a[160:161], v46 offset:16384
    ds_read_b64_tr_b16 a[162:163], v46 offset:16896
    v_rcp_f32 v131, v131
    v_rcp_f32 v132, v132
    v_rcp_f32 v133, v133
    v_mfma_f32_32x32x16_bf16 v[80:95], a[148:151], a[24:27], v[80:95]
    ds_read_b64_tr_b16 a[164:165], v47 offset:16384
    ds_read_b64_tr_b16 a[166:167], v47 offset:16896
    v_rcp_f32 v134, v134
    v_rcp_f32 v135, v135
    v_mul_f32 v96, v96, v128
    s_waitcnt lgkmcnt(4)
    v_mfma_f32_32x32x16_bf16 v[64:79], a[152:155], a[28:31], v[64:79]
    ds_read_b64_tr_b16 a[168:169], v46 offset:18432
    ds_read_b64_tr_b16 a[170:171], v46 offset:18944
    v_mul_f32 v97, v97, v129
    v_mul_f32 v98, v98, v130
    v_mul_f32 v99, v99, v131
    v_mul_f32 v100, v100, v132
    v_mul_f32 v101, v101, v133
    v_mfma_f32_32x32x16_bf16 v[80:95], a[156:159], a[28:31], v[80:95]
    ds_read_b64_tr_b16 a[172:173], v47 offset:18432
    ds_read_b64_tr_b16 a[174:175], v47 offset:18944
    v_mul_f32 v102, v102, v134
    v_mul_f32 v103, v103, v135
    v_cvt_pk_bf16_f32 v160, v96, v97
    v_cvt_pk_bf16_f32 v161, v98, v99
    v_cvt_pk_bf16_f32 v162, v100, v101
    s_waitcnt lgkmcnt(4)
    v_mfma_f32_32x32x16_bf16 v[64:79], a[160:163], a[32:35], v[64:79]
    ds_read_b64_tr_b16 a[144:145], v46 offset:20480
    ds_read_b64_tr_b16 a[146:147], v46 offset:20992
    v_cvt_pk_bf16_f32 v163, v102, v103
    s_add_u32 s32, s35, 2048
    buffer_store_dwordx4 v[160:163], v19, s[16:19], s32 offen offset:0 sc1
    v_mul_f32 v136, v104, v104
    v_mul_f32 v137, v105, v105
    v_mfma_f32_32x32x16_bf16 v[80:95], a[164:167], a[32:35], v[80:95]
    ds_read_b64_tr_b16 a[148:149], v47 offset:20480
    ds_read_b64_tr_b16 a[150:151], v47 offset:20992
    v_mul_f32 v138, v106, v106
    v_mul_f32 v139, v107, v107
    v_mul_f32 v140, v108, v108
    v_mul_f32 v141, v109, v109
    v_mul_f32 v142, v110, v110
    s_waitcnt lgkmcnt(4)
    v_mfma_f32_32x32x16_bf16 v[64:79], a[168:171], a[36:39], v[64:79]
    ds_read_b64_tr_b16 a[152:153], v46 offset:22528
    ds_read_b64_tr_b16 a[154:155], v46 offset:23040
    v_mul_f32 v143, v111, v111
    v_fma_f32 v136, v136, v61, v60
    v_fma_f32 v137, v137, v61, v60
    v_fma_f32 v138, v138, v61, v60
    v_fma_f32 v139, v139, v61, v60
    v_mfma_f32_32x32x16_bf16 v[80:95], a[172:175], a[36:39], v[80:95]
    ds_read_b64_tr_b16 a[156:157], v47 offset:22528
    ds_read_b64_tr_b16 a[158:159], v47 offset:23040
    v_fma_f32 v140, v140, v61, v60
    v_fma_f32 v141, v141, v61, v60
    v_fma_f32 v142, v142, v61, v60
    v_fma_f32 v143, v143, v61, v60
    v_mul_f32 v136, v136, v104
    s_waitcnt lgkmcnt(4)
    v_mfma_f32_32x32x16_bf16 v[64:79], a[144:147], a[40:43], v[64:79]
    ds_read_b64_tr_b16 a[160:161], v46 offset:24576
    ds_read_b64_tr_b16 a[162:163], v46 offset:25088
    v_mul_f32 v137, v137, v105
    v_mul_f32 v138, v138, v106
    v_mul_f32 v139, v139, v107
    v_mul_f32 v140, v140, v108
    v_mul_f32 v141, v141, v109
    v_mfma_f32_32x32x16_bf16 v[80:95], a[148:151], a[40:43], v[80:95]
    ds_read_b64_tr_b16 a[164:165], v47 offset:24576
    ds_read_b64_tr_b16 a[166:167], v47 offset:25088
    v_mul_f32 v142, v142, v110
    v_mul_f32 v143, v143, v111
    v_exp_f32 v136, v136
    s_waitcnt lgkmcnt(4)
    v_mfma_f32_32x32x16_bf16 v[64:79], a[152:155], a[44:47], v[64:79]
    ds_read_b64_tr_b16 a[168:169], v46 offset:26624
    ds_read_b64_tr_b16 a[170:171], v46 offset:27136
    v_exp_f32 v137, v137
    v_exp_f32 v138, v138
    v_mfma_f32_32x32x16_bf16 v[80:95], a[156:159], a[44:47], v[80:95]
    ds_read_b64_tr_b16 a[172:173], v47 offset:26624
    ds_read_b64_tr_b16 a[174:175], v47 offset:27136
    v_exp_f32 v139, v139
    v_exp_f32 v140, v140
    s_waitcnt lgkmcnt(4)
    v_mfma_f32_32x32x16_bf16 v[64:79], a[160:163], a[48:51], v[64:79]
    ds_read_b64_tr_b16 a[144:145], v46 offset:28672
    ds_read_b64_tr_b16 a[146:147], v46 offset:29184
    v_exp_f32 v141, v141
    v_exp_f32 v142, v142
    v_mfma_f32_32x32x16_bf16 v[80:95], a[164:167], a[48:51], v[80:95]
    ds_read_b64_tr_b16 a[148:149], v47 offset:28672
    ds_read_b64_tr_b16 a[150:151], v47 offset:29184
    v_exp_f32 v143, v143
    v_add_f32 v136, 1.0, v136
    v_add_f32 v137, 1.0, v137
    s_waitcnt lgkmcnt(4)
    v_mfma_f32_32x32x16_bf16 v[64:79], a[168:171], a[52:55], v[64:79]
    ds_read_b64_tr_b16 a[152:153], v46 offset:30720
    ds_read_b64_tr_b16 a[154:155], v46 offset:31232
    v_add_f32 v138, 1.0, v138
    v_add_f32 v139, 1.0, v139
    v_add_f32 v140, 1.0, v140
    v_add_f32 v141, 1.0, v141
    v_mfma_f32_32x32x16_bf16 v[80:95], a[172:175], a[52:55], v[80:95]
    ds_read_b64_tr_b16 a[156:157], v47 offset:30720
    ds_read_b64_tr_b16 a[158:159], v47 offset:31232
    v_add_f32 v142, 1.0, v142
    v_add_f32 v143, 1.0, v143
    v_rcp_f32 v136, v136
    s_waitcnt lgkmcnt(4)
    v_mfma_f32_32x32x16_bf16 v[64:79], a[144:147], a[56:59], v[64:79]
    ds_read_b64_tr_b16 a[160:161], v46 offset:32768
    ds_read_b64_tr_b16 a[162:163], v46 offset:33280
    v_rcp_f32 v137, v137
    v_rcp_f32 v138, v138
    v_mfma_f32_32x32x16_bf16 v[80:95], a[148:151], a[56:59], v[80:95]
    ds_read_b64_tr_b16 a[164:165], v47 offset:32768
    ds_read_b64_tr_b16 a[166:167], v47 offset:33280
    v_rcp_f32 v139, v139
    v_rcp_f32 v140, v140
    s_waitcnt lgkmcnt(4)
    v_mfma_f32_32x32x16_bf16 v[64:79], a[152:155], a[60:63], v[64:79]
    ds_read_b64_tr_b16 a[168:169], v46 offset:34816
    ds_read_b64_tr_b16 a[170:171], v46 offset:35328
    v_rcp_f32 v141, v141
    v_rcp_f32 v142, v142
    v_mfma_f32_32x32x16_bf16 v[80:95], a[156:159], a[60:63], v[80:95]
    ds_read_b64_tr_b16 a[172:173], v47 offset:34816
    ds_read_b64_tr_b16 a[174:175], v47 offset:35328
    v_rcp_f32 v143, v143
    v_mul_f32 v104, v104, v136
    v_mul_f32 v105, v105, v137
    s_waitcnt lgkmcnt(4)
    v_mfma_f32_32x32x16_bf16 v[64:79], a[160:163], a[64:67], v[64:79]
    s_waitcnt vmcnt(12)
    s_barrier
    ds_read_b64_tr_b16 a[144:145], v48 offset:0
    ds_read_b64_tr_b16 a[146:147], v48 offset:512
    s_add_u32 m0, s33, 122880
    s_add_u32 s31, s34, 2654592
    buffer_load_dwordx4 v236, s[8:11], s31 offen offset:0 lds
    v_mul_f32 v106, v106, v138
    v_mul_f32 v107, v107, v139
    v_mul_f32 v108, v108, v140
    v_mul_f32 v109, v109, v141
    v_mfma_f32_32x32x16_bf16 v[80:95], a[164:167], a[64:67], v[80:95]
    ds_read_b64_tr_b16 a[148:149], v49 offset:0
    ds_read_b64_tr_b16 a[150:151], v49 offset:512
    buffer_load_dwordx4 v237, s[8:11], s31 offen offset:1024 lds
    v_mul_f32 v110, v110, v142
    v_mul_f32 v111, v111, v143
    v_cvt_pk_bf16_f32 v164, v104, v105
    v_cvt_pk_bf16_f32 v165, v106, v107
    s_waitcnt lgkmcnt(4)
    v_mfma_f32_32x32x16_bf16 v[64:79], a[168:171], a[68:71], v[64:79]
    ds_read_b64_tr_b16 a[152:153], v48 offset:2048
    ds_read_b64_tr_b16 a[154:155], v48 offset:2560
    buffer_load_dwordx4 v238, s[8:11], s31 offen offset:2048 lds
    v_cvt_pk_bf16_f32 v166, v108, v109
    v_cvt_pk_bf16_f32 v167, v110, v111
    s_add_u32 s32, s35, 2048
    buffer_store_dwordx4 v[164:167], v19, s[16:19], s32 offen offset:512 sc1
    v_mfma_f32_32x32x16_bf16 v[80:95], a[172:175], a[68:71], v[80:95]
    ds_read_b64_tr_b16 a[156:157], v49 offset:2048
    ds_read_b64_tr_b16 a[158:159], v49 offset:2560
    buffer_load_dwordx4 v239, s[8:11], s31 offen offset:3072 lds
    v_mul_f32 v128, v112, v112
    v_mul_f32 v129, v113, v113
    v_mul_f32 v130, v114, v114
    v_mul_f32 v131, v115, v115
    s_waitcnt lgkmcnt(4)
    v_mfma_f32_32x32x16_bf16 v[64:79], a[144:147], a[72:75], v[64:79]
    ds_read_b64_tr_b16 a[160:161], v48 offset:4096
    ds_read_b64_tr_b16 a[162:163], v48 offset:4608
    s_add_u32 m0, s33, 126976
    s_add_u32 s31, s34, 2949504
    buffer_load_dwordx4 v236, s[8:11], s31 offen offset:0 lds
    v_mul_f32 v132, v116, v116
    v_mul_f32 v133, v117, v117
    v_mul_f32 v134, v118, v118
    v_mul_f32 v135, v119, v119
    v_mfma_f32_32x32x16_bf16 v[80:95], a[148:151], a[72:75], v[80:95]
    ds_read_b64_tr_b16 a[164:165], v49 offset:4096
    ds_read_b64_tr_b16 a[166:167], v49 offset:4608
    buffer_load_dwordx4 v237, s[8:11], s31 offen offset:1024 lds
    v_fma_f32 v128, v128, v61, v60
    v_fma_f32 v129, v129, v61, v60
    v_fma_f32 v130, v130, v61, v60
    v_fma_f32 v131, v131, v61, v60
    s_waitcnt lgkmcnt(4)
    v_mfma_f32_32x32x16_bf16 v[64:79], a[152:155], a[76:79], v[64:79]
    ds_read_b64_tr_b16 a[168:169], v48 offset:6144
    ds_read_b64_tr_b16 a[170:171], v48 offset:6656
    buffer_load_dwordx4 v238, s[8:11], s31 offen offset:2048 lds
    v_fma_f32 v132, v132, v61, v60
    v_fma_f32 v133, v133, v61, v60
    v_fma_f32 v134, v134, v61, v60
    v_fma_f32 v135, v135, v61, v60
    v_mfma_f32_32x32x16_bf16 v[80:95], a[156:159], a[76:79], v[80:95]
    ds_read_b64_tr_b16 a[172:173], v49 offset:6144
    ds_read_b64_tr_b16 a[174:175], v49 offset:6656
    buffer_load_dwordx4 v239, s[8:11], s31 offen offset:3072 lds
    v_mul_f32 v128, v128, v112
    v_mul_f32 v129, v129, v113
    v_mul_f32 v130, v130, v114
    v_mul_f32 v131, v131, v115
    s_waitcnt lgkmcnt(4)
    v_mfma_f32_32x32x16_bf16 v[64:79], a[160:163], a[80:83], v[64:79]
    ds_read_b64_tr_b16 a[144:145], v48 offset:8192
    ds_read_b64_tr_b16 a[146:147], v48 offset:8704
    s_add_u32 m0, s33, 131072
    s_add_u32 s31, s34, 3244416
    buffer_load_dwordx4 v236, s[8:11], s31 offen offset:0 lds
    v_mul_f32 v132, v132, v116
    v_mul_f32 v133, v133, v117
    v_mul_f32 v134, v134, v118
    v_mul_f32 v135, v135, v119
    v_mfma_f32_32x32x16_bf16 v[80:95], a[164:167], a[80:83], v[80:95]
    ds_read_b64_tr_b16 a[148:149], v49 offset:8192
    ds_read_b64_tr_b16 a[150:151], v49 offset:8704
    s_add_u32 m0, s28, 159744
    s_add_u32 s31, s34, 384
    buffer_load_dwordx4 v240, s[24:27], s31 offen sc1 lds
    v_exp_f32 v128, v128
    v_exp_f32 v129, v129
    s_waitcnt lgkmcnt(4)
    v_mfma_f32_32x32x16_bf16 v[64:79], a[168:171], a[84:87], v[64:79]
    ds_read_b64_tr_b16 a[152:153], v48 offset:10240
    ds_read_b64_tr_b16 a[154:155], v48 offset:10752
    v_exp_f32 v130, v130
    v_exp_f32 v131, v131
    v_mfma_f32_32x32x16_bf16 v[80:95], a[172:175], a[84:87], v[80:95]
    ds_read_b64_tr_b16 a[156:157], v49 offset:10240
    ds_read_b64_tr_b16 a[158:159], v49 offset:10752
    v_exp_f32 v132, v132
    v_exp_f32 v133, v133
    s_waitcnt lgkmcnt(4)
    v_mfma_f32_32x32x16_bf16 v[64:79], a[144:147], a[88:91], v[64:79]
    ds_read_b64_tr_b16 a[160:161], v48 offset:12288
    ds_read_b64_tr_b16 a[162:163], v48 offset:12800
    v_exp_f32 v134, v134
    v_exp_f32 v135, v135
    v_mfma_f32_32x32x16_bf16 v[80:95], a[148:151], a[88:91], v[80:95]
    ds_read_b64_tr_b16 a[164:165], v49 offset:12288
    ds_read_b64_tr_b16 a[166:167], v49 offset:12800
    v_add_f32 v128, 1.0, v128
    v_add_f32 v129, 1.0, v129
    v_add_f32 v130, 1.0, v130
    v_add_f32 v131, 1.0, v131
    s_waitcnt lgkmcnt(4)
    v_mfma_f32_32x32x16_bf16 v[64:79], a[152:155], a[92:95], v[64:79]
    ds_read_b64_tr_b16 a[168:169], v48 offset:14336
    ds_read_b64_tr_b16 a[170:171], v48 offset:14848
    v_add_f32 v132, 1.0, v132
    v_add_f32 v133, 1.0, v133
    v_add_f32 v134, 1.0, v134
    v_add_f32 v135, 1.0, v135
    v_mfma_f32_32x32x16_bf16 v[80:95], a[156:159], a[92:95], v[80:95]
    ds_read_b64_tr_b16 a[172:173], v49 offset:14336
    ds_read_b64_tr_b16 a[174:175], v49 offset:14848
    v_rcp_f32 v128, v128
    v_rcp_f32 v129, v129
    s_waitcnt lgkmcnt(4)
    v_mfma_f32_32x32x16_bf16 v[64:79], a[160:163], a[96:99], v[64:79]
    ds_read_b64_tr_b16 a[144:145], v48 offset:16384
    ds_read_b64_tr_b16 a[146:147], v48 offset:16896
    v_rcp_f32 v130, v130
    v_rcp_f32 v131, v131
    v_mfma_f32_32x32x16_bf16 v[80:95], a[164:167], a[96:99], v[80:95]
    ds_read_b64_tr_b16 a[148:149], v49 offset:16384
    ds_read_b64_tr_b16 a[150:151], v49 offset:16896
    v_rcp_f32 v132, v132
    v_rcp_f32 v133, v133
    s_waitcnt lgkmcnt(4)
    v_mfma_f32_32x32x16_bf16 v[64:79], a[168:171], a[100:103], v[64:79]
    ds_read_b64_tr_b16 a[152:153], v48 offset:18432
    ds_read_b64_tr_b16 a[154:155], v48 offset:18944
    v_rcp_f32 v134, v134
    v_rcp_f32 v135, v135
    v_mfma_f32_32x32x16_bf16 v[80:95], a[172:175], a[100:103], v[80:95]
    ds_read_b64_tr_b16 a[156:157], v49 offset:18432
    ds_read_b64_tr_b16 a[158:159], v49 offset:18944
    v_mul_f32 v112, v112, v128
    v_mul_f32 v113, v113, v129
    v_mul_f32 v114, v114, v130
    v_mul_f32 v115, v115, v131
    s_waitcnt lgkmcnt(4)
    v_mfma_f32_32x32x16_bf16 v[64:79], a[144:147], a[104:107], v[64:79]
    ds_read_b64_tr_b16 a[160:161], v48 offset:20480
    ds_read_b64_tr_b16 a[162:163], v48 offset:20992
    v_mul_f32 v116, v116, v132
    v_mul_f32 v117, v117, v133
    v_mul_f32 v118, v118, v134
    v_mul_f32 v119, v119, v135
    v_mfma_f32_32x32x16_bf16 v[80:95], a[148:151], a[104:107], v[80:95]
    ds_read_b64_tr_b16 a[164:165], v49 offset:20480
    ds_read_b64_tr_b16 a[166:167], v49 offset:20992
    v_cvt_pk_bf16_f32 v168, v112, v113
    v_cvt_pk_bf16_f32 v169, v114, v115
    v_cvt_pk_bf16_f32 v170, v116, v117
    v_cvt_pk_bf16_f32 v171, v118, v119
    s_waitcnt lgkmcnt(4)
    v_mfma_f32_32x32x16_bf16 v[64:79], a[152:155], a[108:111], v[64:79]
    ds_read_b64_tr_b16 a[168:169], v48 offset:22528
    ds_read_b64_tr_b16 a[170:171], v48 offset:23040
    s_add_u32 s32, s35, 3072
    buffer_store_dwordx4 v[168:171], v19, s[16:19], s32 offen offset:0 sc1
    v_mul_f32 v136, v120, v120
    v_mul_f32 v137, v121, v121
    v_mfma_f32_32x32x16_bf16 v[80:95], a[156:159], a[108:111], v[80:95]
    ds_read_b64_tr_b16 a[172:173], v49 offset:22528
    ds_read_b64_tr_b16 a[174:175], v49 offset:23040
    v_mul_f32 v138, v122, v122
    v_mul_f32 v139, v123, v123
    v_mul_f32 v140, v124, v124
    v_mul_f32 v141, v125, v125
    s_waitcnt lgkmcnt(4)
    v_mfma_f32_32x32x16_bf16 v[64:79], a[160:163], a[112:115], v[64:79]
    ds_read_b64_tr_b16 a[144:145], v48 offset:24576
    ds_read_b64_tr_b16 a[146:147], v48 offset:25088
    v_mul_f32 v142, v126, v126
    v_mul_f32 v143, v127, v127
    v_fma_f32 v136, v136, v61, v60
    v_fma_f32 v137, v137, v61, v60
    v_mfma_f32_32x32x16_bf16 v[80:95], a[164:167], a[112:115], v[80:95]
    ds_read_b64_tr_b16 a[148:149], v49 offset:24576
    ds_read_b64_tr_b16 a[150:151], v49 offset:25088
    v_fma_f32 v138, v138, v61, v60
    v_fma_f32 v139, v139, v61, v60
    v_fma_f32 v140, v140, v61, v60
    v_fma_f32 v141, v141, v61, v60
    s_waitcnt lgkmcnt(4)
    v_mfma_f32_32x32x16_bf16 v[64:79], a[168:171], a[116:119], v[64:79]
    ds_read_b64_tr_b16 a[152:153], v48 offset:26624
    ds_read_b64_tr_b16 a[154:155], v48 offset:27136
    v_fma_f32 v142, v142, v61, v60
    v_fma_f32 v143, v143, v61, v60
    v_mul_f32 v136, v136, v120
    v_mul_f32 v137, v137, v121
    v_mfma_f32_32x32x16_bf16 v[80:95], a[172:175], a[116:119], v[80:95]
    ds_read_b64_tr_b16 a[156:157], v49 offset:26624
    ds_read_b64_tr_b16 a[158:159], v49 offset:27136
    v_mul_f32 v138, v138, v122
    v_mul_f32 v139, v139, v123
    v_mul_f32 v140, v140, v124
    v_mul_f32 v141, v141, v125
    s_waitcnt lgkmcnt(4)
    v_mfma_f32_32x32x16_bf16 v[64:79], a[144:147], a[120:123], v[64:79]
    ds_read_b64_tr_b16 a[160:161], v48 offset:28672
    ds_read_b64_tr_b16 a[162:163], v48 offset:29184
    v_mul_f32 v142, v142, v126
    v_mul_f32 v143, v143, v127
    v_exp_f32 v136, v136
    v_mfma_f32_32x32x16_bf16 v[80:95], a[148:151], a[120:123], v[80:95]
    ds_read_b64_tr_b16 a[164:165], v49 offset:28672
    ds_read_b64_tr_b16 a[166:167], v49 offset:29184
    v_exp_f32 v137, v137
    v_exp_f32 v138, v138
    s_waitcnt lgkmcnt(4)
    v_mfma_f32_32x32x16_bf16 v[64:79], a[152:155], a[124:127], v[64:79]
    ds_read_b64_tr_b16 a[168:169], v48 offset:30720
    ds_read_b64_tr_b16 a[170:171], v48 offset:31232
    v_exp_f32 v139, v139
    v_exp_f32 v140, v140
    v_mfma_f32_32x32x16_bf16 v[80:95], a[156:159], a[124:127], v[80:95]
    ds_read_b64_tr_b16 a[172:173], v49 offset:30720
    ds_read_b64_tr_b16 a[174:175], v49 offset:31232
    v_exp_f32 v141, v141
    v_exp_f32 v142, v142
    s_waitcnt lgkmcnt(4)
    v_mfma_f32_32x32x16_bf16 v[64:79], a[160:163], a[128:131], v[64:79]
    ds_read_b64_tr_b16 a[144:145], v48 offset:32768
    ds_read_b64_tr_b16 a[146:147], v48 offset:33280
    v_exp_f32 v143, v143
    v_add_f32 v136, 1.0, v136
    v_add_f32 v137, 1.0, v137
    v_mfma_f32_32x32x16_bf16 v[80:95], a[164:167], a[128:131], v[80:95]
    ds_read_b64_tr_b16 a[148:149], v49 offset:32768
    ds_read_b64_tr_b16 a[150:151], v49 offset:33280
    v_add_f32 v138, 1.0, v138
    v_add_f32 v139, 1.0, v139
    v_add_f32 v140, 1.0, v140
    v_add_f32 v141, 1.0, v141
    s_waitcnt lgkmcnt(4)
    v_mfma_f32_32x32x16_bf16 v[64:79], a[168:171], a[132:135], v[64:79]
    ds_read_b64_tr_b16 a[152:153], v48 offset:34816
    ds_read_b64_tr_b16 a[154:155], v48 offset:35328
    v_add_f32 v142, 1.0, v142
    v_add_f32 v143, 1.0, v143
    v_rcp_f32 v136, v136
    v_mfma_f32_32x32x16_bf16 v[80:95], a[172:175], a[132:135], v[80:95]
    ds_read_b64_tr_b16 a[156:157], v49 offset:34816
    ds_read_b64_tr_b16 a[158:159], v49 offset:35328
    v_rcp_f32 v137, v137
    v_rcp_f32 v138, v138
    s_waitcnt lgkmcnt(4)
    v_mfma_f32_32x32x16_bf16 v[64:79], a[144:147], a[136:139], v[64:79]
    ds_read_b64_tr_b16 a[160:161], v48 offset:36864
    ds_read_b64_tr_b16 a[162:163], v48 offset:37376
    v_rcp_f32 v139, v139
    v_rcp_f32 v140, v140
    v_mfma_f32_32x32x16_bf16 v[80:95], a[148:151], a[136:139], v[80:95]
    ds_read_b64_tr_b16 a[164:165], v49 offset:36864
    ds_read_b64_tr_b16 a[166:167], v49 offset:37376
    v_rcp_f32 v141, v141
    v_rcp_f32 v142, v142
    s_waitcnt lgkmcnt(4)
    v_mfma_f32_32x32x16_bf16 v[64:79], a[152:155], a[140:143], v[64:79]
    s_waitcnt vmcnt(13)
    s_barrier
    ds_read_b64_tr_b16 a[168:169], v50 offset:0
    ds_read_b64_tr_b16 a[170:171], v50 offset:512
    s_add_u32 m0, s33, 0
    s_add_u32 s31, s101, 0
    buffer_load_dwordx4 v8, s[8:11], s31 offen offset:0 lds
    v_rcp_f32 v143, v143
    v_mul_f32 v120, v120, v136
    v_mul_f32 v121, v121, v137
    v_mfma_f32_32x32x16_bf16 v[80:95], a[156:159], a[140:143], v[80:95]
    ds_read_b64_tr_b16 a[172:173], v51 offset:0
    ds_read_b64_tr_b16 a[174:175], v51 offset:512
    buffer_load_dwordx4 v9, s[8:11], s31 offen offset:1024 lds
    v_mul_f32 v122, v122, v138
    v_mul_f32 v123, v123, v139
    v_mul_f32 v124, v124, v140
    v_mul_f32 v125, v125, v141
    s_waitcnt lgkmcnt(4)
    v_mfma_f32_32x32x16_bf16 v[64:79], a[160:163], v[56:59], v[64:79]
    ds_read_b64_tr_b16 a[144:145], v50 offset:2048
    ds_read_b64_tr_b16 a[146:147], v50 offset:2560
    buffer_load_dwordx4 v10, s[8:11], s31 offen offset:2048 lds
    v_mul_f32 v126, v126, v142
    v_mul_f32 v127, v127, v143
    v_cvt_pk_bf16_f32 v172, v120, v121
    v_cvt_pk_bf16_f32 v173, v122, v123
    v_mfma_f32_32x32x16_bf16 v[80:95], a[164:167], v[56:59], v[80:95]
    ds_read_b64_tr_b16 a[148:149], v51 offset:2048
    ds_read_b64_tr_b16 a[150:151], v51 offset:2560
    buffer_load_dwordx4 v11, s[8:11], s31 offen offset:3072 lds
    v_cvt_pk_bf16_f32 v174, v124, v125
    v_cvt_pk_bf16_f32 v175, v126, v127
    s_add_u32 s32, s35, 3072
    buffer_store_dwordx4 v[172:175], v19, s[16:19], s32 offen offset:512 sc1
    s_waitcnt lgkmcnt(4)
    v_mfma_f32_32x32x16_bf16 v[96:111], a[168:171], a[0:3], 0
    ds_read_b64_tr_b16 a[152:153], v50 offset:4096
    ds_read_b64_tr_b16 a[154:155], v50 offset:4608
    s_add_u32 m0, s33, 4096
    s_add_u32 s31, s101, 589824
    buffer_load_dwordx4 v8, s[8:11], s31 offen offset:0 lds
    v_mfma_f32_32x32x16_bf16 v[112:127], a[172:175], a[0:3], 0
    ds_read_b64_tr_b16 a[156:157], v51 offset:4096
    ds_read_b64_tr_b16 a[158:159], v51 offset:4608
    buffer_load_dwordx4 v9, s[8:11], s31 offen offset:1024 lds
    s_waitcnt lgkmcnt(4)
    v_mfma_f32_32x32x16_bf16 v[96:111], a[144:147], a[4:7], v[96:111]
    ds_read_b64_tr_b16 a[160:161], v50 offset:6144
    ds_read_b64_tr_b16 a[162:163], v50 offset:6656
    buffer_load_dwordx4 v10, s[8:11], s31 offen offset:2048 lds
    v_mul_f32 v128, v64, v64
    v_mul_f32 v129, v65, v65
    v_mul_f32 v130, v66, v66
    v_mul_f32 v131, v67, v67
    v_mul_f32 v132, v68, v68
    v_mfma_f32_32x32x16_bf16 v[112:127], a[148:151], a[4:7], v[112:127]
    ds_read_b64_tr_b16 a[164:165], v51 offset:6144
    ds_read_b64_tr_b16 a[166:167], v51 offset:6656
    buffer_load_dwordx4 v11, s[8:11], s31 offen offset:3072 lds
    v_mul_f32 v133, v69, v69
    v_mul_f32 v134, v70, v70
    v_mul_f32 v135, v71, v71
    v_fma_f32 v128, v128, v61, v60
    v_fma_f32 v129, v129, v61, v60
    s_waitcnt lgkmcnt(4)
    v_mfma_f32_32x32x16_bf16 v[96:111], a[152:155], a[8:11], v[96:111]
    ds_read_b64_tr_b16 a[168:169], v50 offset:8192
    ds_read_b64_tr_b16 a[170:171], v50 offset:8704
    s_add_u32 m0, s33, 8192
    s_add_u32 s31, s101, 1179648
    buffer_load_dwordx4 v8, s[8:11], s31 offen offset:0 lds
    v_fma_f32 v130, v130, v61, v60
    v_fma_f32 v131, v131, v61, v60
    v_fma_f32 v132, v132, v61, v60
    v_fma_f32 v133, v133, v61, v60
    v_fma_f32 v134, v134, v61, v60
    v_mfma_f32_32x32x16_bf16 v[112:127], a[156:159], a[8:11], v[112:127]
    ds_read_b64_tr_b16 a[172:173], v51 offset:8192
    ds_read_b64_tr_b16 a[174:175], v51 offset:8704
    s_add_u32 m0, s28, 36864
    s_mov_b32 s31, s101
    buffer_load_dwordx4 v12, s[24:27], s31 offen sc1 lds
    v_fma_f32 v135, v135, v61, v60
    v_mul_f32 v128, v128, v64
    v_mul_f32 v129, v129, v65
    v_mul_f32 v130, v130, v66
    v_mul_f32 v131, v131, v67
    s_waitcnt lgkmcnt(4)
    v_mfma_f32_32x32x16_bf16 v[96:111], a[160:163], a[12:15], v[96:111]
    ds_read_b64_tr_b16 a[144:145], v50 offset:10240
    ds_read_b64_tr_b16 a[146:147], v50 offset:10752
    v_mul_f32 v132, v132, v68
    v_mul_f32 v133, v133, v69
    v_mul_f32 v134, v134, v70
    v_mul_f32 v135, v135, v71
    v_exp_f32 v128, v128
    v_mfma_f32_32x32x16_bf16 v[112:127], a[164:167], a[12:15], v[112:127]
    ds_read_b64_tr_b16 a[148:149], v51 offset:10240
    ds_read_b64_tr_b16 a[150:151], v51 offset:10752
    v_exp_f32 v129, v129
    v_exp_f32 v130, v130
    v_exp_f32 v131, v131
    s_waitcnt lgkmcnt(4)
    v_mfma_f32_32x32x16_bf16 v[96:111], a[168:171], a[16:19], v[96:111]
    ds_read_b64_tr_b16 a[152:153], v50 offset:12288
    ds_read_b64_tr_b16 a[154:155], v50 offset:12800
    v_exp_f32 v132, v132
    v_exp_f32 v133, v133
    v_exp_f32 v134, v134
    v_mfma_f32_32x32x16_bf16 v[112:127], a[172:175], a[16:19], v[112:127]
    ds_read_b64_tr_b16 a[156:157], v51 offset:12288
    ds_read_b64_tr_b16 a[158:159], v51 offset:12800
    v_exp_f32 v135, v135
    v_add_f32 v128, 1.0, v128
    v_add_f32 v129, 1.0, v129
    v_add_f32 v130, 1.0, v130
    s_waitcnt lgkmcnt(4)
    v_mfma_f32_32x32x16_bf16 v[96:111], a[144:147], a[20:23], v[96:111]
    ds_read_b64_tr_b16 a[160:161], v50 offset:14336
    ds_read_b64_tr_b16 a[162:163], v50 offset:14848
    v_add_f32 v131, 1.0, v131
    v_add_f32 v132, 1.0, v132
    v_add_f32 v133, 1.0, v133
    v_add_f32 v134, 1.0, v134
    v_add_f32 v135, 1.0, v135
    v_mfma_f32_32x32x16_bf16 v[112:127], a[148:151], a[20:23], v[112:127]
    ds_read_b64_tr_b16 a[164:165], v51 offset:14336
    ds_read_b64_tr_b16 a[166:167], v51 offset:14848
    v_rcp_f32 v128, v128
    v_rcp_f32 v129, v129
    v_rcp_f32 v130, v130
    s_waitcnt lgkmcnt(4)
    v_mfma_f32_32x32x16_bf16 v[96:111], a[152:155], a[24:27], v[96:111]
    ds_read_b64_tr_b16 a[168:169], v50 offset:16384
    ds_read_b64_tr_b16 a[170:171], v50 offset:16896
    v_rcp_f32 v131, v131
    v_rcp_f32 v132, v132
    v_rcp_f32 v133, v133
    v_mfma_f32_32x32x16_bf16 v[112:127], a[156:159], a[24:27], v[112:127]
    ds_read_b64_tr_b16 a[172:173], v51 offset:16384
    ds_read_b64_tr_b16 a[174:175], v51 offset:16896
    v_rcp_f32 v134, v134
    v_rcp_f32 v135, v135
    v_mul_f32 v64, v64, v128
    s_waitcnt lgkmcnt(4)
    v_mfma_f32_32x32x16_bf16 v[96:111], a[160:163], a[28:31], v[96:111]
    ds_read_b64_tr_b16 a[144:145], v50 offset:18432
    ds_read_b64_tr_b16 a[146:147], v50 offset:18944
    v_mul_f32 v65, v65, v129
    v_mul_f32 v66, v66, v130
    v_mul_f32 v67, v67, v131
    v_mul_f32 v68, v68, v132
    v_mul_f32 v69, v69, v133
    v_mfma_f32_32x32x16_bf16 v[112:127], a[164:167], a[28:31], v[112:127]
    ds_read_b64_tr_b16 a[148:149], v51 offset:18432
    ds_read_b64_tr_b16 a[150:151], v51 offset:18944
    v_mul_f32 v70, v70, v134
    v_mul_f32 v71, v71, v135
    v_cvt_pk_bf16_f32 v144, v64, v65
    v_cvt_pk_bf16_f32 v145, v66, v67
    v_cvt_pk_bf16_f32 v146, v68, v69
    s_waitcnt lgkmcnt(4)
    v_mfma_f32_32x32x16_bf16 v[96:111], a[168:171], a[32:35], v[96:111]
    ds_read_b64_tr_b16 a[152:153], v50 offset:20480
    ds_read_b64_tr_b16 a[154:155], v50 offset:20992
    v_cvt_pk_bf16_f32 v147, v70, v71
    s_add_u32 s32, s35, 4096
    buffer_store_dwordx4 v[144:147], v19, s[16:19], s32 offen offset:0 sc1
    v_mul_f32 v136, v72, v72
    v_mul_f32 v137, v73, v73
    v_mfma_f32_32x32x16_bf16 v[112:127], a[172:175], a[32:35], v[112:127]
    ds_read_b64_tr_b16 a[156:157], v51 offset:20480
    ds_read_b64_tr_b16 a[158:159], v51 offset:20992
    v_mul_f32 v138, v74, v74
    v_mul_f32 v139, v75, v75
    v_mul_f32 v140, v76, v76
    v_mul_f32 v141, v77, v77
    v_mul_f32 v142, v78, v78
    s_waitcnt lgkmcnt(4)
    v_mfma_f32_32x32x16_bf16 v[96:111], a[144:147], a[36:39], v[96:111]
    ds_read_b64_tr_b16 a[160:161], v50 offset:22528
    ds_read_b64_tr_b16 a[162:163], v50 offset:23040
    v_mul_f32 v143, v79, v79
    v_fma_f32 v136, v136, v61, v60
    v_fma_f32 v137, v137, v61, v60
    v_fma_f32 v138, v138, v61, v60
    v_fma_f32 v139, v139, v61, v60
    v_mfma_f32_32x32x16_bf16 v[112:127], a[148:151], a[36:39], v[112:127]
    ds_read_b64_tr_b16 a[164:165], v51 offset:22528
    ds_read_b64_tr_b16 a[166:167], v51 offset:23040
    v_fma_f32 v140, v140, v61, v60
    v_fma_f32 v141, v141, v61, v60
    v_fma_f32 v142, v142, v61, v60
    v_fma_f32 v143, v143, v61, v60
    v_mul_f32 v136, v136, v72
    s_waitcnt lgkmcnt(4)
    v_mfma_f32_32x32x16_bf16 v[96:111], a[152:155], a[40:43], v[96:111]
    ds_read_b64_tr_b16 a[168:169], v50 offset:24576
    ds_read_b64_tr_b16 a[170:171], v50 offset:25088
    v_mul_f32 v137, v137, v73
    v_mul_f32 v138, v138, v74
    v_mul_f32 v139, v139, v75
    v_mul_f32 v140, v140, v76
    v_mul_f32 v141, v141, v77
    v_mfma_f32_32x32x16_bf16 v[112:127], a[156:159], a[40:43], v[112:127]
    ds_read_b64_tr_b16 a[172:173], v51 offset:24576
    ds_read_b64_tr_b16 a[174:175], v51 offset:25088
    v_mul_f32 v142, v142, v78
    v_mul_f32 v143, v143, v79
    v_exp_f32 v136, v136
    s_waitcnt lgkmcnt(4)
    v_mfma_f32_32x32x16_bf16 v[96:111], a[160:163], a[44:47], v[96:111]
    ds_read_b64_tr_b16 a[144:145], v50 offset:26624
    ds_read_b64_tr_b16 a[146:147], v50 offset:27136
    v_exp_f32 v137, v137
    v_exp_f32 v138, v138
    v_mfma_f32_32x32x16_bf16 v[112:127], a[164:167], a[44:47], v[112:127]
    ds_read_b64_tr_b16 a[148:149], v51 offset:26624
    ds_read_b64_tr_b16 a[150:151], v51 offset:27136
    v_exp_f32 v139, v139
    v_exp_f32 v140, v140
    s_waitcnt lgkmcnt(4)
    v_mfma_f32_32x32x16_bf16 v[96:111], a[168:171], a[48:51], v[96:111]
    ds_read_b64_tr_b16 a[152:153], v50 offset:28672
    ds_read_b64_tr_b16 a[154:155], v50 offset:29184
    v_exp_f32 v141, v141
    v_exp_f32 v142, v142
    v_mfma_f32_32x32x16_bf16 v[112:127], a[172:175], a[48:51], v[112:127]
    ds_read_b64_tr_b16 a[156:157], v51 offset:28672
    ds_read_b64_tr_b16 a[158:159], v51 offset:29184
    v_exp_f32 v143, v143
    v_add_f32 v136, 1.0, v136
    v_add_f32 v137, 1.0, v137
    s_waitcnt lgkmcnt(4)
    v_mfma_f32_32x32x16_bf16 v[96:111], a[144:147], a[52:55], v[96:111]
    ds_read_b64_tr_b16 a[160:161], v50 offset:30720
    ds_read_b64_tr_b16 a[162:163], v50 offset:31232
    v_add_f32 v138, 1.0, v138
    v_add_f32 v139, 1.0, v139
    v_add_f32 v140, 1.0, v140
    v_add_f32 v141, 1.0, v141
    v_mfma_f32_32x32x16_bf16 v[112:127], a[148:151], a[52:55], v[112:127]
    ds_read_b64_tr_b16 a[164:165], v51 offset:30720
    ds_read_b64_tr_b16 a[166:167], v51 offset:31232
    v_add_f32 v142, 1.0, v142
    v_add_f32 v143, 1.0, v143
    v_rcp_f32 v136, v136
    s_waitcnt lgkmcnt(4)
    v_mfma_f32_32x32x16_bf16 v[96:111], a[152:155], a[56:59], v[96:111]
    ds_read_b64_tr_b16 a[168:169], v50 offset:32768
    ds_read_b64_tr_b16 a[170:171], v50 offset:33280
    v_rcp_f32 v137, v137
    v_rcp_f32 v138, v138
    v_mfma_f32_32x32x16_bf16 v[112:127], a[156:159], a[56:59], v[112:127]
    ds_read_b64_tr_b16 a[172:173], v51 offset:32768
    ds_read_b64_tr_b16 a[174:175], v51 offset:33280
    v_rcp_f32 v139, v139
    v_rcp_f32 v140, v140
    s_waitcnt lgkmcnt(4)
    v_mfma_f32_32x32x16_bf16 v[96:111], a[160:163], a[60:63], v[96:111]
    ds_read_b64_tr_b16 a[144:145], v50 offset:34816
    ds_read_b64_tr_b16 a[146:147], v50 offset:35328
    v_rcp_f32 v141, v141
    v_rcp_f32 v142, v142
    v_mfma_f32_32x32x16_bf16 v[112:127], a[164:167], a[60:63], v[112:127]
    ds_read_b64_tr_b16 a[148:149], v51 offset:34816
    ds_read_b64_tr_b16 a[150:151], v51 offset:35328
    v_rcp_f32 v143, v143
    v_mul_f32 v72, v72, v136
    v_mul_f32 v73, v73, v137
    s_waitcnt lgkmcnt(4)
    v_mfma_f32_32x32x16_bf16 v[96:111], a[168:171], a[64:67], v[96:111]
    s_waitcnt vmcnt(13)
    s_barrier
    ds_read_b64_tr_b16 a[152:153], v52 offset:0
    ds_read_b64_tr_b16 a[154:155], v52 offset:512
    v_mul_f32 v74, v74, v138
    v_mul_f32 v75, v75, v139
    v_mul_f32 v76, v76, v140
    v_mul_f32 v77, v77, v141
    v_mfma_f32_32x32x16_bf16 v[112:127], a[172:175], a[64:67], v[112:127]
    ds_read_b64_tr_b16 a[156:157], v53 offset:0
    ds_read_b64_tr_b16 a[158:159], v53 offset:512
    v_mul_f32 v78, v78, v142
    v_mul_f32 v79, v79, v143
    v_cvt_pk_bf16_f32 v148, v72, v73
    v_cvt_pk_bf16_f32 v149, v74, v75
    s_waitcnt lgkmcnt(4)
    v_mfma_f32_32x32x16_bf16 v[96:111], a[144:147], a[68:71], v[96:111]
    ds_read_b64_tr_b16 a[160:161], v52 offset:2048
    ds_read_b64_tr_b16 a[162:163], v52 offset:2560
    v_cvt_pk_bf16_f32 v150, v76, v77
    v_cvt_pk_bf16_f32 v151, v78, v79
    s_add_u32 s32, s35, 4096
    buffer_store_dwordx4 v[148:151], v19, s[16:19], s32 offen offset:512 sc1
    v_mfma_f32_32x32x16_bf16 v[112:127], a[148:151], a[68:71], v[112:127]
    ds_read_b64_tr_b16 a[164:165], v53 offset:2048
    ds_read_b64_tr_b16 a[166:167], v53 offset:2560
    v_mul_f32 v128, v80, v80
    v_mul_f32 v129, v81, v81
    v_mul_f32 v130, v82, v82
    v_mul_f32 v131, v83, v83
    s_waitcnt lgkmcnt(4)
    v_mfma_f32_32x32x16_bf16 v[96:111], a[152:155], a[72:75], v[96:111]
    ds_read_b64_tr_b16 a[168:169], v52 offset:4096
    ds_read_b64_tr_b16 a[170:171], v52 offset:4608
    v_mul_f32 v132, v84, v84
    v_mul_f32 v133, v85, v85
    v_mul_f32 v134, v86, v86
    v_mul_f32 v135, v87, v87
    v_mfma_f32_32x32x16_bf16 v[112:127], a[156:159], a[72:75], v[112:127]
    ds_read_b64_tr_b16 a[172:173], v53 offset:4096
    ds_read_b64_tr_b16 a[174:175], v53 offset:4608
    v_fma_f32 v128, v128, v61, v60
    v_fma_f32 v129, v129, v61, v60
    v_fma_f32 v130, v130, v61, v60
    v_fma_f32 v131, v131, v61, v60
    s_waitcnt lgkmcnt(4)
    v_mfma_f32_32x32x16_bf16 v[96:111], a[160:163], a[76:79], v[96:111]
    ds_read_b64_tr_b16 a[144:145], v52 offset:6144
    ds_read_b64_tr_b16 a[146:147], v52 offset:6656
    v_fma_f32 v132, v132, v61, v60
    v_fma_f32 v133, v133, v61, v60
    v_fma_f32 v134, v134, v61, v60
    v_fma_f32 v135, v135, v61, v60
    v_mfma_f32_32x32x16_bf16 v[112:127], a[164:167], a[76:79], v[112:127]
    ds_read_b64_tr_b16 a[148:149], v53 offset:6144
    ds_read_b64_tr_b16 a[150:151], v53 offset:6656
    v_mul_f32 v128, v128, v80
    v_mul_f32 v129, v129, v81
    v_mul_f32 v130, v130, v82
    v_mul_f32 v131, v131, v83
    s_waitcnt lgkmcnt(4)
    v_mfma_f32_32x32x16_bf16 v[96:111], a[168:171], a[80:83], v[96:111]
    ds_read_b64_tr_b16 a[152:153], v52 offset:8192
    ds_read_b64_tr_b16 a[154:155], v52 offset:8704
    v_mul_f32 v132, v132, v84
    v_mul_f32 v133, v133, v85
    v_mul_f32 v134, v134, v86
    v_mul_f32 v135, v135, v87
    v_mfma_f32_32x32x16_bf16 v[112:127], a[172:175], a[80:83], v[112:127]
    ds_read_b64_tr_b16 a[156:157], v53 offset:8192
    ds_read_b64_tr_b16 a[158:159], v53 offset:8704
    v_exp_f32 v128, v128
    v_exp_f32 v129, v129
    s_waitcnt lgkmcnt(4)
    v_mfma_f32_32x32x16_bf16 v[96:111], a[144:147], a[84:87], v[96:111]
    ds_read_b64_tr_b16 a[160:161], v52 offset:10240
    ds_read_b64_tr_b16 a[162:163], v52 offset:10752
    v_exp_f32 v130, v130
    v_exp_f32 v131, v131
    v_mfma_f32_32x32x16_bf16 v[112:127], a[148:151], a[84:87], v[112:127]
    ds_read_b64_tr_b16 a[164:165], v53 offset:10240
    ds_read_b64_tr_b16 a[166:167], v53 offset:10752
    v_exp_f32 v132, v132
    v_exp_f32 v133, v133
    s_waitcnt lgkmcnt(4)
    v_mfma_f32_32x32x16_bf16 v[96:111], a[152:155], a[88:91], v[96:111]
    ds_read_b64_tr_b16 a[168:169], v52 offset:12288
    ds_read_b64_tr_b16 a[170:171], v52 offset:12800
    v_exp_f32 v134, v134
    v_exp_f32 v135, v135
    v_mfma_f32_32x32x16_bf16 v[112:127], a[156:159], a[88:91], v[112:127]
    ds_read_b64_tr_b16 a[172:173], v53 offset:12288
    ds_read_b64_tr_b16 a[174:175], v53 offset:12800
    v_add_f32 v128, 1.0, v128
    v_add_f32 v129, 1.0, v129
    v_add_f32 v130, 1.0, v130
    v_add_f32 v131, 1.0, v131
    s_waitcnt lgkmcnt(4)
    v_mfma_f32_32x32x16_bf16 v[96:111], a[160:163], a[92:95], v[96:111]
    ds_read_b64_tr_b16 a[144:145], v52 offset:14336
    ds_read_b64_tr_b16 a[146:147], v52 offset:14848
    v_add_f32 v132, 1.0, v132
    v_add_f32 v133, 1.0, v133
    v_add_f32 v134, 1.0, v134
    v_add_f32 v135, 1.0, v135
    v_mfma_f32_32x32x16_bf16 v[112:127], a[164:167], a[92:95], v[112:127]
    ds_read_b64_tr_b16 a[148:149], v53 offset:14336
    ds_read_b64_tr_b16 a[150:151], v53 offset:14848
    v_rcp_f32 v128, v128
    v_rcp_f32 v129, v129
    s_waitcnt lgkmcnt(4)
    v_mfma_f32_32x32x16_bf16 v[96:111], a[168:171], a[96:99], v[96:111]
    ds_read_b64_tr_b16 a[152:153], v52 offset:16384
    ds_read_b64_tr_b16 a[154:155], v52 offset:16896
    v_rcp_f32 v130, v130
    v_rcp_f32 v131, v131
    v_mfma_f32_32x32x16_bf16 v[112:127], a[172:175], a[96:99], v[112:127]
    ds_read_b64_tr_b16 a[156:157], v53 offset:16384
    ds_read_b64_tr_b16 a[158:159], v53 offset:16896
    v_rcp_f32 v132, v132
    v_rcp_f32 v133, v133
    s_waitcnt lgkmcnt(4)
    v_mfma_f32_32x32x16_bf16 v[96:111], a[144:147], a[100:103], v[96:111]
    ds_read_b64_tr_b16 a[160:161], v52 offset:18432
    ds_read_b64_tr_b16 a[162:163], v52 offset:18944
    v_rcp_f32 v134, v134
    v_rcp_f32 v135, v135
    v_mfma_f32_32x32x16_bf16 v[112:127], a[148:151], a[100:103], v[112:127]
    ds_read_b64_tr_b16 a[164:165], v53 offset:18432
    ds_read_b64_tr_b16 a[166:167], v53 offset:18944
    v_mul_f32 v80, v80, v128
    v_mul_f32 v81, v81, v129
    v_mul_f32 v82, v82, v130
    v_mul_f32 v83, v83, v131
    s_waitcnt lgkmcnt(4)
    v_mfma_f32_32x32x16_bf16 v[96:111], a[152:155], a[104:107], v[96:111]
    ds_read_b64_tr_b16 a[168:169], v52 offset:20480
    ds_read_b64_tr_b16 a[170:171], v52 offset:20992
    v_mul_f32 v84, v84, v132
    v_mul_f32 v85, v85, v133
    v_mul_f32 v86, v86, v134
    v_mul_f32 v87, v87, v135
    v_mfma_f32_32x32x16_bf16 v[112:127], a[156:159], a[104:107], v[112:127]
    ds_read_b64_tr_b16 a[172:173], v53 offset:20480
    ds_read_b64_tr_b16 a[174:175], v53 offset:20992
    v_cvt_pk_bf16_f32 v152, v80, v81
    v_cvt_pk_bf16_f32 v153, v82, v83
    v_cvt_pk_bf16_f32 v154, v84, v85
    v_cvt_pk_bf16_f32 v155, v86, v87
    s_waitcnt lgkmcnt(4)
    v_mfma_f32_32x32x16_bf16 v[96:111], a[160:163], a[108:111], v[96:111]
    ds_read_b64_tr_b16 a[144:145], v52 offset:22528
    ds_read_b64_tr_b16 a[146:147], v52 offset:23040
    s_add_u32 s32, s35, 5120
    buffer_store_dwordx4 v[152:155], v19, s[16:19], s32 offen offset:0 sc1
    v_mul_f32 v136, v88, v88
    v_mul_f32 v137, v89, v89
    v_mfma_f32_32x32x16_bf16 v[112:127], a[164:167], a[108:111], v[112:127]
    ds_read_b64_tr_b16 a[148:149], v53 offset:22528
    ds_read_b64_tr_b16 a[150:151], v53 offset:23040
    v_mul_f32 v138, v90, v90
    v_mul_f32 v139, v91, v91
    v_mul_f32 v140, v92, v92
    v_mul_f32 v141, v93, v93
    s_waitcnt lgkmcnt(4)
    v_mfma_f32_32x32x16_bf16 v[96:111], a[168:171], a[112:115], v[96:111]
    ds_read_b64_tr_b16 a[152:153], v52 offset:24576
    ds_read_b64_tr_b16 a[154:155], v52 offset:25088
    v_mul_f32 v142, v94, v94
    v_mul_f32 v143, v95, v95
    v_fma_f32 v136, v136, v61, v60
    v_fma_f32 v137, v137, v61, v60
    v_mfma_f32_32x32x16_bf16 v[112:127], a[172:175], a[112:115], v[112:127]
    ds_read_b64_tr_b16 a[156:157], v53 offset:24576
    ds_read_b64_tr_b16 a[158:159], v53 offset:25088
    v_fma_f32 v138, v138, v61, v60
    v_fma_f32 v139, v139, v61, v60
    v_fma_f32 v140, v140, v61, v60
    v_fma_f32 v141, v141, v61, v60
    s_waitcnt lgkmcnt(4)
    v_mfma_f32_32x32x16_bf16 v[96:111], a[144:147], a[116:119], v[96:111]
    ds_read_b64_tr_b16 a[160:161], v52 offset:26624
    ds_read_b64_tr_b16 a[162:163], v52 offset:27136
    v_fma_f32 v142, v142, v61, v60
    v_fma_f32 v143, v143, v61, v60
    v_mul_f32 v136, v136, v88
    v_mul_f32 v137, v137, v89
    v_mfma_f32_32x32x16_bf16 v[112:127], a[148:151], a[116:119], v[112:127]
    ds_read_b64_tr_b16 a[164:165], v53 offset:26624
    ds_read_b64_tr_b16 a[166:167], v53 offset:27136
    v_mul_f32 v138, v138, v90
    v_mul_f32 v139, v139, v91
    v_mul_f32 v140, v140, v92
    v_mul_f32 v141, v141, v93
    s_waitcnt lgkmcnt(4)
    v_mfma_f32_32x32x16_bf16 v[96:111], a[152:155], a[120:123], v[96:111]
    ds_read_b64_tr_b16 a[168:169], v52 offset:28672
    ds_read_b64_tr_b16 a[170:171], v52 offset:29184
    v_mul_f32 v142, v142, v94
    v_mul_f32 v143, v143, v95
    v_exp_f32 v136, v136
    v_mfma_f32_32x32x16_bf16 v[112:127], a[156:159], a[120:123], v[112:127]
    ds_read_b64_tr_b16 a[172:173], v53 offset:28672
    ds_read_b64_tr_b16 a[174:175], v53 offset:29184
    v_exp_f32 v137, v137
    v_exp_f32 v138, v138
    s_waitcnt lgkmcnt(4)
    v_mfma_f32_32x32x16_bf16 v[96:111], a[160:163], a[124:127], v[96:111]
    ds_read_b64_tr_b16 a[144:145], v52 offset:30720
    ds_read_b64_tr_b16 a[146:147], v52 offset:31232
    v_exp_f32 v139, v139
    v_exp_f32 v140, v140
    v_mfma_f32_32x32x16_bf16 v[112:127], a[164:167], a[124:127], v[112:127]
    ds_read_b64_tr_b16 a[148:149], v53 offset:30720
    ds_read_b64_tr_b16 a[150:151], v53 offset:31232
    v_exp_f32 v141, v141
    v_exp_f32 v142, v142
    s_waitcnt lgkmcnt(4)
    v_mfma_f32_32x32x16_bf16 v[96:111], a[168:171], a[128:131], v[96:111]
    ds_read_b64_tr_b16 a[152:153], v52 offset:32768
    ds_read_b64_tr_b16 a[154:155], v52 offset:33280
    v_exp_f32 v143, v143
    v_add_f32 v136, 1.0, v136
    v_add_f32 v137, 1.0, v137
    v_mfma_f32_32x32x16_bf16 v[112:127], a[172:175], a[128:131], v[112:127]
    ds_read_b64_tr_b16 a[156:157], v53 offset:32768
    ds_read_b64_tr_b16 a[158:159], v53 offset:33280
    v_add_f32 v138, 1.0, v138
    v_add_f32 v139, 1.0, v139
    v_add_f32 v140, 1.0, v140
    v_add_f32 v141, 1.0, v141
    s_waitcnt lgkmcnt(4)
    v_mfma_f32_32x32x16_bf16 v[96:111], a[144:147], a[132:135], v[96:111]
    ds_read_b64_tr_b16 a[160:161], v52 offset:34816
    ds_read_b64_tr_b16 a[162:163], v52 offset:35328
    v_add_f32 v142, 1.0, v142
    v_add_f32 v143, 1.0, v143
    v_rcp_f32 v136, v136
    v_mfma_f32_32x32x16_bf16 v[112:127], a[148:151], a[132:135], v[112:127]
    ds_read_b64_tr_b16 a[164:165], v53 offset:34816
    ds_read_b64_tr_b16 a[166:167], v53 offset:35328
    v_rcp_f32 v137, v137
    v_rcp_f32 v138, v138
    s_waitcnt lgkmcnt(4)
    v_mfma_f32_32x32x16_bf16 v[96:111], a[152:155], a[136:139], v[96:111]
    ds_read_b64_tr_b16 a[168:169], v52 offset:36864
    ds_read_b64_tr_b16 a[170:171], v52 offset:37376
    v_rcp_f32 v139, v139
    v_rcp_f32 v140, v140
    v_mfma_f32_32x32x16_bf16 v[112:127], a[156:159], a[136:139], v[112:127]
    ds_read_b64_tr_b16 a[172:173], v53 offset:36864
    ds_read_b64_tr_b16 a[174:175], v53 offset:37376
    v_rcp_f32 v141, v141
    v_rcp_f32 v142, v142
    s_waitcnt lgkmcnt(4)
    v_mfma_f32_32x32x16_bf16 v[96:111], a[160:163], a[140:143], v[96:111]
    s_waitcnt vmcnt(3)
    s_barrier
    ds_read_b64_tr_b16 a[144:145], v54 offset:0
    ds_read_b64_tr_b16 a[146:147], v54 offset:256
    s_bfe_u32 s39, s2, 0x20001
    s_lshl_b32 s39, s39, 3
    s_bfe_u32 s3, s2, 0x30003
    s_add_u32 s39, s39, s3
    s_and_b32 s40, s2, 1
    s_lshl_b32 s40, s40, 2
    s_lshr_b32 s3, s2, 6
    s_add_u32 s40, s40, s3
    v_lshrrev_b32 v1, 6, v0
    v_and_b32 v2, 63, v0
    v_and_b32 v3, 15, v2
    v_lshrrev_b32 v4, 4, v2
    v_lshl_add_u32 v5, v1, 4, v4
    v_lshlrev_b32 v6, 1, v4
    v_xor_b32 v6, v6, v3
    v_xor_b32 v7, 8, v6
    v_lshlrev_b32 v46, 8, v5
    v_lshl_add_u32 v24, v6, 4, v46
    v_lshl_add_u32 v25, v7, 4, v46
    v_add_u32 v7, 0, v4
    v_xor_b32 v7, v7, v3
    v_lshl_add_u32 v20, v7, 4, v46
    v_add_u32 v7, 4, v4
    v_xor_b32 v7, v7, v3
    v_lshl_add_u32 v21, v7, 4, v46
    v_add_u32 v7, 8, v4
    v_xor_b32 v7, v7, v3
    v_lshl_add_u32 v22, v7, 4, v46
    v_add_u32 v7, 12, v4
    v_xor_b32 v7, v7, v3
    v_lshl_add_u32 v23, v7, 4, v46
    s_lshl_b32 s31, s4, 12
    s_lshl_b32 s30, s39, 19
    s_add_u32 s8, s66, s30
    s_addc_u32 s9, s67, 0
    s_mov_b32 s10, 0x80000
    s_mov_b32 s11, 0x20000
    s_add_u32 s12, s68, s30
    s_addc_u32 s13, s69, 0
    s_mov_b32 s14, 0x80000
    s_mov_b32 s15, 0x20000
    s_add_u32 m0, s31, 65536
    s_mov_b32 s29, 0
    buffer_load_dwordx4 v20, s[8:11], s29 offen offset:0 lds
    v_rcp_f32 v143, v143
    v_mul_f32 v88, v88, v136
    v_mul_f32 v89, v89, v137
    v_mfma_f32_32x32x16_bf16 v[112:127], a[164:167], a[140:143], v[112:127]
    ds_read_b64_tr_b16 a[148:149], v54 offset:1024
    ds_read_b64_tr_b16 a[150:151], v54 offset:1280
    buffer_load_dwordx4 v21, s[8:11], s29 offen offset:1024 lds
    v_mul_f32 v90, v90, v138
    v_mul_f32 v91, v91, v139
    v_mul_f32 v92, v92, v140
    v_mul_f32 v93, v93, v141
    s_waitcnt lgkmcnt(4)
    v_mfma_f32_32x32x16_bf16 v[96:111], a[168:171], v[56:59], v[96:111]
    ds_read_b64_tr_b16 a[152:153], v54 offset:2048
    ds_read_b64_tr_b16 a[154:155], v54 offset:2304
    buffer_load_dwordx4 v22, s[8:11], s29 offen offset:2048 lds
    v_mul_f32 v94, v94, v142
    v_mul_f32 v95, v95, v143
    v_cvt_pk_bf16_f32 v156, v88, v89
    v_cvt_pk_bf16_f32 v157, v90, v91
    v_mfma_f32_32x32x16_bf16 v[112:127], a[172:175], v[56:59], v[112:127]
    ds_read_b64_tr_b16 a[156:157], v54 offset:3072
    ds_read_b64_tr_b16 a[158:159], v54 offset:3328
    buffer_load_dwordx4 v23, s[8:11], s29 offen offset:3072 lds
    v_cvt_pk_bf16_f32 v158, v92, v93
    v_cvt_pk_bf16_f32 v159, v94, v95
    s_add_u32 s32, s35, 5120
    buffer_store_dwordx4 v[156:159], v19, s[16:19], s32 offen offset:512 sc1
    s_waitcnt lgkmcnt(4)
    v_mfma_f32_32x32x16_bf16 v[64:79], a[144:147], a[0:3], 0
    ds_read_b64_tr_b16 a[160:161], v54 offset:4096
    ds_read_b64_tr_b16 a[162:163], v54 offset:4352
    s_add_u32 m0, s31, 81920
    v_subrev_u32 v46, 8192, v24
    v_subrev_u32 v47, 8192, v25
    buffer_load_dwordx4 v46, s[12:15], 0 offen offset:0 lds
    v_mfma_f32_32x32x16_bf16 v[64:79], a[148:151], a[4:7], v[64:79]
    ds_read_b64_tr_b16 a[164:165], v54 offset:5120
    ds_read_b64_tr_b16 a[166:167], v54 offset:5376
    buffer_load_dwordx4 v47, s[12:15], 0 offen offset:1024 lds
    s_waitcnt lgkmcnt(4)
    v_mfma_f32_32x32x16_bf16 v[64:79], a[152:155], a[8:11], v[64:79]
    ds_read_b64_tr_b16 a[168:169], v54 offset:6144
    ds_read_b64_tr_b16 a[170:171], v54 offset:6400
    buffer_load_dwordx4 v46, s[12:15], 0 offen offset:2048 lds
    v_mul_f32 v128, v96, v96
    v_mul_f32 v129, v97, v97
    v_mul_f32 v130, v98, v98
    v_mul_f32 v131, v99, v99
    v_mul_f32 v132, v100, v100
    v_mul_f32 v133, v101, v101
    v_mul_f32 v134, v102, v102
    v_mul_f32 v135, v103, v103
    v_fma_f32 v128, v128, v61, v60
    v_mfma_f32_32x32x16_bf16 v[64:79], a[156:159], a[12:15], v[64:79]
    ds_read_b64_tr_b16 a[172:173], v54 offset:7168
    ds_read_b64_tr_b16 a[174:175], v54 offset:7424
    buffer_load_dwordx4 v47, s[12:15], 0 offen offset:3072 lds
    v_fma_f32 v129, v129, v61, v60
    v_fma_f32 v130, v130, v61, v60
    v_fma_f32 v131, v131, v61, v60
    v_fma_f32 v132, v132, v61, v60
    v_fma_f32 v133, v133, v61, v60
    v_fma_f32 v134, v134, v61, v60
    v_fma_f32 v135, v135, v61, v60
    v_mul_f32 v128, v128, v96
    v_mul_f32 v129, v129, v97
    s_waitcnt lgkmcnt(4)
    v_mfma_f32_32x32x16_bf16 v[64:79], a[160:163], a[16:19], v[64:79]
    ds_read_b64_tr_b16 a[144:145], v54 offset:8192
    ds_read_b64_tr_b16 a[146:147], v54 offset:8448
    v_mul_f32 v130, v130, v98
    v_mul_f32 v131, v131, v99
    v_mul_f32 v132, v132, v100
    v_mul_f32 v133, v133, v101
    v_mul_f32 v134, v134, v102
    v_mul_f32 v135, v135, v103
    v_exp_f32 v128, v128
    v_exp_f32 v129, v129
    v_mfma_f32_32x32x16_bf16 v[64:79], a[164:167], a[20:23], v[64:79]
    ds_read_b64_tr_b16 a[148:149], v54 offset:9216
    ds_read_b64_tr_b16 a[150:151], v54 offset:9472
    v_exp_f32 v130, v130
    v_exp_f32 v131, v131
    v_exp_f32 v132, v132
    v_exp_f32 v133, v133
    v_exp_f32 v134, v134
    s_waitcnt lgkmcnt(4)
    v_mfma_f32_32x32x16_bf16 v[64:79], a[168:171], a[24:27], v[64:79]
    ds_read_b64_tr_b16 a[152:153], v54 offset:10240
    ds_read_b64_tr_b16 a[154:155], v54 offset:10496
    v_exp_f32 v135, v135
    v_add_f32 v128, 1.0, v128
    v_add_f32 v129, 1.0, v129
    v_add_f32 v130, 1.0, v130
    v_add_f32 v131, 1.0, v131
    v_add_f32 v132, 1.0, v132
    v_add_f32 v133, 1.0, v133
    v_add_f32 v134, 1.0, v134
    v_mfma_f32_32x32x16_bf16 v[64:79], a[172:175], a[28:31], v[64:79]
    ds_read_b64_tr_b16 a[156:157], v54 offset:11264
    ds_read_b64_tr_b16 a[158:159], v54 offset:11520
    v_add_f32 v135, 1.0, v135
    v_rcp_f32 v128, v128
    v_rcp_f32 v129, v129
    v_rcp_f32 v130, v130
    v_rcp_f32 v131, v131
    s_waitcnt lgkmcnt(4)
    v_mfma_f32_32x32x16_bf16 v[64:79], a[144:147], a[32:35], v[64:79]
    ds_read_b64_tr_b16 a[160:161], v54 offset:12288
    ds_read_b64_tr_b16 a[162:163], v54 offset:12544
    v_rcp_f32 v132, v132
    v_rcp_f32 v133, v133
    v_rcp_f32 v134, v134
    v_rcp_f32 v135, v135
    v_mul_f32 v96, v96, v128
    v_mfma_f32_32x32x16_bf16 v[64:79], a[148:151], a[36:39], v[64:79]
    ds_read_b64_tr_b16 a[164:165], v54 offset:13312
    ds_read_b64_tr_b16 a[166:167], v54 offset:13568
    v_mul_f32 v97, v97, v129
    v_mul_f32 v98, v98, v130
    v_mul_f32 v99, v99, v131
    v_mul_f32 v100, v100, v132
    v_mul_f32 v101, v101, v133
    v_mul_f32 v102, v102, v134
    v_mul_f32 v103, v103, v135
    v_cvt_pk_bf16_f32 v160, v96, v97
    v_cvt_pk_bf16_f32 v161, v98, v99
    s_waitcnt lgkmcnt(4)
    v_mfma_f32_32x32x16_bf16 v[64:79], a[152:155], a[40:43], v[64:79]
    ds_read_b64_tr_b16 a[168:169], v54 offset:14336
    ds_read_b64_tr_b16 a[170:171], v54 offset:14592
    v_cvt_pk_bf16_f32 v162, v100, v101
    v_cvt_pk_bf16_f32 v163, v102, v103
    s_add_u32 s32, s35, 6144
    buffer_store_dwordx4 v[160:163], v19, s[16:19], s32 offen offset:0 sc1
    v_mul_f32 v136, v104, v104
    v_mul_f32 v137, v105, v105
    v_mul_f32 v138, v106, v106
    v_mul_f32 v139, v107, v107
    v_mul_f32 v140, v108, v108
    v_mfma_f32_32x32x16_bf16 v[64:79], a[156:159], a[44:47], v[64:79]
    ds_read_b64_tr_b16 a[172:173], v54 offset:15360
    ds_read_b64_tr_b16 a[174:175], v54 offset:15616
    v_mul_f32 v141, v109, v109
    v_mul_f32 v142, v110, v110
    v_mul_f32 v143, v111, v111
    v_fma_f32 v136, v136, v61, v60
    v_fma_f32 v137, v137, v61, v60
    v_fma_f32 v138, v138, v61, v60
    v_fma_f32 v139, v139, v61, v60
    v_fma_f32 v140, v140, v61, v60
    v_fma_f32 v141, v141, v61, v60
    s_waitcnt lgkmcnt(4)
    v_mfma_f32_32x32x16_bf16 v[64:79], a[160:163], a[48:51], v[64:79]
    ds_read_b64_tr_b16 a[144:145], v54 offset:16384
    ds_read_b64_tr_b16 a[146:147], v54 offset:16640
    v_fma_f32 v142, v142, v61, v60
    v_fma_f32 v143, v143, v61, v60
    v_mul_f32 v136, v136, v104
    v_mul_f32 v137, v137, v105
    v_mul_f32 v138, v138, v106
    v_mul_f32 v139, v139, v107
    v_mul_f32 v140, v140, v108
    v_mul_f32 v141, v141, v109
    v_mul_f32 v142, v142, v110
    v_mfma_f32_32x32x16_bf16 v[64:79], a[164:167], a[52:55], v[64:79]
    ds_read_b64_tr_b16 a[148:149], v54 offset:17408
    ds_read_b64_tr_b16 a[150:151], v54 offset:17664
    v_mul_f32 v143, v143, v111
    v_exp_f32 v136, v136
    v_exp_f32 v137, v137
    v_exp_f32 v138, v138
    v_exp_f32 v139, v139
    s_waitcnt lgkmcnt(4)
    v_mfma_f32_32x32x16_bf16 v[64:79], a[168:171], a[56:59], v[64:79]
    ds_read_b64_tr_b16 a[152:153], v54 offset:18432
    ds_read_b64_tr_b16 a[154:155], v54 offset:18688
    v_exp_f32 v140, v140
    v_exp_f32 v141, v141
    v_exp_f32 v142, v142
    v_exp_f32 v143, v143
    v_add_f32 v136, 1.0, v136
    v_mfma_f32_32x32x16_bf16 v[64:79], a[172:175], a[60:63], v[64:79]
    ds_read_b64_tr_b16 a[156:157], v54 offset:19456
    ds_read_b64_tr_b16 a[158:159], v54 offset:19712
    v_add_f32 v137, 1.0, v137
    v_add_f32 v138, 1.0, v138
    v_add_f32 v139, 1.0, v139
    v_add_f32 v140, 1.0, v140
    v_add_f32 v141, 1.0, v141
    v_add_f32 v142, 1.0, v142
    v_add_f32 v143, 1.0, v143
    v_rcp_f32 v136, v136
    s_waitcnt lgkmcnt(4)
    v_mfma_f32_32x32x16_bf16 v[64:79], a[144:147], a[64:67], v[64:79]
    ds_read_b64_tr_b16 a[160:161], v54 offset:20480
    ds_read_b64_tr_b16 a[162:163], v54 offset:20736
    v_rcp_f32 v137, v137
    v_rcp_f32 v138, v138
    v_rcp_f32 v139, v139
    v_rcp_f32 v140, v140
    v_rcp_f32 v141, v141
    v_mfma_f32_32x32x16_bf16 v[64:79], a[148:151], a[68:71], v[64:79]
    ds_read_b64_tr_b16 a[164:165], v54 offset:21504
    ds_read_b64_tr_b16 a[166:167], v54 offset:21760
    v_rcp_f32 v142, v142
    v_rcp_f32 v143, v143
    v_mul_f32 v104, v104, v136
    v_mul_f32 v105, v105, v137
    v_mul_f32 v106, v106, v138
    v_mul_f32 v107, v107, v139
    v_mul_f32 v108, v108, v140
    s_waitcnt lgkmcnt(4)
    v_mfma_f32_32x32x16_bf16 v[64:79], a[152:155], a[72:75], v[64:79]
    ds_read_b64_tr_b16 a[168:169], v54 offset:22528
    ds_read_b64_tr_b16 a[170:171], v54 offset:22784
    v_mul_f32 v109, v109, v141
    v_mul_f32 v110, v110, v142
    v_mul_f32 v111, v111, v143
    v_cvt_pk_bf16_f32 v164, v104, v105
    v_cvt_pk_bf16_f32 v165, v106, v107
    v_cvt_pk_bf16_f32 v166, v108, v109
    v_cvt_pk_bf16_f32 v167, v110, v111
    s_add_u32 s32, s35, 6144
    buffer_store_dwordx4 v[164:167], v19, s[16:19], s32 offen offset:512 sc1
    v_mfma_f32_32x32x16_bf16 v[64:79], a[156:159], a[76:79], v[64:79]
    ds_read_b64_tr_b16 a[172:173], v54 offset:23552
    ds_read_b64_tr_b16 a[174:175], v54 offset:23808
    v_mul_f32 v128, v112, v112
    v_mul_f32 v129, v113, v113
    v_mul_f32 v130, v114, v114
    v_mul_f32 v131, v115, v115
    v_mul_f32 v132, v116, v116
    v_mul_f32 v133, v117, v117
    v_mul_f32 v134, v118, v118
    v_mul_f32 v135, v119, v119
    v_fma_f32 v128, v128, v61, v60
    s_waitcnt lgkmcnt(4)
    v_mfma_f32_32x32x16_bf16 v[64:79], a[160:163], a[80:83], v[64:79]
    ds_read_b64_tr_b16 a[144:145], v54 offset:24576
    ds_read_b64_tr_b16 a[146:147], v54 offset:24832
    v_fma_f32 v129, v129, v61, v60
    v_fma_f32 v130, v130, v61, v60
    v_fma_f32 v131, v131, v61, v60
    v_fma_f32 v132, v132, v61, v60
    v_fma_f32 v133, v133, v61, v60
    v_fma_f32 v134, v134, v61, v60
    v_fma_f32 v135, v135, v61, v60
    v_mul_f32 v128, v128, v112
    v_mul_f32 v129, v129, v113
    v_mfma_f32_32x32x16_bf16 v[64:79], a[164:167], a[84:87], v[64:79]
    ds_read_b64_tr_b16 a[148:149], v54 offset:25600
    ds_read_b64_tr_b16 a[150:151], v54 offset:25856
    v_mul_f32 v130, v130, v114
    v_mul_f32 v131, v131, v115
    v_mul_f32 v132, v132, v116
    v_mul_f32 v133, v133, v117
    v_mul_f32 v134, v134, v118
    v_mul_f32 v135, v135, v119
    v_exp_f32 v128, v128
    v_exp_f32 v129, v129
    s_waitcnt lgkmcnt(4)
    v_mfma_f32_32x32x16_bf16 v[64:79], a[168:171], a[88:91], v[64:79]
    ds_read_b64_tr_b16 a[152:153], v54 offset:26624
    ds_read_b64_tr_b16 a[154:155], v54 offset:26880
    v_exp_f32 v130, v130
    v_exp_f32 v131, v131
    v_exp_f32 v132, v132
    v_exp_f32 v133, v133
    v_exp_f32 v134, v134
    v_mfma_f32_32x32x16_bf16 v[64:79], a[172:175], a[92:95], v[64:79]
    ds_read_b64_tr_b16 a[156:157], v54 offset:27648
    ds_read_b64_tr_b16 a[158:159], v54 offset:27904
    v_exp_f32 v135, v135
    v_add_f32 v128, 1.0, v128
    v_add_f32 v129, 1.0, v129
    v_add_f32 v130, 1.0, v130
    v_add_f32 v131, 1.0, v131
    v_add_f32 v132, 1.0, v132
    v_add_f32 v133, 1.0, v133
    v_add_f32 v134, 1.0, v134
    s_waitcnt lgkmcnt(4)
    v_mfma_f32_32x32x16_bf16 v[64:79], a[144:147], a[96:99], v[64:79]
    ds_read_b64_tr_b16 a[160:161], v54 offset:28672
    ds_read_b64_tr_b16 a[162:163], v54 offset:28928
    v_add_f32 v135, 1.0, v135
    v_rcp_f32 v128, v128
    v_rcp_f32 v129, v129
    v_rcp_f32 v130, v130
    v_rcp_f32 v131, v131
    v_mfma_f32_32x32x16_bf16 v[64:79], a[148:151], a[100:103], v[64:79]
    ds_read_b64_tr_b16 a[164:165], v54 offset:29696
    ds_read_b64_tr_b16 a[166:167], v54 offset:29952
    v_rcp_f32 v132, v132
    v_rcp_f32 v133, v133
    v_rcp_f32 v134, v134
    v_rcp_f32 v135, v135
    v_mul_f32 v112, v112, v128
    s_waitcnt lgkmcnt(4)
    v_mfma_f32_32x32x16_bf16 v[64:79], a[152:155], a[104:107], v[64:79]
    ds_read_b64_tr_b16 a[168:169], v54 offset:30720
    ds_read_b64_tr_b16 a[170:171], v54 offset:30976
    v_mul_f32 v113, v113, v129
    v_mul_f32 v114, v114, v130
    v_mul_f32 v115, v115, v131
    v_mul_f32 v116, v116, v132
    v_mul_f32 v117, v117, v133
    v_mul_f32 v118, v118, v134
    v_mul_f32 v119, v119, v135
    v_cvt_pk_bf16_f32 v168, v112, v113
    v_cvt_pk_bf16_f32 v169, v114, v115
    v_mfma_f32_32x32x16_bf16 v[64:79], a[156:159], a[108:111], v[64:79]
    ds_read_b64_tr_b16 a[172:173], v54 offset:31744
    ds_read_b64_tr_b16 a[174:175], v54 offset:32000
    v_cvt_pk_bf16_f32 v170, v116, v117
    v_cvt_pk_bf16_f32 v171, v118, v119
    s_add_u32 s32, s35, 7168
    buffer_store_dwordx4 v[168:171], v19, s[16:19], s32 offen offset:0 sc1
    v_mul_f32 v136, v120, v120
    v_mul_f32 v137, v121, v121
    v_mul_f32 v138, v122, v122
    v_mul_f32 v139, v123, v123
    v_mul_f32 v140, v124, v124
    s_waitcnt lgkmcnt(4)
    v_mfma_f32_32x32x16_bf16 v[64:79], a[160:163], a[112:115], v[64:79]
    ds_read_b64_tr_b16 a[144:145], v54 offset:32768
    ds_read_b64_tr_b16 a[146:147], v54 offset:33024
    v_mul_f32 v141, v125, v125
    v_mul_f32 v142, v126, v126
    v_mul_f32 v143, v127, v127
    v_fma_f32 v136, v136, v61, v60
    v_fma_f32 v137, v137, v61, v60
    v_fma_f32 v138, v138, v61, v60
    v_fma_f32 v139, v139, v61, v60
    v_fma_f32 v140, v140, v61, v60
    v_fma_f32 v141, v141, v61, v60
    v_mfma_f32_32x32x16_bf16 v[64:79], a[164:167], a[116:119], v[64:79]
    ds_read_b64_tr_b16 a[148:149], v54 offset:33792
    ds_read_b64_tr_b16 a[150:151], v54 offset:34048
    v_fma_f32 v142, v142, v61, v60
    v_fma_f32 v143, v143, v61, v60
    v_mul_f32 v136, v136, v120
    v_mul_f32 v137, v137, v121
    v_mul_f32 v138, v138, v122
    v_mul_f32 v139, v139, v123
    v_mul_f32 v140, v140, v124
    v_mul_f32 v141, v141, v125
    s_waitcnt lgkmcnt(4)
    v_mfma_f32_32x32x16_bf16 v[64:79], a[168:171], a[120:123], v[64:79]
    ds_read_b64_tr_b16 a[152:153], v54 offset:34816
    ds_read_b64_tr_b16 a[154:155], v54 offset:35072
    v_mul_f32 v142, v142, v126
    v_mul_f32 v143, v143, v127
    v_exp_f32 v136, v136
    v_exp_f32 v137, v137
    v_exp_f32 v138, v138
    v_mfma_f32_32x32x16_bf16 v[64:79], a[172:175], a[124:127], v[64:79]
    ds_read_b64_tr_b16 a[156:157], v54 offset:35840
    ds_read_b64_tr_b16 a[158:159], v54 offset:36096
    v_exp_f32 v139, v139
    v_exp_f32 v140, v140
    v_exp_f32 v141, v141
    v_exp_f32 v142, v142
    s_waitcnt lgkmcnt(4)
    v_mfma_f32_32x32x16_bf16 v[64:79], a[144:147], a[128:131], v[64:79]
    ds_read_b64_tr_b16 a[160:161], v54 offset:36864
    ds_read_b64_tr_b16 a[162:163], v54 offset:37120
    v_exp_f32 v143, v143
    v_add_f32 v136, 1.0, v136
    v_add_f32 v137, 1.0, v137
    v_add_f32 v138, 1.0, v138
    v_add_f32 v139, 1.0, v139
    v_add_f32 v140, 1.0, v140
    v_add_f32 v141, 1.0, v141
    v_mfma_f32_32x32x16_bf16 v[64:79], a[148:151], a[132:135], v[64:79]
    v_add_f32 v142, 1.0, v142
    v_add_f32 v143, 1.0, v143
    v_rcp_f32 v136, v136
    v_rcp_f32 v137, v137
    v_rcp_f32 v138, v138
    s_waitcnt lgkmcnt(2)
    v_mfma_f32_32x32x16_bf16 v[64:79], a[152:155], a[136:139], v[64:79]
    v_rcp_f32 v139, v139
    v_rcp_f32 v140, v140
    v_rcp_f32 v141, v141
    v_rcp_f32 v142, v142
    v_mfma_f32_32x32x16_bf16 v[64:79], a[156:159], a[140:143], v[64:79]
    v_rcp_f32 v143, v143
    v_mul_f32 v120, v120, v136
    v_mul_f32 v121, v121, v137
    v_mul_f32 v122, v122, v138
    v_mul_f32 v123, v123, v139
    v_mul_f32 v124, v124, v140
    v_mul_f32 v125, v125, v141
    s_waitcnt lgkmcnt(0)
    v_mfma_f32_32x32x16_bf16 v[64:79], a[160:163], v[56:59], v[64:79]
    v_mul_f32 v126, v126, v142
    v_mul_f32 v127, v127, v143
    v_cvt_pk_bf16_f32 v172, v120, v121
    v_cvt_pk_bf16_f32 v173, v122, v123
    v_cvt_pk_bf16_f32 v174, v124, v125
    v_cvt_pk_bf16_f32 v175, v126, v127
    s_add_u32 s32, s35, 7168
    buffer_store_dwordx4 v[172:175], v19, s[16:19], s32 offen offset:512 sc1
    s_barrier
    s_add_u32 m0, s31, 98304
    s_mov_b32 s29, 16384
    buffer_load_dwordx4 v20, s[8:11], s29 offen offset:0 lds
    buffer_load_dwordx4 v21, s[8:11], s29 offen offset:1024 lds
    buffer_load_dwordx4 v22, s[8:11], s29 offen offset:2048 lds
    buffer_load_dwordx4 v23, s[8:11], s29 offen offset:3072 lds
    s_add_u32 m0, s31, 114688
    s_mov_b32 s30, 8192
    buffer_load_dwordx4 v24, s[12:15], s30 offen offset:0 lds
    buffer_load_dwordx4 v25, s[12:15], s30 offen offset:1024 lds
    buffer_load_dwordx4 v24, s[12:15], s30 offen offset:2048 lds
    buffer_load_dwordx4 v25, s[12:15], s30 offen offset:3072 lds
    s_add_u32 m0, s31, 0
    s_mov_b32 s29, 32768
    buffer_load_dwordx4 v20, s[8:11], s29 offen offset:0 lds
    buffer_load_dwordx4 v21, s[8:11], s29 offen offset:1024 lds
    buffer_load_dwordx4 v22, s[8:11], s29 offen offset:2048 lds
    buffer_load_dwordx4 v23, s[8:11], s29 offen offset:3072 lds
    s_add_u32 m0, s31, 16384
    s_mov_b32 s30, 24576
    buffer_load_dwordx4 v24, s[12:15], s30 offen offset:0 lds
    buffer_load_dwordx4 v25, s[12:15], s30 offen offset:1024 lds
    buffer_load_dwordx4 v24, s[12:15], s30 offen offset:2048 lds
    buffer_load_dwordx4 v25, s[12:15], s30 offen offset:3072 lds
    v_mul_f32 v128, v64, v64
    v_mul_f32 v129, v65, v65
    v_mul_f32 v130, v66, v66
    v_mul_f32 v131, v67, v67
    v_mul_f32 v132, v68, v68
    v_mul_f32 v133, v69, v69
    v_mul_f32 v134, v70, v70
    v_mul_f32 v135, v71, v71
    v_fma_f32 v128, v128, v61, v60
    v_fma_f32 v129, v129, v61, v60
    v_fma_f32 v130, v130, v61, v60
    v_fma_f32 v131, v131, v61, v60
    v_fma_f32 v132, v132, v61, v60
    v_fma_f32 v133, v133, v61, v60
    v_fma_f32 v134, v134, v61, v60
    v_fma_f32 v135, v135, v61, v60
    v_mul_f32 v128, v128, v64
    v_mul_f32 v129, v129, v65
    v_mul_f32 v130, v130, v66
    v_mul_f32 v131, v131, v67
    v_mul_f32 v132, v132, v68
    v_mul_f32 v133, v133, v69
    v_mul_f32 v134, v134, v70
    v_mul_f32 v135, v135, v71
    v_exp_f32 v128, v128
    v_exp_f32 v129, v129
    v_exp_f32 v130, v130
    v_exp_f32 v131, v131
    v_exp_f32 v132, v132
    v_exp_f32 v133, v133
    v_exp_f32 v134, v134
    v_exp_f32 v135, v135
    v_add_f32 v128, 1.0, v128
    v_add_f32 v129, 1.0, v129
    v_add_f32 v130, 1.0, v130
    v_add_f32 v131, 1.0, v131
    v_add_f32 v132, 1.0, v132
    v_add_f32 v133, 1.0, v133
    v_add_f32 v134, 1.0, v134
    v_add_f32 v135, 1.0, v135
    v_rcp_f32 v128, v128
    v_rcp_f32 v129, v129
    v_rcp_f32 v130, v130
    v_rcp_f32 v131, v131
    v_rcp_f32 v132, v132
    v_rcp_f32 v133, v133
    v_rcp_f32 v134, v134
    v_rcp_f32 v135, v135
    v_mul_f32 v64, v64, v128
    v_mul_f32 v65, v65, v129
    v_mul_f32 v66, v66, v130
    v_mul_f32 v67, v67, v131
    v_mul_f32 v68, v68, v132
    v_mul_f32 v69, v69, v133
    v_mul_f32 v70, v70, v134
    v_mul_f32 v71, v71, v135
    v_cvt_pk_bf16_f32 v144, v64, v65
    v_cvt_pk_bf16_f32 v145, v66, v67
    v_cvt_pk_bf16_f32 v146, v68, v69
    v_cvt_pk_bf16_f32 v147, v70, v71
    v_readfirstlane_b32 s32, v55
    s_nop 4
    buffer_store_dwordx4 v[144:147], v19, s[16:19], s32 offen offset:0 sc1
    v_mul_f32 v136, v72, v72
    v_mul_f32 v137, v73, v73
    v_mul_f32 v138, v74, v74
    v_mul_f32 v139, v75, v75
    v_mul_f32 v140, v76, v76
    v_mul_f32 v141, v77, v77
    v_mul_f32 v142, v78, v78
    v_mul_f32 v143, v79, v79
    v_fma_f32 v136, v136, v61, v60
    v_fma_f32 v137, v137, v61, v60
    v_fma_f32 v138, v138, v61, v60
    v_fma_f32 v139, v139, v61, v60
    v_fma_f32 v140, v140, v61, v60
    v_fma_f32 v141, v141, v61, v60
    v_fma_f32 v142, v142, v61, v60
    v_fma_f32 v143, v143, v61, v60
    v_mul_f32 v136, v136, v72
    v_mul_f32 v137, v137, v73
    v_mul_f32 v138, v138, v74
    v_mul_f32 v139, v139, v75
    v_mul_f32 v140, v140, v76
    v_mul_f32 v141, v141, v77
    v_mul_f32 v142, v142, v78
    v_mul_f32 v143, v143, v79
    v_exp_f32 v136, v136
    v_exp_f32 v137, v137
    v_exp_f32 v138, v138
    v_exp_f32 v139, v139
    v_exp_f32 v140, v140
    v_exp_f32 v141, v141
    v_exp_f32 v142, v142
    v_exp_f32 v143, v143
    v_add_f32 v136, 1.0, v136
    v_add_f32 v137, 1.0, v137
    v_add_f32 v138, 1.0, v138
    v_add_f32 v139, 1.0, v139
    v_add_f32 v140, 1.0, v140
    v_add_f32 v141, 1.0, v141
    v_add_f32 v142, 1.0, v142
    v_add_f32 v143, 1.0, v143
    v_rcp_f32 v136, v136
    v_rcp_f32 v137, v137
    v_rcp_f32 v138, v138
    v_rcp_f32 v139, v139
    v_rcp_f32 v140, v140
    v_rcp_f32 v141, v141
    v_rcp_f32 v142, v142
    v_rcp_f32 v143, v143
    v_mul_f32 v72, v72, v136
    v_mul_f32 v73, v73, v137
    v_mul_f32 v74, v74, v138
    v_mul_f32 v75, v75, v139
    v_mul_f32 v76, v76, v140
    v_mul_f32 v77, v77, v141
    v_mul_f32 v78, v78, v142
    v_mul_f32 v79, v79, v143
    v_cvt_pk_bf16_f32 v148, v72, v73
    v_cvt_pk_bf16_f32 v149, v74, v75
    v_cvt_pk_bf16_f32 v150, v76, v77
    v_cvt_pk_bf16_f32 v151, v78, v79
    v_readfirstlane_b32 s32, v55
    s_nop 4
    buffer_store_dwordx4 v[148:151], v19, s[16:19], s32 offen offset:512 sc1
    v_and_b32 v2, 63, v0
    v_and_b32 v3, 15, v2
    v_lshrrev_b32 v4, 4, v2
    s_add_u32 s24, s88, 0x3000000
    s_addc_u32 s25, s89, 0
    s_mov_b32 s26, 0x3200000
    s_mov_b32 s27, 0x20000
    s_and_b32 s35, s2, 3
    s_lshr_b32 s36, s2, 3
    s_lshl_b32 s35, s35, 5
    s_add_u32 s35, s35, s36
    s_bitcmp1_b32 s2, 2
    s_cselect_b32 s16, s82, s72
    s_cselect_b32 s17, s83, s73
    s_cselect_b32 s36, 36, 32
    s_mul_i32 s18, s36, 1152
    s_mul_i32 s35, s35, s18
    s_add_u32 s16, s16, s35
    s_addc_u32 s17, s17, 0
    s_mov_b32 s19, 0x20000
    s_mov_b32 s41, 0
    v_lshlrev_b32 v176, 4, v0
    s_mov_b32 s34, 0
    v_xor_b32 v5, v3, v4
    v_lshlrev_b32 v5, 4, v5
    v_lshl_or_b32 v5, v3, 8, v5
    v_or_b32 v5, 0x10000, v5
    v_xor_b32 v8, 0, v5
    v_xor_b32 v9, 64, v5
    v_xor_b32 v10, 128, v5
    v_xor_b32 v11, 192, v5
    v_lshrrev_b32 v5, 2, v2
    v_and_b32 v6, 7, v5
    v_lshlrev_b32 v6, 5, v6
    v_lshl_or_b32 v6, v5, 8, v6
    v_bfe_u32 v7, v2, 1, 1
    v_lshlrev_b32 v7, 4, v7
    v_xor_b32 v7, v7, v6
    v_and_b32 v5, 1, v2
    v_lshl_or_b32 v7, v5, 3, v7
    v_or_b32 v7, 0x10000, v7
    v_xor_b32 v12, 0, v7
    v_xor_b32 v13, 32, v7
    v_xor_b32 v14, 64, v7
    v_xor_b32 v15, 96, v7
    v_xor_b32 v16, 128, v7
    v_xor_b32 v17, 160, v7
    v_xor_b32 v18, 192, v7
    v_xor_b32 v19, 224, v7
    v_mov_b32 v56, 0x3f803f80
    v_mov_b32 v57, 0x3f803f80
    v_mov_b32 v58, 0x3f803f80
    v_mov_b32 v59, 0x3f803f80
    v_mov_b32 v5, 0
    v_mov_b32 v6, 147456
    ds_write_b32 v6, v5
    ds_write_b32 v6, v5 offset:4
L_start_20:
    s_waitcnt vmcnt(18) lgkmcnt(0)
    s_barrier
    ds_read_b128 a[128:131], v8 offset:0
    ds_read_b128 a[132:135], v9 offset:0
    ds_read_b128 a[136:139], v10 offset:0
    ds_read_b128 a[140:143], v11 offset:0
    ds_read_b128 a[144:147], v8 offset:4096
    ds_read_b128 a[148:151], v9 offset:4096
    ds_read_b128 a[152:155], v10 offset:4096
    ds_read_b128 a[156:159], v11 offset:4096
    s_cmp_lg_u32 s34, 0
    s_cbranch_scc1 L_have_23
    s_waitcnt lgkmcnt(4)
    v_mfma_f32_16x16x32_bf16 v[144:147], a[128:131], a[192:195], 0
    v_mfma_f32_16x16x32_bf16 v[144:147], a[132:135], a[196:199], v[144:147]
    v_mfma_f32_16x16x32_bf16 v[144:147], a[136:139], a[200:203], v[144:147]
    v_mfma_f32_16x16x32_bf16 v[144:147], a[140:143], a[204:207], v[144:147]
    v_mfma_f32_16x16x32_bf16 v[148:151], a[128:131], a[208:211], 0
    v_mfma_f32_16x16x32_bf16 v[148:151], a[132:135], a[212:215], v[148:151]
    v_mfma_f32_16x16x32_bf16 v[148:151], a[136:139], a[216:219], v[148:151]
    v_mfma_f32_16x16x32_bf16 v[148:151], a[140:143], a[220:223], v[148:151]
    v_mfma_f32_16x16x32_bf16 v[152:155], a[128:131], a[224:227], 0
    v_mfma_f32_16x16x32_bf16 v[152:155], a[132:135], a[228:231], v[152:155]
    v_mfma_f32_16x16x32_bf16 v[152:155], a[136:139], a[232:235], v[152:155]
    v_mfma_f32_16x16x32_bf16 v[152:155], a[140:143], a[236:239], v[152:155]
    v_mfma_f32_16x16x32_bf16 v[156:159], a[128:131], a[240:243], 0
    v_mfma_f32_16x16x32_bf16 v[156:159], a[132:135], a[244:247], v[156:159]
    v_mfma_f32_16x16x32_bf16 v[156:159], a[136:139], a[248:251], v[156:159]
    v_mfma_f32_16x16x32_bf16 v[156:159], a[140:143], a[252:255], v[156:159]
    s_waitcnt lgkmcnt(0)
    v_mfma_f32_16x16x32_bf16 v[160:163], a[144:147], a[192:195], 0
    v_mfma_f32_16x16x32_bf16 v[160:163], a[148:151], a[196:199], v[160:163]
    v_mfma_f32_16x16x32_bf16 v[160:163], a[152:155], a[200:203], v[160:163]
    v_mfma_f32_16x16x32_bf16 v[160:163], a[156:159], a[204:207], v[160:163]
    v_mfma_f32_16x16x32_bf16 v[164:167], a[144:147], a[208:211], 0
    v_mfma_f32_16x16x32_bf16 v[164:167], a[148:151], a[212:215], v[164:167]
    v_mfma_f32_16x16x32_bf16 v[164:167], a[152:155], a[216:219], v[164:167]
    v_mfma_f32_16x16x32_bf16 v[164:167], a[156:159], a[220:223], v[164:167]
    v_mfma_f32_16x16x32_bf16 v[168:171], a[144:147], a[224:227], 0
    v_mfma_f32_16x16x32_bf16 v[168:171], a[148:151], a[228:231], v[168:171]
    v_mfma_f32_16x16x32_bf16 v[168:171], a[152:155], a[232:235], v[168:171]
    v_mfma_f32_16x16x32_bf16 v[168:171], a[156:159], a[236:239], v[168:171]
    v_mfma_f32_16x16x32_bf16 v[172:175], a[144:147], a[240:243], 0
    v_mfma_f32_16x16x32_bf16 v[172:175], a[148:151], a[244:247], v[172:175]
    v_mfma_f32_16x16x32_bf16 v[172:175], a[152:155], a[248:251], v[172:175]
    v_mfma_f32_16x16x32_bf16 v[172:175], a[156:159], a[252:255], v[172:175]
    s_nop 7
    v_max3_f32 v46, v144, v145, v146
    v_max3_f32 v46, v46, v147, v160
    v_max3_f32 v46, v46, v161, v162
    v_max_f32 v46, v46, v163
    v_max3_f32 v47, v148, v149, v150
    v_max3_f32 v47, v47, v151, v164
    v_max3_f32 v47, v47, v165, v166
    v_max_f32 v47, v47, v167
    v_max3_f32 v48, v152, v153, v154
    v_max3_f32 v48, v48, v155, v168
    v_max3_f32 v48, v48, v169, v170
    v_max_f32 v48, v48, v171
    v_max3_f32 v49, v156, v157, v158
    v_max3_f32 v49, v49, v159, v172
    v_max3_f32 v49, v49, v173, v174
    v_max_f32 v49, v49, v175
    v_mov_b32 v50, v46
    v_mov_b32 v51, v47
    v_mov_b32 v52, v48
    v_mov_b32 v53, v49
    s_nop 1
    v_permlane16_swap_b32 v46, v50
    v_permlane16_swap_b32 v47, v51
    v_permlane16_swap_b32 v48, v52
    v_permlane16_swap_b32 v49, v53
    v_max_f32 v46, v46, v50
    v_max_f32 v47, v47, v51
    v_max_f32 v48, v48, v52
    v_max_f32 v49, v49, v53
    v_mov_b32 v50, v46
    v_mov_b32 v51, v47
    v_mov_b32 v52, v48
    v_mov_b32 v53, v49
    s_nop 1
    v_permlane32_swap_b32 v46, v50
    v_permlane32_swap_b32 v47, v51
    v_permlane32_swap_b32 v48, v52
    v_permlane32_swap_b32 v49, v53
    v_max_f32 v46, v46, v50
    v_max_f32 v47, v47, v51
    v_max_f32 v48, v48, v52
    v_max_f32 v49, v49, v53
    v_sub_f32 v112, 0, v46
    v_sub_f32 v113, 0, v46
    v_sub_f32 v114, 0, v46
    v_sub_f32 v115, 0, v46
    v_sub_f32 v116, 0, v47
    v_sub_f32 v117, 0, v47
    v_sub_f32 v118, 0, v47
    v_sub_f32 v119, 0, v47
    v_sub_f32 v120, 0, v48
    v_sub_f32 v121, 0, v48
    v_sub_f32 v122, 0, v48
    v_sub_f32 v123, 0, v48
    v_sub_f32 v124, 0, v49
    v_sub_f32 v125, 0, v49
    v_sub_f32 v126, 0, v49
    v_sub_f32 v127, 0, v49
L_have_23:
    s_add_u32 s37, s31, 32768
    s_add_u32 s38, s31, 65536
    s_mov_b32 s29, 49152
    s_mov_b32 s30, 40960
    s_waitcnt lgkmcnt(0)
    v_mfma_f32_16x16x32_bf16 v[64:67], a[128:131], a[192:195], v[112:115]
    v_mfma_f32_16x16x32_bf16 v[64:67], a[132:135], a[196:199], v[64:67]
    v_mfma_f32_16x16x32_bf16 v[64:67], a[136:139], a[200:203], v[64:67]
    v_mfma_f32_16x16x32_bf16 v[64:67], a[140:143], a[204:207], v[64:67]
    s_and_b32 s28, s2, 7
    s_bfe_u32 s90, s2, 0x30003
    s_lshr_b32 s91, s2, 6
    s_lshr_b32 s101, s28, 2
    s_cmp_lg_u32 s101, 0
    s_cselect_b64 vcc, -1, 0
    v_lshrrev_b32 v1, 6, v0
    v_and_b32 v2, 63, v0
    v_mul_u32_u24 v7, 36864, v1
    v_add_u32 v3, 0, v2
    v_mul_u32_u24 v4, 3641, v3
    v_lshrrev_b32 v4, 16, v4
    v_mul_u32_u24 v5, 18, v4
    v_sub_u32 v3, v3, v5
    v_and_b32 v5, 3, v4
    v_bfe_u32 v6, v4, 2, 2
    v_lshl_or_b32 v5, v6, 3, v5
    v_lshrrev_b32 v6, 4, v4
    v_lshl_or_b32 v5, v6, 2, v5
    v_cndmask_b32 v4, v4, v5, vcc
    v_mul_u32_u24 v4, 1152, v4
    v_lshl_add_u32 v4, v3, 4, v4
    v_add_u32 v4, v4, v7
    v_subrev_u32 v26, 0, v4
    v_add_u32 v3, 64, v2
    v_mul_u32_u24 v4, 3641, v3
    v_lshrrev_b32 v4, 16, v4
    v_mul_u32_u24 v5, 18, v4
    v_mfma_f32_16x16x32_bf16 v[68:71], a[128:131], a[208:211], v[116:119]
    v_exp_f32 v64, v64
    v_mfma_f32_16x16x32_bf16 v[68:71], a[132:135], a[212:215], v[68:71]
    v_mfma_f32_16x16x32_bf16 v[68:71], a[136:139], a[216:219], v[68:71]
    v_exp_f32 v65, v65
    v_mfma_f32_16x16x32_bf16 v[68:71], a[140:143], a[220:223], v[68:71]
    v_exp_f32 v66, v66
    v_cvt_pk_bf16_f32 v80, v64, v65
    v_exp_f32 v67, v67
    v_sub_u32 v3, v3, v5
    v_and_b32 v5, 3, v4
    v_bfe_u32 v6, v4, 2, 2
    v_lshl_or_b32 v5, v6, 3, v5
    v_lshrrev_b32 v6, 4, v4
    v_lshl_or_b32 v5, v6, 2, v5
    v_cndmask_b32 v4, v4, v5, vcc
    v_mul_u32_u24 v4, 1152, v4
    v_lshl_add_u32 v4, v3, 4, v4
    v_add_u32 v4, v4, v7
    v_subrev_u32 v27, 1024, v4
    v_add_u32 v3, 128, v2
    v_mul_u32_u24 v4, 3641, v3
    v_lshrrev_b32 v4, 16, v4
    v_mul_u32_u24 v5, 18, v4
    v_sub_u32 v3, v3, v5
    v_and_b32 v5, 3, v4
    v_bfe_u32 v6, v4, 2, 2
    v_lshl_or_b32 v5, v6, 3, v5
    v_lshrrev_b32 v6, 4, v4
    v_lshl_or_b32 v5, v6, 2, v5
    v_cndmask_b32 v4, v4, v5, vcc
    v_mul_u32_u24 v4, 1152, v4
    v_lshl_add_u32 v4, v3, 4, v4
    v_add_u32 v4, v4, v7
    v_subrev_u32 v28, 2048, v4
    v_add_u32 v3, 192, v2
    v_mul_u32_u24 v4, 3641, v3
    v_mfma_f32_16x16x32_bf16 v[72:75], a[128:131], a[224:227], v[120:123]
    v_exp_f32 v68, v68
    v_mfma_f32_16x16x32_bf16 v[72:75], a[132:135], a[228:231], v[72:75]
    v_cvt_pk_bf16_f32 v81, v66, v67
    v_mfma_f32_16x16x32_bf16 v[72:75], a[136:139], a[232:235], v[72:75]
    v_exp_f32 v69, v69
    v_mfma_f32_16x16x32_bf16 v[72:75], a[140:143], a[236:239], v[72:75]
    v_exp_f32 v70, v70
    v_cvt_pk_bf16_f32 v84, v68, v69
    v_exp_f32 v71, v71
    v_lshrrev_b32 v4, 16, v4
    v_mul_u32_u24 v5, 18, v4
    v_sub_u32 v3, v3, v5
    v_and_b32 v5, 3, v4
    v_bfe_u32 v6, v4, 2, 2
    v_lshl_or_b32 v5, v6, 3, v5
    v_lshrrev_b32 v6, 4, v4
    v_lshl_or_b32 v5, v6, 2, v5
    v_cndmask_b32 v4, v4, v5, vcc
    v_mul_u32_u24 v4, 1152, v4
    v_lshl_add_u32 v4, v3, 4, v4
    v_add_u32 v4, v4, v7
    v_subrev_u32 v29, 3072, v4
    v_add_u32 v3, 256, v2
    v_mul_u32_u24 v4, 3641, v3
    v_lshrrev_b32 v4, 16, v4
    v_mul_u32_u24 v5, 18, v4
    v_sub_u32 v3, v3, v5
    v_and_b32 v5, 3, v4
    v_bfe_u32 v6, v4, 2, 2
    v_lshl_or_b32 v5, v6, 3, v5
    v_lshrrev_b32 v6, 4, v4
    v_lshl_or_b32 v5, v6, 2, v5
    v_cndmask_b32 v4, v4, v5, vcc
    v_mul_u32_u24 v4, 1152, v4
    v_lshl_add_u32 v4, v3, 4, v4
    v_add_u32 v4, v4, v7
    v_subrev_u32 v30, 0, v4
    v_mfma_f32_16x16x32_bf16 v[76:79], a[128:131], a[240:243], v[124:127]
    v_exp_f32 v72, v72
    v_mfma_f32_16x16x32_bf16 v[76:79], a[132:135], a[244:247], v[76:79]
    ds_read_b128 a[128:131], v8 offset:8192
    v_cvt_pk_bf16_f32 v85, v70, v71
    v_mfma_f32_16x16x32_bf16 v[76:79], a[136:139], a[248:251], v[76:79]
    v_exp_f32 v73, v73
    v_mfma_f32_16x16x32_bf16 v[76:79], a[140:143], a[252:255], v[76:79]
    v_exp_f32 v74, v74
    ds_read_b64_tr_b16 a[160:161], v12 offset:24576
    v_cvt_pk_bf16_f32 v88, v72, v73
    v_exp_f32 v75, v75
    ds_read_b64_tr_b16 a[162:163], v12 offset:28672
    s_waitcnt lgkmcnt(3)
    v_add_u32 v3, 320, v2
    v_mul_u32_u24 v4, 3641, v3
    v_lshrrev_b32 v4, 16, v4
    v_mul_u32_u24 v5, 18, v4
    v_sub_u32 v3, v3, v5
    v_and_b32 v5, 3, v4
    v_bfe_u32 v6, v4, 2, 2
    v_lshl_or_b32 v5, v6, 3, v5
    v_lshrrev_b32 v6, 4, v4
    v_lshl_or_b32 v5, v6, 2, v5
    v_cndmask_b32 v4, v4, v5, vcc
    v_mul_u32_u24 v4, 1152, v4
    v_lshl_add_u32 v4, v3, 4, v4
    v_add_u32 v4, v4, v7
    v_subrev_u32 v31, 1024, v4
    v_add_u32 v3, 384, v2
    v_mul_u32_u24 v4, 3641, v3
    v_lshrrev_b32 v4, 16, v4
    v_mul_u32_u24 v5, 18, v4
    v_sub_u32 v3, v3, v5
    v_and_b32 v5, 3, v4
    v_bfe_u32 v6, v4, 2, 2
    v_lshl_or_b32 v5, v6, 3, v5
    v_lshrrev_b32 v6, 4, v4
    v_lshl_or_b32 v5, v6, 2, v5
    v_cndmask_b32 v4, v4, v5, vcc
    v_mul_u32_u24 v4, 1152, v4
    v_lshl_add_u32 v4, v3, 4, v4
    v_mfma_f32_16x16x32_bf16 v[64:67], a[144:147], a[192:195], v[112:115]
    v_exp_f32 v76, v76
    v_mfma_f32_16x16x32_bf16 v[64:67], a[148:151], a[196:199], v[64:67]
    ds_read_b128 a[132:135], v9 offset:8192
    v_cvt_pk_bf16_f32 v89, v74, v75
    v_mfma_f32_16x16x32_bf16 v[64:67], a[152:155], a[200:203], v[64:67]
    v_exp_f32 v77, v77
    v_mfma_f32_16x16x32_bf16 v[64:67], a[156:159], a[204:207], v[64:67]
    v_exp_f32 v78, v78
    ds_read_b64_tr_b16 a[164:165], v13 offset:24576
    v_cvt_pk_bf16_f32 v92, v76, v77
    v_exp_f32 v79, v79
    ds_read_b64_tr_b16 a[166:167], v13 offset:28672
    v_add_u32 v4, v4, v7
    v_subrev_u32 v32, 2048, v4
    v_add_u32 v3, 448, v2
    v_mul_u32_u24 v4, 3641, v3
    v_lshrrev_b32 v4, 16, v4
    v_mul_u32_u24 v5, 18, v4
    v_sub_u32 v3, v3, v5
    v_and_b32 v5, 3, v4
    v_bfe_u32 v6, v4, 2, 2
    v_lshl_or_b32 v5, v6, 3, v5
    v_lshrrev_b32 v6, 4, v4
    v_lshl_or_b32 v5, v6, 2, v5
    v_cndmask_b32 v4, v4, v5, vcc
    v_mul_u32_u24 v4, 1152, v4
    v_lshl_add_u32 v4, v3, 4, v4
    v_add_u32 v4, v4, v7
    v_subrev_u32 v33, 3072, v4
    v_add_u32 v3, 512, v2
    v_mul_u32_u24 v4, 3641, v3
    v_lshrrev_b32 v4, 16, v4
    v_mul_u32_u24 v5, 18, v4
    v_sub_u32 v3, v3, v5
    v_and_b32 v5, 3, v4
    v_bfe_u32 v6, v4, 2, 2
    v_lshl_or_b32 v5, v6, 3, v5
    v_lshrrev_b32 v6, 4, v4
    v_lshl_or_b32 v5, v6, 2, v5
    v_cndmask_b32 v4, v4, v5, vcc
    v_mfma_f32_16x16x32_bf16 v[68:71], a[144:147], a[208:211], v[116:119]
    v_exp_f32 v64, v64
    v_mfma_f32_16x16x32_bf16 v[68:71], a[148:151], a[212:215], v[68:71]
    ds_read_b128 a[136:139], v10 offset:8192
    v_cvt_pk_bf16_f32 v93, v78, v79
    v_mfma_f32_16x16x32_bf16 v[68:71], a[152:155], a[216:219], v[68:71]
    v_exp_f32 v65, v65
    v_mfma_f32_16x16x32_bf16 v[68:71], a[156:159], a[220:223], v[68:71]
    v_exp_f32 v66, v66
    ds_read_b64_tr_b16 a[168:169], v14 offset:24576
    v_cvt_pk_bf16_f32 v82, v64, v65
    v_exp_f32 v67, v67
    ds_read_b64_tr_b16 a[170:171], v14 offset:28672
    v_mul_u32_u24 v4, 1152, v4
    v_lshl_add_u32 v4, v3, 4, v4
    v_add_u32 v4, v4, v7
    v_subrev_u32 v34, 0, v4
    v_and_b32 v3, 7, v2
    s_lshl_b32 s92, s28, 1
    s_lshr_b32 s93, s90, 2
    s_add_u32 s92, s92, s93
    s_and_b32 s93, s90, 3
    s_lshl_b32 s93, s93, 6
    s_add_u32 s92, s92, s93
    s_add_u32 s92, s92, 256
    v_lshl_add_u32 v4, v3, 3, s92
    v_and_b32 v6, 1, v3
    s_lshl_b32 s92, s90, 1
    v_add_u32 v6, s92, v6
    v_lshrrev_b32 v7, 3, v6
    v_and_b32 v6, 7, v6
    v_lshl_add_u32 v7, v6, 3, v7
    v_lshrrev_b32 v3, 1, v3
    v_lshl_add_u32 v7, v3, 6, v7
    s_and_b32 s92, s28, 3
    s_lshl_b32 s92, s92, 1
    v_add_u32 v7, s92, v7
    v_cndmask_b32 v3, v4, v7, vcc
    v_lshlrev_b32 v45, 7, v3
    s_lshl_b32 s92, s90, 4
    v_lshl_add_u32 v5, v1, 2, s92
    v_mfma_f32_16x16x32_bf16 v[72:75], a[144:147], a[224:227], v[120:123]
    v_exp_f32 v68, v68
    v_mfma_f32_16x16x32_bf16 v[72:75], a[148:151], a[228:231], v[72:75]
    ds_read_b128 a[140:143], v11 offset:8192
    v_cvt_pk_bf16_f32 v83, v66, v67
    v_mfma_f32_16x16x32_bf16 v[72:75], a[152:155], a[232:235], v[72:75]
    v_exp_f32 v69, v69
    v_mfma_f32_16x16x32_bf16 v[72:75], a[156:159], a[236:239], v[72:75]
    v_exp_f32 v70, v70
    ds_read_b64_tr_b16 a[172:173], v15 offset:24576
    v_cvt_pk_bf16_f32 v86, v68, v69
    v_exp_f32 v71, v71
    ds_read_b64_tr_b16 a[174:175], v15 offset:28672
    s_mov_b32 s92, 131072
    s_cmp_lg_u32 s101, 0
    s_cselect_b32 s92, 147456, s92
    v_mul_lo_u32 v6, v5, s92
    v_lshl_add_u32 v35, v2, 4, v6
    v_add_u32 v36, s92, v35
    v_add_u32 v37, s92, v36
    v_add_u32 v38, s92, v37
    s_and_b32 s93, s28, 3
    s_cmp_lg_u32 s101, 0
    s_cselect_b32 s92, 36, 32
    s_mul_i32 s92, s92, s93
    s_lshl_b32 s100, s92, 10
    s_mul_i32 s94, s92, 36864
    s_mul_i32 s92, s91, 288
    s_add_u32 s94, s94, s92
    s_add_u32 s42, s94, 1179648
    s_add_u32 s43, s100, 32768
    s_cmp_lg_u32 s101, 0
    s_cselect_b32 s42, s42, 0x70000000
    s_cselect_b32 s43, s43, 0x70000000
    s_cselect_b32 s96, s82, s72
    s_cselect_b32 s97, s83, s73
    s_mov_b32 s98, 4718592
    s_cselect_b32 s98, 5308416, s98
    s_mov_b32 s99, 0x20000
    s_mov_b32 s92, 0x3000000
    v_mfma_f32_16x16x32_bf16 v[76:79], a[144:147], a[240:243], v[124:127]
    v_exp_f32 v72, v72
    v_mfma_f32_16x16x32_bf16 v[76:79], a[148:151], a[244:247], v[76:79]
    ds_read_b128 a[144:147], v8 offset:12288
    v_cvt_pk_bf16_f32 v87, v70, v71
    v_mfma_f32_16x16x32_bf16 v[76:79], a[152:155], a[248:251], v[76:79]
    v_exp_f32 v73, v73
    v_mfma_f32_16x16x32_bf16 v[76:79], a[156:159], a[252:255], v[76:79]
    v_exp_f32 v74, v74
    ds_read_b64_tr_b16 a[176:177], v16 offset:24576
    v_cvt_pk_bf16_f32 v90, v72, v73
    v_exp_f32 v75, v75
    ds_read_b64_tr_b16 a[178:179], v16 offset:28672
    s_waitcnt lgkmcnt(3)
    s_mov_b32 s93, 16777216
    s_cselect_b32 s92, 0x1000000, s92
    s_cselect_b32 s93, 18874368, s93
    s_add_u32 s20, s88, s92
    s_addc_u32 s21, s89, 0
    s_mov_b32 s22, s93
    s_mov_b32 s23, 0x20000
    s_mul_i32 s95, s4, 9216
    v_lshrrev_b32 v3, 2, v2
    v_mul_u32_u24 v3, 288, v3
    v_and_b32 v4, 3, v2
    v_lshl_add_u32 v39, v4, 3, v3
    v_add_u32 v40, 36864, v39
    v_add_u32 v41, 73728, v39
    v_add_u32 v42, 110592, v39
    v_bfe_u32 v3, v2, 4, 1
    v_add_u32 v3, v3, v5
    v_mul_u32_u24 v3, 18432, v3
    v_and_b32 v4, 15, v2
    v_lshl_add_u32 v3, v4, 4, v3
    v_lshrrev_b32 v4, 5, v2
    v_lshl_add_u32 v3, v4, 8, v3
    s_mul_i32 s92, s91, 4608
    v_add_u32 v43, s92, v3
    v_add_u32 v44, 36864, v43
    s_mov_b32 s28, 0
    s_mov_b32 s32, 0
    v_mfma_f32_16x16x32_bf16 v[64:67], a[128:131], a[192:195], v[112:115]
    v_exp_f32 v76, v76
    v_mfma_f32_16x16x32_bf16 v[64:67], a[132:135], a[196:199], v[64:67]
    ds_read_b128 a[148:151], v9 offset:12288
    v_cvt_pk_bf16_f32 v91, v74, v75
    v_mfma_f32_16x16x32_bf16 v[64:67], a[136:139], a[200:203], v[64:67]
    v_exp_f32 v77, v77
    v_mfma_f32_16x16x32_bf16 v[64:67], a[140:143], a[204:207], v[64:67]
    v_mfma_f32_16x16x32_bf16 a[0:3], a[160:163], v[80:83], 0
    v_exp_f32 v78, v78
    v_mfma_f32_16x16x32_bf16 a[16:19], a[164:167], v[80:83], 0
    ds_read_b64_tr_b16 a[180:181], v17 offset:24576
    v_cvt_pk_bf16_f32 v94, v76, v77
    v_mfma_f32_16x16x32_bf16 a[32:35], a[168:171], v[80:83], 0
    v_exp_f32 v79, v79
    v_mfma_f32_16x16x32_bf16 a[48:51], a[172:175], v[80:83], 0
    ds_read_b64_tr_b16 a[182:183], v17 offset:28672
    v_mfma_f32_16x16x32_bf16 v[128:131], v[56:59], v[80:83], 0
    v_mfma_f32_16x16x32_bf16 v[68:71], a[128:131], a[208:211], v[116:119]
    v_exp_f32 v64, v64
    v_mfma_f32_16x16x32_bf16 v[68:71], a[132:135], a[212:215], v[68:71]
    ds_read_b128 a[152:155], v10 offset:12288
    v_cvt_pk_bf16_f32 v95, v78, v79
    v_mfma_f32_16x16x32_bf16 v[68:71], a[136:139], a[216:219], v[68:71]
    v_exp_f32 v65, v65
    v_mfma_f32_16x16x32_bf16 v[68:71], a[140:143], a[220:223], v[68:71]
    v_mfma_f32_16x16x32_bf16 a[4:7], a[160:163], v[84:87], 0
    v_exp_f32 v66, v66
    v_mfma_f32_16x16x32_bf16 a[20:23], a[164:167], v[84:87], 0
    ds_read_b64_tr_b16 a[184:185], v18 offset:24576
    v_cvt_pk_bf16_f32 v96, v64, v65
    v_mfma_f32_16x16x32_bf16 a[36:39], a[168:171], v[84:87], 0
    v_exp_f32 v67, v67
    v_mfma_f32_16x16x32_bf16 a[52:55], a[172:175], v[84:87], 0
    ds_read_b64_tr_b16 a[186:187], v18 offset:28672
    v_mfma_f32_16x16x32_bf16 v[132:135], v[56:59], v[84:87], 0
    v_mfma_f32_16x16x32_bf16 v[72:75], a[128:131], a[224:227], v[120:123]
    v_exp_f32 v68, v68
    v_mfma_f32_16x16x32_bf16 v[72:75], a[132:135], a[228:231], v[72:75]
    ds_read_b128 a[156:159], v11 offset:12288
    v_cvt_pk_bf16_f32 v97, v66, v67
    v_mfma_f32_16x16x32_bf16 v[72:75], a[136:139], a[232:235], v[72:75]
    v_exp_f32 v69, v69
    v_mfma_f32_16x16x32_bf16 v[72:75], a[140:143], a[236:239], v[72:75]
    v_mfma_f32_16x16x32_bf16 a[8:11], a[160:163], v[88:91], 0
    v_exp_f32 v70, v70
    v_mfma_f32_16x16x32_bf16 a[24:27], a[164:167], v[88:91], 0
    ds_read_b64_tr_b16 a[188:189], v19 offset:24576
    v_cvt_pk_bf16_f32 v100, v68, v69
    v_mfma_f32_16x16x32_bf16 a[40:43], a[168:171], v[88:91], 0
    v_exp_f32 v71, v71
    v_mfma_f32_16x16x32_bf16 a[56:59], a[172:175], v[88:91], 0
    ds_read_b64_tr_b16 a[190:191], v19 offset:28672
    s_waitcnt vmcnt(10)
    s_barrier
    v_mfma_f32_16x16x32_bf16 v[136:139], v[56:59], v[88:91], 0
    v_mfma_f32_16x16x32_bf16 v[76:79], a[128:131], a[240:243], v[124:127]
    v_exp_f32 v72, v72
    v_mfma_f32_16x16x32_bf16 v[76:79], a[132:135], a[244:247], v[76:79]
    ds_read_b128 a[128:131], v8 offset:32768
    v_cvt_pk_bf16_f32 v101, v70, v71
    v_mfma_f32_16x16x32_bf16 v[76:79], a[136:139], a[248:251], v[76:79]
    v_exp_f32 v73, v73
    s_mov_b32 m0, s37
    v_mfma_f32_16x16x32_bf16 v[76:79], a[140:143], a[252:255], v[76:79]
    buffer_load_dwordx4 v20, s[8:11], s29 offen offset:0 lds
    v_mfma_f32_16x16x32_bf16 a[12:15], a[160:163], v[92:95], 0
    v_exp_f32 v74, v74
    v_mfma_f32_16x16x32_bf16 a[28:31], a[164:167], v[92:95], 0
    ds_read_b64_tr_b16 a[160:161], v12 offset:49152
    v_cvt_pk_bf16_f32 v104, v72, v73
    v_mfma_f32_16x16x32_bf16 a[44:47], a[168:171], v[92:95], 0
    v_exp_f32 v75, v75
    v_mfma_f32_16x16x32_bf16 a[60:63], a[172:175], v[92:95], 0
    ds_read_b64_tr_b16 a[162:163], v12 offset:53248
    s_waitcnt lgkmcnt(3)
    v_mfma_f32_16x16x32_bf16 v[140:143], v[56:59], v[92:95], 0
    v_mfma_f32_16x16x32_bf16 v[64:67], a[144:147], a[192:195], v[112:115]
    v_exp_f32 v76, v76
    v_mfma_f32_16x16x32_bf16 v[64:67], a[148:151], a[196:199], v[64:67]
    ds_read_b128 a[132:135], v9 offset:32768
    v_cvt_pk_bf16_f32 v105, v74, v75
    v_mfma_f32_16x16x32_bf16 v[64:67], a[152:155], a[200:203], v[64:67]
    v_exp_f32 v77, v77
    v_mfma_f32_16x16x32_bf16 v[64:67], a[156:159], a[204:207], v[64:67]
    buffer_load_dwordx4 v21, s[8:11], s29 offen offset:1024 lds
    v_mfma_f32_16x16x32_bf16 a[64:67], a[176:179], v[80:83], 0
    v_exp_f32 v78, v78
    v_mfma_f32_16x16x32_bf16 a[80:83], a[180:183], v[80:83], 0
    ds_read_b64_tr_b16 a[164:165], v13 offset:49152
    v_cvt_pk_bf16_f32 v108, v76, v77
    v_mfma_f32_16x16x32_bf16 a[96:99], a[184:187], v[80:83], 0
    v_exp_f32 v79, v79
    v_mfma_f32_16x16x32_bf16 a[112:115], a[188:191], v[80:83], 0
    ds_read_b64_tr_b16 a[166:167], v13 offset:53248
    v_mfma_f32_16x16x32_bf16 v[68:71], a[144:147], a[208:211], v[116:119]
    v_exp_f32 v64, v64
    v_mfma_f32_16x16x32_bf16 v[68:71], a[148:151], a[212:215], v[68:71]
    ds_read_b128 a[136:139], v10 offset:32768
    v_cvt_pk_bf16_f32 v109, v78, v79
    v_mfma_f32_16x16x32_bf16 v[68:71], a[152:155], a[216:219], v[68:71]
    v_exp_f32 v65, v65
    v_mfma_f32_16x16x32_bf16 v[68:71], a[156:159], a[220:223], v[68:71]
    buffer_load_dwordx4 v22, s[8:11], s29 offen offset:2048 lds
    v_mfma_f32_16x16x32_bf16 a[68:71], a[176:179], v[84:87], 0
    v_exp_f32 v66, v66
    v_mfma_f32_16x16x32_bf16 a[84:87], a[180:183], v[84:87], 0
    ds_read_b64_tr_b16 a[168:169], v14 offset:49152
    v_cvt_pk_bf16_f32 v98, v64, v65
    v_mfma_f32_16x16x32_bf16 a[100:103], a[184:187], v[84:87], 0
    v_exp_f32 v67, v67
    v_mfma_f32_16x16x32_bf16 a[116:119], a[188:191], v[84:87], 0
    ds_read_b64_tr_b16 a[170:171], v14 offset:53248
    v_mfma_f32_16x16x32_bf16 v[72:75], a[144:147], a[224:227], v[120:123]
    v_exp_f32 v68, v68
    v_mfma_f32_16x16x32_bf16 v[72:75], a[148:151], a[228:231], v[72:75]
    ds_read_b128 a[140:143], v11 offset:32768
    v_cvt_pk_bf16_f32 v99, v66, v67
    v_mfma_f32_16x16x32_bf16 v[72:75], a[152:155], a[232:235], v[72:75]
    v_exp_f32 v69, v69
    v_mfma_f32_16x16x32_bf16 v[72:75], a[156:159], a[236:239], v[72:75]
    buffer_load_dwordx4 v23, s[8:11], s29 offen offset:3072 lds
    s_add_u32 s29, s29, 16384
    v_mfma_f32_16x16x32_bf16 a[72:75], a[176:179], v[88:91], 0
    v_exp_f32 v70, v70
    v_mfma_f32_16x16x32_bf16 a[88:91], a[180:183], v[88:91], 0
    ds_read_b64_tr_b16 a[172:173], v15 offset:49152
    v_cvt_pk_bf16_f32 v102, v68, v69
    v_mfma_f32_16x16x32_bf16 a[104:107], a[184:187], v[88:91], 0
    v_exp_f32 v71, v71
    v_mfma_f32_16x16x32_bf16 a[120:123], a[188:191], v[88:91], 0
    ds_read_b64_tr_b16 a[174:175], v15 offset:53248
    v_mfma_f32_16x16x32_bf16 v[76:79], a[144:147], a[240:243], v[124:127]
    v_exp_f32 v72, v72
    v_mfma_f32_16x16x32_bf16 v[76:79], a[148:151], a[244:247], v[76:79]
    ds_read_b128 a[144:147], v8 offset:36864
    v_cvt_pk_bf16_f32 v103, v70, v71
    v_mfma_f32_16x16x32_bf16 v[76:79], a[152:155], a[248:251], v[76:79]
    v_exp_f32 v73, v73
    s_add_u32 m0, s37, 16384
    v_mfma_f32_16x16x32_bf16 v[76:79], a[156:159], a[252:255], v[76:79]
    buffer_load_dwordx4 v24, s[12:15], s30 offen offset:0 lds
    v_mfma_f32_16x16x32_bf16 a[76:79], a[176:179], v[92:95], 0
    v_exp_f32 v74, v74
    v_mfma_f32_16x16x32_bf16 a[92:95], a[180:183], v[92:95], 0
    ds_read_b64_tr_b16 a[176:177], v16 offset:49152
    v_cvt_pk_bf16_f32 v106, v72, v73
    v_mfma_f32_16x16x32_bf16 a[108:111], a[184:187], v[92:95], 0
    v_exp_f32 v75, v75
    v_mfma_f32_16x16x32_bf16 a[124:127], a[188:191], v[92:95], 0
    ds_read_b64_tr_b16 a[178:179], v16 offset:53248
    s_waitcnt lgkmcnt(3)
    v_mfma_f32_16x16x32_bf16 v[64:67], a[128:131], a[192:195], v[112:115]
    v_exp_f32 v76, v76
    v_mfma_f32_16x16x32_bf16 v[64:67], a[132:135], a[196:199], v[64:67]
    ds_read_b128 a[148:151], v9 offset:36864
    v_cvt_pk_bf16_f32 v107, v74, v75
    v_mfma_f32_16x16x32_bf16 v[64:67], a[136:139], a[200:203], v[64:67]
    v_exp_f32 v77, v77
    v_mfma_f32_16x16x32_bf16 v[64:67], a[140:143], a[204:207], v[64:67]
    buffer_load_dwordx4 v25, s[12:15], s30 offen offset:1024 lds
    v_mfma_f32_16x16x32_bf16 a[0:3], a[160:163], v[96:99], a[0:3]
    v_exp_f32 v78, v78
    v_mfma_f32_16x16x32_bf16 a[16:19], a[164:167], v[96:99], a[16:19]
    ds_read_b64_tr_b16 a[180:181], v17 offset:49152
    v_cvt_pk_bf16_f32 v110, v76, v77
    v_mfma_f32_16x16x32_bf16 a[32:35], a[168:171], v[96:99], a[32:35]
    v_exp_f32 v79, v79
    v_mfma_f32_16x16x32_bf16 a[48:51], a[172:175], v[96:99], a[48:51]
    ds_read_b64_tr_b16 a[182:183], v17 offset:53248
    v_mfma_f32_16x16x32_bf16 v[128:131], v[56:59], v[96:99], v[128:131]
    v_mfma_f32_16x16x32_bf16 v[68:71], a[128:131], a[208:211], v[116:119]
    v_exp_f32 v64, v64
    v_mfma_f32_16x16x32_bf16 v[68:71], a[132:135], a[212:215], v[68:71]
    ds_read_b128 a[152:155], v10 offset:36864
    v_cvt_pk_bf16_f32 v111, v78, v79
    v_mfma_f32_16x16x32_bf16 v[68:71], a[136:139], a[216:219], v[68:71]
    v_exp_f32 v65, v65
    v_mfma_f32_16x16x32_bf16 v[68:71], a[140:143], a[220:223], v[68:71]
    buffer_load_dwordx4 v24, s[12:15], s30 offen offset:2048 lds
    v_mfma_f32_16x16x32_bf16 a[4:7], a[160:163], v[100:103], a[4:7]
    v_exp_f32 v66, v66
    v_mfma_f32_16x16x32_bf16 a[20:23], a[164:167], v[100:103], a[20:23]
    ds_read_b64_tr_b16 a[184:185], v18 offset:49152
    v_cvt_pk_bf16_f32 v80, v64, v65
    v_mfma_f32_16x16x32_bf16 a[36:39], a[168:171], v[100:103], a[36:39]
    v_exp_f32 v67, v67
    v_mfma_f32_16x16x32_bf16 a[52:55], a[172:175], v[100:103], a[52:55]
    ds_read_b64_tr_b16 a[186:187], v18 offset:53248
    v_mfma_f32_16x16x32_bf16 v[132:135], v[56:59], v[100:103], v[132:135]
    v_mfma_f32_16x16x32_bf16 v[72:75], a[128:131], a[224:227], v[120:123]
    v_exp_f32 v68, v68
    v_mfma_f32_16x16x32_bf16 v[72:75], a[132:135], a[228:231], v[72:75]
    ds_read_b128 a[156:159], v11 offset:36864
    v_cvt_pk_bf16_f32 v81, v66, v67
    v_mfma_f32_16x16x32_bf16 v[72:75], a[136:139], a[232:235], v[72:75]
    v_exp_f32 v69, v69
    v_mfma_f32_16x16x32_bf16 v[72:75], a[140:143], a[236:239], v[72:75]
    buffer_load_dwordx4 v25, s[12:15], s30 offen offset:3072 lds
    s_add_u32 s30, s30, 16384
    v_mfma_f32_16x16x32_bf16 a[8:11], a[160:163], v[104:107], a[8:11]
    v_exp_f32 v70, v70
    v_mfma_f32_16x16x32_bf16 a[24:27], a[164:167], v[104:107], a[24:27]
    ds_read_b64_tr_b16 a[188:189], v19 offset:49152
    v_cvt_pk_bf16_f32 v84, v68, v69
    v_mfma_f32_16x16x32_bf16 a[40:43], a[168:171], v[104:107], a[40:43]
    v_exp_f32 v71, v71
    v_mfma_f32_16x16x32_bf16 a[56:59], a[172:175], v[104:107], a[56:59]
    ds_read_b64_tr_b16 a[190:191], v19 offset:53248
    v_mfma_f32_16x16x32_bf16 v[136:139], v[56:59], v[104:107], v[136:139]
    s_xor_b32 s37, s37, 0x10000
    v_mfma_f32_16x16x32_bf16 v[76:79], a[128:131], a[240:243], v[124:127]
    v_exp_f32 v72, v72
    v_mfma_f32_16x16x32_bf16 v[76:79], a[132:135], a[244:247], v[76:79]
    ds_read_b128 a[128:131], v8 offset:40960
    v_cvt_pk_bf16_f32 v85, v70, v71
    v_mfma_f32_16x16x32_bf16 v[76:79], a[136:139], a[248:251], v[76:79]
    v_exp_f32 v73, v73
    v_mfma_f32_16x16x32_bf16 v[76:79], a[140:143], a[252:255], v[76:79]
    v_mfma_f32_16x16x32_bf16 a[12:15], a[160:163], v[108:111], a[12:15]
    v_exp_f32 v74, v74
    v_mfma_f32_16x16x32_bf16 a[28:31], a[164:167], v[108:111], a[28:31]
    ds_read_b64_tr_b16 a[160:161], v12 offset:57344
    v_cvt_pk_bf16_f32 v88, v72, v73
    v_mfma_f32_16x16x32_bf16 a[44:47], a[168:171], v[108:111], a[44:47]
    v_exp_f32 v75, v75
    v_mfma_f32_16x16x32_bf16 a[60:63], a[172:175], v[108:111], a[60:63]
    ds_read_b64_tr_b16 a[162:163], v12 offset:61440
    s_waitcnt lgkmcnt(3)
    v_mfma_f32_16x16x32_bf16 v[140:143], v[56:59], v[108:111], v[140:143]
    v_mfma_f32_16x16x32_bf16 v[64:67], a[144:147], a[192:195], v[112:115]
    v_exp_f32 v76, v76
    v_mfma_f32_16x16x32_bf16 v[64:67], a[148:151], a[196:199], v[64:67]
    ds_read_b128 a[132:135], v9 offset:40960
    v_cvt_pk_bf16_f32 v89, v74, v75
    v_mfma_f32_16x16x32_bf16 v[64:67], a[152:155], a[200:203], v[64:67]
    v_exp_f32 v77, v77
    v_mfma_f32_16x16x32_bf16 v[64:67], a[156:159], a[204:207], v[64:67]
    buffer_load_dwordx4 v[180:183], v176, s[16:19], s41 offen
    s_add_u32 s41, s41, 4096
    v_mfma_f32_16x16x32_bf16 a[64:67], a[176:179], v[96:99], a[64:67]
    v_exp_f32 v78, v78
    v_mfma_f32_16x16x32_bf16 a[80:83], a[180:183], v[96:99], a[80:83]
    ds_read_b64_tr_b16 a[164:165], v13 offset:57344
    v_cvt_pk_bf16_f32 v92, v76, v77
    v_mfma_f32_16x16x32_bf16 a[96:99], a[184:187], v[96:99], a[96:99]
    v_exp_f32 v79, v79
    v_mfma_f32_16x16x32_bf16 a[112:115], a[188:191], v[96:99], a[112:115]
    ds_read_b64_tr_b16 a[166:167], v13 offset:61440
    v_mfma_f32_16x16x32_bf16 v[68:71], a[144:147], a[208:211], v[116:119]
    v_exp_f32 v64, v64
    v_mfma_f32_16x16x32_bf16 v[68:71], a[148:151], a[212:215], v[68:71]
    ds_read_b128 a[136:139], v10 offset:40960
    v_cvt_pk_bf16_f32 v93, v78, v79
    v_mfma_f32_16x16x32_bf16 v[68:71], a[152:155], a[216:219], v[68:71]
    v_exp_f32 v65, v65
    v_mfma_f32_16x16x32_bf16 v[68:71], a[156:159], a[220:223], v[68:71]
    v_mfma_f32_16x16x32_bf16 a[68:71], a[176:179], v[100:103], a[68:71]
    v_exp_f32 v66, v66
    v_mfma_f32_16x16x32_bf16 a[84:87], a[180:183], v[100:103], a[84:87]
    ds_read_b64_tr_b16 a[168:169], v14 offset:57344
    v_cvt_pk_bf16_f32 v82, v64, v65
    v_mfma_f32_16x16x32_bf16 a[100:103], a[184:187], v[100:103], a[100:103]
    v_exp_f32 v67, v67
    v_mfma_f32_16x16x32_bf16 a[116:119], a[188:191], v[100:103], a[116:119]
    ds_read_b64_tr_b16 a[170:171], v14 offset:61440
    v_mfma_f32_16x16x32_bf16 v[72:75], a[144:147], a[224:227], v[120:123]
    v_exp_f32 v68, v68
    v_mfma_f32_16x16x32_bf16 v[72:75], a[148:151], a[228:231], v[72:75]
    ds_read_b128 a[140:143], v11 offset:40960
    v_cvt_pk_bf16_f32 v83, v66, v67
    v_mfma_f32_16x16x32_bf16 v[72:75], a[152:155], a[232:235], v[72:75]
    v_exp_f32 v69, v69
    v_mfma_f32_16x16x32_bf16 v[72:75], a[156:159], a[236:239], v[72:75]
    v_mfma_f32_16x16x32_bf16 a[72:75], a[176:179], v[104:107], a[72:75]
    v_exp_f32 v70, v70
    v_mfma_f32_16x16x32_bf16 a[88:91], a[180:183], v[104:107], a[88:91]
    ds_read_b64_tr_b16 a[172:173], v15 offset:57344
    v_cvt_pk_bf16_f32 v86, v68, v69
    v_mfma_f32_16x16x32_bf16 a[104:107], a[184:187], v[104:107], a[104:107]
    v_exp_f32 v71, v71
    v_mfma_f32_16x16x32_bf16 a[120:123], a[188:191], v[104:107], a[120:123]
    ds_read_b64_tr_b16 a[174:175], v15 offset:61440
    v_mfma_f32_16x16x32_bf16 v[76:79], a[144:147], a[240:243], v[124:127]
    v_exp_f32 v72, v72
    v_mfma_f32_16x16x32_bf16 v[76:79], a[148:151], a[244:247], v[76:79]
    ds_read_b128 a[144:147], v8 offset:45056
    v_cvt_pk_bf16_f32 v87, v70, v71
    v_mfma_f32_16x16x32_bf16 v[76:79], a[152:155], a[248:251], v[76:79]
    v_exp_f32 v73, v73
    v_mfma_f32_16x16x32_bf16 v[76:79], a[156:159], a[252:255], v[76:79]
    v_mfma_f32_16x16x32_bf16 a[76:79], a[176:179], v[108:111], a[76:79]
    v_exp_f32 v74, v74
    v_mfma_f32_16x16x32_bf16 a[92:95], a[180:183], v[108:111], a[92:95]
    ds_read_b64_tr_b16 a[176:177], v16 offset:57344
    v_cvt_pk_bf16_f32 v90, v72, v73
    v_mfma_f32_16x16x32_bf16 a[108:111], a[184:187], v[108:111], a[108:111]
    v_exp_f32 v75, v75
    v_mfma_f32_16x16x32_bf16 a[124:127], a[188:191], v[108:111], a[124:127]
    ds_read_b64_tr_b16 a[178:179], v16 offset:61440
    s_waitcnt lgkmcnt(3)
    v_mfma_f32_16x16x32_bf16 v[64:67], a[128:131], a[192:195], v[112:115]
    v_exp_f32 v76, v76
    v_mfma_f32_16x16x32_bf16 v[64:67], a[132:135], a[196:199], v[64:67]
    ds_read_b128 a[148:151], v9 offset:45056
    v_cvt_pk_bf16_f32 v91, v74, v75
    v_mfma_f32_16x16x32_bf16 v[64:67], a[136:139], a[200:203], v[64:67]
    v_exp_f32 v77, v77
    v_mfma_f32_16x16x32_bf16 v[64:67], a[140:143], a[204:207], v[64:67]
    v_mfma_f32_16x16x32_bf16 a[0:3], a[160:163], v[80:83], a[0:3]
    v_exp_f32 v78, v78
    v_mfma_f32_16x16x32_bf16 a[16:19], a[164:167], v[80:83], a[16:19]
    ds_read_b64_tr_b16 a[180:181], v17 offset:57344
    v_cvt_pk_bf16_f32 v94, v76, v77
    v_mfma_f32_16x16x32_bf16 a[32:35], a[168:171], v[80:83], a[32:35]
    v_exp_f32 v79, v79
    v_mfma_f32_16x16x32_bf16 a[48:51], a[172:175], v[80:83], a[48:51]
    ds_read_b64_tr_b16 a[182:183], v17 offset:61440
    v_mfma_f32_16x16x32_bf16 v[128:131], v[56:59], v[80:83], v[128:131]
    v_xor_b32 v9, 0x10000, v9
    v_xor_b32 v17, 0x10000, v17
    v_xor_b32 v12, 0x10000, v12
    v_xor_b32 v13, 0x10000, v13
    v_mfma_f32_16x16x32_bf16 v[68:71], a[128:131], a[208:211], v[116:119]
    v_exp_f32 v64, v64
    v_mfma_f32_16x16x32_bf16 v[68:71], a[132:135], a[212:215], v[68:71]
    ds_read_b128 a[152:155], v10 offset:45056
    v_cvt_pk_bf16_f32 v95, v78, v79
    v_mfma_f32_16x16x32_bf16 v[68:71], a[136:139], a[216:219], v[68:71]
    v_exp_f32 v65, v65
    v_mfma_f32_16x16x32_bf16 v[68:71], a[140:143], a[220:223], v[68:71]
    v_mfma_f32_16x16x32_bf16 a[4:7], a[160:163], v[84:87], a[4:7]
    v_exp_f32 v66, v66
    v_mfma_f32_16x16x32_bf16 a[20:23], a[164:167], v[84:87], a[20:23]
    ds_read_b64_tr_b16 a[184:185], v18 offset:57344
    v_cvt_pk_bf16_f32 v96, v64, v65
    v_mfma_f32_16x16x32_bf16 a[36:39], a[168:171], v[84:87], a[36:39]
    v_exp_f32 v67, v67
    v_mfma_f32_16x16x32_bf16 a[52:55], a[172:175], v[84:87], a[52:55]
    ds_read_b64_tr_b16 a[186:187], v18 offset:61440
    v_mfma_f32_16x16x32_bf16 v[132:135], v[56:59], v[84:87], v[132:135]
    v_xor_b32 v14, 0x10000, v14
    v_xor_b32 v15, 0x10000, v15
    v_xor_b32 v8, 0x10000, v8
    v_mfma_f32_16x16x32_bf16 v[72:75], a[128:131], a[224:227], v[120:123]
    v_exp_f32 v68, v68
    v_mfma_f32_16x16x32_bf16 v[72:75], a[132:135], a[228:231], v[72:75]
    ds_read_b128 a[156:159], v11 offset:45056
    v_cvt_pk_bf16_f32 v97, v66, v67
    v_mfma_f32_16x16x32_bf16 v[72:75], a[136:139], a[232:235], v[72:75]
    v_exp_f32 v69, v69
    v_mfma_f32_16x16x32_bf16 v[72:75], a[140:143], a[236:239], v[72:75]
    v_mfma_f32_16x16x32_bf16 a[8:11], a[160:163], v[88:91], a[8:11]
    v_exp_f32 v70, v70
    v_mfma_f32_16x16x32_bf16 a[24:27], a[164:167], v[88:91], a[24:27]
    ds_read_b64_tr_b16 a[188:189], v19 offset:57344
    v_cvt_pk_bf16_f32 v100, v68, v69
    v_mfma_f32_16x16x32_bf16 a[40:43], a[168:171], v[88:91], a[40:43]
    v_exp_f32 v71, v71
    v_mfma_f32_16x16x32_bf16 a[56:59], a[172:175], v[88:91], a[56:59]
    ds_read_b64_tr_b16 a[190:191], v19 offset:61440
    s_waitcnt vmcnt(9)
    s_barrier
    s_cmp_lg_u32 s4, 0
    s_cbranch_scc1 L_fs_24
    s_lshl_b32 s3, s2, 7
    s_mov_b64 exec, 1
    v_mov_b32 v2, s62
    v_mov_b32 v3, s63
    v_mov_b32 v1, 65536
    buffer_store_dwordx2 v[2:3], v1, s[44:47], s3 offen sc1
    s_mov_b64 exec, -1
L_fs_24:
    v_mfma_f32_16x16x32_bf16 v[136:139], v[56:59], v[88:91], v[136:139]
    v_xor_b32 v16, 0x10000, v16
    v_xor_b32 v10, 0x10000, v10
    v_xor_b32 v18, 0x10000, v18
    v_mfma_f32_16x16x32_bf16 v[76:79], a[128:131], a[240:243], v[124:127]
    v_exp_f32 v72, v72
    v_mfma_f32_16x16x32_bf16 v[76:79], a[132:135], a[244:247], v[76:79]
    ds_read_b128 a[128:131], v8 offset:0
    v_cvt_pk_bf16_f32 v101, v70, v71
    v_mfma_f32_16x16x32_bf16 v[76:79], a[136:139], a[248:251], v[76:79]
    v_exp_f32 v73, v73
    s_mov_b32 m0, s38
    v_mfma_f32_16x16x32_bf16 v[76:79], a[140:143], a[252:255], v[76:79]
    buffer_load_dwordx4 v20, s[8:11], s29 offen offset:0 lds
    v_mfma_f32_16x16x32_bf16 a[12:15], a[160:163], v[92:95], a[12:15]
    v_exp_f32 v74, v74
    v_mfma_f32_16x16x32_bf16 a[28:31], a[164:167], v[92:95], a[28:31]
    ds_read_b64_tr_b16 a[160:161], v12 offset:16384
    v_cvt_pk_bf16_f32 v104, v72, v73
    v_mfma_f32_16x16x32_bf16 a[44:47], a[168:171], v[92:95], a[44:47]
    v_exp_f32 v75, v75
    v_mfma_f32_16x16x32_bf16 a[60:63], a[172:175], v[92:95], a[60:63]
    ds_read_b64_tr_b16 a[162:163], v12 offset:20480
    s_waitcnt lgkmcnt(3)
    v_mfma_f32_16x16x32_bf16 v[140:143], v[56:59], v[92:95], v[140:143]
    v_xor_b32 v11, 0x10000, v11
    v_xor_b32 v19, 0x10000, v19
    v_mfma_f32_16x16x32_bf16 v[64:67], a[144:147], a[192:195], v[112:115]
    v_exp_f32 v76, v76
    v_mfma_f32_16x16x32_bf16 v[64:67], a[148:151], a[196:199], v[64:67]
    ds_read_b128 a[132:135], v9 offset:0
    v_cvt_pk_bf16_f32 v105, v74, v75
    v_mfma_f32_16x16x32_bf16 v[64:67], a[152:155], a[200:203], v[64:67]
    v_exp_f32 v77, v77
    v_mfma_f32_16x16x32_bf16 v[64:67], a[156:159], a[204:207], v[64:67]
    buffer_load_dwordx4 v21, s[8:11], s29 offen offset:1024 lds
    v_mfma_f32_16x16x32_bf16 a[64:67], a[176:179], v[80:83], a[64:67]
    v_exp_f32 v78, v78
    v_mfma_f32_16x16x32_bf16 a[80:83], a[180:183], v[80:83], a[80:83]
    ds_read_b64_tr_b16 a[164:165], v13 offset:16384
    v_cvt_pk_bf16_f32 v108, v76, v77
    v_mfma_f32_16x16x32_bf16 a[96:99], a[184:187], v[80:83], a[96:99]
    v_exp_f32 v79, v79
    v_mfma_f32_16x16x32_bf16 a[112:115], a[188:191], v[80:83], a[112:115]
    ds_read_b64_tr_b16 a[166:167], v13 offset:20480
    v_mfma_f32_16x16x32_bf16 v[68:71], a[144:147], a[208:211], v[116:119]
    v_exp_f32 v64, v64
    v_mfma_f32_16x16x32_bf16 v[68:71], a[148:151], a[212:215], v[68:71]
    ds_read_b128 a[136:139], v10 offset:0
    v_cvt_pk_bf16_f32 v109, v78, v79
    v_mfma_f32_16x16x32_bf16 v[68:71], a[152:155], a[216:219], v[68:71]
    v_exp_f32 v65, v65
    v_mfma_f32_16x16x32_bf16 v[68:71], a[156:159], a[220:223], v[68:71]
    buffer_load_dwordx4 v22, s[8:11], s29 offen offset:2048 lds
    v_mfma_f32_16x16x32_bf16 a[68:71], a[176:179], v[84:87], a[68:71]
    v_exp_f32 v66, v66
    v_mfma_f32_16x16x32_bf16 a[84:87], a[180:183], v[84:87], a[84:87]
    ds_read_b64_tr_b16 a[168:169], v14 offset:16384
    v_cvt_pk_bf16_f32 v98, v64, v65
    v_mfma_f32_16x16x32_bf16 a[100:103], a[184:187], v[84:87], a[100:103]
    v_exp_f32 v67, v67
    v_mfma_f32_16x16x32_bf16 a[116:119], a[188:191], v[84:87], a[116:119]
    ds_read_b64_tr_b16 a[170:171], v14 offset:20480
    v_mfma_f32_16x16x32_bf16 v[72:75], a[144:147], a[224:227], v[120:123]
    v_exp_f32 v68, v68
    v_mfma_f32_16x16x32_bf16 v[72:75], a[148:151], a[228:231], v[72:75]
    ds_read_b128 a[140:143], v11 offset:0
    v_cvt_pk_bf16_f32 v99, v66, v67
    v_mfma_f32_16x16x32_bf16 v[72:75], a[152:155], a[232:235], v[72:75]
    v_exp_f32 v69, v69
    v_mfma_f32_16x16x32_bf16 v[72:75], a[156:159], a[236:239], v[72:75]
    buffer_load_dwordx4 v23, s[8:11], s29 offen offset:3072 lds
    s_add_u32 s29, s29, 16384
    v_mfma_f32_16x16x32_bf16 a[72:75], a[176:179], v[88:91], a[72:75]
    v_exp_f32 v70, v70
    v_mfma_f32_16x16x32_bf16 a[88:91], a[180:183], v[88:91], a[88:91]
    ds_read_b64_tr_b16 a[172:173], v15 offset:16384
    v_cvt_pk_bf16_f32 v102, v68, v69
    v_mfma_f32_16x16x32_bf16 a[104:107], a[184:187], v[88:91], a[104:107]
    v_exp_f32 v71, v71
    v_mfma_f32_16x16x32_bf16 a[120:123], a[188:191], v[88:91], a[120:123]
    ds_read_b64_tr_b16 a[174:175], v15 offset:20480
    v_mfma_f32_16x16x32_bf16 v[76:79], a[144:147], a[240:243], v[124:127]
    v_exp_f32 v72, v72
    v_mfma_f32_16x16x32_bf16 v[76:79], a[148:151], a[244:247], v[76:79]
    ds_read_b128 a[144:147], v8 offset:4096
    v_cvt_pk_bf16_f32 v103, v70, v71
    v_mfma_f32_16x16x32_bf16 v[76:79], a[152:155], a[248:251], v[76:79]
    v_exp_f32 v73, v73
    s_add_u32 m0, s38, 16384
    v_mfma_f32_16x16x32_bf16 v[76:79], a[156:159], a[252:255], v[76:79]
    buffer_load_dwordx4 v24, s[12:15], s30 offen offset:0 lds
    v_mfma_f32_16x16x32_bf16 a[76:79], a[176:179], v[92:95], a[76:79]
    v_exp_f32 v74, v74
    v_mfma_f32_16x16x32_bf16 a[92:95], a[180:183], v[92:95], a[92:95]
    ds_read_b64_tr_b16 a[176:177], v16 offset:16384
    v_cvt_pk_bf16_f32 v106, v72, v73
    v_mfma_f32_16x16x32_bf16 a[108:111], a[184:187], v[92:95], a[108:111]
    v_exp_f32 v75, v75
    v_mfma_f32_16x16x32_bf16 a[124:127], a[188:191], v[92:95], a[124:127]
    ds_read_b64_tr_b16 a[178:179], v16 offset:20480
    s_waitcnt lgkmcnt(3)
    s_mov_b32 s33, 15
.p2align 4
L_loop_21:
    v_mfma_f32_16x16x32_bf16 v[64:67], a[128:131], a[192:195], v[112:115]
    v_exp_f32 v76, v76
    v_mfma_f32_16x16x32_bf16 v[64:67], a[132:135], a[196:199], v[64:67]
    ds_read_b128 a[148:151], v9 offset:4096
    v_cvt_pk_bf16_f32 v107, v74, v75
    v_mfma_f32_16x16x32_bf16 v[64:67], a[136:139], a[200:203], v[64:67]
    v_exp_f32 v77, v77
    v_mfma_f32_16x16x32_bf16 v[64:67], a[140:143], a[204:207], v[64:67]
    buffer_load_dwordx4 v25, s[12:15], s30 offen offset:1024 lds
    v_mfma_f32_16x16x32_bf16 a[0:3], a[160:163], v[96:99], a[0:3]
    v_exp_f32 v78, v78
    v_mfma_f32_16x16x32_bf16 a[16:19], a[164:167], v[96:99], a[16:19]
    ds_read_b64_tr_b16 a[180:181], v17 offset:16384
    v_cvt_pk_bf16_f32 v110, v76, v77
    v_mfma_f32_16x16x32_bf16 a[32:35], a[168:171], v[96:99], a[32:35]
    v_exp_f32 v79, v79
    v_mfma_f32_16x16x32_bf16 a[48:51], a[172:175], v[96:99], a[48:51]
    ds_read_b64_tr_b16 a[182:183], v17 offset:20480
    v_mfma_f32_16x16x32_bf16 v[128:131], v[56:59], v[96:99], v[128:131]
    v_mfma_f32_16x16x32_bf16 v[68:71], a[128:131], a[208:211], v[116:119]
    v_exp_f32 v64, v64
    v_mfma_f32_16x16x32_bf16 v[68:71], a[132:135], a[212:215], v[68:71]
    ds_read_b128 a[152:155], v10 offset:4096
    v_cvt_pk_bf16_f32 v111, v78, v79
    v_mfma_f32_16x16x32_bf16 v[68:71], a[136:139], a[216:219], v[68:71]
    v_exp_f32 v65, v65
    v_mfma_f32_16x16x32_bf16 v[68:71], a[140:143], a[220:223], v[68:71]
    buffer_load_dwordx4 v24, s[12:15], s30 offen offset:2048 lds
    v_mfma_f32_16x16x32_bf16 a[4:7], a[160:163], v[100:103], a[4:7]
    v_exp_f32 v66, v66
    v_mfma_f32_16x16x32_bf16 a[20:23], a[164:167], v[100:103], a[20:23]
    ds_read_b64_tr_b16 a[184:185], v18 offset:16384
    v_cvt_pk_bf16_f32 v80, v64, v65
    v_mfma_f32_16x16x32_bf16 a[36:39], a[168:171], v[100:103], a[36:39]
    v_exp_f32 v67, v67
    v_mfma_f32_16x16x32_bf16 a[52:55], a[172:175], v[100:103], a[52:55]
    ds_read_b64_tr_b16 a[186:187], v18 offset:20480
    v_mfma_f32_16x16x32_bf16 v[132:135], v[56:59], v[100:103], v[132:135]
    v_mfma_f32_16x16x32_bf16 v[72:75], a[128:131], a[224:227], v[120:123]
    v_exp_f32 v68, v68
    v_mfma_f32_16x16x32_bf16 v[72:75], a[132:135], a[228:231], v[72:75]
    ds_read_b128 a[156:159], v11 offset:4096
    v_cvt_pk_bf16_f32 v81, v66, v67
    v_mfma_f32_16x16x32_bf16 v[72:75], a[136:139], a[232:235], v[72:75]
    v_exp_f32 v69, v69
    v_mfma_f32_16x16x32_bf16 v[72:75], a[140:143], a[236:239], v[72:75]
    buffer_load_dwordx4 v25, s[12:15], s30 offen offset:3072 lds
    s_add_u32 s30, s30, 16384
    v_mfma_f32_16x16x32_bf16 a[8:11], a[160:163], v[104:107], a[8:11]
    v_exp_f32 v70, v70
    v_mfma_f32_16x16x32_bf16 a[24:27], a[164:167], v[104:107], a[24:27]
    ds_read_b64_tr_b16 a[188:189], v19 offset:16384
    v_cvt_pk_bf16_f32 v84, v68, v69
    v_mfma_f32_16x16x32_bf16 a[40:43], a[168:171], v[104:107], a[40:43]
    v_exp_f32 v71, v71
    v_mfma_f32_16x16x32_bf16 a[56:59], a[172:175], v[104:107], a[56:59]
    ds_read_b64_tr_b16 a[190:191], v19 offset:20480
    v_mfma_f32_16x16x32_bf16 v[136:139], v[56:59], v[104:107], v[136:139]
    s_xor_b32 s38, s38, 0x10000
    v_mfma_f32_16x16x32_bf16 v[76:79], a[128:131], a[240:243], v[124:127]
    v_exp_f32 v72, v72
    v_mfma_f32_16x16x32_bf16 v[76:79], a[132:135], a[244:247], v[76:79]
    ds_read_b128 a[128:131], v8 offset:8192
    v_cvt_pk_bf16_f32 v85, v70, v71
    v_mfma_f32_16x16x32_bf16 v[76:79], a[136:139], a[248:251], v[76:79]
    v_exp_f32 v73, v73
    v_mfma_f32_16x16x32_bf16 v[76:79], a[140:143], a[252:255], v[76:79]
    v_mfma_f32_16x16x32_bf16 a[12:15], a[160:163], v[108:111], a[12:15]
    v_exp_f32 v74, v74
    v_mfma_f32_16x16x32_bf16 a[28:31], a[164:167], v[108:111], a[28:31]
    ds_read_b64_tr_b16 a[160:161], v12 offset:24576
    v_cvt_pk_bf16_f32 v88, v72, v73
    v_mfma_f32_16x16x32_bf16 a[44:47], a[168:171], v[108:111], a[44:47]
    v_exp_f32 v75, v75
    v_mfma_f32_16x16x32_bf16 a[60:63], a[172:175], v[108:111], a[60:63]
    ds_read_b64_tr_b16 a[162:163], v12 offset:28672
    s_waitcnt lgkmcnt(3)
    v_mfma_f32_16x16x32_bf16 v[140:143], v[56:59], v[108:111], v[140:143]
    v_mfma_f32_16x16x32_bf16 v[64:67], a[144:147], a[192:195], v[112:115]
    v_exp_f32 v76, v76
    v_mfma_f32_16x16x32_bf16 v[64:67], a[148:151], a[196:199], v[64:67]
    ds_read_b128 a[132:135], v9 offset:8192
    v_cvt_pk_bf16_f32 v89, v74, v75
    v_mfma_f32_16x16x32_bf16 v[64:67], a[152:155], a[200:203], v[64:67]
    v_exp_f32 v77, v77
    v_mfma_f32_16x16x32_bf16 v[64:67], a[156:159], a[204:207], v[64:67]
    buffer_load_dwordx4 v[180:183], v176, s[16:19], s41 offen
    s_add_u32 s41, s41, 4096
    v_mfma_f32_16x16x32_bf16 a[64:67], a[176:179], v[96:99], a[64:67]
    v_exp_f32 v78, v78
    v_mfma_f32_16x16x32_bf16 a[80:83], a[180:183], v[96:99], a[80:83]
    ds_read_b64_tr_b16 a[164:165], v13 offset:24576
    v_cvt_pk_bf16_f32 v92, v76, v77
    v_mfma_f32_16x16x32_bf16 a[96:99], a[184:187], v[96:99], a[96:99]
    v_exp_f32 v79, v79
    v_mfma_f32_16x16x32_bf16 a[112:115], a[188:191], v[96:99], a[112:115]
    ds_read_b64_tr_b16 a[166:167], v13 offset:28672
    v_mfma_f32_16x16x32_bf16 v[68:71], a[144:147], a[208:211], v[116:119]
    v_exp_f32 v64, v64
    v_mfma_f32_16x16x32_bf16 v[68:71], a[148:151], a[212:215], v[68:71]
    ds_read_b128 a[136:139], v10 offset:8192
    v_cvt_pk_bf16_f32 v93, v78, v79
    v_mfma_f32_16x16x32_bf16 v[68:71], a[152:155], a[216:219], v[68:71]
    v_exp_f32 v65, v65
    v_mfma_f32_16x16x32_bf16 v[68:71], a[156:159], a[220:223], v[68:71]
    v_mfma_f32_16x16x32_bf16 a[68:71], a[176:179], v[100:103], a[68:71]
    v_exp_f32 v66, v66
    v_mfma_f32_16x16x32_bf16 a[84:87], a[180:183], v[100:103], a[84:87]
    ds_read_b64_tr_b16 a[168:169], v14 offset:24576
    v_cvt_pk_bf16_f32 v82, v64, v65
    v_mfma_f32_16x16x32_bf16 a[100:103], a[184:187], v[100:103], a[100:103]
    v_exp_f32 v67, v67
    v_mfma_f32_16x16x32_bf16 a[116:119], a[188:191], v[100:103], a[116:119]
    ds_read_b64_tr_b16 a[170:171], v14 offset:28672
    v_mfma_f32_16x16x32_bf16 v[72:75], a[144:147], a[224:227], v[120:123]
    v_exp_f32 v68, v68
    v_mfma_f32_16x16x32_bf16 v[72:75], a[148:151], a[228:231], v[72:75]
    ds_read_b128 a[140:143], v11 offset:8192
    v_cvt_pk_bf16_f32 v83, v66, v67
    v_mfma_f32_16x16x32_bf16 v[72:75], a[152:155], a[232:235], v[72:75]
    v_exp_f32 v69, v69
    v_mfma_f32_16x16x32_bf16 v[72:75], a[156:159], a[236:239], v[72:75]
    v_mfma_f32_16x16x32_bf16 a[72:75], a[176:179], v[104:107], a[72:75]
    v_exp_f32 v70, v70
    v_mfma_f32_16x16x32_bf16 a[88:91], a[180:183], v[104:107], a[88:91]
    ds_read_b64_tr_b16 a[172:173], v15 offset:24576
    v_cvt_pk_bf16_f32 v86, v68, v69
    v_mfma_f32_16x16x32_bf16 a[104:107], a[184:187], v[104:107], a[104:107]
    v_exp_f32 v71, v71
    v_mfma_f32_16x16x32_bf16 a[120:123], a[188:191], v[104:107], a[120:123]
    ds_read_b64_tr_b16 a[174:175], v15 offset:28672
    v_mfma_f32_16x16x32_bf16 v[76:79], a[144:147], a[240:243], v[124:127]
    v_exp_f32 v72, v72
    v_mfma_f32_16x16x32_bf16 v[76:79], a[148:151], a[244:247], v[76:79]
    ds_read_b128 a[144:147], v8 offset:12288
    v_cvt_pk_bf16_f32 v87, v70, v71
    v_mfma_f32_16x16x32_bf16 v[76:79], a[152:155], a[248:251], v[76:79]
    v_exp_f32 v73, v73
    v_mfma_f32_16x16x32_bf16 v[76:79], a[156:159], a[252:255], v[76:79]
    v_mfma_f32_16x16x32_bf16 a[76:79], a[176:179], v[108:111], a[76:79]
    v_exp_f32 v74, v74
    v_mfma_f32_16x16x32_bf16 a[92:95], a[180:183], v[108:111], a[92:95]
    ds_read_b64_tr_b16 a[176:177], v16 offset:24576
    v_cvt_pk_bf16_f32 v90, v72, v73
    v_mfma_f32_16x16x32_bf16 a[108:111], a[184:187], v[108:111], a[108:111]
    v_exp_f32 v75, v75
    v_mfma_f32_16x16x32_bf16 a[124:127], a[188:191], v[108:111], a[124:127]
    ds_read_b64_tr_b16 a[178:179], v16 offset:28672
    s_waitcnt lgkmcnt(3)
    v_mfma_f32_16x16x32_bf16 v[64:67], a[128:131], a[192:195], v[112:115]
    v_exp_f32 v76, v76
    v_mfma_f32_16x16x32_bf16 v[64:67], a[132:135], a[196:199], v[64:67]
    ds_read_b128 a[148:151], v9 offset:12288
    v_cvt_pk_bf16_f32 v91, v74, v75
    v_mfma_f32_16x16x32_bf16 v[64:67], a[136:139], a[200:203], v[64:67]
    v_exp_f32 v77, v77
    v_mfma_f32_16x16x32_bf16 v[64:67], a[140:143], a[204:207], v[64:67]
    v_mfma_f32_16x16x32_bf16 a[0:3], a[160:163], v[80:83], a[0:3]
    v_exp_f32 v78, v78
    v_mfma_f32_16x16x32_bf16 a[16:19], a[164:167], v[80:83], a[16:19]
    ds_read_b64_tr_b16 a[180:181], v17 offset:24576
    v_cvt_pk_bf16_f32 v94, v76, v77
    v_mfma_f32_16x16x32_bf16 a[32:35], a[168:171], v[80:83], a[32:35]
    v_exp_f32 v79, v79
    v_mfma_f32_16x16x32_bf16 a[48:51], a[172:175], v[80:83], a[48:51]
    ds_read_b64_tr_b16 a[182:183], v17 offset:28672
    v_mfma_f32_16x16x32_bf16 v[128:131], v[56:59], v[80:83], v[128:131]
    v_mfma_f32_16x16x32_bf16 v[68:71], a[128:131], a[208:211], v[116:119]
    v_exp_f32 v64, v64
    v_mfma_f32_16x16x32_bf16 v[68:71], a[132:135], a[212:215], v[68:71]
    ds_read_b128 a[152:155], v10 offset:12288
    v_cvt_pk_bf16_f32 v95, v78, v79
    v_mfma_f32_16x16x32_bf16 v[68:71], a[136:139], a[216:219], v[68:71]
    v_exp_f32 v65, v65
    v_mfma_f32_16x16x32_bf16 v[68:71], a[140:143], a[220:223], v[68:71]
    v_mfma_f32_16x16x32_bf16 a[4:7], a[160:163], v[84:87], a[4:7]
    v_exp_f32 v66, v66
    v_mfma_f32_16x16x32_bf16 a[20:23], a[164:167], v[84:87], a[20:23]
    ds_read_b64_tr_b16 a[184:185], v18 offset:24576
    v_cvt_pk_bf16_f32 v96, v64, v65
    v_mfma_f32_16x16x32_bf16 a[36:39], a[168:171], v[84:87], a[36:39]
    v_exp_f32 v67, v67
    v_mfma_f32_16x16x32_bf16 a[52:55], a[172:175], v[84:87], a[52:55]
    ds_read_b64_tr_b16 a[186:187], v18 offset:28672
    v_mfma_f32_16x16x32_bf16 v[132:135], v[56:59], v[84:87], v[132:135]
    v_mfma_f32_16x16x32_bf16 v[72:75], a[128:131], a[224:227], v[120:123]
    v_exp_f32 v68, v68
    v_mfma_f32_16x16x32_bf16 v[72:75], a[132:135], a[228:231], v[72:75]
    ds_read_b128 a[156:159], v11 offset:12288
    v_cvt_pk_bf16_f32 v97, v66, v67
    v_mfma_f32_16x16x32_bf16 v[72:75], a[136:139], a[232:235], v[72:75]
    v_exp_f32 v69, v69
    v_mfma_f32_16x16x32_bf16 v[72:75], a[140:143], a[236:239], v[72:75]
    v_mfma_f32_16x16x32_bf16 a[8:11], a[160:163], v[88:91], a[8:11]
    v_exp_f32 v70, v70
    v_mfma_f32_16x16x32_bf16 a[24:27], a[164:167], v[88:91], a[24:27]
    ds_read_b64_tr_b16 a[188:189], v19 offset:24576
    v_cvt_pk_bf16_f32 v100, v68, v69
    v_mfma_f32_16x16x32_bf16 a[40:43], a[168:171], v[88:91], a[40:43]
    v_exp_f32 v71, v71
    v_mfma_f32_16x16x32_bf16 a[56:59], a[172:175], v[88:91], a[56:59]
    ds_read_b64_tr_b16 a[190:191], v19 offset:28672
    s_waitcnt vmcnt(9)
    s_barrier
    v_mfma_f32_16x16x32_bf16 v[136:139], v[56:59], v[88:91], v[136:139]
    v_mfma_f32_16x16x32_bf16 v[76:79], a[128:131], a[240:243], v[124:127]
    v_exp_f32 v72, v72
    v_mfma_f32_16x16x32_bf16 v[76:79], a[132:135], a[244:247], v[76:79]
    ds_read_b128 a[128:131], v8 offset:32768
    v_cvt_pk_bf16_f32 v101, v70, v71
    v_mfma_f32_16x16x32_bf16 v[76:79], a[136:139], a[248:251], v[76:79]
    v_exp_f32 v73, v73
    s_mov_b32 m0, s37
    v_mfma_f32_16x16x32_bf16 v[76:79], a[140:143], a[252:255], v[76:79]
    buffer_load_dwordx4 v20, s[8:11], s29 offen offset:0 lds
    v_mfma_f32_16x16x32_bf16 a[12:15], a[160:163], v[92:95], a[12:15]
    v_exp_f32 v74, v74
    v_mfma_f32_16x16x32_bf16 a[28:31], a[164:167], v[92:95], a[28:31]
    ds_read_b64_tr_b16 a[160:161], v12 offset:49152
    v_cvt_pk_bf16_f32 v104, v72, v73
    v_mfma_f32_16x16x32_bf16 a[44:47], a[168:171], v[92:95], a[44:47]
    v_exp_f32 v75, v75
    v_mfma_f32_16x16x32_bf16 a[60:63], a[172:175], v[92:95], a[60:63]
    ds_read_b64_tr_b16 a[162:163], v12 offset:53248
    s_waitcnt lgkmcnt(3)
    v_mfma_f32_16x16x32_bf16 v[140:143], v[56:59], v[92:95], v[140:143]
    v_mfma_f32_16x16x32_bf16 v[64:67], a[144:147], a[192:195], v[112:115]
    v_exp_f32 v76, v76
    v_mfma_f32_16x16x32_bf16 v[64:67], a[148:151], a[196:199], v[64:67]
    ds_read_b128 a[132:135], v9 offset:32768
    v_cvt_pk_bf16_f32 v105, v74, v75
    v_mfma_f32_16x16x32_bf16 v[64:67], a[152:155], a[200:203], v[64:67]
    v_exp_f32 v77, v77
    v_mfma_f32_16x16x32_bf16 v[64:67], a[156:159], a[204:207], v[64:67]
    buffer_load_dwordx4 v21, s[8:11], s29 offen offset:1024 lds
    v_mfma_f32_16x16x32_bf16 a[64:67], a[176:179], v[80:83], a[64:67]
    v_exp_f32 v78, v78
    v_mfma_f32_16x16x32_bf16 a[80:83], a[180:183], v[80:83], a[80:83]
    ds_read_b64_tr_b16 a[164:165], v13 offset:49152
    v_cvt_pk_bf16_f32 v108, v76, v77
    v_mfma_f32_16x16x32_bf16 a[96:99], a[184:187], v[80:83], a[96:99]
    v_exp_f32 v79, v79
    v_mfma_f32_16x16x32_bf16 a[112:115], a[188:191], v[80:83], a[112:115]
    ds_read_b64_tr_b16 a[166:167], v13 offset:53248
    v_mfma_f32_16x16x32_bf16 v[68:71], a[144:147], a[208:211], v[116:119]
    v_exp_f32 v64, v64
    v_mfma_f32_16x16x32_bf16 v[68:71], a[148:151], a[212:215], v[68:71]
    ds_read_b128 a[136:139], v10 offset:32768
    v_cvt_pk_bf16_f32 v109, v78, v79
    v_mfma_f32_16x16x32_bf16 v[68:71], a[152:155], a[216:219], v[68:71]
    v_exp_f32 v65, v65
    v_mfma_f32_16x16x32_bf16 v[68:71], a[156:159], a[220:223], v[68:71]
    buffer_load_dwordx4 v22, s[8:11], s29 offen offset:2048 lds
    v_mfma_f32_16x16x32_bf16 a[68:71], a[176:179], v[84:87], a[68:71]
    v_exp_f32 v66, v66
    v_mfma_f32_16x16x32_bf16 a[84:87], a[180:183], v[84:87], a[84:87]
    ds_read_b64_tr_b16 a[168:169], v14 offset:49152
    v_cvt_pk_bf16_f32 v98, v64, v65
    v_mfma_f32_16x16x32_bf16 a[100:103], a[184:187], v[84:87], a[100:103]
    v_exp_f32 v67, v67
    v_mfma_f32_16x16x32_bf16 a[116:119], a[188:191], v[84:87], a[116:119]
    ds_read_b64_tr_b16 a[170:171], v14 offset:53248
    v_mfma_f32_16x16x32_bf16 v[72:75], a[144:147], a[224:227], v[120:123]
    v_exp_f32 v68, v68
    v_mfma_f32_16x16x32_bf16 v[72:75], a[148:151], a[228:231], v[72:75]
    ds_read_b128 a[140:143], v11 offset:32768
    v_cvt_pk_bf16_f32 v99, v66, v67
    v_mfma_f32_16x16x32_bf16 v[72:75], a[152:155], a[232:235], v[72:75]
    v_exp_f32 v69, v69
    v_mfma_f32_16x16x32_bf16 v[72:75], a[156:159], a[236:239], v[72:75]
    buffer_load_dwordx4 v23, s[8:11], s29 offen offset:3072 lds
    s_add_u32 s29, s29, 16384
    v_mfma_f32_16x16x32_bf16 a[72:75], a[176:179], v[88:91], a[72:75]
    v_exp_f32 v70, v70
    v_mfma_f32_16x16x32_bf16 a[88:91], a[180:183], v[88:91], a[88:91]
    ds_read_b64_tr_b16 a[172:173], v15 offset:49152
    v_cvt_pk_bf16_f32 v102, v68, v69
    v_mfma_f32_16x16x32_bf16 a[104:107], a[184:187], v[88:91], a[104:107]
    v_exp_f32 v71, v71
    v_mfma_f32_16x16x32_bf16 a[120:123], a[188:191], v[88:91], a[120:123]
    ds_read_b64_tr_b16 a[174:175], v15 offset:53248
    v_mfma_f32_16x16x32_bf16 v[76:79], a[144:147], a[240:243], v[124:127]
    v_exp_f32 v72, v72
    v_mfma_f32_16x16x32_bf16 v[76:79], a[148:151], a[244:247], v[76:79]
    ds_read_b128 a[144:147], v8 offset:36864
    v_cvt_pk_bf16_f32 v103, v70, v71
    v_mfma_f32_16x16x32_bf16 v[76:79], a[152:155], a[248:251], v[76:79]
    v_exp_f32 v73, v73
    s_add_u32 m0, s37, 16384
    v_mfma_f32_16x16x32_bf16 v[76:79], a[156:159], a[252:255], v[76:79]
    buffer_load_dwordx4 v24, s[12:15], s30 offen offset:0 lds
    v_mfma_f32_16x16x32_bf16 a[76:79], a[176:179], v[92:95], a[76:79]
    v_exp_f32 v74, v74
    v_mfma_f32_16x16x32_bf16 a[92:95], a[180:183], v[92:95], a[92:95]
    ds_read_b64_tr_b16 a[176:177], v16 offset:49152
    v_cvt_pk_bf16_f32 v106, v72, v73
    v_mfma_f32_16x16x32_bf16 a[108:111], a[184:187], v[92:95], a[108:111]
    v_exp_f32 v75, v75
    v_mfma_f32_16x16x32_bf16 a[124:127], a[188:191], v[92:95], a[124:127]
    ds_read_b64_tr_b16 a[178:179], v16 offset:53248
    s_waitcnt lgkmcnt(3)
    v_mfma_f32_16x16x32_bf16 v[64:67], a[128:131], a[192:195], v[112:115]
    v_exp_f32 v76, v76
    v_mfma_f32_16x16x32_bf16 v[64:67], a[132:135], a[196:199], v[64:67]
    ds_read_b128 a[148:151], v9 offset:36864
    v_cvt_pk_bf16_f32 v107, v74, v75
    v_mfma_f32_16x16x32_bf16 v[64:67], a[136:139], a[200:203], v[64:67]
    v_exp_f32 v77, v77
    v_mfma_f32_16x16x32_bf16 v[64:67], a[140:143], a[204:207], v[64:67]
    buffer_load_dwordx4 v25, s[12:15], s30 offen offset:1024 lds
    v_mfma_f32_16x16x32_bf16 a[0:3], a[160:163], v[96:99], a[0:3]
    v_exp_f32 v78, v78
    v_mfma_f32_16x16x32_bf16 a[16:19], a[164:167], v[96:99], a[16:19]
    ds_read_b64_tr_b16 a[180:181], v17 offset:49152
    v_cvt_pk_bf16_f32 v110, v76, v77
    v_mfma_f32_16x16x32_bf16 a[32:35], a[168:171], v[96:99], a[32:35]
    v_exp_f32 v79, v79
    v_mfma_f32_16x16x32_bf16 a[48:51], a[172:175], v[96:99], a[48:51]
    ds_read_b64_tr_b16 a[182:183], v17 offset:53248
    v_mfma_f32_16x16x32_bf16 v[128:131], v[56:59], v[96:99], v[128:131]
    v_mfma_f32_16x16x32_bf16 v[68:71], a[128:131], a[208:211], v[116:119]
    v_exp_f32 v64, v64
    v_mfma_f32_16x16x32_bf16 v[68:71], a[132:135], a[212:215], v[68:71]
    ds_read_b128 a[152:155], v10 offset:36864
    v_cvt_pk_bf16_f32 v111, v78, v79
    v_mfma_f32_16x16x32_bf16 v[68:71], a[136:139], a[216:219], v[68:71]
    v_exp_f32 v65, v65
    v_mfma_f32_16x16x32_bf16 v[68:71], a[140:143], a[220:223], v[68:71]
    buffer_load_dwordx4 v24, s[12:15], s30 offen offset:2048 lds
    v_mfma_f32_16x16x32_bf16 a[4:7], a[160:163], v[100:103], a[4:7]
    v_exp_f32 v66, v66
    v_mfma_f32_16x16x32_bf16 a[20:23], a[164:167], v[100:103], a[20:23]
    ds_read_b64_tr_b16 a[184:185], v18 offset:49152
    v_cvt_pk_bf16_f32 v80, v64, v65
    v_mfma_f32_16x16x32_bf16 a[36:39], a[168:171], v[100:103], a[36:39]
    v_exp_f32 v67, v67
    v_mfma_f32_16x16x32_bf16 a[52:55], a[172:175], v[100:103], a[52:55]
    ds_read_b64_tr_b16 a[186:187], v18 offset:53248
    v_mfma_f32_16x16x32_bf16 v[132:135], v[56:59], v[100:103], v[132:135]
    v_mfma_f32_16x16x32_bf16 v[72:75], a[128:131], a[224:227], v[120:123]
    v_exp_f32 v68, v68
    v_mfma_f32_16x16x32_bf16 v[72:75], a[132:135], a[228:231], v[72:75]
    ds_read_b128 a[156:159], v11 offset:36864
    v_cvt_pk_bf16_f32 v81, v66, v67
    v_mfma_f32_16x16x32_bf16 v[72:75], a[136:139], a[232:235], v[72:75]
    v_exp_f32 v69, v69
    v_mfma_f32_16x16x32_bf16 v[72:75], a[140:143], a[236:239], v[72:75]
    buffer_load_dwordx4 v25, s[12:15], s30 offen offset:3072 lds
    s_add_u32 s30, s30, 16384
    v_mfma_f32_16x16x32_bf16 a[8:11], a[160:163], v[104:107], a[8:11]
    v_exp_f32 v70, v70
    v_mfma_f32_16x16x32_bf16 a[24:27], a[164:167], v[104:107], a[24:27]
    ds_read_b64_tr_b16 a[188:189], v19 offset:49152
    v_cvt_pk_bf16_f32 v84, v68, v69
    v_mfma_f32_16x16x32_bf16 a[40:43], a[168:171], v[104:107], a[40:43]
    v_exp_f32 v71, v71
    v_mfma_f32_16x16x32_bf16 a[56:59], a[172:175], v[104:107], a[56:59]
    ds_read_b64_tr_b16 a[190:191], v19 offset:53248
    v_mfma_f32_16x16x32_bf16 v[136:139], v[56:59], v[104:107], v[136:139]
    s_xor_b32 s37, s37, 0x10000
    v_mfma_f32_16x16x32_bf16 v[76:79], a[128:131], a[240:243], v[124:127]
    v_exp_f32 v72, v72
    v_mfma_f32_16x16x32_bf16 v[76:79], a[132:135], a[244:247], v[76:79]
    ds_read_b128 a[128:131], v8 offset:40960
    v_cvt_pk_bf16_f32 v85, v70, v71
    v_mfma_f32_16x16x32_bf16 v[76:79], a[136:139], a[248:251], v[76:79]
    v_exp_f32 v73, v73
    v_mfma_f32_16x16x32_bf16 v[76:79], a[140:143], a[252:255], v[76:79]
    v_mfma_f32_16x16x32_bf16 a[12:15], a[160:163], v[108:111], a[12:15]
    v_exp_f32 v74, v74
    v_mfma_f32_16x16x32_bf16 a[28:31], a[164:167], v[108:111], a[28:31]
    ds_read_b64_tr_b16 a[160:161], v12 offset:57344
    v_cvt_pk_bf16_f32 v88, v72, v73
    v_mfma_f32_16x16x32_bf16 a[44:47], a[168:171], v[108:111], a[44:47]
    v_exp_f32 v75, v75
    v_mfma_f32_16x16x32_bf16 a[60:63], a[172:175], v[108:111], a[60:63]
    ds_read_b64_tr_b16 a[162:163], v12 offset:61440
    s_waitcnt lgkmcnt(3)
    v_mfma_f32_16x16x32_bf16 v[140:143], v[56:59], v[108:111], v[140:143]
    v_mfma_f32_16x16x32_bf16 v[64:67], a[144:147], a[192:195], v[112:115]
    v_exp_f32 v76, v76
    v_mfma_f32_16x16x32_bf16 v[64:67], a[148:151], a[196:199], v[64:67]
    ds_read_b128 a[132:135], v9 offset:40960
    v_cvt_pk_bf16_f32 v89, v74, v75
    v_mfma_f32_16x16x32_bf16 v[64:67], a[152:155], a[200:203], v[64:67]
    v_exp_f32 v77, v77
    v_mfma_f32_16x16x32_bf16 v[64:67], a[156:159], a[204:207], v[64:67]
    buffer_load_dwordx4 v[180:183], v176, s[16:19], s41 offen
    s_add_u32 s41, s41, 4096
    v_mfma_f32_16x16x32_bf16 a[64:67], a[176:179], v[96:99], a[64:67]
    v_exp_f32 v78, v78
    v_mfma_f32_16x16x32_bf16 a[80:83], a[180:183], v[96:99], a[80:83]
    ds_read_b64_tr_b16 a[164:165], v13 offset:57344
    v_cvt_pk_bf16_f32 v92, v76, v77
    v_mfma_f32_16x16x32_bf16 a[96:99], a[184:187], v[96:99], a[96:99]
    v_exp_f32 v79, v79
    v_mfma_f32_16x16x32_bf16 a[112:115], a[188:191], v[96:99], a[112:115]
    ds_read_b64_tr_b16 a[166:167], v13 offset:61440
    v_mfma_f32_16x16x32_bf16 v[68:71], a[144:147], a[208:211], v[116:119]
    v_exp_f32 v64, v64
    v_mfma_f32_16x16x32_bf16 v[68:71], a[148:151], a[212:215], v[68:71]
    ds_read_b128 a[136:139], v10 offset:40960
    v_cvt_pk_bf16_f32 v93, v78, v79
    v_mfma_f32_16x16x32_bf16 v[68:71], a[152:155], a[216:219], v[68:71]
    v_exp_f32 v65, v65
    v_mfma_f32_16x16x32_bf16 v[68:71], a[156:159], a[220:223], v[68:71]
    v_mfma_f32_16x16x32_bf16 a[68:71], a[176:179], v[100:103], a[68:71]
    v_exp_f32 v66, v66
    v_mfma_f32_16x16x32_bf16 a[84:87], a[180:183], v[100:103], a[84:87]
    ds_read_b64_tr_b16 a[168:169], v14 offset:57344
    v_cvt_pk_bf16_f32 v82, v64, v65
    v_mfma_f32_16x16x32_bf16 a[100:103], a[184:187], v[100:103], a[100:103]
    v_exp_f32 v67, v67
    v_mfma_f32_16x16x32_bf16 a[116:119], a[188:191], v[100:103], a[116:119]
    ds_read_b64_tr_b16 a[170:171], v14 offset:61440
    v_mfma_f32_16x16x32_bf16 v[72:75], a[144:147], a[224:227], v[120:123]
    v_exp_f32 v68, v68
    v_mfma_f32_16x16x32_bf16 v[72:75], a[148:151], a[228:231], v[72:75]
    ds_read_b128 a[140:143], v11 offset:40960
    v_cvt_pk_bf16_f32 v83, v66, v67
    v_mfma_f32_16x16x32_bf16 v[72:75], a[152:155], a[232:235], v[72:75]
    v_exp_f32 v69, v69
    v_mfma_f32_16x16x32_bf16 v[72:75], a[156:159], a[236:239], v[72:75]
    v_mfma_f32_16x16x32_bf16 a[72:75], a[176:179], v[104:107], a[72:75]
    v_exp_f32 v70, v70
    v_mfma_f32_16x16x32_bf16 a[88:91], a[180:183], v[104:107], a[88:91]
    ds_read_b64_tr_b16 a[172:173], v15 offset:57344
    v_cvt_pk_bf16_f32 v86, v68, v69
    v_mfma_f32_16x16x32_bf16 a[104:107], a[184:187], v[104:107], a[104:107]
    v_exp_f32 v71, v71
    v_mfma_f32_16x16x32_bf16 a[120:123], a[188:191], v[104:107], a[120:123]
    ds_read_b64_tr_b16 a[174:175], v15 offset:61440
    v_mfma_f32_16x16x32_bf16 v[76:79], a[144:147], a[240:243], v[124:127]
    v_exp_f32 v72, v72
    v_mfma_f32_16x16x32_bf16 v[76:79], a[148:151], a[244:247], v[76:79]
    ds_read_b128 a[144:147], v8 offset:45056
    v_cvt_pk_bf16_f32 v87, v70, v71
    v_mfma_f32_16x16x32_bf16 v[76:79], a[152:155], a[248:251], v[76:79]
    v_exp_f32 v73, v73
    v_mfma_f32_16x16x32_bf16 v[76:79], a[156:159], a[252:255], v[76:79]
    v_mfma_f32_16x16x32_bf16 a[76:79], a[176:179], v[108:111], a[76:79]
    v_exp_f32 v74, v74
    v_mfma_f32_16x16x32_bf16 a[92:95], a[180:183], v[108:111], a[92:95]
    ds_read_b64_tr_b16 a[176:177], v16 offset:57344
    v_cvt_pk_bf16_f32 v90, v72, v73
    v_mfma_f32_16x16x32_bf16 a[108:111], a[184:187], v[108:111], a[108:111]
    v_exp_f32 v75, v75
    v_mfma_f32_16x16x32_bf16 a[124:127], a[188:191], v[108:111], a[124:127]
    ds_read_b64_tr_b16 a[178:179], v16 offset:61440
    s_waitcnt lgkmcnt(3)
    v_mfma_f32_16x16x32_bf16 v[64:67], a[128:131], a[192:195], v[112:115]
    v_exp_f32 v76, v76
    v_mfma_f32_16x16x32_bf16 v[64:67], a[132:135], a[196:199], v[64:67]
    ds_read_b128 a[148:151], v9 offset:45056
    v_cvt_pk_bf16_f32 v91, v74, v75
    v_mfma_f32_16x16x32_bf16 v[64:67], a[136:139], a[200:203], v[64:67]
    v_exp_f32 v77, v77
    v_mfma_f32_16x16x32_bf16 v[64:67], a[140:143], a[204:207], v[64:67]
    v_mfma_f32_16x16x32_bf16 a[0:3], a[160:163], v[80:83], a[0:3]
    v_exp_f32 v78, v78
    v_mfma_f32_16x16x32_bf16 a[16:19], a[164:167], v[80:83], a[16:19]
    ds_read_b64_tr_b16 a[180:181], v17 offset:57344
    v_cvt_pk_bf16_f32 v94, v76, v77
    v_mfma_f32_16x16x32_bf16 a[32:35], a[168:171], v[80:83], a[32:35]
    v_exp_f32 v79, v79
    v_mfma_f32_16x16x32_bf16 a[48:51], a[172:175], v[80:83], a[48:51]
    ds_read_b64_tr_b16 a[182:183], v17 offset:61440
    v_mfma_f32_16x16x32_bf16 v[128:131], v[56:59], v[80:83], v[128:131]
    v_xor_b32 v9, 0x10000, v9
    v_xor_b32 v17, 0x10000, v17
    v_xor_b32 v12, 0x10000, v12
    v_xor_b32 v13, 0x10000, v13
    v_mfma_f32_16x16x32_bf16 v[68:71], a[128:131], a[208:211], v[116:119]
    v_exp_f32 v64, v64
    v_mfma_f32_16x16x32_bf16 v[68:71], a[132:135], a[212:215], v[68:71]
    ds_read_b128 a[152:155], v10 offset:45056
    v_cvt_pk_bf16_f32 v95, v78, v79
    v_mfma_f32_16x16x32_bf16 v[68:71], a[136:139], a[216:219], v[68:71]
    v_exp_f32 v65, v65
    v_mfma_f32_16x16x32_bf16 v[68:71], a[140:143], a[220:223], v[68:71]
    v_mfma_f32_16x16x32_bf16 a[4:7], a[160:163], v[84:87], a[4:7]
    v_exp_f32 v66, v66
    v_mfma_f32_16x16x32_bf16 a[20:23], a[164:167], v[84:87], a[20:23]
    ds_read_b64_tr_b16 a[184:185], v18 offset:57344
    v_cvt_pk_bf16_f32 v96, v64, v65
    v_mfma_f32_16x16x32_bf16 a[36:39], a[168:171], v[84:87], a[36:39]
    v_exp_f32 v67, v67
    v_mfma_f32_16x16x32_bf16 a[52:55], a[172:175], v[84:87], a[52:55]
    ds_read_b64_tr_b16 a[186:187], v18 offset:61440
    v_mfma_f32_16x16x32_bf16 v[132:135], v[56:59], v[84:87], v[132:135]
    v_xor_b32 v14, 0x10000, v14
    v_xor_b32 v15, 0x10000, v15
    v_xor_b32 v8, 0x10000, v8
    v_mfma_f32_16x16x32_bf16 v[72:75], a[128:131], a[224:227], v[120:123]
    v_exp_f32 v68, v68
    v_mfma_f32_16x16x32_bf16 v[72:75], a[132:135], a[228:231], v[72:75]
    ds_read_b128 a[156:159], v11 offset:45056
    v_cvt_pk_bf16_f32 v97, v66, v67
    v_mfma_f32_16x16x32_bf16 v[72:75], a[136:139], a[232:235], v[72:75]
    v_exp_f32 v69, v69
    v_mfma_f32_16x16x32_bf16 v[72:75], a[140:143], a[236:239], v[72:75]
    v_mfma_f32_16x16x32_bf16 a[8:11], a[160:163], v[88:91], a[8:11]
    v_exp_f32 v70, v70
    v_mfma_f32_16x16x32_bf16 a[24:27], a[164:167], v[88:91], a[24:27]
    ds_read_b64_tr_b16 a[188:189], v19 offset:57344
    v_cvt_pk_bf16_f32 v100, v68, v69
    v_mfma_f32_16x16x32_bf16 a[40:43], a[168:171], v[88:91], a[40:43]
    v_exp_f32 v71, v71
    v_mfma_f32_16x16x32_bf16 a[56:59], a[172:175], v[88:91], a[56:59]
    ds_read_b64_tr_b16 a[190:191], v19 offset:61440
    s_waitcnt vmcnt(9)
    s_barrier
    v_mfma_f32_16x16x32_bf16 v[136:139], v[56:59], v[88:91], v[136:139]
    v_xor_b32 v16, 0x10000, v16
    v_xor_b32 v10, 0x10000, v10
    v_xor_b32 v18, 0x10000, v18
    v_mfma_f32_16x16x32_bf16 v[76:79], a[128:131], a[240:243], v[124:127]
    v_exp_f32 v72, v72
    v_mfma_f32_16x16x32_bf16 v[76:79], a[132:135], a[244:247], v[76:79]
    ds_read_b128 a[128:131], v8 offset:0
    v_cvt_pk_bf16_f32 v101, v70, v71
    v_mfma_f32_16x16x32_bf16 v[76:79], a[136:139], a[248:251], v[76:79]
    v_exp_f32 v73, v73
    s_mov_b32 m0, s38
    v_mfma_f32_16x16x32_bf16 v[76:79], a[140:143], a[252:255], v[76:79]
    buffer_load_dwordx4 v20, s[8:11], s29 offen offset:0 lds
    v_mfma_f32_16x16x32_bf16 a[12:15], a[160:163], v[92:95], a[12:15]
    v_exp_f32 v74, v74
    v_mfma_f32_16x16x32_bf16 a[28:31], a[164:167], v[92:95], a[28:31]
    ds_read_b64_tr_b16 a[160:161], v12 offset:16384
    v_cvt_pk_bf16_f32 v104, v72, v73
    v_mfma_f32_16x16x32_bf16 a[44:47], a[168:171], v[92:95], a[44:47]
    v_exp_f32 v75, v75
    v_mfma_f32_16x16x32_bf16 a[60:63], a[172:175], v[92:95], a[60:63]
    ds_read_b64_tr_b16 a[162:163], v12 offset:20480
    s_waitcnt lgkmcnt(3)
    v_mfma_f32_16x16x32_bf16 v[140:143], v[56:59], v[92:95], v[140:143]
    v_xor_b32 v11, 0x10000, v11
    v_xor_b32 v19, 0x10000, v19
    v_mfma_f32_16x16x32_bf16 v[64:67], a[144:147], a[192:195], v[112:115]
    v_exp_f32 v76, v76
    v_mfma_f32_16x16x32_bf16 v[64:67], a[148:151], a[196:199], v[64:67]
    ds_read_b128 a[132:135], v9 offset:0
    v_cvt_pk_bf16_f32 v105, v74, v75
    v_mfma_f32_16x16x32_bf16 v[64:67], a[152:155], a[200:203], v[64:67]
    v_exp_f32 v77, v77
    v_mfma_f32_16x16x32_bf16 v[64:67], a[156:159], a[204:207], v[64:67]
    buffer_load_dwordx4 v21, s[8:11], s29 offen offset:1024 lds
    v_mfma_f32_16x16x32_bf16 a[64:67], a[176:179], v[80:83], a[64:67]
    v_exp_f32 v78, v78
    v_mfma_f32_16x16x32_bf16 a[80:83], a[180:183], v[80:83], a[80:83]
    ds_read_b64_tr_b16 a[164:165], v13 offset:16384
    v_cvt_pk_bf16_f32 v108, v76, v77
    v_mfma_f32_16x16x32_bf16 a[96:99], a[184:187], v[80:83], a[96:99]
    v_exp_f32 v79, v79
    v_mfma_f32_16x16x32_bf16 a[112:115], a[188:191], v[80:83], a[112:115]
    ds_read_b64_tr_b16 a[166:167], v13 offset:20480
    v_mfma_f32_16x16x32_bf16 v[68:71], a[144:147], a[208:211], v[116:119]
    v_exp_f32 v64, v64
    v_mfma_f32_16x16x32_bf16 v[68:71], a[148:151], a[212:215], v[68:71]
    ds_read_b128 a[136:139], v10 offset:0
    v_cvt_pk_bf16_f32 v109, v78, v79
    v_mfma_f32_16x16x32_bf16 v[68:71], a[152:155], a[216:219], v[68:71]
    v_exp_f32 v65, v65
    v_mfma_f32_16x16x32_bf16 v[68:71], a[156:159], a[220:223], v[68:71]
    buffer_load_dwordx4 v22, s[8:11], s29 offen offset:2048 lds
    v_mfma_f32_16x16x32_bf16 a[68:71], a[176:179], v[84:87], a[68:71]
    v_exp_f32 v66, v66
    v_mfma_f32_16x16x32_bf16 a[84:87], a[180:183], v[84:87], a[84:87]
    ds_read_b64_tr_b16 a[168:169], v14 offset:16384
    v_cvt_pk_bf16_f32 v98, v64, v65
    v_mfma_f32_16x16x32_bf16 a[100:103], a[184:187], v[84:87], a[100:103]
    v_exp_f32 v67, v67
    v_mfma_f32_16x16x32_bf16 a[116:119], a[188:191], v[84:87], a[116:119]
    ds_read_b64_tr_b16 a[170:171], v14 offset:20480
    v_mfma_f32_16x16x32_bf16 v[72:75], a[144:147], a[224:227], v[120:123]
    v_exp_f32 v68, v68
    v_mfma_f32_16x16x32_bf16 v[72:75], a[148:151], a[228:231], v[72:75]
    ds_read_b128 a[140:143], v11 offset:0
    v_cvt_pk_bf16_f32 v99, v66, v67
    v_mfma_f32_16x16x32_bf16 v[72:75], a[152:155], a[232:235], v[72:75]
    v_exp_f32 v69, v69
    v_mfma_f32_16x16x32_bf16 v[72:75], a[156:159], a[236:239], v[72:75]
    buffer_load_dwordx4 v23, s[8:11], s29 offen offset:3072 lds
    s_add_u32 s29, s29, 16384
    v_mfma_f32_16x16x32_bf16 a[72:75], a[176:179], v[88:91], a[72:75]
    v_exp_f32 v70, v70
    v_mfma_f32_16x16x32_bf16 a[88:91], a[180:183], v[88:91], a[88:91]
    ds_read_b64_tr_b16 a[172:173], v15 offset:16384
    v_cvt_pk_bf16_f32 v102, v68, v69
    v_mfma_f32_16x16x32_bf16 a[104:107], a[184:187], v[88:91], a[104:107]
    v_exp_f32 v71, v71
    v_mfma_f32_16x16x32_bf16 a[120:123], a[188:191], v[88:91], a[120:123]
    ds_read_b64_tr_b16 a[174:175], v15 offset:20480
    v_mfma_f32_16x16x32_bf16 v[76:79], a[144:147], a[240:243], v[124:127]
    v_exp_f32 v72, v72
    v_mfma_f32_16x16x32_bf16 v[76:79], a[148:151], a[244:247], v[76:79]
    ds_read_b128 a[144:147], v8 offset:4096
    v_cvt_pk_bf16_f32 v103, v70, v71
    v_mfma_f32_16x16x32_bf16 v[76:79], a[152:155], a[248:251], v[76:79]
    v_exp_f32 v73, v73
    s_add_u32 m0, s38, 16384
    v_mfma_f32_16x16x32_bf16 v[76:79], a[156:159], a[252:255], v[76:79]
    buffer_load_dwordx4 v24, s[12:15], s30 offen offset:0 lds
    v_mfma_f32_16x16x32_bf16 a[76:79], a[176:179], v[92:95], a[76:79]
    v_exp_f32 v74, v74
    v_mfma_f32_16x16x32_bf16 a[92:95], a[180:183], v[92:95], a[92:95]
    ds_read_b64_tr_b16 a[176:177], v16 offset:16384
    v_cvt_pk_bf16_f32 v106, v72, v73
    v_mfma_f32_16x16x32_bf16 a[108:111], a[184:187], v[92:95], a[108:111]
    v_exp_f32 v75, v75
    v_mfma_f32_16x16x32_bf16 a[124:127], a[188:191], v[92:95], a[124:127]
    ds_read_b64_tr_b16 a[178:179], v16 offset:20480
    s_waitcnt lgkmcnt(3)
    s_sub_u32 s33, s33, 1
    s_cmp_lg_u32 s33, 0
    s_cbranch_scc1 L_loop_21
CODE_TAIL:
    s_mov_b32 s5, 65536
    buffer_load_dwordx2 v[180:181], v45, s[44:47], s5 offen sc1
    v_exp_f32 v76, v76
    v_cvt_pk_bf16_f32 v107, v74, v75
    v_exp_f32 v77, v77
    v_mfma_f32_16x16x32_bf16 a[0:3], a[160:163], v[96:99], a[0:3]
    v_exp_f32 v78, v78
    v_mfma_f32_16x16x32_bf16 a[16:19], a[164:167], v[96:99], a[16:19]
    ds_read_b64_tr_b16 a[180:181], v17 offset:16384
    v_cvt_pk_bf16_f32 v110, v76, v77
    v_mfma_f32_16x16x32_bf16 a[32:35], a[168:171], v[96:99], a[32:35]
    v_exp_f32 v79, v79
    v_mfma_f32_16x16x32_bf16 a[48:51], a[172:175], v[96:99], a[48:51]
    ds_read_b64_tr_b16 a[182:183], v17 offset:20480
    v_mfma_f32_16x16x32_bf16 v[128:131], v[56:59], v[96:99], v[128:131]
    v_cvt_pk_bf16_f32 v111, v78, v79
    v_mfma_f32_16x16x32_bf16 a[4:7], a[160:163], v[100:103], a[4:7]
    v_mfma_f32_16x16x32_bf16 a[20:23], a[164:167], v[100:103], a[20:23]
    ds_read_b64_tr_b16 a[184:185], v18 offset:16384
    v_mfma_f32_16x16x32_bf16 a[36:39], a[168:171], v[100:103], a[36:39]
    v_mfma_f32_16x16x32_bf16 a[52:55], a[172:175], v[100:103], a[52:55]
    ds_read_b64_tr_b16 a[186:187], v18 offset:20480
    v_mfma_f32_16x16x32_bf16 v[132:135], v[56:59], v[100:103], v[132:135]
    v_mfma_f32_16x16x32_bf16 a[8:11], a[160:163], v[104:107], a[8:11]
    v_mfma_f32_16x16x32_bf16 a[24:27], a[164:167], v[104:107], a[24:27]
    ds_read_b64_tr_b16 a[188:189], v19 offset:16384
    v_mfma_f32_16x16x32_bf16 a[40:43], a[168:171], v[104:107], a[40:43]
    v_mfma_f32_16x16x32_bf16 a[56:59], a[172:175], v[104:107], a[56:59]
    ds_read_b64_tr_b16 a[190:191], v19 offset:20480
    v_mfma_f32_16x16x32_bf16 v[136:139], v[56:59], v[104:107], v[136:139]
    v_mfma_f32_16x16x32_bf16 a[12:15], a[160:163], v[108:111], a[12:15]
    v_mfma_f32_16x16x32_bf16 a[28:31], a[164:167], v[108:111], a[28:31]
    v_mfma_f32_16x16x32_bf16 a[44:47], a[168:171], v[108:111], a[44:47]
    v_mfma_f32_16x16x32_bf16 a[60:63], a[172:175], v[108:111], a[60:63]
    s_waitcnt lgkmcnt(0)
    v_mfma_f32_16x16x32_bf16 v[140:143], v[56:59], v[108:111], v[140:143]
    v_mfma_f32_16x16x32_bf16 a[64:67], a[176:179], v[96:99], a[64:67]
    v_mfma_f32_16x16x32_bf16 a[80:83], a[180:183], v[96:99], a[80:83]
    v_mfma_f32_16x16x32_bf16 a[96:99], a[184:187], v[96:99], a[96:99]
    v_mfma_f32_16x16x32_bf16 a[112:115], a[188:191], v[96:99], a[112:115]
    v_mfma_f32_16x16x32_bf16 a[68:71], a[176:179], v[100:103], a[68:71]
    v_mfma_f32_16x16x32_bf16 a[84:87], a[180:183], v[100:103], a[84:87]
    v_mfma_f32_16x16x32_bf16 a[100:103], a[184:187], v[100:103], a[100:103]
    v_mfma_f32_16x16x32_bf16 a[116:119], a[188:191], v[100:103], a[116:119]
    v_mfma_f32_16x16x32_bf16 a[72:75], a[176:179], v[104:107], a[72:75]
    v_mfma_f32_16x16x32_bf16 a[88:91], a[180:183], v[104:107], a[88:91]
    v_mfma_f32_16x16x32_bf16 a[104:107], a[184:187], v[104:107], a[104:107]
    v_mfma_f32_16x16x32_bf16 a[120:123], a[188:191], v[104:107], a[120:123]
    v_mfma_f32_16x16x32_bf16 a[76:79], a[176:179], v[108:111], a[76:79]
    v_mfma_f32_16x16x32_bf16 a[92:95], a[180:183], v[108:111], a[92:95]
    v_mfma_f32_16x16x32_bf16 a[108:111], a[184:187], v[108:111], a[108:111]
    v_mfma_f32_16x16x32_bf16 a[124:127], a[188:191], v[108:111], a[124:127]
    s_nop 7
    v_add_f32 v46, v128, v132
    v_add_f32 v47, v136, v140
    s_mov_b32 s35, 0x4b800000
    v_add_f32 v46, v46, v47
    v_mov_b32 v52, 147456
    v_cmp_ngt_f32 vcc, s35, v46
    v_mov_b32 v53, 1
    s_cbranch_vccz L_ok_25
    ds_write_b32 v52, v53
L_ok_25:
    s_waitcnt vmcnt(0)
    v_cmp_ne_u64 vcc, s[62:63], v[180:181]
    s_nop 1
    s_cbranch_vccz L_up_26
    ds_write_b32 v52, v53 offset:4
L_up_26:
    s_waitcnt lgkmcnt(0)
    s_barrier
    ds_read_b32 v53, v52
    ds_read_b32 v54, v52 offset:4
    v_rcp_f32 v46, v128
    v_rcp_f32 v47, v132
    v_rcp_f32 v48, v136
    v_rcp_f32 v49, v140
    s_lshl_b32 s35, s40, 4
    s_lshl_b32 s36, s4, 2
    s_add_u32 s35, s35, s36
    s_lshl_b32 s35, s35, 17
    s_lshl_b32 s36, s39, 12
    s_add_u32 s35, s35, s36
    v_and_b32 v2, 63, v0
    v_lshlrev_b32 v2, 4, v2
    v_add_u32 v3, 131072, v2
    v_add_u32 v4, 262144, v2
    v_add_u32 v5, 393216, v2
    s_waitcnt lgkmcnt(0)
    v_readfirstlane_b32 s36, v53
    v_readfirstlane_b32 s33, v54
    s_nop 3
    s_andn2_b32 s36, s36, s34
    s_cmp_lg_u32 s36, 0
    s_cbranch_scc1 L_fb_22
    s_cmp_lg_u32 s33, 0
    s_cbranch_scc1 L_notyet_27
    s_add_u32 s29, s94, 0
    s_add_u32 m0, s95, 0
    s_nop 0
    buffer_load_dwordx4 v26, s[96:99], s29 offen offset:0 lds
    buffer_load_dwordx4 v27, s[96:99], s29 offen offset:1024 lds
    buffer_load_dwordx4 v28, s[96:99], s29 offen offset:2048 lds
    buffer_load_dwordx4 v29, s[96:99], s29 offen offset:3072 lds
    s_add_u32 m0, s95, 4096
    s_nop 0
    buffer_load_dwordx4 v30, s[96:99], s29 offen offset:0 lds
    buffer_load_dwordx4 v31, s[96:99], s29 offen offset:1024 lds
    buffer_load_dwordx4 v32, s[96:99], s29 offen offset:2048 lds
    buffer_load_dwordx4 v33, s[96:99], s29 offen offset:3072 lds
    s_add_u32 m0, s95, 8192
    s_nop 0
    buffer_load_dwordx4 v34, s[96:99], s29 offen offset:0 lds
    s_add_u32 s29, s100, 0
    buffer_load_dwordx4 a[128:131], v35, s[20:23], s29 offen offset:0 sc1
    buffer_load_dwordx4 a[132:135], v36, s[20:23], s29 offen offset:0 sc1
    buffer_load_dwordx4 a[136:139], v37, s[20:23], s29 offen offset:0 sc1
    buffer_load_dwordx4 a[140:143], v38, s[20:23], s29 offen offset:0 sc1
    s_add_u32 s29, s100, 0
    buffer_load_dwordx4 a[144:147], v35, s[20:23], s29 offen offset:1024 sc1
    buffer_load_dwordx4 a[148:151], v36, s[20:23], s29 offen offset:1024 sc1
    buffer_load_dwordx4 a[152:155], v37, s[20:23], s29 offen offset:1024 sc1
    buffer_load_dwordx4 a[156:159], v38, s[20:23], s29 offen offset:1024 sc1
    s_add_u32 s29, s94, 147456
    s_add_u32 m0, s95, 36864
    s_nop 0
    buffer_load_dwordx4 v26, s[96:99], s29 offen offset:0 lds
    buffer_load_dwordx4 v27, s[96:99], s29 offen offset:1024 lds
    buffer_load_dwordx4 v28, s[96:99], s29 offen offset:2048 lds
    buffer_load_dwordx4 v29, s[96:99], s29 offen offset:3072 lds
    s_add_u32 m0, s95, 40960
    s_nop 0
    buffer_load_dwordx4 v30, s[96:99], s29 offen offset:0 lds
    buffer_load_dwordx4 v31, s[96:99], s29 offen offset:1024 lds
    buffer_load_dwordx4 v32, s[96:99], s29 offen offset:2048 lds
    buffer_load_dwordx4 v33, s[96:99], s29 offen offset:3072 lds
    s_add_u32 m0, s95, 45056
    s_nop 0
    buffer_load_dwordx4 v34, s[96:99], s29 offen offset:0 lds
    s_add_u32 s29, s100, 0
    buffer_load_dwordx4 a[160:163], v35, s[20:23], s29 offen offset:2048 sc1
    buffer_load_dwordx4 a[164:167], v36, s[20:23], s29 offen offset:2048 sc1
    buffer_load_dwordx4 a[168:171], v37, s[20:23], s29 offen offset:2048 sc1
    buffer_load_dwordx4 a[172:175], v38, s[20:23], s29 offen offset:2048 sc1
    s_add_u32 s29, s100, 0
    buffer_load_dwordx4 a[176:179], v35, s[20:23], s29 offen offset:3072 sc1
    buffer_load_dwordx4 a[180:183], v36, s[20:23], s29 offen offset:3072 sc1
    buffer_load_dwordx4 a[184:187], v37, s[20:23], s29 offen offset:3072 sc1
    buffer_load_dwordx4 a[188:191], v38, s[20:23], s29 offen offset:3072 sc1
    s_add_u32 s29, s100, 4096
    buffer_load_dwordx4 a[192:195], v35, s[20:23], s29 offen offset:0 sc1
    buffer_load_dwordx4 a[196:199], v36, s[20:23], s29 offen offset:0 sc1
    buffer_load_dwordx4 a[200:203], v37, s[20:23], s29 offen offset:0 sc1
    buffer_load_dwordx4 a[204:207], v38, s[20:23], s29 offen offset:0 sc1
    s_add_u32 s29, s100, 4096
    buffer_load_dwordx4 a[208:211], v35, s[20:23], s29 offen offset:1024 sc1
    buffer_load_dwordx4 a[212:215], v36, s[20:23], s29 offen offset:1024 sc1
    buffer_load_dwordx4 a[216:219], v37, s[20:23], s29 offen offset:1024 sc1
    buffer_load_dwordx4 a[220:223], v38, s[20:23], s29 offen offset:1024 sc1
    s_add_u32 s29, s100, 4096
    buffer_load_dwordx4 a[224:227], v35, s[20:23], s29 offen offset:2048 sc1
    buffer_load_dwordx4 a[228:231], v36, s[20:23], s29 offen offset:2048 sc1
    buffer_load_dwordx4 a[232:235], v37, s[20:23], s29 offen offset:2048 sc1
    buffer_load_dwordx4 a[236:239], v38, s[20:23], s29 offen offset:2048 sc1
    s_add_u32 s29, s100, 4096
    buffer_load_dwordx4 a[240:243], v35, s[20:23], s29 offen offset:3072 sc1
    buffer_load_dwordx4 a[244:247], v36, s[20:23], s29 offen offset:3072 sc1
    buffer_load_dwordx4 a[248:251], v37, s[20:23], s29 offen offset:3072 sc1
    buffer_load_dwordx4 a[252:255], v38, s[20:23], s29 offen offset:3072 sc1
L_notyet_27:
    v_accvgpr_read_b32 v144, a0
    v_accvgpr_read_b32 v145, a1
    v_accvgpr_read_b32 v146, a2
    v_accvgpr_read_b32 v147, a3
    v_accvgpr_read_b32 v148, a16
    v_accvgpr_read_b32 v149, a17
    v_accvgpr_read_b32 v150, a18
    v_accvgpr_read_b32 v151, a19
    v_mul_f32 v144, v144, v46
    v_mul_f32 v145, v145, v46
    v_mul_f32 v146, v146, v46
    v_mul_f32 v147, v147, v46
    v_mul_f32 v148, v148, v46
    v_mul_f32 v149, v149, v46
    v_mul_f32 v150, v150, v46
    v_mul_f32 v151, v151, v46
    v_cvt_pk_bf16_f32 v152, v144, v145
    v_cvt_pk_bf16_f32 v153, v146, v147
    v_cvt_pk_bf16_f32 v154, v148, v149
    v_cvt_pk_bf16_f32 v155, v150, v151
    buffer_store_dwordx4 v[152:155], v2, s[24:27], s35 offen offset:0 sc1
    v_accvgpr_read_b32 v156, a32
    v_accvgpr_read_b32 v157, a33
    v_accvgpr_read_b32 v158, a34
    v_accvgpr_read_b32 v159, a35
    v_accvgpr_read_b32 v160, a48
    v_accvgpr_read_b32 v161, a49
    v_accvgpr_read_b32 v162, a50
    v_accvgpr_read_b32 v163, a51
    v_mul_f32 v156, v156, v46
    v_mul_f32 v157, v157, v46
    v_mul_f32 v158, v158, v46
    v_mul_f32 v159, v159, v46
    v_mul_f32 v160, v160, v46
    v_mul_f32 v161, v161, v46
    v_mul_f32 v162, v162, v46
    v_mul_f32 v163, v163, v46
    v_cvt_pk_bf16_f32 v164, v156, v157
    v_cvt_pk_bf16_f32 v165, v158, v159
    v_cvt_pk_bf16_f32 v166, v160, v161
    v_cvt_pk_bf16_f32 v167, v162, v163
    buffer_store_dwordx4 v[164:167], v2, s[24:27], s35 offen offset:1024 sc1
    v_accvgpr_read_b32 v168, a64
    v_accvgpr_read_b32 v169, a65
    v_accvgpr_read_b32 v170, a66
    v_accvgpr_read_b32 v171, a67
    v_accvgpr_read_b32 v172, a80
    v_accvgpr_read_b32 v173, a81
    v_accvgpr_read_b32 v174, a82
    v_accvgpr_read_b32 v175, a83
    v_mul_f32 v168, v168, v46
    v_mul_f32 v169, v169, v46
    v_mul_f32 v170, v170, v46
    v_mul_f32 v171, v171, v46
    v_mul_f32 v172, v172, v46
    v_mul_f32 v173, v173, v46
    v_mul_f32 v174, v174, v46
    v_mul_f32 v175, v175, v46
    v_cvt_pk_bf16_f32 v176, v168, v169
    v_cvt_pk_bf16_f32 v177, v170, v171
    v_cvt_pk_bf16_f32 v178, v172, v173
    v_cvt_pk_bf16_f32 v179, v174, v175
    buffer_store_dwordx4 v[176:179], v2, s[24:27], s35 offen offset:2048 sc1
    v_accvgpr_read_b32 v180, a96
    v_accvgpr_read_b32 v181, a97
    v_accvgpr_read_b32 v182, a98
    v_accvgpr_read_b32 v183, a99
    v_accvgpr_read_b32 v184, a112
    v_accvgpr_read_b32 v185, a113
    v_accvgpr_read_b32 v186, a114
    v_accvgpr_read_b32 v187, a115
    v_mul_f32 v180, v180, v46
    v_mul_f32 v181, v181, v46
    v_mul_f32 v182, v182, v46
    v_mul_f32 v183, v183, v46
    v_mul_f32 v184, v184, v46
    v_mul_f32 v185, v185, v46
    v_mul_f32 v186, v186, v46
    v_mul_f32 v187, v187, v46
    v_cvt_pk_bf16_f32 v188, v180, v181
    v_cvt_pk_bf16_f32 v189, v182, v183
    v_cvt_pk_bf16_f32 v190, v184, v185
    v_cvt_pk_bf16_f32 v191, v186, v187
    buffer_store_dwordx4 v[188:191], v2, s[24:27], s35 offen offset:3072 sc1
    v_accvgpr_read_b32 v192, a4
    v_accvgpr_read_b32 v193, a5
    v_accvgpr_read_b32 v194, a6
    v_accvgpr_read_b32 v195, a7
    v_accvgpr_read_b32 v196, a20
    v_accvgpr_read_b32 v197, a21
    v_accvgpr_read_b32 v198, a22
    v_accvgpr_read_b32 v199, a23
    v_mul_f32 v192, v192, v47
    v_mul_f32 v193, v193, v47
    v_mul_f32 v194, v194, v47
    v_mul_f32 v195, v195, v47
    v_mul_f32 v196, v196, v47
    v_mul_f32 v197, v197, v47
    v_mul_f32 v198, v198, v47
    v_mul_f32 v199, v199, v47
    v_cvt_pk_bf16_f32 v200, v192, v193
    v_cvt_pk_bf16_f32 v201, v194, v195
    v_cvt_pk_bf16_f32 v202, v196, v197
    v_cvt_pk_bf16_f32 v203, v198, v199
    buffer_store_dwordx4 v[200:203], v3, s[24:27], s35 offen offset:0 sc1
    v_accvgpr_read_b32 v204, a36
    v_accvgpr_read_b32 v205, a37
    v_accvgpr_read_b32 v206, a38
    v_accvgpr_read_b32 v207, a39
    v_accvgpr_read_b32 v208, a52
    v_accvgpr_read_b32 v209, a53
    v_accvgpr_read_b32 v210, a54
    v_accvgpr_read_b32 v211, a55
    v_mul_f32 v204, v204, v47
    v_mul_f32 v205, v205, v47
    v_mul_f32 v206, v206, v47
    v_mul_f32 v207, v207, v47
    v_mul_f32 v208, v208, v47
    v_mul_f32 v209, v209, v47
    v_mul_f32 v210, v210, v47
    v_mul_f32 v211, v211, v47
    v_cvt_pk_bf16_f32 v212, v204, v205
    v_cvt_pk_bf16_f32 v213, v206, v207
    v_cvt_pk_bf16_f32 v214, v208, v209
    v_cvt_pk_bf16_f32 v215, v210, v211
    buffer_store_dwordx4 v[212:215], v3, s[24:27], s35 offen offset:1024 sc1
    v_accvgpr_read_b32 v216, a68
    v_accvgpr_read_b32 v217, a69
    v_accvgpr_read_b32 v218, a70
    v_accvgpr_read_b32 v219, a71
    v_accvgpr_read_b32 v220, a84
    v_accvgpr_read_b32 v221, a85
    v_accvgpr_read_b32 v222, a86
    v_accvgpr_read_b32 v223, a87
    v_mul_f32 v216, v216, v47
    v_mul_f32 v217, v217, v47
    v_mul_f32 v218, v218, v47
    v_mul_f32 v219, v219, v47
    v_mul_f32 v220, v220, v47
    v_mul_f32 v221, v221, v47
    v_mul_f32 v222, v222, v47
    v_mul_f32 v223, v223, v47
    v_cvt_pk_bf16_f32 v224, v216, v217
    v_cvt_pk_bf16_f32 v225, v218, v219
    v_cvt_pk_bf16_f32 v226, v220, v221
    v_cvt_pk_bf16_f32 v227, v222, v223
    buffer_store_dwordx4 v[224:227], v3, s[24:27], s35 offen offset:2048 sc1
    v_accvgpr_read_b32 v228, a100
    v_accvgpr_read_b32 v229, a101
    v_accvgpr_read_b32 v230, a102
    v_accvgpr_read_b32 v231, a103
    v_accvgpr_read_b32 v232, a116
    v_accvgpr_read_b32 v233, a117
    v_accvgpr_read_b32 v234, a118
    v_accvgpr_read_b32 v235, a119
    v_mul_f32 v228, v228, v47
    v_mul_f32 v229, v229, v47
    v_mul_f32 v230, v230, v47
    v_mul_f32 v231, v231, v47
    v_mul_f32 v232, v232, v47
    v_mul_f32 v233, v233, v47
    v_mul_f32 v234, v234, v47
    v_mul_f32 v235, v235, v47
    v_cvt_pk_bf16_f32 v236, v228, v229
    v_cvt_pk_bf16_f32 v237, v230, v231
    v_cvt_pk_bf16_f32 v238, v232, v233
    v_cvt_pk_bf16_f32 v239, v234, v235
    buffer_store_dwordx4 v[236:239], v3, s[24:27], s35 offen offset:3072 sc1
    v_accvgpr_read_b32 v144, a8
    v_accvgpr_read_b32 v145, a9
    v_accvgpr_read_b32 v146, a10
    v_accvgpr_read_b32 v147, a11
    v_accvgpr_read_b32 v148, a24
    v_accvgpr_read_b32 v149, a25
    v_accvgpr_read_b32 v150, a26
    v_accvgpr_read_b32 v151, a27
    v_mul_f32 v144, v144, v48
    v_mul_f32 v145, v145, v48
    v_mul_f32 v146, v146, v48
    v_mul_f32 v147, v147, v48
    v_mul_f32 v148, v148, v48
    v_mul_f32 v149, v149, v48
    v_mul_f32 v150, v150, v48
    v_mul_f32 v151, v151, v48
    v_cvt_pk_bf16_f32 v152, v144, v145
    v_cvt_pk_bf16_f32 v153, v146, v147
    v_cvt_pk_bf16_f32 v154, v148, v149
    v_cvt_pk_bf16_f32 v155, v150, v151
    buffer_store_dwordx4 v[152:155], v4, s[24:27], s35 offen offset:0 sc1
    v_accvgpr_read_b32 v156, a40
    v_accvgpr_read_b32 v157, a41
    v_accvgpr_read_b32 v158, a42
    v_accvgpr_read_b32 v159, a43
    v_accvgpr_read_b32 v160, a56
    v_accvgpr_read_b32 v161, a57
    v_accvgpr_read_b32 v162, a58
    v_accvgpr_read_b32 v163, a59
    v_mul_f32 v156, v156, v48
    v_mul_f32 v157, v157, v48
    v_mul_f32 v158, v158, v48
    v_mul_f32 v159, v159, v48
    v_mul_f32 v160, v160, v48
    v_mul_f32 v161, v161, v48
    v_mul_f32 v162, v162, v48
    v_mul_f32 v163, v163, v48
    v_cvt_pk_bf16_f32 v164, v156, v157
    v_cvt_pk_bf16_f32 v165, v158, v159
    v_cvt_pk_bf16_f32 v166, v160, v161
    v_cvt_pk_bf16_f32 v167, v162, v163
    buffer_store_dwordx4 v[164:167], v4, s[24:27], s35 offen offset:1024 sc1
    v_accvgpr_read_b32 v168, a72
    v_accvgpr_read_b32 v169, a73
    v_accvgpr_read_b32 v170, a74
    v_accvgpr_read_b32 v171, a75
    v_accvgpr_read_b32 v172, a88
    v_accvgpr_read_b32 v173, a89
    v_accvgpr_read_b32 v174, a90
    v_accvgpr_read_b32 v175, a91
    v_mul_f32 v168, v168, v48
    v_mul_f32 v169, v169, v48
    v_mul_f32 v170, v170, v48
    v_mul_f32 v171, v171, v48
    v_mul_f32 v172, v172, v48
    v_mul_f32 v173, v173, v48
    v_mul_f32 v174, v174, v48
    v_mul_f32 v175, v175, v48
    v_cvt_pk_bf16_f32 v176, v168, v169
    v_cvt_pk_bf16_f32 v177, v170, v171
    v_cvt_pk_bf16_f32 v178, v172, v173
    v_cvt_pk_bf16_f32 v179, v174, v175
    buffer_store_dwordx4 v[176:179], v4, s[24:27], s35 offen offset:2048 sc1
    v_accvgpr_read_b32 v180, a104
    v_accvgpr_read_b32 v181, a105
    v_accvgpr_read_b32 v182, a106
    v_accvgpr_read_b32 v183, a107
    v_accvgpr_read_b32 v184, a120
    v_accvgpr_read_b32 v185, a121
    v_accvgpr_read_b32 v186, a122
    v_accvgpr_read_b32 v187, a123
    v_mul_f32 v180, v180, v48
    v_mul_f32 v181, v181, v48
    v_mul_f32 v182, v182, v48
    v_mul_f32 v183, v183, v48
    v_mul_f32 v184, v184, v48
    v_mul_f32 v185, v185, v48
    v_mul_f32 v186, v186, v48
    v_mul_f32 v187, v187, v48
    v_cvt_pk_bf16_f32 v188, v180, v181
    v_cvt_pk_bf16_f32 v189, v182, v183
    v_cvt_pk_bf16_f32 v190, v184, v185
    v_cvt_pk_bf16_f32 v191, v186, v187
    buffer_store_dwordx4 v[188:191], v4, s[24:27], s35 offen offset:3072 sc1
    v_accvgpr_read_b32 v192, a12
    v_accvgpr_read_b32 v193, a13
    v_accvgpr_read_b32 v194, a14
    v_accvgpr_read_b32 v195, a15
    v_accvgpr_read_b32 v196, a28
    v_accvgpr_read_b32 v197, a29
    v_accvgpr_read_b32 v198, a30
    v_accvgpr_read_b32 v199, a31
    v_mul_f32 v192, v192, v49
    v_mul_f32 v193, v193, v49
    v_mul_f32 v194, v194, v49
    v_mul_f32 v195, v195, v49
    v_mul_f32 v196, v196, v49
    v_mul_f32 v197, v197, v49
    v_mul_f32 v198, v198, v49
    v_mul_f32 v199, v199, v49
    v_cvt_pk_bf16_f32 v200, v192, v193
    v_cvt_pk_bf16_f32 v201, v194, v195
    v_cvt_pk_bf16_f32 v202, v196, v197
    v_cvt_pk_bf16_f32 v203, v198, v199
    buffer_store_dwordx4 v[200:203], v5, s[24:27], s35 offen offset:0 sc1
    v_accvgpr_read_b32 v204, a44
    v_accvgpr_read_b32 v205, a45
    v_accvgpr_read_b32 v206, a46
    v_accvgpr_read_b32 v207, a47
    v_accvgpr_read_b32 v208, a60
    v_accvgpr_read_b32 v209, a61
    v_accvgpr_read_b32 v210, a62
    v_accvgpr_read_b32 v211, a63
    v_mul_f32 v204, v204, v49
    v_mul_f32 v205, v205, v49
    v_mul_f32 v206, v206, v49
    v_mul_f32 v207, v207, v49
    v_mul_f32 v208, v208, v49
    v_mul_f32 v209, v209, v49
    v_mul_f32 v210, v210, v49
    v_mul_f32 v211, v211, v49
    v_cvt_pk_bf16_f32 v212, v204, v205
    v_cvt_pk_bf16_f32 v213, v206, v207
    v_cvt_pk_bf16_f32 v214, v208, v209
    v_cvt_pk_bf16_f32 v215, v210, v211
    buffer_store_dwordx4 v[212:215], v5, s[24:27], s35 offen offset:1024 sc1
    v_accvgpr_read_b32 v216, a76
    v_accvgpr_read_b32 v217, a77
    v_accvgpr_read_b32 v218, a78
    v_accvgpr_read_b32 v219, a79
    v_accvgpr_read_b32 v220, a92
    v_accvgpr_read_b32 v221, a93
    v_accvgpr_read_b32 v222, a94
    v_accvgpr_read_b32 v223, a95
    v_mul_f32 v216, v216, v49
    v_mul_f32 v217, v217, v49
    v_mul_f32 v218, v218, v49
    v_mul_f32 v219, v219, v49
    v_mul_f32 v220, v220, v49
    v_mul_f32 v221, v221, v49
    v_mul_f32 v222, v222, v49
    v_mul_f32 v223, v223, v49
    v_cvt_pk_bf16_f32 v224, v216, v217
    v_cvt_pk_bf16_f32 v225, v218, v219
    v_cvt_pk_bf16_f32 v226, v220, v221
    v_cvt_pk_bf16_f32 v227, v222, v223
    buffer_store_dwordx4 v[224:227], v5, s[24:27], s35 offen offset:2048 sc1
    v_accvgpr_read_b32 v228, a108
    v_accvgpr_read_b32 v229, a109
    v_accvgpr_read_b32 v230, a110
    v_accvgpr_read_b32 v231, a111
    v_accvgpr_read_b32 v232, a124
    v_accvgpr_read_b32 v233, a125
    v_accvgpr_read_b32 v234, a126
    v_accvgpr_read_b32 v235, a127
    v_mul_f32 v228, v228, v49
    v_mul_f32 v229, v229, v49
    v_mul_f32 v230, v230, v49
    v_mul_f32 v231, v231, v49
    v_mul_f32 v232, v232, v49
    v_mul_f32 v233, v233, v49
    v_mul_f32 v234, v234, v49
    v_mul_f32 v235, v235, v49
    v_cvt_pk_bf16_f32 v236, v228, v229
    v_cvt_pk_bf16_f32 v237, v230, v231
    v_cvt_pk_bf16_f32 v238, v232, v233
    v_cvt_pk_bf16_f32 v239, v234, v235
    buffer_store_dwordx4 v[236:239], v5, s[24:27], s35 offen offset:3072 sc1
    s_cmp_eq_u32 s33, 0
    s_cbranch_scc1 L_atty_28
    s_add_u32 s29, s94, 0
    s_add_u32 m0, s95, 0
    s_nop 0
    buffer_load_dwordx4 v26, s[96:99], s29 offen offset:0 lds
    buffer_load_dwordx4 v27, s[96:99], s29 offen offset:1024 lds
    buffer_load_dwordx4 v28, s[96:99], s29 offen offset:2048 lds
    buffer_load_dwordx4 v29, s[96:99], s29 offen offset:3072 lds
    s_add_u32 m0, s95, 4096
    s_nop 0
    buffer_load_dwordx4 v30, s[96:99], s29 offen offset:0 lds
    buffer_load_dwordx4 v31, s[96:99], s29 offen offset:1024 lds
    buffer_load_dwordx4 v32, s[96:99], s29 offen offset:2048 lds
    buffer_load_dwordx4 v33, s[96:99], s29 offen offset:3072 lds
    s_add_u32 m0, s95, 8192
    s_nop 0
    buffer_load_dwordx4 v34, s[96:99], s29 offen offset:0 lds
    s_add_u32 s29, s94, 147456
    s_add_u32 m0, s95, 36864
    s_nop 0
    buffer_load_dwordx4 v26, s[96:99], s29 offen offset:0 lds
    buffer_load_dwordx4 v27, s[96:99], s29 offen offset:1024 lds
    buffer_load_dwordx4 v28, s[96:99], s29 offen offset:2048 lds
    buffer_load_dwordx4 v29, s[96:99], s29 offen offset:3072 lds
    s_add_u32 m0, s95, 40960
    s_nop 0
    buffer_load_dwordx4 v30, s[96:99], s29 offen offset:0 lds
    buffer_load_dwordx4 v31, s[96:99], s29 offen offset:1024 lds
    buffer_load_dwordx4 v32, s[96:99], s29 offen offset:2048 lds
    buffer_load_dwordx4 v33, s[96:99], s29 offen offset:3072 lds
    s_add_u32 m0, s95, 45056
    s_nop 0
    buffer_load_dwordx4 v34, s[96:99], s29 offen offset:0 lds
    s_waitcnt vmcnt(18) lgkmcnt(0)
    s_barrier
    s_cmp_lg_u32 s4, 0
    s_cbranch_scc1 L_fs_29
    s_lshl_b32 s3, s2, 7
    s_mov_b64 exec, 1
    v_mov_b32 v2, s62
    v_mov_b32 v3, s63
    v_mov_b32 v1, 98304
    buffer_store_dwordx2 v[2:3], v1, s[44:47], s3 offen sc1
    s_mov_b64 exec, -1
L_fs_29:
    s_mov_b32 s3, 0x40000
    s_mov_b32 s5, 65536
L_fw_30:
    buffer_load_dwordx2 v[4:5], v45, s[44:47], s5 offen sc1
    s_sub_u32 s3, s3, 1
    s_cbranch_scc1 L_fd_31
    s_waitcnt vmcnt(0)
    v_cmp_eq_u64 vcc, s[62:63], v[4:5]
    s_nop 1
    s_cmp_eq_u64 vcc, exec
    s_cbranch_scc0 L_fw_30
L_fd_31:
    s_waitcnt vmcnt(0)
    s_add_u32 s29, s100, 0
    buffer_load_dwordx4 a[128:131], v35, s[20:23], s29 offen offset:0 sc1
    buffer_load_dwordx4 a[132:135], v36, s[20:23], s29 offen offset:0 sc1
    buffer_load_dwordx4 a[136:139], v37, s[20:23], s29 offen offset:0 sc1
    buffer_load_dwordx4 a[140:143], v38, s[20:23], s29 offen offset:0 sc1
    s_add_u32 s29, s100, 0
    buffer_load_dwordx4 a[144:147], v35, s[20:23], s29 offen offset:1024 sc1
    buffer_load_dwordx4 a[148:151], v36, s[20:23], s29 offen offset:1024 sc1
    buffer_load_dwordx4 a[152:155], v37, s[20:23], s29 offen offset:1024 sc1
    buffer_load_dwordx4 a[156:159], v38, s[20:23], s29 offen offset:1024 sc1
    s_add_u32 s29, s100, 0
    buffer_load_dwordx4 a[160:163], v35, s[20:23], s29 offen offset:2048 sc1
    buffer_load_dwordx4 a[164:167], v36, s[20:23], s29 offen offset:2048 sc1
    buffer_load_dwordx4 a[168:171], v37, s[20:23], s29 offen offset:2048 sc1
    buffer_load_dwordx4 a[172:175], v38, s[20:23], s29 offen offset:2048 sc1
    s_add_u32 s29, s100, 0
    buffer_load_dwordx4 a[176:179], v35, s[20:23], s29 offen offset:3072 sc1
    buffer_load_dwordx4 a[180:183], v36, s[20:23], s29 offen offset:3072 sc1
    buffer_load_dwordx4 a[184:187], v37, s[20:23], s29 offen offset:3072 sc1
    buffer_load_dwordx4 a[188:191], v38, s[20:23], s29 offen offset:3072 sc1
    s_add_u32 s29, s100, 4096
    buffer_load_dwordx4 a[192:195], v35, s[20:23], s29 offen offset:0 sc1
    buffer_load_dwordx4 a[196:199], v36, s[20:23], s29 offen offset:0 sc1
    buffer_load_dwordx4 a[200:203], v37, s[20:23], s29 offen offset:0 sc1
    buffer_load_dwordx4 a[204:207], v38, s[20:23], s29 offen offset:0 sc1
    s_add_u32 s29, s100, 4096
    buffer_load_dwordx4 a[208:211], v35, s[20:23], s29 offen offset:1024 sc1
    buffer_load_dwordx4 a[212:215], v36, s[20:23], s29 offen offset:1024 sc1
    buffer_load_dwordx4 a[216:219], v37, s[20:23], s29 offen offset:1024 sc1
    buffer_load_dwordx4 a[220:223], v38, s[20:23], s29 offen offset:1024 sc1
    s_add_u32 s29, s100, 4096
    buffer_load_dwordx4 a[224:227], v35, s[20:23], s29 offen offset:2048 sc1
    buffer_load_dwordx4 a[228:231], v36, s[20:23], s29 offen offset:2048 sc1
    buffer_load_dwordx4 a[232:235], v37, s[20:23], s29 offen offset:2048 sc1
    buffer_load_dwordx4 a[236:239], v38, s[20:23], s29 offen offset:2048 sc1
    s_add_u32 s29, s100, 4096
    buffer_load_dwordx4 a[240:243], v35, s[20:23], s29 offen offset:3072 sc1
    buffer_load_dwordx4 a[244:247], v36, s[20:23], s29 offen offset:3072 sc1
    buffer_load_dwordx4 a[248:251], v37, s[20:23], s29 offen offset:3072 sc1
    buffer_load_dwordx4 a[252:255], v38, s[20:23], s29 offen offset:3072 sc1
L_atty_28:
    s_and_b32 s31, s2, 7
    s_mul_i32 s31, s31, 2359296
    s_add_u32 s31, s31, 0x5000000
    s_add_u32 s16, s88, s31
    s_addc_u32 s17, s89, 0
    s_mov_b32 s18, 0x240000
    s_mov_b32 s19, 0x20000
    s_mov_b32 s34, 4096
    s_waitcnt vmcnt(28)
    s_barrier
    ds_read_b64_tr_b16 v[48:49], v39 offset:0
    ds_read_b64_tr_b16 v[50:51], v39 offset:4608
    ds_read_b64_tr_b16 v[52:53], v39 offset:32
    ds_read_b64_tr_b16 v[54:55], v39 offset:4640
    ds_read_b64_tr_b16 v[56:57], v39 offset:64
    ds_read_b64_tr_b16 v[58:59], v39 offset:4672
    ds_read_b64_tr_b16 v[60:61], v39 offset:96
    ds_read_b64_tr_b16 v[62:63], v39 offset:4704
    ds_read_b64_tr_b16 v[64:65], v39 offset:128
    ds_read_b64_tr_b16 v[66:67], v39 offset:4736
    s_waitcnt vmcnt(63) lgkmcnt(8)
    v_mfma_f32_16x16x32_bf16 v[112:115], v[48:51], a[128:131], 0
    ds_read_b64_tr_b16 v[68:69], v39 offset:160
    v_mfma_f32_16x16x32_bf16 v[116:119], v[48:51], a[132:135], 0
    ds_read_b64_tr_b16 v[70:71], v39 offset:4768
    v_mfma_f32_16x16x32_bf16 v[120:123], v[48:51], a[136:139], 0
    s_add_u32 s31, s94, 294912
    s_add_u32 m0, s95, 73728
    s_nop 0
    buffer_load_dwordx4 v26, s[96:99], s31 offen offset:0 lds
    v_mfma_f32_16x16x32_bf16 v[124:127], v[48:51], a[140:143], 0
    s_waitcnt lgkmcnt(8)
    v_mfma_f32_16x16x32_bf16 v[128:131], v[52:55], a[128:131], 0
    ds_read_b64_tr_b16 v[72:73], v39 offset:192
    v_mfma_f32_16x16x32_bf16 v[132:135], v[52:55], a[132:135], 0
    ds_read_b64_tr_b16 v[74:75], v39 offset:4800
    v_mfma_f32_16x16x32_bf16 v[136:139], v[52:55], a[136:139], 0
    buffer_load_dwordx4 v27, s[96:99], s31 offen offset:1024 lds
    v_mfma_f32_16x16x32_bf16 v[140:143], v[52:55], a[140:143], 0
    s_waitcnt lgkmcnt(8)
    v_mfma_f32_16x16x32_bf16 v[144:147], v[56:59], a[128:131], 0
    ds_read_b64_tr_b16 v[76:77], v39 offset:224
    v_mfma_f32_16x16x32_bf16 v[148:151], v[56:59], a[132:135], 0
    ds_read_b64_tr_b16 v[78:79], v39 offset:4832
    v_mfma_f32_16x16x32_bf16 v[152:155], v[56:59], a[136:139], 0
    buffer_load_dwordx4 v28, s[96:99], s31 offen offset:2048 lds
    v_mfma_f32_16x16x32_bf16 v[156:159], v[56:59], a[140:143], 0
    s_waitcnt lgkmcnt(8)
    v_mfma_f32_16x16x32_bf16 v[160:163], v[60:63], a[128:131], 0
    ds_read_b64_tr_b16 v[80:81], v39 offset:256
    v_mfma_f32_16x16x32_bf16 v[164:167], v[60:63], a[132:135], 0
    ds_read_b64_tr_b16 v[82:83], v39 offset:4864
    v_mfma_f32_16x16x32_bf16 v[168:171], v[60:63], a[136:139], 0
    buffer_load_dwordx4 v29, s[96:99], s31 offen offset:3072 lds
    v_mfma_f32_16x16x32_bf16 v[172:175], v[60:63], a[140:143], 0
    s_waitcnt lgkmcnt(8)
    v_mfma_f32_16x16x32_bf16 v[176:179], v[64:67], a[128:131], 0
    ds_read_b64_tr_b16 v[84:85], v39 offset:9216
    v_mfma_f32_16x16x32_bf16 v[180:183], v[64:67], a[132:135], 0
    ds_read_b64_tr_b16 v[86:87], v39 offset:13824
    v_mfma_f32_16x16x32_bf16 v[184:187], v[64:67], a[136:139], 0
    s_add_u32 m0, s95, 77824
    s_nop 0
    buffer_load_dwordx4 v30, s[96:99], s31 offen offset:0 lds
    v_mfma_f32_16x16x32_bf16 v[188:191], v[64:67], a[140:143], 0
    s_waitcnt lgkmcnt(8)
    v_mfma_f32_16x16x32_bf16 v[192:195], v[68:71], a[128:131], 0
    ds_read_b64_tr_b16 v[88:89], v39 offset:9248
    v_mfma_f32_16x16x32_bf16 v[196:199], v[68:71], a[132:135], 0
    ds_read_b64_tr_b16 v[90:91], v39 offset:13856
    v_mfma_f32_16x16x32_bf16 v[200:203], v[68:71], a[136:139], 0
    buffer_load_dwordx4 v31, s[96:99], s31 offen offset:1024 lds
    v_mfma_f32_16x16x32_bf16 v[204:207], v[68:71], a[140:143], 0
    s_waitcnt lgkmcnt(8)
    v_mfma_f32_16x16x32_bf16 v[208:211], v[72:75], a[128:131], 0
    ds_read_b64_tr_b16 v[92:93], v39 offset:9280
    v_mfma_f32_16x16x32_bf16 v[212:215], v[72:75], a[132:135], 0
    ds_read_b64_tr_b16 v[94:95], v39 offset:13888
    v_mfma_f32_16x16x32_bf16 v[216:219], v[72:75], a[136:139], 0
    buffer_load_dwordx4 v32, s[96:99], s31 offen offset:2048 lds
    v_mfma_f32_16x16x32_bf16 v[220:223], v[72:75], a[140:143], 0
    s_waitcnt lgkmcnt(8)
    v_mfma_f32_16x16x32_bf16 v[224:227], v[76:79], a[128:131], 0
    ds_read_b64_tr_b16 v[96:97], v39 offset:9312
    v_mfma_f32_16x16x32_bf16 v[228:231], v[76:79], a[132:135], 0
    ds_read_b64_tr_b16 v[98:99], v39 offset:13920
    v_mfma_f32_16x16x32_bf16 v[232:235], v[76:79], a[136:139], 0
    buffer_load_dwordx4 v33, s[96:99], s31 offen offset:3072 lds
    v_mfma_f32_16x16x32_bf16 v[236:239], v[76:79], a[140:143], 0
    s_waitcnt lgkmcnt(8)
    v_mfma_f32_16x16x32_bf16 v[240:243], v[80:83], a[128:131], 0
    ds_read_b64_tr_b16 v[100:101], v39 offset:9344
    v_mfma_f32_16x16x32_bf16 v[244:247], v[80:83], a[132:135], 0
    ds_read_b64_tr_b16 v[102:103], v39 offset:13952
    v_mfma_f32_16x16x32_bf16 v[248:251], v[80:83], a[136:139], 0
    s_add_u32 m0, s95, 81920
    s_nop 0
    buffer_load_dwordx4 v34, s[96:99], s31 offen offset:0 lds
    v_mfma_f32_16x16x32_bf16 v[252:255], v[80:83], a[140:143], 0
    s_waitcnt vmcnt(33) lgkmcnt(8)
    v_mfma_f32_16x16x32_bf16 v[112:115], v[84:87], a[144:147], v[112:115]
    ds_read_b64_tr_b16 v[48:49], v39 offset:9376
    v_mfma_f32_16x16x32_bf16 v[116:119], v[84:87], a[148:151], v[116:119]
    ds_read_b64_tr_b16 v[50:51], v39 offset:13984
    v_mfma_f32_16x16x32_bf16 v[120:123], v[84:87], a[152:155], v[120:123]
    s_add_u32 s32, s100, 8192
    buffer_load_dwordx4 a[0:3], v35, s[20:23], s32 offen offset:0 sc1
    v_mfma_f32_16x16x32_bf16 v[124:127], v[84:87], a[156:159], v[124:127]
    s_waitcnt lgkmcnt(8)
    v_mfma_f32_16x16x32_bf16 v[128:131], v[88:91], a[144:147], v[128:131]
    ds_read_b64_tr_b16 v[52:53], v39 offset:9408
    v_mfma_f32_16x16x32_bf16 v[132:135], v[88:91], a[148:151], v[132:135]
    ds_read_b64_tr_b16 v[54:55], v39 offset:14016
    v_mfma_f32_16x16x32_bf16 v[136:139], v[88:91], a[152:155], v[136:139]
    buffer_load_dwordx4 a[4:7], v36, s[20:23], s32 offen offset:0 sc1
    v_mfma_f32_16x16x32_bf16 v[140:143], v[88:91], a[156:159], v[140:143]
    s_waitcnt lgkmcnt(8)
    v_mfma_f32_16x16x32_bf16 v[144:147], v[92:95], a[144:147], v[144:147]
    ds_read_b64_tr_b16 v[56:57], v39 offset:9440
    v_mfma_f32_16x16x32_bf16 v[148:151], v[92:95], a[148:151], v[148:151]
    ds_read_b64_tr_b16 v[58:59], v39 offset:14048
    v_mfma_f32_16x16x32_bf16 v[152:155], v[92:95], a[152:155], v[152:155]
    buffer_load_dwordx4 a[8:11], v37, s[20:23], s32 offen offset:0 sc1
    v_mfma_f32_16x16x32_bf16 v[156:159], v[92:95], a[156:159], v[156:159]
    s_waitcnt lgkmcnt(8)
    v_mfma_f32_16x16x32_bf16 v[160:163], v[96:99], a[144:147], v[160:163]
    ds_read_b64_tr_b16 v[60:61], v39 offset:9472
    v_mfma_f32_16x16x32_bf16 v[164:167], v[96:99], a[148:151], v[164:167]
    ds_read_b64_tr_b16 v[62:63], v39 offset:14080
    v_mfma_f32_16x16x32_bf16 v[168:171], v[96:99], a[152:155], v[168:171]
    buffer_load_dwordx4 a[12:15], v38, s[20:23], s32 offen offset:0 sc1
    v_mfma_f32_16x16x32_bf16 v[172:175], v[96:99], a[156:159], v[172:175]
    s_waitcnt lgkmcnt(8)
    v_mfma_f32_16x16x32_bf16 v[176:179], v[100:103], a[144:147], v[176:179]
    ds_read_b64_tr_b16 v[64:65], v39 offset:18432
    v_mfma_f32_16x16x32_bf16 v[180:183], v[100:103], a[148:151], v[180:183]
    ds_read_b64_tr_b16 v[66:67], v39 offset:23040
    v_mfma_f32_16x16x32_bf16 v[184:187], v[100:103], a[152:155], v[184:187]
    s_add_u32 s32, s100, 8192
    buffer_load_dwordx4 a[16:19], v35, s[20:23], s32 offen offset:1024 sc1
    v_mfma_f32_16x16x32_bf16 v[188:191], v[100:103], a[156:159], v[188:191]
    s_waitcnt lgkmcnt(8)
    v_mfma_f32_16x16x32_bf16 v[192:195], v[48:51], a[144:147], v[192:195]
    ds_read_b64_tr_b16 v[68:69], v39 offset:18464
    v_mfma_f32_16x16x32_bf16 v[196:199], v[48:51], a[148:151], v[196:199]
    ds_read_b64_tr_b16 v[70:71], v39 offset:23072
    v_mfma_f32_16x16x32_bf16 v[200:203], v[48:51], a[152:155], v[200:203]
    buffer_load_dwordx4 a[20:23], v36, s[20:23], s32 offen offset:1024 sc1
    v_mfma_f32_16x16x32_bf16 v[204:207], v[48:51], a[156:159], v[204:207]
    s_waitcnt lgkmcnt(8)
    v_mfma_f32_16x16x32_bf16 v[208:211], v[52:55], a[144:147], v[208:211]
    ds_read_b64_tr_b16 v[72:73], v39 offset:18496
    v_mfma_f32_16x16x32_bf16 v[212:215], v[52:55], a[148:151], v[212:215]
    ds_read_b64_tr_b16 v[74:75], v39 offset:23104
    v_mfma_f32_16x16x32_bf16 v[216:219], v[52:55], a[152:155], v[216:219]
    buffer_load_dwordx4 a[24:27], v37, s[20:23], s32 offen offset:1024 sc1
    v_mfma_f32_16x16x32_bf16 v[220:223], v[52:55], a[156:159], v[220:223]
    s_waitcnt lgkmcnt(8)
    v_mfma_f32_16x16x32_bf16 v[224:227], v[56:59], a[144:147], v[224:227]
    ds_read_b64_tr_b16 v[76:77], v39 offset:18528
    v_mfma_f32_16x16x32_bf16 v[228:231], v[56:59], a[148:151], v[228:231]
    ds_read_b64_tr_b16 v[78:79], v39 offset:23136
    v_mfma_f32_16x16x32_bf16 v[232:235], v[56:59], a[152:155], v[232:235]
    buffer_load_dwordx4 a[28:31], v38, s[20:23], s32 offen offset:1024 sc1
    v_mfma_f32_16x16x32_bf16 v[236:239], v[56:59], a[156:159], v[236:239]
    s_waitcnt lgkmcnt(8)
    v_mfma_f32_16x16x32_bf16 v[240:243], v[60:63], a[144:147], v[240:243]
    ds_read_b64_tr_b16 v[80:81], v39 offset:18560
    v_mfma_f32_16x16x32_bf16 v[244:247], v[60:63], a[148:151], v[244:247]
    ds_read_b64_tr_b16 v[82:83], v39 offset:23168
    v_mfma_f32_16x16x32_bf16 v[248:251], v[60:63], a[152:155], v[248:251]
    v_mfma_f32_16x16x32_bf16 v[252:255], v[60:63], a[156:159], v[252:255]
    s_waitcnt vmcnt(37) lgkmcnt(8)
    v_mfma_f32_16x16x32_bf16 v[112:115], v[64:67], a[160:163], v[112:115]
    ds_read_b64_tr_b16 v[84:85], v39 offset:18592
    v_mfma_f32_16x16x32_bf16 v[116:119], v[64:67], a[164:167], v[116:119]
    ds_read_b64_tr_b16 v[86:87], v39 offset:23200
    v_mfma_f32_16x16x32_bf16 v[120:123], v[64:67], a[168:171], v[120:123]
    s_add_u32 s32, s100, 8192
    buffer_load_dwordx4 a[32:35], v35, s[20:23], s32 offen offset:2048 sc1
    v_mfma_f32_16x16x32_bf16 v[124:127], v[64:67], a[172:175], v[124:127]
    s_waitcnt lgkmcnt(8)
    v_mfma_f32_16x16x32_bf16 v[128:131], v[68:71], a[160:163], v[128:131]
    ds_read_b64_tr_b16 v[88:89], v39 offset:18624
    v_mfma_f32_16x16x32_bf16 v[132:135], v[68:71], a[164:167], v[132:135]
    ds_read_b64_tr_b16 v[90:91], v39 offset:23232
    v_mfma_f32_16x16x32_bf16 v[136:139], v[68:71], a[168:171], v[136:139]
    buffer_load_dwordx4 a[36:39], v36, s[20:23], s32 offen offset:2048 sc1
    v_mfma_f32_16x16x32_bf16 v[140:143], v[68:71], a[172:175], v[140:143]
    s_waitcnt lgkmcnt(8)
    v_mfma_f32_16x16x32_bf16 v[144:147], v[72:75], a[160:163], v[144:147]
    ds_read_b64_tr_b16 v[92:93], v39 offset:18656
    v_mfma_f32_16x16x32_bf16 v[148:151], v[72:75], a[164:167], v[148:151]
    ds_read_b64_tr_b16 v[94:95], v39 offset:23264
    v_mfma_f32_16x16x32_bf16 v[152:155], v[72:75], a[168:171], v[152:155]
    buffer_load_dwordx4 a[40:43], v37, s[20:23], s32 offen offset:2048 sc1
    v_mfma_f32_16x16x32_bf16 v[156:159], v[72:75], a[172:175], v[156:159]
    s_waitcnt lgkmcnt(8)
    v_mfma_f32_16x16x32_bf16 v[160:163], v[76:79], a[160:163], v[160:163]
    ds_read_b64_tr_b16 v[96:97], v39 offset:18688
    v_mfma_f32_16x16x32_bf16 v[164:167], v[76:79], a[164:167], v[164:167]
    ds_read_b64_tr_b16 v[98:99], v39 offset:23296
    v_mfma_f32_16x16x32_bf16 v[168:171], v[76:79], a[168:171], v[168:171]
    buffer_load_dwordx4 a[44:47], v38, s[20:23], s32 offen offset:2048 sc1
    v_mfma_f32_16x16x32_bf16 v[172:175], v[76:79], a[172:175], v[172:175]
    s_waitcnt lgkmcnt(8)
    v_mfma_f32_16x16x32_bf16 v[176:179], v[80:83], a[160:163], v[176:179]
    ds_read_b64_tr_b16 v[100:101], v39 offset:27648
    v_mfma_f32_16x16x32_bf16 v[180:183], v[80:83], a[164:167], v[180:183]
    ds_read_b64_tr_b16 v[102:103], v39 offset:32256
    v_mfma_f32_16x16x32_bf16 v[184:187], v[80:83], a[168:171], v[184:187]
    v_mfma_f32_16x16x32_bf16 v[188:191], v[80:83], a[172:175], v[188:191]
    s_waitcnt lgkmcnt(8)
    v_mfma_f32_16x16x32_bf16 v[192:195], v[84:87], a[160:163], v[192:195]
    ds_read_b64_tr_b16 v[48:49], v39 offset:27680
    v_mfma_f32_16x16x32_bf16 v[196:199], v[84:87], a[164:167], v[196:199]
    ds_read_b64_tr_b16 v[50:51], v39 offset:32288
    v_mfma_f32_16x16x32_bf16 v[200:203], v[84:87], a[168:171], v[200:203]
    v_mfma_f32_16x16x32_bf16 v[204:207], v[84:87], a[172:175], v[204:207]
    s_waitcnt lgkmcnt(8)
    v_mfma_f32_16x16x32_bf16 v[208:211], v[88:91], a[160:163], v[208:211]
    ds_read_b64_tr_b16 v[52:53], v39 offset:27712
    v_mfma_f32_16x16x32_bf16 v[212:215], v[88:91], a[164:167], v[212:215]
    ds_read_b64_tr_b16 v[54:55], v39 offset:32320
    v_mfma_f32_16x16x32_bf16 v[216:219], v[88:91], a[168:171], v[216:219]
    v_mfma_f32_16x16x32_bf16 v[220:223], v[88:91], a[172:175], v[220:223]
    s_waitcnt lgkmcnt(8)
    v_mfma_f32_16x16x32_bf16 v[224:227], v[92:95], a[160:163], v[224:227]
    ds_read_b64_tr_b16 v[56:57], v39 offset:27744
    v_mfma_f32_16x16x32_bf16 v[228:231], v[92:95], a[164:167], v[228:231]
    ds_read_b64_tr_b16 v[58:59], v39 offset:32352
    v_mfma_f32_16x16x32_bf16 v[232:235], v[92:95], a[168:171], v[232:235]
    v_mfma_f32_16x16x32_bf16 v[236:239], v[92:95], a[172:175], v[236:239]
    s_waitcnt lgkmcnt(8)
    v_mfma_f32_16x16x32_bf16 v[240:243], v[96:99], a[160:163], v[240:243]
    ds_read_b64_tr_b16 v[60:61], v39 offset:27776
    v_mfma_f32_16x16x32_bf16 v[244:247], v[96:99], a[164:167], v[244:247]
    ds_read_b64_tr_b16 v[62:63], v39 offset:32384
    v_mfma_f32_16x16x32_bf16 v[248:251], v[96:99], a[168:171], v[248:251]
    v_mfma_f32_16x16x32_bf16 v[252:255], v[96:99], a[172:175], v[252:255]
    s_waitcnt vmcnt(37) lgkmcnt(8)
    v_mfma_f32_16x16x32_bf16 v[112:115], v[100:103], a[176:179], v[112:115]
    ds_read_b64_tr_b16 v[64:65], v39 offset:27808
    v_mfma_f32_16x16x32_bf16 v[116:119], v[100:103], a[180:183], v[116:119]
    ds_read_b64_tr_b16 v[66:67], v39 offset:32416
    v_mfma_f32_16x16x32_bf16 v[120:123], v[100:103], a[184:187], v[120:123]
    s_add_u32 s32, s100, 8192
    buffer_load_dwordx4 a[48:51], v35, s[20:23], s32 offen offset:3072 sc1
    v_mfma_f32_16x16x32_bf16 v[124:127], v[100:103], a[188:191], v[124:127]
    s_waitcnt lgkmcnt(8)
    v_mfma_f32_16x16x32_bf16 v[128:131], v[48:51], a[176:179], v[128:131]
    ds_read_b64_tr_b16 v[68:69], v39 offset:27840
    v_mfma_f32_16x16x32_bf16 v[132:135], v[48:51], a[180:183], v[132:135]
    ds_read_b64_tr_b16 v[70:71], v39 offset:32448
    v_mfma_f32_16x16x32_bf16 v[136:139], v[48:51], a[184:187], v[136:139]
    buffer_load_dwordx4 a[52:55], v36, s[20:23], s32 offen offset:3072 sc1
    v_mfma_f32_16x16x32_bf16 v[140:143], v[48:51], a[188:191], v[140:143]
    s_waitcnt lgkmcnt(8)
    v_mfma_f32_16x16x32_bf16 v[144:147], v[52:55], a[176:179], v[144:147]
    ds_read_b64_tr_b16 v[72:73], v39 offset:27872
    v_mfma_f32_16x16x32_bf16 v[148:151], v[52:55], a[180:183], v[148:151]
    ds_read_b64_tr_b16 v[74:75], v39 offset:32480
    v_mfma_f32_16x16x32_bf16 v[152:155], v[52:55], a[184:187], v[152:155]
    buffer_load_dwordx4 a[56:59], v37, s[20:23], s32 offen offset:3072 sc1
    v_mfma_f32_16x16x32_bf16 v[156:159], v[52:55], a[188:191], v[156:159]
    s_waitcnt lgkmcnt(8)
    v_mfma_f32_16x16x32_bf16 v[160:163], v[56:59], a[176:179], v[160:163]
    ds_read_b64_tr_b16 v[76:77], v39 offset:27904
    v_mfma_f32_16x16x32_bf16 v[164:167], v[56:59], a[180:183], v[164:167]
    ds_read_b64_tr_b16 v[78:79], v39 offset:32512
    v_mfma_f32_16x16x32_bf16 v[168:171], v[56:59], a[184:187], v[168:171]
    buffer_load_dwordx4 a[60:63], v38, s[20:23], s32 offen offset:3072 sc1
    v_mfma_f32_16x16x32_bf16 v[172:175], v[56:59], a[188:191], v[172:175]
    s_waitcnt lgkmcnt(8)
    v_mfma_f32_16x16x32_bf16 v[176:179], v[60:63], a[176:179], v[176:179]
    s_waitcnt vmcnt(25)
    s_barrier
    s_cmp_lg_u32 s4, 0
    s_cbranch_scc1 L_fs_34
    s_lshl_b32 s3, s2, 7
    s_mov_b64 exec, 1
    v_mov_b32 v2, s62
    v_mov_b32 v3, s63
    v_mov_b32 v1, 98304
    buffer_store_dwordx2 v[2:3], v1, s[44:47], s3 offen sc1
    s_mov_b64 exec, -1
L_fs_34:
    ds_read_b64_tr_b16 v[80:81], v40 offset:0
    v_mfma_f32_16x16x32_bf16 v[180:183], v[60:63], a[180:183], v[180:183]
    ds_read_b64_tr_b16 v[82:83], v40 offset:4608
    v_mfma_f32_16x16x32_bf16 v[184:187], v[60:63], a[184:187], v[184:187]
    s_add_u32 s31, s94, 442368
    s_add_u32 m0, s95, 110592
    s_nop 0
    buffer_load_dwordx4 v26, s[96:99], s31 offen offset:0 lds
    v_mfma_f32_16x16x32_bf16 v[188:191], v[60:63], a[188:191], v[188:191]
    s_waitcnt lgkmcnt(8)
    v_mfma_f32_16x16x32_bf16 v[192:195], v[64:67], a[176:179], v[192:195]
    ds_read_b64_tr_b16 v[84:85], v40 offset:32
    v_mfma_f32_16x16x32_bf16 v[196:199], v[64:67], a[180:183], v[196:199]
    ds_read_b64_tr_b16 v[86:87], v40 offset:4640
    v_mfma_f32_16x16x32_bf16 v[200:203], v[64:67], a[184:187], v[200:203]
    buffer_load_dwordx4 v27, s[96:99], s31 offen offset:1024 lds
    v_mfma_f32_16x16x32_bf16 v[204:207], v[64:67], a[188:191], v[204:207]
    s_waitcnt lgkmcnt(8)
    v_mfma_f32_16x16x32_bf16 v[208:211], v[68:71], a[176:179], v[208:211]
    ds_read_b64_tr_b16 v[88:89], v40 offset:64
    v_mfma_f32_16x16x32_bf16 v[212:215], v[68:71], a[180:183], v[212:215]
    ds_read_b64_tr_b16 v[90:91], v40 offset:4672
    v_mfma_f32_16x16x32_bf16 v[216:219], v[68:71], a[184:187], v[216:219]
    buffer_load_dwordx4 v28, s[96:99], s31 offen offset:2048 lds
    v_mfma_f32_16x16x32_bf16 v[220:223], v[68:71], a[188:191], v[220:223]
    s_waitcnt lgkmcnt(8)
    v_mfma_f32_16x16x32_bf16 v[224:227], v[72:75], a[176:179], v[224:227]
    ds_read_b64_tr_b16 v[92:93], v40 offset:96
    v_mfma_f32_16x16x32_bf16 v[228:231], v[72:75], a[180:183], v[228:231]
    ds_read_b64_tr_b16 v[94:95], v40 offset:4704
    v_mfma_f32_16x16x32_bf16 v[232:235], v[72:75], a[184:187], v[232:235]
    buffer_load_dwordx4 v29, s[96:99], s31 offen offset:3072 lds
    v_mfma_f32_16x16x32_bf16 v[236:239], v[72:75], a[188:191], v[236:239]
    s_waitcnt lgkmcnt(8)
    v_mfma_f32_16x16x32_bf16 v[240:243], v[76:79], a[176:179], v[240:243]
    ds_read_b64_tr_b16 v[96:97], v40 offset:128
    v_mfma_f32_16x16x32_bf16 v[244:247], v[76:79], a[180:183], v[244:247]
    ds_read_b64_tr_b16 v[98:99], v40 offset:4736
    v_mfma_f32_16x16x32_bf16 v[248:251], v[76:79], a[184:187], v[248:251]
    s_add_u32 m0, s95, 114688
    s_nop 0
    buffer_load_dwordx4 v30, s[96:99], s31 offen offset:0 lds
    v_mfma_f32_16x16x32_bf16 v[252:255], v[76:79], a[188:191], v[252:255]
    s_waitcnt vmcnt(63) lgkmcnt(8)
    v_mfma_f32_16x16x32_bf16 v[112:115], v[80:83], a[192:195], v[112:115]
    ds_read_b64_tr_b16 v[100:101], v40 offset:160
    v_mfma_f32_16x16x32_bf16 v[116:119], v[80:83], a[196:199], v[116:119]
    ds_read_b64_tr_b16 v[102:103], v40 offset:4768
    v_mfma_f32_16x16x32_bf16 v[120:123], v[80:83], a[200:203], v[120:123]
    buffer_load_dwordx4 v31, s[96:99], s31 offen offset:1024 lds
    v_mfma_f32_16x16x32_bf16 v[124:127], v[80:83], a[204:207], v[124:127]
    s_waitcnt lgkmcnt(8)
    v_mfma_f32_16x16x32_bf16 v[128:131], v[84:87], a[192:195], v[128:131]
    ds_read_b64_tr_b16 v[48:49], v40 offset:192
    v_mfma_f32_16x16x32_bf16 v[132:135], v[84:87], a[196:199], v[132:135]
    ds_read_b64_tr_b16 v[50:51], v40 offset:4800
    v_mfma_f32_16x16x32_bf16 v[136:139], v[84:87], a[200:203], v[136:139]
    buffer_load_dwordx4 v32, s[96:99], s31 offen offset:2048 lds
    v_mfma_f32_16x16x32_bf16 v[140:143], v[84:87], a[204:207], v[140:143]
    s_waitcnt lgkmcnt(8)
    v_mfma_f32_16x16x32_bf16 v[144:147], v[88:91], a[192:195], v[144:147]
    ds_read_b64_tr_b16 v[52:53], v40 offset:224
    v_mfma_f32_16x16x32_bf16 v[148:151], v[88:91], a[196:199], v[148:151]
    ds_read_b64_tr_b16 v[54:55], v40 offset:4832
    v_mfma_f32_16x16x32_bf16 v[152:155], v[88:91], a[200:203], v[152:155]
    buffer_load_dwordx4 v33, s[96:99], s31 offen offset:3072 lds
    v_mfma_f32_16x16x32_bf16 v[156:159], v[88:91], a[204:207], v[156:159]
    s_waitcnt lgkmcnt(8)
    v_mfma_f32_16x16x32_bf16 v[160:163], v[92:95], a[192:195], v[160:163]
    ds_read_b64_tr_b16 v[56:57], v40 offset:256
    v_mfma_f32_16x16x32_bf16 v[164:167], v[92:95], a[196:199], v[164:167]
    ds_read_b64_tr_b16 v[58:59], v40 offset:4864
    v_mfma_f32_16x16x32_bf16 v[168:171], v[92:95], a[200:203], v[168:171]
    s_add_u32 m0, s95, 118784
    s_nop 0
    buffer_load_dwordx4 v34, s[96:99], s31 offen offset:0 lds
    v_mfma_f32_16x16x32_bf16 v[172:175], v[92:95], a[204:207], v[172:175]
    s_waitcnt lgkmcnt(8)
    v_mfma_f32_16x16x32_bf16 v[176:179], v[96:99], a[192:195], v[176:179]
    ds_read_b64_tr_b16 v[60:61], v40 offset:9216
    v_mfma_f32_16x16x32_bf16 v[180:183], v[96:99], a[196:199], v[180:183]
    ds_read_b64_tr_b16 v[62:63], v40 offset:13824
    v_mfma_f32_16x16x32_bf16 v[184:187], v[96:99], a[200:203], v[184:187]
    s_add_u32 s32, s100, 12288
    buffer_load_dwordx4 a[64:67], v35, s[20:23], s32 offen offset:0 sc1
    v_mfma_f32_16x16x32_bf16 v[188:191], v[96:99], a[204:207], v[188:191]
    s_waitcnt lgkmcnt(8)
    v_mfma_f32_16x16x32_bf16 v[192:195], v[100:103], a[192:195], v[192:195]
    ds_read_b64_tr_b16 v[64:65], v40 offset:9248
    v_mfma_f32_16x16x32_bf16 v[196:199], v[100:103], a[196:199], v[196:199]
    ds_read_b64_tr_b16 v[66:67], v40 offset:13856
    v_mfma_f32_16x16x32_bf16 v[200:203], v[100:103], a[200:203], v[200:203]
    buffer_load_dwordx4 a[68:71], v36, s[20:23], s32 offen offset:0 sc1
    v_mfma_f32_16x16x32_bf16 v[204:207], v[100:103], a[204:207], v[204:207]
    s_waitcnt lgkmcnt(8)
    v_mfma_f32_16x16x32_bf16 v[208:211], v[48:51], a[192:195], v[208:211]
    ds_read_b64_tr_b16 v[68:69], v40 offset:9280
    v_mfma_f32_16x16x32_bf16 v[212:215], v[48:51], a[196:199], v[212:215]
    ds_read_b64_tr_b16 v[70:71], v40 offset:13888
    v_mfma_f32_16x16x32_bf16 v[216:219], v[48:51], a[200:203], v[216:219]
    buffer_load_dwordx4 a[72:75], v37, s[20:23], s32 offen offset:0 sc1
    v_mfma_f32_16x16x32_bf16 v[220:223], v[48:51], a[204:207], v[220:223]
    s_waitcnt lgkmcnt(8)
    v_mfma_f32_16x16x32_bf16 v[224:227], v[52:55], a[192:195], v[224:227]
    ds_read_b64_tr_b16 v[72:73], v40 offset:9312
    v_mfma_f32_16x16x32_bf16 v[228:231], v[52:55], a[196:199], v[228:231]
    ds_read_b64_tr_b16 v[74:75], v40 offset:13920
    v_mfma_f32_16x16x32_bf16 v[232:235], v[52:55], a[200:203], v[232:235]
    buffer_load_dwordx4 a[76:79], v38, s[20:23], s32 offen offset:0 sc1
    v_mfma_f32_16x16x32_bf16 v[236:239], v[52:55], a[204:207], v[236:239]
    s_waitcnt lgkmcnt(8)
    v_mfma_f32_16x16x32_bf16 v[240:243], v[56:59], a[192:195], v[240:243]
    ds_read_b64_tr_b16 v[76:77], v40 offset:9344
    v_mfma_f32_16x16x32_bf16 v[244:247], v[56:59], a[196:199], v[244:247]
    ds_read_b64_tr_b16 v[78:79], v40 offset:13952
    v_mfma_f32_16x16x32_bf16 v[248:251], v[56:59], a[200:203], v[248:251]
    v_mfma_f32_16x16x32_bf16 v[252:255], v[56:59], a[204:207], v[252:255]
    s_waitcnt vmcnt(63) lgkmcnt(8)
    v_mfma_f32_16x16x32_bf16 v[112:115], v[60:63], a[208:211], v[112:115]
    ds_read_b64_tr_b16 v[80:81], v40 offset:9376
    v_mfma_f32_16x16x32_bf16 v[116:119], v[60:63], a[212:215], v[116:119]
    ds_read_b64_tr_b16 v[82:83], v40 offset:13984
    v_mfma_f32_16x16x32_bf16 v[120:123], v[60:63], a[216:219], v[120:123]
    s_add_u32 s32, s100, 12288
    buffer_load_dwordx4 a[80:83], v35, s[20:23], s32 offen offset:1024 sc1
    v_mfma_f32_16x16x32_bf16 v[124:127], v[60:63], a[220:223], v[124:127]
    s_waitcnt lgkmcnt(8)
    v_mfma_f32_16x16x32_bf16 v[128:131], v[64:67], a[208:211], v[128:131]
    ds_read_b64_tr_b16 v[84:85], v40 offset:9408
    v_mfma_f32_16x16x32_bf16 v[132:135], v[64:67], a[212:215], v[132:135]
    ds_read_b64_tr_b16 v[86:87], v40 offset:14016
    v_mfma_f32_16x16x32_bf16 v[136:139], v[64:67], a[216:219], v[136:139]
    buffer_load_dwordx4 a[84:87], v36, s[20:23], s32 offen offset:1024 sc1
    v_mfma_f32_16x16x32_bf16 v[140:143], v[64:67], a[220:223], v[140:143]
    s_waitcnt lgkmcnt(8)
    v_mfma_f32_16x16x32_bf16 v[144:147], v[68:71], a[208:211], v[144:147]
    ds_read_b64_tr_b16 v[88:89], v40 offset:9440
    v_mfma_f32_16x16x32_bf16 v[148:151], v[68:71], a[212:215], v[148:151]
    ds_read_b64_tr_b16 v[90:91], v40 offset:14048
    v_mfma_f32_16x16x32_bf16 v[152:155], v[68:71], a[216:219], v[152:155]
    buffer_load_dwordx4 a[88:91], v37, s[20:23], s32 offen offset:1024 sc1
    v_mfma_f32_16x16x32_bf16 v[156:159], v[68:71], a[220:223], v[156:159]
    s_waitcnt lgkmcnt(8)
    v_mfma_f32_16x16x32_bf16 v[160:163], v[72:75], a[208:211], v[160:163]
    ds_read_b64_tr_b16 v[92:93], v40 offset:9472
    v_mfma_f32_16x16x32_bf16 v[164:167], v[72:75], a[212:215], v[164:167]
    ds_read_b64_tr_b16 v[94:95], v40 offset:14080
    v_mfma_f32_16x16x32_bf16 v[168:171], v[72:75], a[216:219], v[168:171]
    buffer_load_dwordx4 a[92:95], v38, s[20:23], s32 offen offset:1024 sc1
    v_mfma_f32_16x16x32_bf16 v[172:175], v[72:75], a[220:223], v[172:175]
    s_waitcnt lgkmcnt(8)
    v_mfma_f32_16x16x32_bf16 v[176:179], v[76:79], a[208:211], v[176:179]
    ds_read_b64_tr_b16 v[96:97], v40 offset:18432
    v_mfma_f32_16x16x32_bf16 v[180:183], v[76:79], a[212:215], v[180:183]
    ds_read_b64_tr_b16 v[98:99], v40 offset:23040
    v_mfma_f32_16x16x32_bf16 v[184:187], v[76:79], a[216:219], v[184:187]
    v_mfma_f32_16x16x32_bf16 v[188:191], v[76:79], a[220:223], v[188:191]
    s_waitcnt lgkmcnt(8)
    v_mfma_f32_16x16x32_bf16 v[192:195], v[80:83], a[208:211], v[192:195]
    ds_read_b64_tr_b16 v[100:101], v40 offset:18464
    v_mfma_f32_16x16x32_bf16 v[196:199], v[80:83], a[212:215], v[196:199]
    ds_read_b64_tr_b16 v[102:103], v40 offset:23072
    v_mfma_f32_16x16x32_bf16 v[200:203], v[80:83], a[216:219], v[200:203]
    v_mfma_f32_16x16x32_bf16 v[204:207], v[80:83], a[220:223], v[204:207]
    s_waitcnt lgkmcnt(8)
    v_mfma_f32_16x16x32_bf16 v[208:211], v[84:87], a[208:211], v[208:211]
    ds_read_b64_tr_b16 v[48:49], v40 offset:18496
    v_mfma_f32_16x16x32_bf16 v[212:215], v[84:87], a[212:215], v[212:215]
    ds_read_b64_tr_b16 v[50:51], v40 offset:23104
    v_mfma_f32_16x16x32_bf16 v[216:219], v[84:87], a[216:219], v[216:219]
    v_mfma_f32_16x16x32_bf16 v[220:223], v[84:87], a[220:223], v[220:223]
    s_waitcnt lgkmcnt(8)
    v_mfma_f32_16x16x32_bf16 v[224:227], v[88:91], a[208:211], v[224:227]
    ds_read_b64_tr_b16 v[52:53], v40 offset:18528
    v_mfma_f32_16x16x32_bf16 v[228:231], v[88:91], a[212:215], v[228:231]
    ds_read_b64_tr_b16 v[54:55], v40 offset:23136
    v_mfma_f32_16x16x32_bf16 v[232:235], v[88:91], a[216:219], v[232:235]
    v_mfma_f32_16x16x32_bf16 v[236:239], v[88:91], a[220:223], v[236:239]
    s_waitcnt lgkmcnt(8)
    v_mfma_f32_16x16x32_bf16 v[240:243], v[92:95], a[208:211], v[240:243]
    ds_read_b64_tr_b16 v[56:57], v40 offset:18560
    v_mfma_f32_16x16x32_bf16 v[244:247], v[92:95], a[212:215], v[244:247]
    ds_read_b64_tr_b16 v[58:59], v40 offset:23168
    v_mfma_f32_16x16x32_bf16 v[248:251], v[92:95], a[216:219], v[248:251]
    v_mfma_f32_16x16x32_bf16 v[252:255], v[92:95], a[220:223], v[252:255]
    s_waitcnt vmcnt(63) lgkmcnt(8)
    v_mfma_f32_16x16x32_bf16 v[112:115], v[96:99], a[224:227], v[112:115]
    ds_read_b64_tr_b16 v[60:61], v40 offset:18592
    v_mfma_f32_16x16x32_bf16 v[116:119], v[96:99], a[228:231], v[116:119]
    ds_read_b64_tr_b16 v[62:63], v40 offset:23200
    v_mfma_f32_16x16x32_bf16 v[120:123], v[96:99], a[232:235], v[120:123]
    s_add_u32 s32, s100, 12288
    buffer_load_dwordx4 a[96:99], v35, s[20:23], s32 offen offset:2048 sc1
    v_mfma_f32_16x16x32_bf16 v[124:127], v[96:99], a[236:239], v[124:127]
    s_waitcnt lgkmcnt(8)
    v_mfma_f32_16x16x32_bf16 v[128:131], v[100:103], a[224:227], v[128:131]
    ds_read_b64_tr_b16 v[64:65], v40 offset:18624
    v_mfma_f32_16x16x32_bf16 v[132:135], v[100:103], a[228:231], v[132:135]
    ds_read_b64_tr_b16 v[66:67], v40 offset:23232
    v_mfma_f32_16x16x32_bf16 v[136:139], v[100:103], a[232:235], v[136:139]
    buffer_load_dwordx4 a[100:103], v36, s[20:23], s32 offen offset:2048 sc1
    v_mfma_f32_16x16x32_bf16 v[140:143], v[100:103], a[236:239], v[140:143]
    s_waitcnt lgkmcnt(8)
    v_mfma_f32_16x16x32_bf16 v[144:147], v[48:51], a[224:227], v[144:147]
    ds_read_b64_tr_b16 v[68:69], v40 offset:18656
    v_mfma_f32_16x16x32_bf16 v[148:151], v[48:51], a[228:231], v[148:151]
    ds_read_b64_tr_b16 v[70:71], v40 offset:23264
    v_mfma_f32_16x16x32_bf16 v[152:155], v[48:51], a[232:235], v[152:155]
    buffer_load_dwordx4 a[104:107], v37, s[20:23], s32 offen offset:2048 sc1
    v_mfma_f32_16x16x32_bf16 v[156:159], v[48:51], a[236:239], v[156:159]
    s_waitcnt lgkmcnt(8)
    v_mfma_f32_16x16x32_bf16 v[160:163], v[52:55], a[224:227], v[160:163]
    ds_read_b64_tr_b16 v[72:73], v40 offset:18688
    v_mfma_f32_16x16x32_bf16 v[164:167], v[52:55], a[228:231], v[164:167]
    ds_read_b64_tr_b16 v[74:75], v40 offset:23296
    v_mfma_f32_16x16x32_bf16 v[168:171], v[52:55], a[232:235], v[168:171]
    buffer_load_dwordx4 a[108:111], v38, s[20:23], s32 offen offset:2048 sc1
    v_mfma_f32_16x16x32_bf16 v[172:175], v[52:55], a[236:239], v[172:175]
    s_waitcnt lgkmcnt(8)
    v_mfma_f32_16x16x32_bf16 v[176:179], v[56:59], a[224:227], v[176:179]
    ds_read_b64_tr_b16 v[76:77], v40 offset:27648
    v_mfma_f32_16x16x32_bf16 v[180:183], v[56:59], a[228:231], v[180:183]
    ds_read_b64_tr_b16 v[78:79], v40 offset:32256
    v_mfma_f32_16x16x32_bf16 v[184:187], v[56:59], a[232:235], v[184:187]
    v_mfma_f32_16x16x32_bf16 v[188:191], v[56:59], a[236:239], v[188:191]
    s_waitcnt lgkmcnt(8)
    v_mfma_f32_16x16x32_bf16 v[192:195], v[60:63], a[224:227], v[192:195]
    ds_read_b64_tr_b16 v[80:81], v40 offset:27680
    v_mfma_f32_16x16x32_bf16 v[196:199], v[60:63], a[228:231], v[196:199]
    ds_read_b64_tr_b16 v[82:83], v40 offset:32288
    v_mfma_f32_16x16x32_bf16 v[200:203], v[60:63], a[232:235], v[200:203]
    v_mfma_f32_16x16x32_bf16 v[204:207], v[60:63], a[236:239], v[204:207]
    s_waitcnt lgkmcnt(8)
    v_mfma_f32_16x16x32_bf16 v[208:211], v[64:67], a[224:227], v[208:211]
    ds_read_b64_tr_b16 v[84:85], v40 offset:27712
    v_mfma_f32_16x16x32_bf16 v[212:215], v[64:67], a[228:231], v[212:215]
    ds_read_b64_tr_b16 v[86:87], v40 offset:32320
    v_mfma_f32_16x16x32_bf16 v[216:219], v[64:67], a[232:235], v[216:219]
    v_mfma_f32_16x16x32_bf16 v[220:223], v[64:67], a[236:239], v[220:223]
    s_waitcnt lgkmcnt(8)
    v_mfma_f32_16x16x32_bf16 v[224:227], v[68:71], a[224:227], v[224:227]
    ds_read_b64_tr_b16 v[88:89], v40 offset:27744
    v_mfma_f32_16x16x32_bf16 v[228:231], v[68:71], a[228:231], v[228:231]
    ds_read_b64_tr_b16 v[90:91], v40 offset:32352
    v_mfma_f32_16x16x32_bf16 v[232:235], v[68:71], a[232:235], v[232:235]
    v_mfma_f32_16x16x32_bf16 v[236:239], v[68:71], a[236:239], v[236:239]
    s_waitcnt lgkmcnt(8)
    v_mfma_f32_16x16x32_bf16 v[240:243], v[72:75], a[224:227], v[240:243]
    ds_read_b64_tr_b16 v[92:93], v40 offset:27776
    v_mfma_f32_16x16x32_bf16 v[244:247], v[72:75], a[228:231], v[244:247]
    ds_read_b64_tr_b16 v[94:95], v40 offset:32384
    v_mfma_f32_16x16x32_bf16 v[248:251], v[72:75], a[232:235], v[248:251]
    v_mfma_f32_16x16x32_bf16 v[252:255], v[72:75], a[236:239], v[252:255]
    s_waitcnt vmcnt(63) lgkmcnt(8)
    v_mfma_f32_16x16x32_bf16 v[112:115], v[76:79], a[240:243], v[112:115]
    ds_read_b64_tr_b16 v[96:97], v40 offset:27808
    v_mfma_f32_16x16x32_bf16 v[116:119], v[76:79], a[244:247], v[116:119]
    ds_read_b64_tr_b16 v[98:99], v40 offset:32416
    v_mfma_f32_16x16x32_bf16 v[120:123], v[76:79], a[248:251], v[120:123]
    s_add_u32 s32, s100, 12288
    buffer_load_dwordx4 a[112:115], v35, s[20:23], s32 offen offset:3072 sc1
    v_mfma_f32_16x16x32_bf16 v[124:127], v[76:79], a[252:255], v[124:127]
    s_waitcnt lgkmcnt(8)
    v_mfma_f32_16x16x32_bf16 v[128:131], v[80:83], a[240:243], v[128:131]
    ds_read_b64_tr_b16 v[100:101], v40 offset:27840
    v_mfma_f32_16x16x32_bf16 v[132:135], v[80:83], a[244:247], v[132:135]
    ds_read_b64_tr_b16 v[102:103], v40 offset:32448
    v_mfma_f32_16x16x32_bf16 v[136:139], v[80:83], a[248:251], v[136:139]
    buffer_load_dwordx4 a[116:119], v36, s[20:23], s32 offen offset:3072 sc1
    v_mfma_f32_16x16x32_bf16 v[140:143], v[80:83], a[252:255], v[140:143]
    s_waitcnt lgkmcnt(8)
    v_mfma_f32_16x16x32_bf16 v[144:147], v[84:87], a[240:243], v[144:147]
    ds_read_b64_tr_b16 v[48:49], v40 offset:27872
    v_mfma_f32_16x16x32_bf16 v[148:151], v[84:87], a[244:247], v[148:151]
    ds_read_b64_tr_b16 v[50:51], v40 offset:32480
    v_mfma_f32_16x16x32_bf16 v[152:155], v[84:87], a[248:251], v[152:155]
    buffer_load_dwordx4 a[120:123], v37, s[20:23], s32 offen offset:3072 sc1
    v_mfma_f32_16x16x32_bf16 v[156:159], v[84:87], a[252:255], v[156:159]
    s_waitcnt lgkmcnt(8)
    v_mfma_f32_16x16x32_bf16 v[160:163], v[88:91], a[240:243], v[160:163]
    ds_read_b64_tr_b16 v[52:53], v40 offset:27904
    v_mfma_f32_16x16x32_bf16 v[164:167], v[88:91], a[244:247], v[164:167]
    ds_read_b64_tr_b16 v[54:55], v40 offset:32512
    v_mfma_f32_16x16x32_bf16 v[168:171], v[88:91], a[248:251], v[168:171]
    buffer_load_dwordx4 a[124:127], v38, s[20:23], s32 offen offset:3072 sc1
    v_mfma_f32_16x16x32_bf16 v[172:175], v[88:91], a[252:255], v[172:175]
    s_waitcnt lgkmcnt(8)
    v_mfma_f32_16x16x32_bf16 v[176:179], v[92:95], a[240:243], v[176:179]
    s_waitcnt vmcnt(41)
    s_barrier
    ds_read_b64_tr_b16 v[56:57], v41 offset:0
    v_mfma_f32_16x16x32_bf16 v[180:183], v[92:95], a[244:247], v[180:183]
    ds_read_b64_tr_b16 v[58:59], v41 offset:4608
    v_mfma_f32_16x16x32_bf16 v[184:187], v[92:95], a[248:251], v[184:187]
    s_add_u32 s31, s94, 589824
    s_add_u32 m0, s95, 0
    s_nop 0
    buffer_load_dwordx4 v26, s[96:99], s31 offen offset:0 lds
    v_mfma_f32_16x16x32_bf16 v[188:191], v[92:95], a[252:255], v[188:191]
    s_waitcnt lgkmcnt(8)
    v_mfma_f32_16x16x32_bf16 v[192:195], v[96:99], a[240:243], v[192:195]
    ds_read_b64_tr_b16 v[60:61], v41 offset:32
    v_mfma_f32_16x16x32_bf16 v[196:199], v[96:99], a[244:247], v[196:199]
    ds_read_b64_tr_b16 v[62:63], v41 offset:4640
    v_mfma_f32_16x16x32_bf16 v[200:203], v[96:99], a[248:251], v[200:203]
    buffer_load_dwordx4 v27, s[96:99], s31 offen offset:1024 lds
    v_mfma_f32_16x16x32_bf16 v[204:207], v[96:99], a[252:255], v[204:207]
    s_waitcnt lgkmcnt(8)
    v_mfma_f32_16x16x32_bf16 v[208:211], v[100:103], a[240:243], v[208:211]
    ds_read_b64_tr_b16 v[64:65], v41 offset:64
    v_mfma_f32_16x16x32_bf16 v[212:215], v[100:103], a[244:247], v[212:215]
    ds_read_b64_tr_b16 v[66:67], v41 offset:4672
    v_mfma_f32_16x16x32_bf16 v[216:219], v[100:103], a[248:251], v[216:219]
    buffer_load_dwordx4 v28, s[96:99], s31 offen offset:2048 lds
    v_mfma_f32_16x16x32_bf16 v[220:223], v[100:103], a[252:255], v[220:223]
    s_waitcnt lgkmcnt(8)
    v_mfma_f32_16x16x32_bf16 v[224:227], v[48:51], a[240:243], v[224:227]
    ds_read_b64_tr_b16 v[68:69], v41 offset:96
    v_mfma_f32_16x16x32_bf16 v[228:231], v[48:51], a[244:247], v[228:231]
    ds_read_b64_tr_b16 v[70:71], v41 offset:4704
    v_mfma_f32_16x16x32_bf16 v[232:235], v[48:51], a[248:251], v[232:235]
    buffer_load_dwordx4 v29, s[96:99], s31 offen offset:3072 lds
    v_mfma_f32_16x16x32_bf16 v[236:239], v[48:51], a[252:255], v[236:239]
    s_waitcnt lgkmcnt(8)
    v_mfma_f32_16x16x32_bf16 v[240:243], v[52:55], a[240:243], v[240:243]
    ds_read_b64_tr_b16 v[72:73], v41 offset:128
    v_mfma_f32_16x16x32_bf16 v[244:247], v[52:55], a[244:247], v[244:247]
    ds_read_b64_tr_b16 v[74:75], v41 offset:4736
    v_mfma_f32_16x16x32_bf16 v[248:251], v[52:55], a[248:251], v[248:251]
    s_add_u32 m0, s95, 4096
    s_nop 0
    buffer_load_dwordx4 v30, s[96:99], s31 offen offset:0 lds
    v_mfma_f32_16x16x32_bf16 v[252:255], v[52:55], a[252:255], v[252:255]
    s_waitcnt vmcnt(42) lgkmcnt(8)
    v_mfma_f32_16x16x32_bf16 v[112:115], v[56:59], a[0:3], v[112:115]
    ds_read_b64_tr_b16 v[76:77], v41 offset:160
    v_mfma_f32_16x16x32_bf16 v[116:119], v[56:59], a[4:7], v[116:119]
    ds_read_b64_tr_b16 v[78:79], v41 offset:4768
    v_mfma_f32_16x16x32_bf16 v[120:123], v[56:59], a[8:11], v[120:123]
    buffer_load_dwordx4 v31, s[96:99], s31 offen offset:1024 lds
    v_mfma_f32_16x16x32_bf16 v[124:127], v[56:59], a[12:15], v[124:127]
    s_waitcnt lgkmcnt(8)
    v_mfma_f32_16x16x32_bf16 v[128:131], v[60:63], a[0:3], v[128:131]
    ds_read_b64_tr_b16 v[80:81], v41 offset:192
    v_mfma_f32_16x16x32_bf16 v[132:135], v[60:63], a[4:7], v[132:135]
    ds_read_b64_tr_b16 v[82:83], v41 offset:4800
    v_mfma_f32_16x16x32_bf16 v[136:139], v[60:63], a[8:11], v[136:139]
    buffer_load_dwordx4 v32, s[96:99], s31 offen offset:2048 lds
    v_mfma_f32_16x16x32_bf16 v[140:143], v[60:63], a[12:15], v[140:143]
    s_waitcnt lgkmcnt(8)
    v_mfma_f32_16x16x32_bf16 v[144:147], v[64:67], a[0:3], v[144:147]
    ds_read_b64_tr_b16 v[84:85], v41 offset:224
    v_mfma_f32_16x16x32_bf16 v[148:151], v[64:67], a[4:7], v[148:151]
    ds_read_b64_tr_b16 v[86:87], v41 offset:4832
    v_mfma_f32_16x16x32_bf16 v[152:155], v[64:67], a[8:11], v[152:155]
    buffer_load_dwordx4 v33, s[96:99], s31 offen offset:3072 lds
    v_mfma_f32_16x16x32_bf16 v[156:159], v[64:67], a[12:15], v[156:159]
    s_waitcnt lgkmcnt(8)
    v_mfma_f32_16x16x32_bf16 v[160:163], v[68:71], a[0:3], v[160:163]
    ds_read_b64_tr_b16 v[88:89], v41 offset:256
    v_mfma_f32_16x16x32_bf16 v[164:167], v[68:71], a[4:7], v[164:167]
    ds_read_b64_tr_b16 v[90:91], v41 offset:4864
    v_mfma_f32_16x16x32_bf16 v[168:171], v[68:71], a[8:11], v[168:171]
    s_add_u32 m0, s95, 8192
    s_nop 0
    buffer_load_dwordx4 v34, s[96:99], s31 offen offset:0 lds
    v_mfma_f32_16x16x32_bf16 v[172:175], v[68:71], a[12:15], v[172:175]
    s_waitcnt lgkmcnt(8)
    v_mfma_f32_16x16x32_bf16 v[176:179], v[72:75], a[0:3], v[176:179]
    ds_read_b64_tr_b16 v[92:93], v41 offset:9216
    v_mfma_f32_16x16x32_bf16 v[180:183], v[72:75], a[4:7], v[180:183]
    ds_read_b64_tr_b16 v[94:95], v41 offset:13824
    v_mfma_f32_16x16x32_bf16 v[184:187], v[72:75], a[8:11], v[184:187]
    s_add_u32 s32, s100, 16384
    buffer_load_dwordx4 a[128:131], v35, s[20:23], s32 offen offset:0 sc1
    v_mfma_f32_16x16x32_bf16 v[188:191], v[72:75], a[12:15], v[188:191]
    s_waitcnt lgkmcnt(8)
    v_mfma_f32_16x16x32_bf16 v[192:195], v[76:79], a[0:3], v[192:195]
    ds_read_b64_tr_b16 v[96:97], v41 offset:9248
    v_mfma_f32_16x16x32_bf16 v[196:199], v[76:79], a[4:7], v[196:199]
    ds_read_b64_tr_b16 v[98:99], v41 offset:13856
    v_mfma_f32_16x16x32_bf16 v[200:203], v[76:79], a[8:11], v[200:203]
    buffer_load_dwordx4 a[132:135], v36, s[20:23], s32 offen offset:0 sc1
    v_mfma_f32_16x16x32_bf16 v[204:207], v[76:79], a[12:15], v[204:207]
    s_waitcnt lgkmcnt(8)
    v_mfma_f32_16x16x32_bf16 v[208:211], v[80:83], a[0:3], v[208:211]
    ds_read_b64_tr_b16 v[100:101], v41 offset:9280
    v_mfma_f32_16x16x32_bf16 v[212:215], v[80:83], a[4:7], v[212:215]
    ds_read_b64_tr_b16 v[102:103], v41 offset:13888
    v_mfma_f32_16x16x32_bf16 v[216:219], v[80:83], a[8:11], v[216:219]
    buffer_load_dwordx4 a[136:139], v37, s[20:23], s32 offen offset:0 sc1
    v_mfma_f32_16x16x32_bf16 v[220:223], v[80:83], a[12:15], v[220:223]
    s_waitcnt lgkmcnt(8)
    v_mfma_f32_16x16x32_bf16 v[224:227], v[84:87], a[0:3], v[224:227]
    ds_read_b64_tr_b16 v[48:49], v41 offset:9312
    v_mfma_f32_16x16x32_bf16 v[228:231], v[84:87], a[4:7], v[228:231]
    ds_read_b64_tr_b16 v[50:51], v41 offset:13920
    v_mfma_f32_16x16x32_bf16 v[232:235], v[84:87], a[8:11], v[232:235]
    buffer_load_dwordx4 a[140:143], v38, s[20:23], s32 offen offset:0 sc1
    v_mfma_f32_16x16x32_bf16 v[236:239], v[84:87], a[12:15], v[236:239]
    s_waitcnt lgkmcnt(8)
    v_mfma_f32_16x16x32_bf16 v[240:243], v[88:91], a[0:3], v[240:243]
    ds_read_b64_tr_b16 v[52:53], v41 offset:9344
    v_mfma_f32_16x16x32_bf16 v[244:247], v[88:91], a[4:7], v[244:247]
    ds_read_b64_tr_b16 v[54:55], v41 offset:13952
    v_mfma_f32_16x16x32_bf16 v[248:251], v[88:91], a[8:11], v[248:251]
    v_mfma_f32_16x16x32_bf16 v[252:255], v[88:91], a[12:15], v[252:255]
    s_waitcnt vmcnt(46) lgkmcnt(8)
    v_mfma_f32_16x16x32_bf16 v[112:115], v[92:95], a[16:19], v[112:115]
    ds_read_b64_tr_b16 v[56:57], v41 offset:9376
    v_mfma_f32_16x16x32_bf16 v[116:119], v[92:95], a[20:23], v[116:119]
    ds_read_b64_tr_b16 v[58:59], v41 offset:13984
    v_mfma_f32_16x16x32_bf16 v[120:123], v[92:95], a[24:27], v[120:123]
    s_add_u32 s32, s100, 16384
    buffer_load_dwordx4 a[144:147], v35, s[20:23], s32 offen offset:1024 sc1
    v_mfma_f32_16x16x32_bf16 v[124:127], v[92:95], a[28:31], v[124:127]
    s_waitcnt lgkmcnt(8)
    v_mfma_f32_16x16x32_bf16 v[128:131], v[96:99], a[16:19], v[128:131]
    ds_read_b64_tr_b16 v[60:61], v41 offset:9408
    v_mfma_f32_16x16x32_bf16 v[132:135], v[96:99], a[20:23], v[132:135]
    ds_read_b64_tr_b16 v[62:63], v41 offset:14016
    v_mfma_f32_16x16x32_bf16 v[136:139], v[96:99], a[24:27], v[136:139]
    buffer_load_dwordx4 a[148:151], v36, s[20:23], s32 offen offset:1024 sc1
    v_mfma_f32_16x16x32_bf16 v[140:143], v[96:99], a[28:31], v[140:143]
    s_waitcnt lgkmcnt(8)
    v_mfma_f32_16x16x32_bf16 v[144:147], v[100:103], a[16:19], v[144:147]
    ds_read_b64_tr_b16 v[64:65], v41 offset:9440
    v_mfma_f32_16x16x32_bf16 v[148:151], v[100:103], a[20:23], v[148:151]
    ds_read_b64_tr_b16 v[66:67], v41 offset:14048
    v_mfma_f32_16x16x32_bf16 v[152:155], v[100:103], a[24:27], v[152:155]
    buffer_load_dwordx4 a[152:155], v37, s[20:23], s32 offen offset:1024 sc1
    v_mfma_f32_16x16x32_bf16 v[156:159], v[100:103], a[28:31], v[156:159]
    s_waitcnt lgkmcnt(8)
    v_mfma_f32_16x16x32_bf16 v[160:163], v[48:51], a[16:19], v[160:163]
    ds_read_b64_tr_b16 v[68:69], v41 offset:9472
    v_mfma_f32_16x16x32_bf16 v[164:167], v[48:51], a[20:23], v[164:167]
    ds_read_b64_tr_b16 v[70:71], v41 offset:14080
    v_mfma_f32_16x16x32_bf16 v[168:171], v[48:51], a[24:27], v[168:171]
    buffer_load_dwordx4 a[156:159], v38, s[20:23], s32 offen offset:1024 sc1
    v_mfma_f32_16x16x32_bf16 v[172:175], v[48:51], a[28:31], v[172:175]
    s_waitcnt lgkmcnt(8)
    v_mfma_f32_16x16x32_bf16 v[176:179], v[52:55], a[16:19], v[176:179]
    ds_read_b64_tr_b16 v[72:73], v41 offset:18432
    v_mfma_f32_16x16x32_bf16 v[180:183], v[52:55], a[20:23], v[180:183]
    ds_read_b64_tr_b16 v[74:75], v41 offset:23040
    v_mfma_f32_16x16x32_bf16 v[184:187], v[52:55], a[24:27], v[184:187]
    v_mfma_f32_16x16x32_bf16 v[188:191], v[52:55], a[28:31], v[188:191]
    s_waitcnt lgkmcnt(8)
    v_mfma_f32_16x16x32_bf16 v[192:195], v[56:59], a[16:19], v[192:195]
    ds_read_b64_tr_b16 v[76:77], v41 offset:18464
    v_mfma_f32_16x16x32_bf16 v[196:199], v[56:59], a[20:23], v[196:199]
    ds_read_b64_tr_b16 v[78:79], v41 offset:23072
    v_mfma_f32_16x16x32_bf16 v[200:203], v[56:59], a[24:27], v[200:203]
    v_mfma_f32_16x16x32_bf16 v[204:207], v[56:59], a[28:31], v[204:207]
    s_waitcnt lgkmcnt(8)
    v_mfma_f32_16x16x32_bf16 v[208:211], v[60:63], a[16:19], v[208:211]
    ds_read_b64_tr_b16 v[80:81], v41 offset:18496
    v_mfma_f32_16x16x32_bf16 v[212:215], v[60:63], a[20:23], v[212:215]
    ds_read_b64_tr_b16 v[82:83], v41 offset:23104
    v_mfma_f32_16x16x32_bf16 v[216:219], v[60:63], a[24:27], v[216:219]
    v_mfma_f32_16x16x32_bf16 v[220:223], v[60:63], a[28:31], v[220:223]
    s_waitcnt lgkmcnt(8)
    v_mfma_f32_16x16x32_bf16 v[224:227], v[64:67], a[16:19], v[224:227]
    ds_read_b64_tr_b16 v[84:85], v41 offset:18528
    v_mfma_f32_16x16x32_bf16 v[228:231], v[64:67], a[20:23], v[228:231]
    ds_read_b64_tr_b16 v[86:87], v41 offset:23136
    v_mfma_f32_16x16x32_bf16 v[232:235], v[64:67], a[24:27], v[232:235]
    v_mfma_f32_16x16x32_bf16 v[236:239], v[64:67], a[28:31], v[236:239]
    s_waitcnt lgkmcnt(8)
    v_mfma_f32_16x16x32_bf16 v[240:243], v[68:71], a[16:19], v[240:243]
    ds_read_b64_tr_b16 v[88:89], v41 offset:18560
    v_mfma_f32_16x16x32_bf16 v[244:247], v[68:71], a[20:23], v[244:247]
    ds_read_b64_tr_b16 v[90:91], v41 offset:23168
    v_mfma_f32_16x16x32_bf16 v[248:251], v[68:71], a[24:27], v[248:251]
    v_mfma_f32_16x16x32_bf16 v[252:255], v[68:71], a[28:31], v[252:255]
    s_waitcnt vmcnt(46) lgkmcnt(8)
    v_mfma_f32_16x16x32_bf16 v[112:115], v[72:75], a[32:35], v[112:115]
    ds_read_b64_tr_b16 v[92:93], v41 offset:18592
    v_mfma_f32_16x16x32_bf16 v[116:119], v[72:75], a[36:39], v[116:119]
    ds_read_b64_tr_b16 v[94:95], v41 offset:23200
    v_mfma_f32_16x16x32_bf16 v[120:123], v[72:75], a[40:43], v[120:123]
    s_add_u32 s32, s100, 16384
    buffer_load_dwordx4 a[160:163], v35, s[20:23], s32 offen offset:2048 sc1
    v_mfma_f32_16x16x32_bf16 v[124:127], v[72:75], a[44:47], v[124:127]
    s_waitcnt lgkmcnt(8)
    v_mfma_f32_16x16x32_bf16 v[128:131], v[76:79], a[32:35], v[128:131]
    ds_read_b64_tr_b16 v[96:97], v41 offset:18624
    v_mfma_f32_16x16x32_bf16 v[132:135], v[76:79], a[36:39], v[132:135]
    ds_read_b64_tr_b16 v[98:99], v41 offset:23232
    v_mfma_f32_16x16x32_bf16 v[136:139], v[76:79], a[40:43], v[136:139]
    buffer_load_dwordx4 a[164:167], v36, s[20:23], s32 offen offset:2048 sc1
    v_mfma_f32_16x16x32_bf16 v[140:143], v[76:79], a[44:47], v[140:143]
    s_waitcnt lgkmcnt(8)
    v_mfma_f32_16x16x32_bf16 v[144:147], v[80:83], a[32:35], v[144:147]
    ds_read_b64_tr_b16 v[100:101], v41 offset:18656
    v_mfma_f32_16x16x32_bf16 v[148:151], v[80:83], a[36:39], v[148:151]
    ds_read_b64_tr_b16 v[102:103], v41 offset:23264
    v_mfma_f32_16x16x32_bf16 v[152:155], v[80:83], a[40:43], v[152:155]
    buffer_load_dwordx4 a[168:171], v37, s[20:23], s32 offen offset:2048 sc1
    v_mfma_f32_16x16x32_bf16 v[156:159], v[80:83], a[44:47], v[156:159]
    s_waitcnt lgkmcnt(8)
    v_mfma_f32_16x16x32_bf16 v[160:163], v[84:87], a[32:35], v[160:163]
    ds_read_b64_tr_b16 v[48:49], v41 offset:18688
    v_mfma_f32_16x16x32_bf16 v[164:167], v[84:87], a[36:39], v[164:167]
    ds_read_b64_tr_b16 v[50:51], v41 offset:23296
    v_mfma_f32_16x16x32_bf16 v[168:171], v[84:87], a[40:43], v[168:171]
    buffer_load_dwordx4 a[172:175], v38, s[20:23], s32 offen offset:2048 sc1
    v_mfma_f32_16x16x32_bf16 v[172:175], v[84:87], a[44:47], v[172:175]
    s_waitcnt lgkmcnt(8)
    v_mfma_f32_16x16x32_bf16 v[176:179], v[88:91], a[32:35], v[176:179]
    ds_read_b64_tr_b16 v[52:53], v41 offset:27648
    v_mfma_f32_16x16x32_bf16 v[180:183], v[88:91], a[36:39], v[180:183]
    ds_read_b64_tr_b16 v[54:55], v41 offset:32256
    v_mfma_f32_16x16x32_bf16 v[184:187], v[88:91], a[40:43], v[184:187]
    v_mfma_f32_16x16x32_bf16 v[188:191], v[88:91], a[44:47], v[188:191]
    s_waitcnt lgkmcnt(8)
    v_mfma_f32_16x16x32_bf16 v[192:195], v[92:95], a[32:35], v[192:195]
    ds_read_b64_tr_b16 v[56:57], v41 offset:27680
    v_mfma_f32_16x16x32_bf16 v[196:199], v[92:95], a[36:39], v[196:199]
    ds_read_b64_tr_b16 v[58:59], v41 offset:32288
    v_mfma_f32_16x16x32_bf16 v[200:203], v[92:95], a[40:43], v[200:203]
    v_mfma_f32_16x16x32_bf16 v[204:207], v[92:95], a[44:47], v[204:207]
    s_waitcnt lgkmcnt(8)
    v_mfma_f32_16x16x32_bf16 v[208:211], v[96:99], a[32:35], v[208:211]
    ds_read_b64_tr_b16 v[60:61], v41 offset:27712
    v_mfma_f32_16x16x32_bf16 v[212:215], v[96:99], a[36:39], v[212:215]
    ds_read_b64_tr_b16 v[62:63], v41 offset:32320
    v_mfma_f32_16x16x32_bf16 v[216:219], v[96:99], a[40:43], v[216:219]
    v_mfma_f32_16x16x32_bf16 v[220:223], v[96:99], a[44:47], v[220:223]
    s_waitcnt lgkmcnt(8)
    v_mfma_f32_16x16x32_bf16 v[224:227], v[100:103], a[32:35], v[224:227]
    ds_read_b64_tr_b16 v[64:65], v41 offset:27744
    v_mfma_f32_16x16x32_bf16 v[228:231], v[100:103], a[36:39], v[228:231]
    ds_read_b64_tr_b16 v[66:67], v41 offset:32352
    v_mfma_f32_16x16x32_bf16 v[232:235], v[100:103], a[40:43], v[232:235]
    v_mfma_f32_16x16x32_bf16 v[236:239], v[100:103], a[44:47], v[236:239]
    s_waitcnt lgkmcnt(8)
    v_mfma_f32_16x16x32_bf16 v[240:243], v[48:51], a[32:35], v[240:243]
    ds_read_b64_tr_b16 v[68:69], v41 offset:27776
    v_mfma_f32_16x16x32_bf16 v[244:247], v[48:51], a[36:39], v[244:247]
    ds_read_b64_tr_b16 v[70:71], v41 offset:32384
    v_mfma_f32_16x16x32_bf16 v[248:251], v[48:51], a[40:43], v[248:251]
    v_mfma_f32_16x16x32_bf16 v[252:255], v[48:51], a[44:47], v[252:255]
    s_waitcnt vmcnt(46) lgkmcnt(8)
    v_mfma_f32_16x16x32_bf16 v[112:115], v[52:55], a[48:51], v[112:115]
    ds_read_b64_tr_b16 v[72:73], v41 offset:27808
    v_mfma_f32_16x16x32_bf16 v[116:119], v[52:55], a[52:55], v[116:119]
    ds_read_b64_tr_b16 v[74:75], v41 offset:32416
    v_mfma_f32_16x16x32_bf16 v[120:123], v[52:55], a[56:59], v[120:123]
    s_add_u32 s32, s100, 16384
    buffer_load_dwordx4 a[176:179], v35, s[20:23], s32 offen offset:3072 sc1
    v_mfma_f32_16x16x32_bf16 v[124:127], v[52:55], a[60:63], v[124:127]
    s_waitcnt lgkmcnt(8)
    v_mfma_f32_16x16x32_bf16 v[128:131], v[56:59], a[48:51], v[128:131]
    ds_read_b64_tr_b16 v[76:77], v41 offset:27840
    v_mfma_f32_16x16x32_bf16 v[132:135], v[56:59], a[52:55], v[132:135]
    ds_read_b64_tr_b16 v[78:79], v41 offset:32448
    v_mfma_f32_16x16x32_bf16 v[136:139], v[56:59], a[56:59], v[136:139]
    buffer_load_dwordx4 a[180:183], v36, s[20:23], s32 offen offset:3072 sc1
    v_mfma_f32_16x16x32_bf16 v[140:143], v[56:59], a[60:63], v[140:143]
    s_waitcnt lgkmcnt(8)
    v_mfma_f32_16x16x32_bf16 v[144:147], v[60:63], a[48:51], v[144:147]
    ds_read_b64_tr_b16 v[80:81], v41 offset:27872
    v_mfma_f32_16x16x32_bf16 v[148:151], v[60:63], a[52:55], v[148:151]
    ds_read_b64_tr_b16 v[82:83], v41 offset:32480
    v_mfma_f32_16x16x32_bf16 v[152:155], v[60:63], a[56:59], v[152:155]
    buffer_load_dwordx4 a[184:187], v37, s[20:23], s32 offen offset:3072 sc1
    v_mfma_f32_16x16x32_bf16 v[156:159], v[60:63], a[60:63], v[156:159]
    s_waitcnt lgkmcnt(8)
    v_mfma_f32_16x16x32_bf16 v[160:163], v[64:67], a[48:51], v[160:163]
    ds_read_b64_tr_b16 v[84:85], v41 offset:27904
    v_mfma_f32_16x16x32_bf16 v[164:167], v[64:67], a[52:55], v[164:167]
    ds_read_b64_tr_b16 v[86:87], v41 offset:32512
    v_mfma_f32_16x16x32_bf16 v[168:171], v[64:67], a[56:59], v[168:171]
    buffer_load_dwordx4 a[188:191], v38, s[20:23], s32 offen offset:3072 sc1
    v_mfma_f32_16x16x32_bf16 v[172:175], v[64:67], a[60:63], v[172:175]
    s_waitcnt lgkmcnt(8)
    v_mfma_f32_16x16x32_bf16 v[176:179], v[68:71], a[48:51], v[176:179]
    s_waitcnt vmcnt(41)
    s_barrier
    ds_read_b64_tr_b16 v[88:89], v42 offset:0
    v_mfma_f32_16x16x32_bf16 v[180:183], v[68:71], a[52:55], v[180:183]
    ds_read_b64_tr_b16 v[90:91], v42 offset:4608
    v_mfma_f32_16x16x32_bf16 v[184:187], v[68:71], a[56:59], v[184:187]
    s_add_u32 s31, s94, 737280
    s_add_u32 m0, s95, 36864
    s_nop 0
    buffer_load_dwordx4 v26, s[96:99], s31 offen offset:0 lds
    v_mfma_f32_16x16x32_bf16 v[188:191], v[68:71], a[60:63], v[188:191]
    s_waitcnt lgkmcnt(8)
    v_mfma_f32_16x16x32_bf16 v[192:195], v[72:75], a[48:51], v[192:195]
    ds_read_b64_tr_b16 v[92:93], v42 offset:32
    v_mfma_f32_16x16x32_bf16 v[196:199], v[72:75], a[52:55], v[196:199]
    ds_read_b64_tr_b16 v[94:95], v42 offset:4640
    v_mfma_f32_16x16x32_bf16 v[200:203], v[72:75], a[56:59], v[200:203]
    buffer_load_dwordx4 v27, s[96:99], s31 offen offset:1024 lds
    v_mfma_f32_16x16x32_bf16 v[204:207], v[72:75], a[60:63], v[204:207]
    s_waitcnt lgkmcnt(8)
    v_mfma_f32_16x16x32_bf16 v[208:211], v[76:79], a[48:51], v[208:211]
    ds_read_b64_tr_b16 v[96:97], v42 offset:64
    v_mfma_f32_16x16x32_bf16 v[212:215], v[76:79], a[52:55], v[212:215]
    ds_read_b64_tr_b16 v[98:99], v42 offset:4672
    v_mfma_f32_16x16x32_bf16 v[216:219], v[76:79], a[56:59], v[216:219]
    buffer_load_dwordx4 v28, s[96:99], s31 offen offset:2048 lds
    v_mfma_f32_16x16x32_bf16 v[220:223], v[76:79], a[60:63], v[220:223]
    s_waitcnt lgkmcnt(8)
    v_mfma_f32_16x16x32_bf16 v[224:227], v[80:83], a[48:51], v[224:227]
    ds_read_b64_tr_b16 v[100:101], v42 offset:96
    v_mfma_f32_16x16x32_bf16 v[228:231], v[80:83], a[52:55], v[228:231]
    ds_read_b64_tr_b16 v[102:103], v42 offset:4704
    v_mfma_f32_16x16x32_bf16 v[232:235], v[80:83], a[56:59], v[232:235]
    buffer_load_dwordx4 v29, s[96:99], s31 offen offset:3072 lds
    v_mfma_f32_16x16x32_bf16 v[236:239], v[80:83], a[60:63], v[236:239]
    s_waitcnt lgkmcnt(8)
    v_mfma_f32_16x16x32_bf16 v[240:243], v[84:87], a[48:51], v[240:243]
    ds_read_b64_tr_b16 v[48:49], v42 offset:128
    v_mfma_f32_16x16x32_bf16 v[244:247], v[84:87], a[52:55], v[244:247]
    ds_read_b64_tr_b16 v[50:51], v42 offset:4736
    v_mfma_f32_16x16x32_bf16 v[248:251], v[84:87], a[56:59], v[248:251]
    s_add_u32 m0, s95, 40960
    s_nop 0
    buffer_load_dwordx4 v30, s[96:99], s31 offen offset:0 lds
    v_mfma_f32_16x16x32_bf16 v[252:255], v[84:87], a[60:63], v[252:255]
    s_waitcnt vmcnt(42) lgkmcnt(8)
    v_mfma_f32_16x16x32_bf16 v[112:115], v[88:91], a[64:67], v[112:115]
    ds_read_b64_tr_b16 v[52:53], v42 offset:160
    v_mfma_f32_16x16x32_bf16 v[116:119], v[88:91], a[68:71], v[116:119]
    ds_read_b64_tr_b16 v[54:55], v42 offset:4768
    v_mfma_f32_16x16x32_bf16 v[120:123], v[88:91], a[72:75], v[120:123]
    buffer_load_dwordx4 v31, s[96:99], s31 offen offset:1024 lds
    v_mfma_f32_16x16x32_bf16 v[124:127], v[88:91], a[76:79], v[124:127]
    s_waitcnt lgkmcnt(8)
    v_mfma_f32_16x16x32_bf16 v[128:131], v[92:95], a[64:67], v[128:131]
    ds_read_b64_tr_b16 v[56:57], v42 offset:192
    v_mfma_f32_16x16x32_bf16 v[132:135], v[92:95], a[68:71], v[132:135]
    ds_read_b64_tr_b16 v[58:59], v42 offset:4800
    v_mfma_f32_16x16x32_bf16 v[136:139], v[92:95], a[72:75], v[136:139]
    buffer_load_dwordx4 v32, s[96:99], s31 offen offset:2048 lds
    v_mfma_f32_16x16x32_bf16 v[140:143], v[92:95], a[76:79], v[140:143]
    s_waitcnt lgkmcnt(8)
    v_mfma_f32_16x16x32_bf16 v[144:147], v[96:99], a[64:67], v[144:147]
    ds_read_b64_tr_b16 v[60:61], v42 offset:224
    v_mfma_f32_16x16x32_bf16 v[148:151], v[96:99], a[68:71], v[148:151]
    ds_read_b64_tr_b16 v[62:63], v42 offset:4832
    v_mfma_f32_16x16x32_bf16 v[152:155], v[96:99], a[72:75], v[152:155]
    buffer_load_dwordx4 v33, s[96:99], s31 offen offset:3072 lds
    v_mfma_f32_16x16x32_bf16 v[156:159], v[96:99], a[76:79], v[156:159]
    s_waitcnt lgkmcnt(8)
    v_mfma_f32_16x16x32_bf16 v[160:163], v[100:103], a[64:67], v[160:163]
    ds_read_b64_tr_b16 v[64:65], v42 offset:256
    v_mfma_f32_16x16x32_bf16 v[164:167], v[100:103], a[68:71], v[164:167]
    ds_read_b64_tr_b16 v[66:67], v42 offset:4864
    v_mfma_f32_16x16x32_bf16 v[168:171], v[100:103], a[72:75], v[168:171]
    s_add_u32 m0, s95, 45056
    s_nop 0
    buffer_load_dwordx4 v34, s[96:99], s31 offen offset:0 lds
    v_mfma_f32_16x16x32_bf16 v[172:175], v[100:103], a[76:79], v[172:175]
    s_waitcnt lgkmcnt(8)
    v_mfma_f32_16x16x32_bf16 v[176:179], v[48:51], a[64:67], v[176:179]
    ds_read_b64_tr_b16 v[68:69], v42 offset:9216
    v_mfma_f32_16x16x32_bf16 v[180:183], v[48:51], a[68:71], v[180:183]
    ds_read_b64_tr_b16 v[70:71], v42 offset:13824
    v_mfma_f32_16x16x32_bf16 v[184:187], v[48:51], a[72:75], v[184:187]
    s_add_u32 s32, s100, 20480
    buffer_load_dwordx4 a[192:195], v35, s[20:23], s32 offen offset:0 sc1
    v_mfma_f32_16x16x32_bf16 v[188:191], v[48:51], a[76:79], v[188:191]
    s_waitcnt lgkmcnt(8)
    v_mfma_f32_16x16x32_bf16 v[192:195], v[52:55], a[64:67], v[192:195]
    ds_read_b64_tr_b16 v[72:73], v42 offset:9248
    v_mfma_f32_16x16x32_bf16 v[196:199], v[52:55], a[68:71], v[196:199]
    ds_read_b64_tr_b16 v[74:75], v42 offset:13856
    v_mfma_f32_16x16x32_bf16 v[200:203], v[52:55], a[72:75], v[200:203]
    buffer_load_dwordx4 a[196:199], v36, s[20:23], s32 offen offset:0 sc1
    v_mfma_f32_16x16x32_bf16 v[204:207], v[52:55], a[76:79], v[204:207]
    s_waitcnt lgkmcnt(8)
    v_mfma_f32_16x16x32_bf16 v[208:211], v[56:59], a[64:67], v[208:211]
    ds_read_b64_tr_b16 v[76:77], v42 offset:9280
    v_mfma_f32_16x16x32_bf16 v[212:215], v[56:59], a[68:71], v[212:215]
    ds_read_b64_tr_b16 v[78:79], v42 offset:13888
    v_mfma_f32_16x16x32_bf16 v[216:219], v[56:59], a[72:75], v[216:219]
    buffer_load_dwordx4 a[200:203], v37, s[20:23], s32 offen offset:0 sc1
    v_mfma_f32_16x16x32_bf16 v[220:223], v[56:59], a[76:79], v[220:223]
    s_waitcnt lgkmcnt(8)
    v_mfma_f32_16x16x32_bf16 v[224:227], v[60:63], a[64:67], v[224:227]
    ds_read_b64_tr_b16 v[80:81], v42 offset:9312
    v_mfma_f32_16x16x32_bf16 v[228:231], v[60:63], a[68:71], v[228:231]
    ds_read_b64_tr_b16 v[82:83], v42 offset:13920
    v_mfma_f32_16x16x32_bf16 v[232:235], v[60:63], a[72:75], v[232:235]
    buffer_load_dwordx4 a[204:207], v38, s[20:23], s32 offen offset:0 sc1
    v_mfma_f32_16x16x32_bf16 v[236:239], v[60:63], a[76:79], v[236:239]
    s_waitcnt lgkmcnt(8)
    v_mfma_f32_16x16x32_bf16 v[240:243], v[64:67], a[64:67], v[240:243]
    ds_read_b64_tr_b16 v[84:85], v42 offset:9344
    v_mfma_f32_16x16x32_bf16 v[244:247], v[64:67], a[68:71], v[244:247]
    ds_read_b64_tr_b16 v[86:87], v42 offset:13952
    v_mfma_f32_16x16x32_bf16 v[248:251], v[64:67], a[72:75], v[248:251]
    v_mfma_f32_16x16x32_bf16 v[252:255], v[64:67], a[76:79], v[252:255]
    s_waitcnt vmcnt(46) lgkmcnt(8)
    v_mfma_f32_16x16x32_bf16 v[112:115], v[68:71], a[80:83], v[112:115]
    ds_read_b64_tr_b16 v[88:89], v42 offset:9376
    v_mfma_f32_16x16x32_bf16 v[116:119], v[68:71], a[84:87], v[116:119]
    ds_read_b64_tr_b16 v[90:91], v42 offset:13984
    v_mfma_f32_16x16x32_bf16 v[120:123], v[68:71], a[88:91], v[120:123]
    s_add_u32 s32, s100, 20480
    buffer_load_dwordx4 a[208:211], v35, s[20:23], s32 offen offset:1024 sc1
    v_mfma_f32_16x16x32_bf16 v[124:127], v[68:71], a[92:95], v[124:127]
    s_waitcnt lgkmcnt(8)
    v_mfma_f32_16x16x32_bf16 v[128:131], v[72:75], a[80:83], v[128:131]
    ds_read_b64_tr_b16 v[92:93], v42 offset:9408
    v_mfma_f32_16x16x32_bf16 v[132:135], v[72:75], a[84:87], v[132:135]
    ds_read_b64_tr_b16 v[94:95], v42 offset:14016
    v_mfma_f32_16x16x32_bf16 v[136:139], v[72:75], a[88:91], v[136:139]
    buffer_load_dwordx4 a[212:215], v36, s[20:23], s32 offen offset:1024 sc1
    v_mfma_f32_16x16x32_bf16 v[140:143], v[72:75], a[92:95], v[140:143]
    s_waitcnt lgkmcnt(8)
    v_mfma_f32_16x16x32_bf16 v[144:147], v[76:79], a[80:83], v[144:147]
    ds_read_b64_tr_b16 v[96:97], v42 offset:9440
    v_mfma_f32_16x16x32_bf16 v[148:151], v[76:79], a[84:87], v[148:151]
    ds_read_b64_tr_b16 v[98:99], v42 offset:14048
    v_mfma_f32_16x16x32_bf16 v[152:155], v[76:79], a[88:91], v[152:155]
    buffer_load_dwordx4 a[216:219], v37, s[20:23], s32 offen offset:1024 sc1
    v_mfma_f32_16x16x32_bf16 v[156:159], v[76:79], a[92:95], v[156:159]
    s_waitcnt lgkmcnt(8)
    v_mfma_f32_16x16x32_bf16 v[160:163], v[80:83], a[80:83], v[160:163]
    ds_read_b64_tr_b16 v[100:101], v42 offset:9472
    v_mfma_f32_16x16x32_bf16 v[164:167], v[80:83], a[84:87], v[164:167]
    ds_read_b64_tr_b16 v[102:103], v42 offset:14080
    v_mfma_f32_16x16x32_bf16 v[168:171], v[80:83], a[88:91], v[168:171]
    buffer_load_dwordx4 a[220:223], v38, s[20:23], s32 offen offset:1024 sc1
    v_mfma_f32_16x16x32_bf16 v[172:175], v[80:83], a[92:95], v[172:175]
    s_waitcnt lgkmcnt(8)
    v_mfma_f32_16x16x32_bf16 v[176:179], v[84:87], a[80:83], v[176:179]
    ds_read_b64_tr_b16 v[48:49], v42 offset:18432
    v_mfma_f32_16x16x32_bf16 v[180:183], v[84:87], a[84:87], v[180:183]
    ds_read_b64_tr_b16 v[50:51], v42 offset:23040
    v_mfma_f32_16x16x32_bf16 v[184:187], v[84:87], a[88:91], v[184:187]
    v_mfma_f32_16x16x32_bf16 v[188:191], v[84:87], a[92:95], v[188:191]
    s_waitcnt lgkmcnt(8)
    v_mfma_f32_16x16x32_bf16 v[192:195], v[88:91], a[80:83], v[192:195]
    ds_read_b64_tr_b16 v[52:53], v42 offset:18464
    v_mfma_f32_16x16x32_bf16 v[196:199], v[88:91], a[84:87], v[196:199]
    ds_read_b64_tr_b16 v[54:55], v42 offset:23072
    v_mfma_f32_16x16x32_bf16 v[200:203], v[88:91], a[88:91], v[200:203]
    v_mfma_f32_16x16x32_bf16 v[204:207], v[88:91], a[92:95], v[204:207]
    s_waitcnt lgkmcnt(8)
    v_mfma_f32_16x16x32_bf16 v[208:211], v[92:95], a[80:83], v[208:211]
    ds_read_b64_tr_b16 v[56:57], v42 offset:18496
    v_mfma_f32_16x16x32_bf16 v[212:215], v[92:95], a[84:87], v[212:215]
    ds_read_b64_tr_b16 v[58:59], v42 offset:23104
    v_mfma_f32_16x16x32_bf16 v[216:219], v[92:95], a[88:91], v[216:219]
    v_mfma_f32_16x16x32_bf16 v[220:223], v[92:95], a[92:95], v[220:223]
    s_waitcnt lgkmcnt(8)
    v_mfma_f32_16x16x32_bf16 v[224:227], v[96:99], a[80:83], v[224:227]
    ds_read_b64_tr_b16 v[60:61], v42 offset:18528
    v_mfma_f32_16x16x32_bf16 v[228:231], v[96:99], a[84:87], v[228:231]
    ds_read_b64_tr_b16 v[62:63], v42 offset:23136
    v_mfma_f32_16x16x32_bf16 v[232:235], v[96:99], a[88:91], v[232:235]
    v_mfma_f32_16x16x32_bf16 v[236:239], v[96:99], a[92:95], v[236:239]
    s_waitcnt lgkmcnt(8)
    v_mfma_f32_16x16x32_bf16 v[240:243], v[100:103], a[80:83], v[240:243]
    ds_read_b64_tr_b16 v[64:65], v42 offset:18560
    v_mfma_f32_16x16x32_bf16 v[244:247], v[100:103], a[84:87], v[244:247]
    ds_read_b64_tr_b16 v[66:67], v42 offset:23168
    v_mfma_f32_16x16x32_bf16 v[248:251], v[100:103], a[88:91], v[248:251]
    v_mfma_f32_16x16x32_bf16 v[252:255], v[100:103], a[92:95], v[252:255]
    s_waitcnt vmcnt(46) lgkmcnt(8)
    v_mfma_f32_16x16x32_bf16 v[112:115], v[48:51], a[96:99], v[112:115]
    ds_read_b64_tr_b16 v[68:69], v42 offset:18592
    v_mfma_f32_16x16x32_bf16 v[116:119], v[48:51], a[100:103], v[116:119]
    ds_read_b64_tr_b16 v[70:71], v42 offset:23200
    v_mfma_f32_16x16x32_bf16 v[120:123], v[48:51], a[104:107], v[120:123]
    s_add_u32 s32, s100, 20480
    buffer_load_dwordx4 a[224:227], v35, s[20:23], s32 offen offset:2048 sc1
    v_mfma_f32_16x16x32_bf16 v[124:127], v[48:51], a[108:111], v[124:127]
    s_waitcnt lgkmcnt(8)
    v_mfma_f32_16x16x32_bf16 v[128:131], v[52:55], a[96:99], v[128:131]
    ds_read_b64_tr_b16 v[72:73], v42 offset:18624
    v_mfma_f32_16x16x32_bf16 v[132:135], v[52:55], a[100:103], v[132:135]
    ds_read_b64_tr_b16 v[74:75], v42 offset:23232
    v_mfma_f32_16x16x32_bf16 v[136:139], v[52:55], a[104:107], v[136:139]
    buffer_load_dwordx4 a[228:231], v36, s[20:23], s32 offen offset:2048 sc1
    v_mfma_f32_16x16x32_bf16 v[140:143], v[52:55], a[108:111], v[140:143]
    s_waitcnt lgkmcnt(8)
    v_mfma_f32_16x16x32_bf16 v[144:147], v[56:59], a[96:99], v[144:147]
    ds_read_b64_tr_b16 v[76:77], v42 offset:18656
    v_mfma_f32_16x16x32_bf16 v[148:151], v[56:59], a[100:103], v[148:151]
    ds_read_b64_tr_b16 v[78:79], v42 offset:23264
    v_mfma_f32_16x16x32_bf16 v[152:155], v[56:59], a[104:107], v[152:155]
    buffer_load_dwordx4 a[232:235], v37, s[20:23], s32 offen offset:2048 sc1
    v_mfma_f32_16x16x32_bf16 v[156:159], v[56:59], a[108:111], v[156:159]
    s_waitcnt lgkmcnt(8)
    v_mfma_f32_16x16x32_bf16 v[160:163], v[60:63], a[96:99], v[160:163]
    ds_read_b64_tr_b16 v[80:81], v42 offset:18688
    v_mfma_f32_16x16x32_bf16 v[164:167], v[60:63], a[100:103], v[164:167]
    ds_read_b64_tr_b16 v[82:83], v42 offset:23296
    v_mfma_f32_16x16x32_bf16 v[168:171], v[60:63], a[104:107], v[168:171]
    buffer_load_dwordx4 a[236:239], v38, s[20:23], s32 offen offset:2048 sc1
    v_mfma_f32_16x16x32_bf16 v[172:175], v[60:63], a[108:111], v[172:175]
    s_waitcnt lgkmcnt(8)
    v_mfma_f32_16x16x32_bf16 v[176:179], v[64:67], a[96:99], v[176:179]
    ds_read_b64_tr_b16 v[84:85], v42 offset:27648
    v_mfma_f32_16x16x32_bf16 v[180:183], v[64:67], a[100:103], v[180:183]
    ds_read_b64_tr_b16 v[86:87], v42 offset:32256
    v_mfma_f32_16x16x32_bf16 v[184:187], v[64:67], a[104:107], v[184:187]
    v_mfma_f32_16x16x32_bf16 v[188:191], v[64:67], a[108:111], v[188:191]
    s_waitcnt lgkmcnt(8)
    v_mfma_f32_16x16x32_bf16 v[192:195], v[68:71], a[96:99], v[192:195]
    ds_read_b64_tr_b16 v[88:89], v42 offset:27680
    v_mfma_f32_16x16x32_bf16 v[196:199], v[68:71], a[100:103], v[196:199]
    ds_read_b64_tr_b16 v[90:91], v42 offset:32288
    v_mfma_f32_16x16x32_bf16 v[200:203], v[68:71], a[104:107], v[200:203]
    v_mfma_f32_16x16x32_bf16 v[204:207], v[68:71], a[108:111], v[204:207]
    s_waitcnt lgkmcnt(8)
    v_mfma_f32_16x16x32_bf16 v[208:211], v[72:75], a[96:99], v[208:211]
    ds_read_b64_tr_b16 v[92:93], v42 offset:27712
    v_mfma_f32_16x16x32_bf16 v[212:215], v[72:75], a[100:103], v[212:215]
    ds_read_b64_tr_b16 v[94:95], v42 offset:32320
    v_mfma_f32_16x16x32_bf16 v[216:219], v[72:75], a[104:107], v[216:219]
    v_mfma_f32_16x16x32_bf16 v[220:223], v[72:75], a[108:111], v[220:223]
    s_waitcnt lgkmcnt(8)
    v_mfma_f32_16x16x32_bf16 v[224:227], v[76:79], a[96:99], v[224:227]
    ds_read_b64_tr_b16 v[96:97], v42 offset:27744
    v_mfma_f32_16x16x32_bf16 v[228:231], v[76:79], a[100:103], v[228:231]
    ds_read_b64_tr_b16 v[98:99], v42 offset:32352
    v_mfma_f32_16x16x32_bf16 v[232:235], v[76:79], a[104:107], v[232:235]
    v_mfma_f32_16x16x32_bf16 v[236:239], v[76:79], a[108:111], v[236:239]
    s_waitcnt lgkmcnt(8)
    v_mfma_f32_16x16x32_bf16 v[240:243], v[80:83], a[96:99], v[240:243]
    ds_read_b64_tr_b16 v[100:101], v42 offset:27776
    v_mfma_f32_16x16x32_bf16 v[244:247], v[80:83], a[100:103], v[244:247]
    ds_read_b64_tr_b16 v[102:103], v42 offset:32384
    v_mfma_f32_16x16x32_bf16 v[248:251], v[80:83], a[104:107], v[248:251]
    v_mfma_f32_16x16x32_bf16 v[252:255], v[80:83], a[108:111], v[252:255]
    s_waitcnt vmcnt(46) lgkmcnt(8)
    v_mfma_f32_16x16x32_bf16 v[112:115], v[84:87], a[112:115], v[112:115]
    ds_read_b64_tr_b16 v[48:49], v42 offset:27808
    v_mfma_f32_16x16x32_bf16 v[116:119], v[84:87], a[116:119], v[116:119]
    ds_read_b64_tr_b16 v[50:51], v42 offset:32416
    v_mfma_f32_16x16x32_bf16 v[120:123], v[84:87], a[120:123], v[120:123]
    s_add_u32 s32, s100, 20480
    buffer_load_dwordx4 a[240:243], v35, s[20:23], s32 offen offset:3072 sc1
    v_mfma_f32_16x16x32_bf16 v[124:127], v[84:87], a[124:127], v[124:127]
    s_waitcnt lgkmcnt(8)
    v_mfma_f32_16x16x32_bf16 v[128:131], v[88:91], a[112:115], v[128:131]
    ds_read_b64_tr_b16 v[52:53], v42 offset:27840
    v_mfma_f32_16x16x32_bf16 v[132:135], v[88:91], a[116:119], v[132:135]
    ds_read_b64_tr_b16 v[54:55], v42 offset:32448
    v_mfma_f32_16x16x32_bf16 v[136:139], v[88:91], a[120:123], v[136:139]
    buffer_load_dwordx4 a[244:247], v36, s[20:23], s32 offen offset:3072 sc1
    v_mfma_f32_16x16x32_bf16 v[140:143], v[88:91], a[124:127], v[140:143]
    s_waitcnt lgkmcnt(8)
    v_mfma_f32_16x16x32_bf16 v[144:147], v[92:95], a[112:115], v[144:147]
    ds_read_b64_tr_b16 v[56:57], v42 offset:27872
    v_mfma_f32_16x16x32_bf16 v[148:151], v[92:95], a[116:119], v[148:151]
    ds_read_b64_tr_b16 v[58:59], v42 offset:32480
    v_mfma_f32_16x16x32_bf16 v[152:155], v[92:95], a[120:123], v[152:155]
    buffer_load_dwordx4 a[248:251], v37, s[20:23], s32 offen offset:3072 sc1
    v_mfma_f32_16x16x32_bf16 v[156:159], v[92:95], a[124:127], v[156:159]
    s_waitcnt lgkmcnt(8)
    v_mfma_f32_16x16x32_bf16 v[160:163], v[96:99], a[112:115], v[160:163]
    ds_read_b64_tr_b16 v[60:61], v42 offset:27904
    v_mfma_f32_16x16x32_bf16 v[164:167], v[96:99], a[116:119], v[164:167]
    ds_read_b64_tr_b16 v[62:63], v42 offset:32512
    v_mfma_f32_16x16x32_bf16 v[168:171], v[96:99], a[120:123], v[168:171]
    buffer_load_dwordx4 a[252:255], v38, s[20:23], s32 offen offset:3072 sc1
    v_mfma_f32_16x16x32_bf16 v[172:175], v[96:99], a[124:127], v[172:175]
    s_waitcnt lgkmcnt(8)
    v_mfma_f32_16x16x32_bf16 v[176:179], v[100:103], a[112:115], v[176:179]
    s_waitcnt vmcnt(41)
    s_barrier
    ds_read_b64_tr_b16 v[64:65], v39 offset:0
    v_mfma_f32_16x16x32_bf16 v[180:183], v[100:103], a[116:119], v[180:183]
    ds_read_b64_tr_b16 v[66:67], v39 offset:4608
    v_mfma_f32_16x16x32_bf16 v[184:187], v[100:103], a[120:123], v[184:187]
    s_add_u32 s31, s94, 884736
    s_add_u32 m0, s95, 73728
    s_nop 0
    buffer_load_dwordx4 v26, s[96:99], s31 offen offset:0 lds
    v_mfma_f32_16x16x32_bf16 v[188:191], v[100:103], a[124:127], v[188:191]
    s_waitcnt lgkmcnt(8)
    v_mfma_f32_16x16x32_bf16 v[192:195], v[48:51], a[112:115], v[192:195]
    ds_read_b64_tr_b16 v[68:69], v39 offset:32
    v_mfma_f32_16x16x32_bf16 v[196:199], v[48:51], a[116:119], v[196:199]
    ds_read_b64_tr_b16 v[70:71], v39 offset:4640
    v_mfma_f32_16x16x32_bf16 v[200:203], v[48:51], a[120:123], v[200:203]
    buffer_load_dwordx4 v27, s[96:99], s31 offen offset:1024 lds
    v_mfma_f32_16x16x32_bf16 v[204:207], v[48:51], a[124:127], v[204:207]
    s_waitcnt lgkmcnt(8)
    v_mfma_f32_16x16x32_bf16 v[208:211], v[52:55], a[112:115], v[208:211]
    ds_read_b64_tr_b16 v[72:73], v39 offset:64
    v_mfma_f32_16x16x32_bf16 v[212:215], v[52:55], a[116:119], v[212:215]
    ds_read_b64_tr_b16 v[74:75], v39 offset:4672
    v_mfma_f32_16x16x32_bf16 v[216:219], v[52:55], a[120:123], v[216:219]
    buffer_load_dwordx4 v28, s[96:99], s31 offen offset:2048 lds
    v_mfma_f32_16x16x32_bf16 v[220:223], v[52:55], a[124:127], v[220:223]
    s_waitcnt lgkmcnt(8)
    v_mfma_f32_16x16x32_bf16 v[224:227], v[56:59], a[112:115], v[224:227]
    ds_read_b64_tr_b16 v[76:77], v39 offset:96
    v_mfma_f32_16x16x32_bf16 v[228:231], v[56:59], a[116:119], v[228:231]
    ds_read_b64_tr_b16 v[78:79], v39 offset:4704
    v_mfma_f32_16x16x32_bf16 v[232:235], v[56:59], a[120:123], v[232:235]
    buffer_load_dwordx4 v29, s[96:99], s31 offen offset:3072 lds
    v_mfma_f32_16x16x32_bf16 v[236:239], v[56:59], a[124:127], v[236:239]
    s_waitcnt lgkmcnt(8)
    v_mfma_f32_16x16x32_bf16 v[240:243], v[60:63], a[112:115], v[240:243]
    ds_read_b64_tr_b16 v[80:81], v39 offset:128
    v_mfma_f32_16x16x32_bf16 v[244:247], v[60:63], a[116:119], v[244:247]
    ds_read_b64_tr_b16 v[82:83], v39 offset:4736
    v_mfma_f32_16x16x32_bf16 v[248:251], v[60:63], a[120:123], v[248:251]
    s_add_u32 m0, s95, 77824
    s_nop 0
    buffer_load_dwordx4 v30, s[96:99], s31 offen offset:0 lds
    v_mfma_f32_16x16x32_bf16 v[252:255], v[60:63], a[124:127], v[252:255]
    s_waitcnt vmcnt(42) lgkmcnt(8)
    v_mfma_f32_16x16x32_bf16 v[112:115], v[64:67], a[128:131], v[112:115]
    ds_read_b64_tr_b16 v[84:85], v39 offset:160
    v_mfma_f32_16x16x32_bf16 v[116:119], v[64:67], a[132:135], v[116:119]
    ds_read_b64_tr_b16 v[86:87], v39 offset:4768
    v_mfma_f32_16x16x32_bf16 v[120:123], v[64:67], a[136:139], v[120:123]
    buffer_load_dwordx4 v31, s[96:99], s31 offen offset:1024 lds
    v_mfma_f32_16x16x32_bf16 v[124:127], v[64:67], a[140:143], v[124:127]
    s_waitcnt lgkmcnt(8)
    v_mfma_f32_16x16x32_bf16 v[128:131], v[68:71], a[128:131], v[128:131]
    ds_read_b64_tr_b16 v[88:89], v39 offset:192
    v_mfma_f32_16x16x32_bf16 v[132:135], v[68:71], a[132:135], v[132:135]
    ds_read_b64_tr_b16 v[90:91], v39 offset:4800
    v_mfma_f32_16x16x32_bf16 v[136:139], v[68:71], a[136:139], v[136:139]
    buffer_load_dwordx4 v32, s[96:99], s31 offen offset:2048 lds
    v_mfma_f32_16x16x32_bf16 v[140:143], v[68:71], a[140:143], v[140:143]
    s_waitcnt lgkmcnt(8)
    v_mfma_f32_16x16x32_bf16 v[144:147], v[72:75], a[128:131], v[144:147]
    ds_read_b64_tr_b16 v[92:93], v39 offset:224
    v_mfma_f32_16x16x32_bf16 v[148:151], v[72:75], a[132:135], v[148:151]
    ds_read_b64_tr_b16 v[94:95], v39 offset:4832
    v_mfma_f32_16x16x32_bf16 v[152:155], v[72:75], a[136:139], v[152:155]
    buffer_load_dwordx4 v33, s[96:99], s31 offen offset:3072 lds
    v_mfma_f32_16x16x32_bf16 v[156:159], v[72:75], a[140:143], v[156:159]
    s_waitcnt lgkmcnt(8)
    v_mfma_f32_16x16x32_bf16 v[160:163], v[76:79], a[128:131], v[160:163]
    ds_read_b64_tr_b16 v[96:97], v39 offset:256
    v_mfma_f32_16x16x32_bf16 v[164:167], v[76:79], a[132:135], v[164:167]
    ds_read_b64_tr_b16 v[98:99], v39 offset:4864
    v_mfma_f32_16x16x32_bf16 v[168:171], v[76:79], a[136:139], v[168:171]
    s_add_u32 m0, s95, 81920
    s_nop 0
    buffer_load_dwordx4 v34, s[96:99], s31 offen offset:0 lds
    v_mfma_f32_16x16x32_bf16 v[172:175], v[76:79], a[140:143], v[172:175]
    s_waitcnt lgkmcnt(8)
    v_mfma_f32_16x16x32_bf16 v[176:179], v[80:83], a[128:131], v[176:179]
    ds_read_b64_tr_b16 v[100:101], v39 offset:9216
    v_mfma_f32_16x16x32_bf16 v[180:183], v[80:83], a[132:135], v[180:183]
    ds_read_b64_tr_b16 v[102:103], v39 offset:13824
    v_mfma_f32_16x16x32_bf16 v[184:187], v[80:83], a[136:139], v[184:187]
    s_add_u32 s32, s100, 24576
    buffer_load_dwordx4 a[0:3], v35, s[20:23], s32 offen offset:0 sc1
    v_mfma_f32_16x16x32_bf16 v[188:191], v[80:83], a[140:143], v[188:191]
    s_waitcnt lgkmcnt(8)
    v_mfma_f32_16x16x32_bf16 v[192:195], v[84:87], a[128:131], v[192:195]
    ds_read_b64_tr_b16 v[48:49], v39 offset:9248
    v_mfma_f32_16x16x32_bf16 v[196:199], v[84:87], a[132:135], v[196:199]
    ds_read_b64_tr_b16 v[50:51], v39 offset:13856
    v_mfma_f32_16x16x32_bf16 v[200:203], v[84:87], a[136:139], v[200:203]
    buffer_load_dwordx4 a[4:7], v36, s[20:23], s32 offen offset:0 sc1
    v_mfma_f32_16x16x32_bf16 v[204:207], v[84:87], a[140:143], v[204:207]
    s_waitcnt lgkmcnt(8)
    v_mfma_f32_16x16x32_bf16 v[208:211], v[88:91], a[128:131], v[208:211]
    ds_read_b64_tr_b16 v[52:53], v39 offset:9280
    v_mfma_f32_16x16x32_bf16 v[212:215], v[88:91], a[132:135], v[212:215]
    ds_read_b64_tr_b16 v[54:55], v39 offset:13888
    v_mfma_f32_16x16x32_bf16 v[216:219], v[88:91], a[136:139], v[216:219]
    buffer_load_dwordx4 a[8:11], v37, s[20:23], s32 offen offset:0 sc1
    v_mfma_f32_16x16x32_bf16 v[220:223], v[88:91], a[140:143], v[220:223]
    s_waitcnt lgkmcnt(8)
    v_mfma_f32_16x16x32_bf16 v[224:227], v[92:95], a[128:131], v[224:227]
    ds_read_b64_tr_b16 v[56:57], v39 offset:9312
    v_mfma_f32_16x16x32_bf16 v[228:231], v[92:95], a[132:135], v[228:231]
    ds_read_b64_tr_b16 v[58:59], v39 offset:13920
    v_mfma_f32_16x16x32_bf16 v[232:235], v[92:95], a[136:139], v[232:235]
    buffer_load_dwordx4 a[12:15], v38, s[20:23], s32 offen offset:0 sc1
    v_mfma_f32_16x16x32_bf16 v[236:239], v[92:95], a[140:143], v[236:239]
    s_waitcnt lgkmcnt(8)
    v_mfma_f32_16x16x32_bf16 v[240:243], v[96:99], a[128:131], v[240:243]
    ds_read_b64_tr_b16 v[60:61], v39 offset:9344
    v_mfma_f32_16x16x32_bf16 v[244:247], v[96:99], a[132:135], v[244:247]
    ds_read_b64_tr_b16 v[62:63], v39 offset:13952
    v_mfma_f32_16x16x32_bf16 v[248:251], v[96:99], a[136:139], v[248:251]
    v_mfma_f32_16x16x32_bf16 v[252:255], v[96:99], a[140:143], v[252:255]
    s_waitcnt vmcnt(46) lgkmcnt(8)
    v_mfma_f32_16x16x32_bf16 v[112:115], v[100:103], a[144:147], v[112:115]
    ds_read_b64_tr_b16 v[64:65], v39 offset:9376
    v_mfma_f32_16x16x32_bf16 v[116:119], v[100:103], a[148:151], v[116:119]
    ds_read_b64_tr_b16 v[66:67], v39 offset:13984
    v_mfma_f32_16x16x32_bf16 v[120:123], v[100:103], a[152:155], v[120:123]
    s_add_u32 s32, s100, 24576
    buffer_load_dwordx4 a[16:19], v35, s[20:23], s32 offen offset:1024 sc1
    v_mfma_f32_16x16x32_bf16 v[124:127], v[100:103], a[156:159], v[124:127]
    s_waitcnt lgkmcnt(8)
    v_mfma_f32_16x16x32_bf16 v[128:131], v[48:51], a[144:147], v[128:131]
    ds_read_b64_tr_b16 v[68:69], v39 offset:9408
    v_mfma_f32_16x16x32_bf16 v[132:135], v[48:51], a[148:151], v[132:135]
    ds_read_b64_tr_b16 v[70:71], v39 offset:14016
    v_mfma_f32_16x16x32_bf16 v[136:139], v[48:51], a[152:155], v[136:139]
    buffer_load_dwordx4 a[20:23], v36, s[20:23], s32 offen offset:1024 sc1
    v_mfma_f32_16x16x32_bf16 v[140:143], v[48:51], a[156:159], v[140:143]
    s_waitcnt lgkmcnt(8)
    v_mfma_f32_16x16x32_bf16 v[144:147], v[52:55], a[144:147], v[144:147]
    ds_read_b64_tr_b16 v[72:73], v39 offset:9440
    v_mfma_f32_16x16x32_bf16 v[148:151], v[52:55], a[148:151], v[148:151]
    ds_read_b64_tr_b16 v[74:75], v39 offset:14048
    v_mfma_f32_16x16x32_bf16 v[152:155], v[52:55], a[152:155], v[152:155]
    buffer_load_dwordx4 a[24:27], v37, s[20:23], s32 offen offset:1024 sc1
    v_mfma_f32_16x16x32_bf16 v[156:159], v[52:55], a[156:159], v[156:159]
    s_waitcnt lgkmcnt(8)
    v_mfma_f32_16x16x32_bf16 v[160:163], v[56:59], a[144:147], v[160:163]
    ds_read_b64_tr_b16 v[76:77], v39 offset:9472
    v_mfma_f32_16x16x32_bf16 v[164:167], v[56:59], a[148:151], v[164:167]
    ds_read_b64_tr_b16 v[78:79], v39 offset:14080
    v_mfma_f32_16x16x32_bf16 v[168:171], v[56:59], a[152:155], v[168:171]
    buffer_load_dwordx4 a[28:31], v38, s[20:23], s32 offen offset:1024 sc1
    v_mfma_f32_16x16x32_bf16 v[172:175], v[56:59], a[156:159], v[172:175]
    s_waitcnt lgkmcnt(8)
    v_mfma_f32_16x16x32_bf16 v[176:179], v[60:63], a[144:147], v[176:179]
    ds_read_b64_tr_b16 v[80:81], v39 offset:18432
    v_mfma_f32_16x16x32_bf16 v[180:183], v[60:63], a[148:151], v[180:183]
    ds_read_b64_tr_b16 v[82:83], v39 offset:23040
    v_mfma_f32_16x16x32_bf16 v[184:187], v[60:63], a[152:155], v[184:187]
    v_mfma_f32_16x16x32_bf16 v[188:191], v[60:63], a[156:159], v[188:191]
    s_waitcnt lgkmcnt(8)
    v_mfma_f32_16x16x32_bf16 v[192:195], v[64:67], a[144:147], v[192:195]
    ds_read_b64_tr_b16 v[84:85], v39 offset:18464
    v_mfma_f32_16x16x32_bf16 v[196:199], v[64:67], a[148:151], v[196:199]
    ds_read_b64_tr_b16 v[86:87], v39 offset:23072
    v_mfma_f32_16x16x32_bf16 v[200:203], v[64:67], a[152:155], v[200:203]
    v_mfma_f32_16x16x32_bf16 v[204:207], v[64:67], a[156:159], v[204:207]
    s_waitcnt lgkmcnt(8)
    v_mfma_f32_16x16x32_bf16 v[208:211], v[68:71], a[144:147], v[208:211]
    ds_read_b64_tr_b16 v[88:89], v39 offset:18496
    v_mfma_f32_16x16x32_bf16 v[212:215], v[68:71], a[148:151], v[212:215]
    ds_read_b64_tr_b16 v[90:91], v39 offset:23104
    v_mfma_f32_16x16x32_bf16 v[216:219], v[68:71], a[152:155], v[216:219]
    v_mfma_f32_16x16x32_bf16 v[220:223], v[68:71], a[156:159], v[220:223]
    s_waitcnt lgkmcnt(8)
    v_mfma_f32_16x16x32_bf16 v[224:227], v[72:75], a[144:147], v[224:227]
    ds_read_b64_tr_b16 v[92:93], v39 offset:18528
    v_mfma_f32_16x16x32_bf16 v[228:231], v[72:75], a[148:151], v[228:231]
    ds_read_b64_tr_b16 v[94:95], v39 offset:23136
    v_mfma_f32_16x16x32_bf16 v[232:235], v[72:75], a[152:155], v[232:235]
    v_mfma_f32_16x16x32_bf16 v[236:239], v[72:75], a[156:159], v[236:239]
    s_waitcnt lgkmcnt(8)
    v_mfma_f32_16x16x32_bf16 v[240:243], v[76:79], a[144:147], v[240:243]
    ds_read_b64_tr_b16 v[96:97], v39 offset:18560
    v_mfma_f32_16x16x32_bf16 v[244:247], v[76:79], a[148:151], v[244:247]
    ds_read_b64_tr_b16 v[98:99], v39 offset:23168
    v_mfma_f32_16x16x32_bf16 v[248:251], v[76:79], a[152:155], v[248:251]
    v_mfma_f32_16x16x32_bf16 v[252:255], v[76:79], a[156:159], v[252:255]
    s_waitcnt vmcnt(46) lgkmcnt(8)
    v_mfma_f32_16x16x32_bf16 v[112:115], v[80:83], a[160:163], v[112:115]
    ds_read_b64_tr_b16 v[100:101], v39 offset:18592
    v_mfma_f32_16x16x32_bf16 v[116:119], v[80:83], a[164:167], v[116:119]
    ds_read_b64_tr_b16 v[102:103], v39 offset:23200
    v_mfma_f32_16x16x32_bf16 v[120:123], v[80:83], a[168:171], v[120:123]
    s_add_u32 s32, s100, 24576
    buffer_load_dwordx4 a[32:35], v35, s[20:23], s32 offen offset:2048 sc1
    v_mfma_f32_16x16x32_bf16 v[124:127], v[80:83], a[172:175], v[124:127]
    s_waitcnt lgkmcnt(8)
    v_mfma_f32_16x16x32_bf16 v[128:131], v[84:87], a[160:163], v[128:131]
    ds_read_b64_tr_b16 v[48:49], v39 offset:18624
    v_mfma_f32_16x16x32_bf16 v[132:135], v[84:87], a[164:167], v[132:135]
    ds_read_b64_tr_b16 v[50:51], v39 offset:23232
    v_mfma_f32_16x16x32_bf16 v[136:139], v[84:87], a[168:171], v[136:139]
    buffer_load_dwordx4 a[36:39], v36, s[20:23], s32 offen offset:2048 sc1
    v_mfma_f32_16x16x32_bf16 v[140:143], v[84:87], a[172:175], v[140:143]
    s_waitcnt lgkmcnt(8)
    v_mfma_f32_16x16x32_bf16 v[144:147], v[88:91], a[160:163], v[144:147]
    ds_read_b64_tr_b16 v[52:53], v39 offset:18656
    v_mfma_f32_16x16x32_bf16 v[148:151], v[88:91], a[164:167], v[148:151]
    ds_read_b64_tr_b16 v[54:55], v39 offset:23264
    v_mfma_f32_16x16x32_bf16 v[152:155], v[88:91], a[168:171], v[152:155]
    buffer_load_dwordx4 a[40:43], v37, s[20:23], s32 offen offset:2048 sc1
    v_mfma_f32_16x16x32_bf16 v[156:159], v[88:91], a[172:175], v[156:159]
    s_waitcnt lgkmcnt(8)
    v_mfma_f32_16x16x32_bf16 v[160:163], v[92:95], a[160:163], v[160:163]
    ds_read_b64_tr_b16 v[56:57], v39 offset:18688
    v_mfma_f32_16x16x32_bf16 v[164:167], v[92:95], a[164:167], v[164:167]
    ds_read_b64_tr_b16 v[58:59], v39 offset:23296
    v_mfma_f32_16x16x32_bf16 v[168:171], v[92:95], a[168:171], v[168:171]
    buffer_load_dwordx4 a[44:47], v38, s[20:23], s32 offen offset:2048 sc1
    v_mfma_f32_16x16x32_bf16 v[172:175], v[92:95], a[172:175], v[172:175]
    s_waitcnt lgkmcnt(8)
    v_mfma_f32_16x16x32_bf16 v[176:179], v[96:99], a[160:163], v[176:179]
    ds_read_b64_tr_b16 v[60:61], v39 offset:27648
    v_mfma_f32_16x16x32_bf16 v[180:183], v[96:99], a[164:167], v[180:183]
    ds_read_b64_tr_b16 v[62:63], v39 offset:32256
    v_mfma_f32_16x16x32_bf16 v[184:187], v[96:99], a[168:171], v[184:187]
    v_mfma_f32_16x16x32_bf16 v[188:191], v[96:99], a[172:175], v[188:191]
    s_waitcnt lgkmcnt(8)
    v_mfma_f32_16x16x32_bf16 v[192:195], v[100:103], a[160:163], v[192:195]
    ds_read_b64_tr_b16 v[64:65], v39 offset:27680
    v_mfma_f32_16x16x32_bf16 v[196:199], v[100:103], a[164:167], v[196:199]
    ds_read_b64_tr_b16 v[66:67], v39 offset:32288
    v_mfma_f32_16x16x32_bf16 v[200:203], v[100:103], a[168:171], v[200:203]
    v_mfma_f32_16x16x32_bf16 v[204:207], v[100:103], a[172:175], v[204:207]
    s_waitcnt lgkmcnt(8)
    v_mfma_f32_16x16x32_bf16 v[208:211], v[48:51], a[160:163], v[208:211]
    ds_read_b64_tr_b16 v[68:69], v39 offset:27712
    v_mfma_f32_16x16x32_bf16 v[212:215], v[48:51], a[164:167], v[212:215]
    ds_read_b64_tr_b16 v[70:71], v39 offset:32320
    v_mfma_f32_16x16x32_bf16 v[216:219], v[48:51], a[168:171], v[216:219]
    v_mfma_f32_16x16x32_bf16 v[220:223], v[48:51], a[172:175], v[220:223]
    s_waitcnt lgkmcnt(8)
    v_mfma_f32_16x16x32_bf16 v[224:227], v[52:55], a[160:163], v[224:227]
    ds_read_b64_tr_b16 v[72:73], v39 offset:27744
    v_mfma_f32_16x16x32_bf16 v[228:231], v[52:55], a[164:167], v[228:231]
    ds_read_b64_tr_b16 v[74:75], v39 offset:32352
    v_mfma_f32_16x16x32_bf16 v[232:235], v[52:55], a[168:171], v[232:235]
    v_mfma_f32_16x16x32_bf16 v[236:239], v[52:55], a[172:175], v[236:239]
    s_waitcnt lgkmcnt(8)
    v_mfma_f32_16x16x32_bf16 v[240:243], v[56:59], a[160:163], v[240:243]
    ds_read_b64_tr_b16 v[76:77], v39 offset:27776
    v_mfma_f32_16x16x32_bf16 v[244:247], v[56:59], a[164:167], v[244:247]
    ds_read_b64_tr_b16 v[78:79], v39 offset:32384
    v_mfma_f32_16x16x32_bf16 v[248:251], v[56:59], a[168:171], v[248:251]
    v_mfma_f32_16x16x32_bf16 v[252:255], v[56:59], a[172:175], v[252:255]
    s_waitcnt vmcnt(46) lgkmcnt(8)
    v_mfma_f32_16x16x32_bf16 v[112:115], v[60:63], a[176:179], v[112:115]
    ds_read_b64_tr_b16 v[80:81], v39 offset:27808
    v_mfma_f32_16x16x32_bf16 v[116:119], v[60:63], a[180:183], v[116:119]
    ds_read_b64_tr_b16 v[82:83], v39 offset:32416
    v_mfma_f32_16x16x32_bf16 v[120:123], v[60:63], a[184:187], v[120:123]
    s_add_u32 s32, s100, 24576
    buffer_load_dwordx4 a[48:51], v35, s[20:23], s32 offen offset:3072 sc1
    v_mfma_f32_16x16x32_bf16 v[124:127], v[60:63], a[188:191], v[124:127]
    s_waitcnt lgkmcnt(8)
    v_mfma_f32_16x16x32_bf16 v[128:131], v[64:67], a[176:179], v[128:131]
    ds_read_b64_tr_b16 v[84:85], v39 offset:27840
    v_mfma_f32_16x16x32_bf16 v[132:135], v[64:67], a[180:183], v[132:135]
    ds_read_b64_tr_b16 v[86:87], v39 offset:32448
    v_mfma_f32_16x16x32_bf16 v[136:139], v[64:67], a[184:187], v[136:139]
    buffer_load_dwordx4 a[52:55], v36, s[20:23], s32 offen offset:3072 sc1
    v_mfma_f32_16x16x32_bf16 v[140:143], v[64:67], a[188:191], v[140:143]
    s_waitcnt lgkmcnt(8)
    v_mfma_f32_16x16x32_bf16 v[144:147], v[68:71], a[176:179], v[144:147]
    ds_read_b64_tr_b16 v[88:89], v39 offset:27872
    v_mfma_f32_16x16x32_bf16 v[148:151], v[68:71], a[180:183], v[148:151]
    ds_read_b64_tr_b16 v[90:91], v39 offset:32480
    v_mfma_f32_16x16x32_bf16 v[152:155], v[68:71], a[184:187], v[152:155]
    buffer_load_dwordx4 a[56:59], v37, s[20:23], s32 offen offset:3072 sc1
    v_mfma_f32_16x16x32_bf16 v[156:159], v[68:71], a[188:191], v[156:159]
    s_waitcnt lgkmcnt(8)
    v_mfma_f32_16x16x32_bf16 v[160:163], v[72:75], a[176:179], v[160:163]
    ds_read_b64_tr_b16 v[92:93], v39 offset:27904
    v_mfma_f32_16x16x32_bf16 v[164:167], v[72:75], a[180:183], v[164:167]
    ds_read_b64_tr_b16 v[94:95], v39 offset:32512
    v_mfma_f32_16x16x32_bf16 v[168:171], v[72:75], a[184:187], v[168:171]
    buffer_load_dwordx4 a[60:63], v38, s[20:23], s32 offen offset:3072 sc1
    v_mfma_f32_16x16x32_bf16 v[172:175], v[72:75], a[188:191], v[172:175]
    s_waitcnt lgkmcnt(8)
    v_mfma_f32_16x16x32_bf16 v[176:179], v[76:79], a[176:179], v[176:179]
    s_waitcnt vmcnt(41)
    s_barrier
    ds_read_b64_tr_b16 v[96:97], v40 offset:0
    v_mfma_f32_16x16x32_bf16 v[180:183], v[76:79], a[180:183], v[180:183]
    ds_read_b64_tr_b16 v[98:99], v40 offset:4608
    v_mfma_f32_16x16x32_bf16 v[184:187], v[76:79], a[184:187], v[184:187]
    s_add_u32 s31, s94, 1032192
    s_add_u32 m0, s95, 110592
    s_nop 0
    buffer_load_dwordx4 v26, s[96:99], s31 offen offset:0 lds
    v_mfma_f32_16x16x32_bf16 v[188:191], v[76:79], a[188:191], v[188:191]
    s_waitcnt lgkmcnt(8)
    v_mfma_f32_16x16x32_bf16 v[192:195], v[80:83], a[176:179], v[192:195]
    ds_read_b64_tr_b16 v[100:101], v40 offset:32
    v_mfma_f32_16x16x32_bf16 v[196:199], v[80:83], a[180:183], v[196:199]
    ds_read_b64_tr_b16 v[102:103], v40 offset:4640
    v_mfma_f32_16x16x32_bf16 v[200:203], v[80:83], a[184:187], v[200:203]
    buffer_load_dwordx4 v27, s[96:99], s31 offen offset:1024 lds
    v_mfma_f32_16x16x32_bf16 v[204:207], v[80:83], a[188:191], v[204:207]
    s_waitcnt lgkmcnt(8)
    v_mfma_f32_16x16x32_bf16 v[208:211], v[84:87], a[176:179], v[208:211]
    ds_read_b64_tr_b16 v[48:49], v40 offset:64
    v_mfma_f32_16x16x32_bf16 v[212:215], v[84:87], a[180:183], v[212:215]
    ds_read_b64_tr_b16 v[50:51], v40 offset:4672
    v_mfma_f32_16x16x32_bf16 v[216:219], v[84:87], a[184:187], v[216:219]
    buffer_load_dwordx4 v28, s[96:99], s31 offen offset:2048 lds
    v_mfma_f32_16x16x32_bf16 v[220:223], v[84:87], a[188:191], v[220:223]
    s_waitcnt lgkmcnt(8)
    v_mfma_f32_16x16x32_bf16 v[224:227], v[88:91], a[176:179], v[224:227]
    ds_read_b64_tr_b16 v[52:53], v40 offset:96
    v_mfma_f32_16x16x32_bf16 v[228:231], v[88:91], a[180:183], v[228:231]
    ds_read_b64_tr_b16 v[54:55], v40 offset:4704
    v_mfma_f32_16x16x32_bf16 v[232:235], v[88:91], a[184:187], v[232:235]
    buffer_load_dwordx4 v29, s[96:99], s31 offen offset:3072 lds
    v_mfma_f32_16x16x32_bf16 v[236:239], v[88:91], a[188:191], v[236:239]
    s_waitcnt lgkmcnt(8)
    v_mfma_f32_16x16x32_bf16 v[240:243], v[92:95], a[176:179], v[240:243]
    ds_read_b64_tr_b16 v[56:57], v40 offset:128
    v_mfma_f32_16x16x32_bf16 v[244:247], v[92:95], a[180:183], v[244:247]
    ds_read_b64_tr_b16 v[58:59], v40 offset:4736
    v_mfma_f32_16x16x32_bf16 v[248:251], v[92:95], a[184:187], v[248:251]
    s_add_u32 m0, s95, 114688
    s_nop 0
    buffer_load_dwordx4 v30, s[96:99], s31 offen offset:0 lds
    v_mfma_f32_16x16x32_bf16 v[252:255], v[92:95], a[188:191], v[252:255]
    s_waitcnt vmcnt(42) lgkmcnt(8)
    v_mfma_f32_16x16x32_bf16 v[112:115], v[96:99], a[192:195], v[112:115]
    ds_read_b64_tr_b16 v[60:61], v40 offset:160
    v_mfma_f32_16x16x32_bf16 v[116:119], v[96:99], a[196:199], v[116:119]
    ds_read_b64_tr_b16 v[62:63], v40 offset:4768
    v_mfma_f32_16x16x32_bf16 v[120:123], v[96:99], a[200:203], v[120:123]
    buffer_load_dwordx4 v31, s[96:99], s31 offen offset:1024 lds
    v_mfma_f32_16x16x32_bf16 v[124:127], v[96:99], a[204:207], v[124:127]
    s_waitcnt lgkmcnt(8)
    v_mfma_f32_16x16x32_bf16 v[128:131], v[100:103], a[192:195], v[128:131]
    ds_read_b64_tr_b16 v[64:65], v40 offset:192
    v_mfma_f32_16x16x32_bf16 v[132:135], v[100:103], a[196:199], v[132:135]
    ds_read_b64_tr_b16 v[66:67], v40 offset:4800
    v_mfma_f32_16x16x32_bf16 v[136:139], v[100:103], a[200:203], v[136:139]
    buffer_load_dwordx4 v32, s[96:99], s31 offen offset:2048 lds
    v_mfma_f32_16x16x32_bf16 v[140:143], v[100:103], a[204:207], v[140:143]
    s_waitcnt lgkmcnt(8)
    v_mfma_f32_16x16x32_bf16 v[144:147], v[48:51], a[192:195], v[144:147]
    ds_read_b64_tr_b16 v[68:69], v40 offset:224
    v_mfma_f32_16x16x32_bf16 v[148:151], v[48:51], a[196:199], v[148:151]
    ds_read_b64_tr_b16 v[70:71], v40 offset:4832
    v_mfma_f32_16x16x32_bf16 v[152:155], v[48:51], a[200:203], v[152:155]
    buffer_load_dwordx4 v33, s[96:99], s31 offen offset:3072 lds
    v_mfma_f32_16x16x32_bf16 v[156:159], v[48:51], a[204:207], v[156:159]
    s_waitcnt lgkmcnt(8)
    v_mfma_f32_16x16x32_bf16 v[160:163], v[52:55], a[192:195], v[160:163]
    ds_read_b64_tr_b16 v[72:73], v40 offset:256
    v_mfma_f32_16x16x32_bf16 v[164:167], v[52:55], a[196:199], v[164:167]
    ds_read_b64_tr_b16 v[74:75], v40 offset:4864
    v_mfma_f32_16x16x32_bf16 v[168:171], v[52:55], a[200:203], v[168:171]
    s_add_u32 m0, s95, 118784
    s_nop 0
    buffer_load_dwordx4 v34, s[96:99], s31 offen offset:0 lds
    v_mfma_f32_16x16x32_bf16 v[172:175], v[52:55], a[204:207], v[172:175]
    s_waitcnt lgkmcnt(8)
    v_mfma_f32_16x16x32_bf16 v[176:179], v[56:59], a[192:195], v[176:179]
    ds_read_b64_tr_b16 v[76:77], v40 offset:9216
    v_mfma_f32_16x16x32_bf16 v[180:183], v[56:59], a[196:199], v[180:183]
    ds_read_b64_tr_b16 v[78:79], v40 offset:13824
    v_mfma_f32_16x16x32_bf16 v[184:187], v[56:59], a[200:203], v[184:187]
    s_add_u32 s32, s100, 28672
    buffer_load_dwordx4 a[64:67], v35, s[20:23], s32 offen offset:0 sc1
    v_mfma_f32_16x16x32_bf16 v[188:191], v[56:59], a[204:207], v[188:191]
    s_waitcnt lgkmcnt(8)
    v_mfma_f32_16x16x32_bf16 v[192:195], v[60:63], a[192:195], v[192:195]
    ds_read_b64_tr_b16 v[80:81], v40 offset:9248
    v_mfma_f32_16x16x32_bf16 v[196:199], v[60:63], a[196:199], v[196:199]
    ds_read_b64_tr_b16 v[82:83], v40 offset:13856
    v_mfma_f32_16x16x32_bf16 v[200:203], v[60:63], a[200:203], v[200:203]
    buffer_load_dwordx4 a[68:71], v36, s[20:23], s32 offen offset:0 sc1
    v_mfma_f32_16x16x32_bf16 v[204:207], v[60:63], a[204:207], v[204:207]
    s_waitcnt lgkmcnt(8)
    v_mfma_f32_16x16x32_bf16 v[208:211], v[64:67], a[192:195], v[208:211]
    ds_read_b64_tr_b16 v[84:85], v40 offset:9280
    v_mfma_f32_16x16x32_bf16 v[212:215], v[64:67], a[196:199], v[212:215]
    ds_read_b64_tr_b16 v[86:87], v40 offset:13888
    v_mfma_f32_16x16x32_bf16 v[216:219], v[64:67], a[200:203], v[216:219]
    buffer_load_dwordx4 a[72:75], v37, s[20:23], s32 offen offset:0 sc1
    v_mfma_f32_16x16x32_bf16 v[220:223], v[64:67], a[204:207], v[220:223]
    s_waitcnt lgkmcnt(8)
    v_mfma_f32_16x16x32_bf16 v[224:227], v[68:71], a[192:195], v[224:227]
    ds_read_b64_tr_b16 v[88:89], v40 offset:9312
    v_mfma_f32_16x16x32_bf16 v[228:231], v[68:71], a[196:199], v[228:231]
    ds_read_b64_tr_b16 v[90:91], v40 offset:13920
    v_mfma_f32_16x16x32_bf16 v[232:235], v[68:71], a[200:203], v[232:235]
    buffer_load_dwordx4 a[76:79], v38, s[20:23], s32 offen offset:0 sc1
    v_mfma_f32_16x16x32_bf16 v[236:239], v[68:71], a[204:207], v[236:239]
    s_waitcnt lgkmcnt(8)
    v_mfma_f32_16x16x32_bf16 v[240:243], v[72:75], a[192:195], v[240:243]
    ds_read_b64_tr_b16 v[92:93], v40 offset:9344
    v_mfma_f32_16x16x32_bf16 v[244:247], v[72:75], a[196:199], v[244:247]
    ds_read_b64_tr_b16 v[94:95], v40 offset:13952
    v_mfma_f32_16x16x32_bf16 v[248:251], v[72:75], a[200:203], v[248:251]
    v_mfma_f32_16x16x32_bf16 v[252:255], v[72:75], a[204:207], v[252:255]
    s_waitcnt vmcnt(46) lgkmcnt(8)
    v_mfma_f32_16x16x32_bf16 v[112:115], v[76:79], a[208:211], v[112:115]
    ds_read_b64_tr_b16 v[96:97], v40 offset:9376
    v_mfma_f32_16x16x32_bf16 v[116:119], v[76:79], a[212:215], v[116:119]
    ds_read_b64_tr_b16 v[98:99], v40 offset:13984
    v_mfma_f32_16x16x32_bf16 v[120:123], v[76:79], a[216:219], v[120:123]
    s_add_u32 s32, s100, 28672
    buffer_load_dwordx4 a[80:83], v35, s[20:23], s32 offen offset:1024 sc1
    v_mfma_f32_16x16x32_bf16 v[124:127], v[76:79], a[220:223], v[124:127]
    s_waitcnt lgkmcnt(8)
    v_mfma_f32_16x16x32_bf16 v[128:131], v[80:83], a[208:211], v[128:131]
    ds_read_b64_tr_b16 v[100:101], v40 offset:9408
    v_mfma_f32_16x16x32_bf16 v[132:135], v[80:83], a[212:215], v[132:135]
    ds_read_b64_tr_b16 v[102:103], v40 offset:14016
    v_mfma_f32_16x16x32_bf16 v[136:139], v[80:83], a[216:219], v[136:139]
    buffer_load_dwordx4 a[84:87], v36, s[20:23], s32 offen offset:1024 sc1
    v_mfma_f32_16x16x32_bf16 v[140:143], v[80:83], a[220:223], v[140:143]
    s_waitcnt lgkmcnt(8)
    v_mfma_f32_16x16x32_bf16 v[144:147], v[84:87], a[208:211], v[144:147]
    ds_read_b64_tr_b16 v[48:49], v40 offset:9440
    v_mfma_f32_16x16x32_bf16 v[148:151], v[84:87], a[212:215], v[148:151]
    ds_read_b64_tr_b16 v[50:51], v40 offset:14048
    v_mfma_f32_16x16x32_bf16 v[152:155], v[84:87], a[216:219], v[152:155]
    buffer_load_dwordx4 a[88:91], v37, s[20:23], s32 offen offset:1024 sc1
    v_mfma_f32_16x16x32_bf16 v[156:159], v[84:87], a[220:223], v[156:159]
    s_waitcnt lgkmcnt(8)
    v_mfma_f32_16x16x32_bf16 v[160:163], v[88:91], a[208:211], v[160:163]
    ds_read_b64_tr_b16 v[52:53], v40 offset:9472
    v_mfma_f32_16x16x32_bf16 v[164:167], v[88:91], a[212:215], v[164:167]
    ds_read_b64_tr_b16 v[54:55], v40 offset:14080
    v_mfma_f32_16x16x32_bf16 v[168:171], v[88:91], a[216:219], v[168:171]
    buffer_load_dwordx4 a[92:95], v38, s[20:23], s32 offen offset:1024 sc1
    v_mfma_f32_16x16x32_bf16 v[172:175], v[88:91], a[220:223], v[172:175]
    s_waitcnt lgkmcnt(8)
    v_mfma_f32_16x16x32_bf16 v[176:179], v[92:95], a[208:211], v[176:179]
    ds_read_b64_tr_b16 v[56:57], v40 offset:18432
    v_mfma_f32_16x16x32_bf16 v[180:183], v[92:95], a[212:215], v[180:183]
    ds_read_b64_tr_b16 v[58:59], v40 offset:23040
    v_mfma_f32_16x16x32_bf16 v[184:187], v[92:95], a[216:219], v[184:187]
    v_mfma_f32_16x16x32_bf16 v[188:191], v[92:95], a[220:223], v[188:191]
    s_waitcnt lgkmcnt(8)
    v_mfma_f32_16x16x32_bf16 v[192:195], v[96:99], a[208:211], v[192:195]
    ds_read_b64_tr_b16 v[60:61], v40 offset:18464
    v_mfma_f32_16x16x32_bf16 v[196:199], v[96:99], a[212:215], v[196:199]
    ds_read_b64_tr_b16 v[62:63], v40 offset:23072
    v_mfma_f32_16x16x32_bf16 v[200:203], v[96:99], a[216:219], v[200:203]
    v_mfma_f32_16x16x32_bf16 v[204:207], v[96:99], a[220:223], v[204:207]
    s_waitcnt lgkmcnt(8)
    v_mfma_f32_16x16x32_bf16 v[208:211], v[100:103], a[208:211], v[208:211]
    ds_read_b64_tr_b16 v[64:65], v40 offset:18496
    v_mfma_f32_16x16x32_bf16 v[212:215], v[100:103], a[212:215], v[212:215]
    ds_read_b64_tr_b16 v[66:67], v40 offset:23104
    v_mfma_f32_16x16x32_bf16 v[216:219], v[100:103], a[216:219], v[216:219]
    v_mfma_f32_16x16x32_bf16 v[220:223], v[100:103], a[220:223], v[220:223]
    s_waitcnt lgkmcnt(8)
    v_mfma_f32_16x16x32_bf16 v[224:227], v[48:51], a[208:211], v[224:227]
    ds_read_b64_tr_b16 v[68:69], v40 offset:18528
    v_mfma_f32_16x16x32_bf16 v[228:231], v[48:51], a[212:215], v[228:231]
    ds_read_b64_tr_b16 v[70:71], v40 offset:23136
    v_mfma_f32_16x16x32_bf16 v[232:235], v[48:51], a[216:219], v[232:235]
    v_mfma_f32_16x16x32_bf16 v[236:239], v[48:51], a[220:223], v[236:239]
    s_waitcnt lgkmcnt(8)
    v_mfma_f32_16x16x32_bf16 v[240:243], v[52:55], a[208:211], v[240:243]
    ds_read_b64_tr_b16 v[72:73], v40 offset:18560
    v_mfma_f32_16x16x32_bf16 v[244:247], v[52:55], a[212:215], v[244:247]
    ds_read_b64_tr_b16 v[74:75], v40 offset:23168
    v_mfma_f32_16x16x32_bf16 v[248:251], v[52:55], a[216:219], v[248:251]
    v_mfma_f32_16x16x32_bf16 v[252:255], v[52:55], a[220:223], v[252:255]
    s_waitcnt vmcnt(46) lgkmcnt(8)
    v_mfma_f32_16x16x32_bf16 v[112:115], v[56:59], a[224:227], v[112:115]
    ds_read_b64_tr_b16 v[76:77], v40 offset:18592
    v_mfma_f32_16x16x32_bf16 v[116:119], v[56:59], a[228:231], v[116:119]
    ds_read_b64_tr_b16 v[78:79], v40 offset:23200
    v_mfma_f32_16x16x32_bf16 v[120:123], v[56:59], a[232:235], v[120:123]
    s_add_u32 s32, s100, 28672
    buffer_load_dwordx4 a[96:99], v35, s[20:23], s32 offen offset:2048 sc1
    v_mfma_f32_16x16x32_bf16 v[124:127], v[56:59], a[236:239], v[124:127]
    s_waitcnt lgkmcnt(8)
    v_mfma_f32_16x16x32_bf16 v[128:131], v[60:63], a[224:227], v[128:131]
    ds_read_b64_tr_b16 v[80:81], v40 offset:18624
    v_mfma_f32_16x16x32_bf16 v[132:135], v[60:63], a[228:231], v[132:135]
    ds_read_b64_tr_b16 v[82:83], v40 offset:23232
    v_mfma_f32_16x16x32_bf16 v[136:139], v[60:63], a[232:235], v[136:139]
    buffer_load_dwordx4 a[100:103], v36, s[20:23], s32 offen offset:2048 sc1
    v_mfma_f32_16x16x32_bf16 v[140:143], v[60:63], a[236:239], v[140:143]
    s_waitcnt lgkmcnt(8)
    v_mfma_f32_16x16x32_bf16 v[144:147], v[64:67], a[224:227], v[144:147]
    ds_read_b64_tr_b16 v[84:85], v40 offset:18656
    v_mfma_f32_16x16x32_bf16 v[148:151], v[64:67], a[228:231], v[148:151]
    ds_read_b64_tr_b16 v[86:87], v40 offset:23264
    v_mfma_f32_16x16x32_bf16 v[152:155], v[64:67], a[232:235], v[152:155]
    buffer_load_dwordx4 a[104:107], v37, s[20:23], s32 offen offset:2048 sc1
    v_mfma_f32_16x16x32_bf16 v[156:159], v[64:67], a[236:239], v[156:159]
    s_waitcnt lgkmcnt(8)
    v_mfma_f32_16x16x32_bf16 v[160:163], v[68:71], a[224:227], v[160:163]
    ds_read_b64_tr_b16 v[88:89], v40 offset:18688
    v_mfma_f32_16x16x32_bf16 v[164:167], v[68:71], a[228:231], v[164:167]
    ds_read_b64_tr_b16 v[90:91], v40 offset:23296
    v_mfma_f32_16x16x32_bf16 v[168:171], v[68:71], a[232:235], v[168:171]
    buffer_load_dwordx4 a[108:111], v38, s[20:23], s32 offen offset:2048 sc1
    v_mfma_f32_16x16x32_bf16 v[172:175], v[68:71], a[236:239], v[172:175]
    s_waitcnt lgkmcnt(8)
    v_mfma_f32_16x16x32_bf16 v[176:179], v[72:75], a[224:227], v[176:179]
    ds_read_b64_tr_b16 v[92:93], v40 offset:27648
    v_mfma_f32_16x16x32_bf16 v[180:183], v[72:75], a[228:231], v[180:183]
    ds_read_b64_tr_b16 v[94:95], v40 offset:32256
    v_mfma_f32_16x16x32_bf16 v[184:187], v[72:75], a[232:235], v[184:187]
    v_mfma_f32_16x16x32_bf16 v[188:191], v[72:75], a[236:239], v[188:191]
    s_waitcnt lgkmcnt(8)
    v_mfma_f32_16x16x32_bf16 v[192:195], v[76:79], a[224:227], v[192:195]
    ds_read_b64_tr_b16 v[96:97], v40 offset:27680
    v_mfma_f32_16x16x32_bf16 v[196:199], v[76:79], a[228:231], v[196:199]
    ds_read_b64_tr_b16 v[98:99], v40 offset:32288
    v_mfma_f32_16x16x32_bf16 v[200:203], v[76:79], a[232:235], v[200:203]
    v_mfma_f32_16x16x32_bf16 v[204:207], v[76:79], a[236:239], v[204:207]
    s_waitcnt lgkmcnt(8)
    v_mfma_f32_16x16x32_bf16 v[208:211], v[80:83], a[224:227], v[208:211]
    ds_read_b64_tr_b16 v[100:101], v40 offset:27712
    v_mfma_f32_16x16x32_bf16 v[212:215], v[80:83], a[228:231], v[212:215]
    ds_read_b64_tr_b16 v[102:103], v40 offset:32320
    v_mfma_f32_16x16x32_bf16 v[216:219], v[80:83], a[232:235], v[216:219]
    v_mfma_f32_16x16x32_bf16 v[220:223], v[80:83], a[236:239], v[220:223]
    s_waitcnt lgkmcnt(8)
    v_mfma_f32_16x16x32_bf16 v[224:227], v[84:87], a[224:227], v[224:227]
    ds_read_b64_tr_b16 v[48:49], v40 offset:27744
    v_mfma_f32_16x16x32_bf16 v[228:231], v[84:87], a[228:231], v[228:231]
    ds_read_b64_tr_b16 v[50:51], v40 offset:32352
    v_mfma_f32_16x16x32_bf16 v[232:235], v[84:87], a[232:235], v[232:235]
    v_mfma_f32_16x16x32_bf16 v[236:239], v[84:87], a[236:239], v[236:239]
    s_waitcnt lgkmcnt(8)
    v_mfma_f32_16x16x32_bf16 v[240:243], v[88:91], a[224:227], v[240:243]
    ds_read_b64_tr_b16 v[52:53], v40 offset:27776
    v_mfma_f32_16x16x32_bf16 v[244:247], v[88:91], a[228:231], v[244:247]
    ds_read_b64_tr_b16 v[54:55], v40 offset:32384
    v_mfma_f32_16x16x32_bf16 v[248:251], v[88:91], a[232:235], v[248:251]
    v_mfma_f32_16x16x32_bf16 v[252:255], v[88:91], a[236:239], v[252:255]
    s_waitcnt vmcnt(46) lgkmcnt(8)
    v_mfma_f32_16x16x32_bf16 v[112:115], v[92:95], a[240:243], v[112:115]
    ds_read_b64_tr_b16 v[56:57], v40 offset:27808
    v_mfma_f32_16x16x32_bf16 v[116:119], v[92:95], a[244:247], v[116:119]
    ds_read_b64_tr_b16 v[58:59], v40 offset:32416
    v_mfma_f32_16x16x32_bf16 v[120:123], v[92:95], a[248:251], v[120:123]
    s_add_u32 s32, s100, 28672
    buffer_load_dwordx4 a[112:115], v35, s[20:23], s32 offen offset:3072 sc1
    v_mfma_f32_16x16x32_bf16 v[124:127], v[92:95], a[252:255], v[124:127]
    s_waitcnt lgkmcnt(8)
    v_mfma_f32_16x16x32_bf16 v[128:131], v[96:99], a[240:243], v[128:131]
    ds_read_b64_tr_b16 v[60:61], v40 offset:27840
    v_mfma_f32_16x16x32_bf16 v[132:135], v[96:99], a[244:247], v[132:135]
    ds_read_b64_tr_b16 v[62:63], v40 offset:32448
    v_mfma_f32_16x16x32_bf16 v[136:139], v[96:99], a[248:251], v[136:139]
    buffer_load_dwordx4 a[116:119], v36, s[20:23], s32 offen offset:3072 sc1
    v_mfma_f32_16x16x32_bf16 v[140:143], v[96:99], a[252:255], v[140:143]
    s_waitcnt lgkmcnt(8)
    v_mfma_f32_16x16x32_bf16 v[144:147], v[100:103], a[240:243], v[144:147]
    ds_read_b64_tr_b16 v[64:65], v40 offset:27872
    v_mfma_f32_16x16x32_bf16 v[148:151], v[100:103], a[244:247], v[148:151]
    ds_read_b64_tr_b16 v[66:67], v40 offset:32480
    v_mfma_f32_16x16x32_bf16 v[152:155], v[100:103], a[248:251], v[152:155]
    buffer_load_dwordx4 a[120:123], v37, s[20:23], s32 offen offset:3072 sc1
    v_mfma_f32_16x16x32_bf16 v[156:159], v[100:103], a[252:255], v[156:159]
    s_waitcnt lgkmcnt(8)
    v_mfma_f32_16x16x32_bf16 v[160:163], v[48:51], a[240:243], v[160:163]
    ds_read_b64_tr_b16 v[68:69], v40 offset:27904
    v_mfma_f32_16x16x32_bf16 v[164:167], v[48:51], a[244:247], v[164:167]
    ds_read_b64_tr_b16 v[70:71], v40 offset:32512
    v_mfma_f32_16x16x32_bf16 v[168:171], v[48:51], a[248:251], v[168:171]
    buffer_load_dwordx4 a[124:127], v38, s[20:23], s32 offen offset:3072 sc1
    v_mfma_f32_16x16x32_bf16 v[172:175], v[48:51], a[252:255], v[172:175]
    s_waitcnt lgkmcnt(8)
    v_mfma_f32_16x16x32_bf16 v[176:179], v[52:55], a[240:243], v[176:179]
    s_waitcnt vmcnt(41)
    s_barrier
    ds_read_b64_tr_b16 v[72:73], v41 offset:0
    v_mfma_f32_16x16x32_bf16 v[180:183], v[52:55], a[244:247], v[180:183]
    ds_read_b64_tr_b16 v[74:75], v41 offset:4608
    v_mfma_f32_16x16x32_bf16 v[184:187], v[52:55], a[248:251], v[184:187]
    s_add_u32 m0, s95, 0
    s_nop 0
    buffer_load_dwordx4 v26, s[96:99], s42 offen offset:0 lds
    v_mfma_f32_16x16x32_bf16 v[188:191], v[52:55], a[252:255], v[188:191]
    s_waitcnt lgkmcnt(8)
    v_mfma_f32_16x16x32_bf16 v[192:195], v[56:59], a[240:243], v[192:195]
    ds_read_b64_tr_b16 v[76:77], v41 offset:32
    v_mfma_f32_16x16x32_bf16 v[196:199], v[56:59], a[244:247], v[196:199]
    ds_read_b64_tr_b16 v[78:79], v41 offset:4640
    v_mfma_f32_16x16x32_bf16 v[200:203], v[56:59], a[248:251], v[200:203]
    buffer_load_dwordx4 v27, s[96:99], s42 offen offset:1024 lds
    v_mfma_f32_16x16x32_bf16 v[204:207], v[56:59], a[252:255], v[204:207]
    s_waitcnt lgkmcnt(8)
    v_mfma_f32_16x16x32_bf16 v[208:211], v[60:63], a[240:243], v[208:211]
    ds_read_b64_tr_b16 v[80:81], v41 offset:64
    v_mfma_f32_16x16x32_bf16 v[212:215], v[60:63], a[244:247], v[212:215]
    ds_read_b64_tr_b16 v[82:83], v41 offset:4672
    v_mfma_f32_16x16x32_bf16 v[216:219], v[60:63], a[248:251], v[216:219]
    buffer_load_dwordx4 v28, s[96:99], s42 offen offset:2048 lds
    v_mfma_f32_16x16x32_bf16 v[220:223], v[60:63], a[252:255], v[220:223]
    s_waitcnt lgkmcnt(8)
    v_mfma_f32_16x16x32_bf16 v[224:227], v[64:67], a[240:243], v[224:227]
    ds_read_b64_tr_b16 v[84:85], v41 offset:96
    v_mfma_f32_16x16x32_bf16 v[228:231], v[64:67], a[244:247], v[228:231]
    ds_read_b64_tr_b16 v[86:87], v41 offset:4704
    v_mfma_f32_16x16x32_bf16 v[232:235], v[64:67], a[248:251], v[232:235]
    buffer_load_dwordx4 v29, s[96:99], s42 offen offset:3072 lds
    v_mfma_f32_16x16x32_bf16 v[236:239], v[64:67], a[252:255], v[236:239]
    s_waitcnt lgkmcnt(8)
    v_mfma_f32_16x16x32_bf16 v[240:243], v[68:71], a[240:243], v[240:243]
    ds_read_b64_tr_b16 v[88:89], v41 offset:128
    v_mfma_f32_16x16x32_bf16 v[244:247], v[68:71], a[244:247], v[244:247]
    ds_read_b64_tr_b16 v[90:91], v41 offset:4736
    v_mfma_f32_16x16x32_bf16 v[248:251], v[68:71], a[248:251], v[248:251]
    s_add_u32 m0, s95, 4096
    s_nop 0
    buffer_load_dwordx4 v30, s[96:99], s42 offen offset:0 lds
    v_mfma_f32_16x16x32_bf16 v[252:255], v[68:71], a[252:255], v[252:255]
    s_waitcnt vmcnt(42) lgkmcnt(8)
    v_mfma_f32_16x16x32_bf16 v[112:115], v[72:75], a[0:3], v[112:115]
    ds_read_b64_tr_b16 v[92:93], v41 offset:160
    v_mfma_f32_16x16x32_bf16 v[116:119], v[72:75], a[4:7], v[116:119]
    ds_read_b64_tr_b16 v[94:95], v41 offset:4768
    v_mfma_f32_16x16x32_bf16 v[120:123], v[72:75], a[8:11], v[120:123]
    buffer_load_dwordx4 v31, s[96:99], s42 offen offset:1024 lds
    v_mfma_f32_16x16x32_bf16 v[124:127], v[72:75], a[12:15], v[124:127]
    s_waitcnt lgkmcnt(8)
    v_mfma_f32_16x16x32_bf16 v[128:131], v[76:79], a[0:3], v[128:131]
    ds_read_b64_tr_b16 v[96:97], v41 offset:192
    v_mfma_f32_16x16x32_bf16 v[132:135], v[76:79], a[4:7], v[132:135]
    ds_read_b64_tr_b16 v[98:99], v41 offset:4800
    v_mfma_f32_16x16x32_bf16 v[136:139], v[76:79], a[8:11], v[136:139]
    buffer_load_dwordx4 v32, s[96:99], s42 offen offset:2048 lds
    v_mfma_f32_16x16x32_bf16 v[140:143], v[76:79], a[12:15], v[140:143]
    s_waitcnt lgkmcnt(8)
    v_mfma_f32_16x16x32_bf16 v[144:147], v[80:83], a[0:3], v[144:147]
    ds_read_b64_tr_b16 v[100:101], v41 offset:224
    v_mfma_f32_16x16x32_bf16 v[148:151], v[80:83], a[4:7], v[148:151]
    ds_read_b64_tr_b16 v[102:103], v41 offset:4832
    v_mfma_f32_16x16x32_bf16 v[152:155], v[80:83], a[8:11], v[152:155]
    buffer_load_dwordx4 v33, s[96:99], s42 offen offset:3072 lds
    v_mfma_f32_16x16x32_bf16 v[156:159], v[80:83], a[12:15], v[156:159]
    s_waitcnt lgkmcnt(8)
    v_mfma_f32_16x16x32_bf16 v[160:163], v[84:87], a[0:3], v[160:163]
    ds_read_b64_tr_b16 v[48:49], v41 offset:256
    v_mfma_f32_16x16x32_bf16 v[164:167], v[84:87], a[4:7], v[164:167]
    ds_read_b64_tr_b16 v[50:51], v41 offset:4864
    v_mfma_f32_16x16x32_bf16 v[168:171], v[84:87], a[8:11], v[168:171]
    s_add_u32 m0, s95, 8192
    s_nop 0
    buffer_load_dwordx4 v34, s[96:99], s42 offen offset:0 lds
    v_mfma_f32_16x16x32_bf16 v[172:175], v[84:87], a[12:15], v[172:175]
    s_waitcnt lgkmcnt(8)
    v_mfma_f32_16x16x32_bf16 v[176:179], v[88:91], a[0:3], v[176:179]
    ds_read_b64_tr_b16 v[52:53], v41 offset:9216
    v_mfma_f32_16x16x32_bf16 v[180:183], v[88:91], a[4:7], v[180:183]
    ds_read_b64_tr_b16 v[54:55], v41 offset:13824
    v_mfma_f32_16x16x32_bf16 v[184:187], v[88:91], a[8:11], v[184:187]
    buffer_load_dwordx4 a[128:131], v35, s[20:23], s43 offen offset:0 sc1
    v_mfma_f32_16x16x32_bf16 v[188:191], v[88:91], a[12:15], v[188:191]
    s_waitcnt lgkmcnt(8)
    v_mfma_f32_16x16x32_bf16 v[192:195], v[92:95], a[0:3], v[192:195]
    ds_read_b64_tr_b16 v[56:57], v41 offset:9248
    v_mfma_f32_16x16x32_bf16 v[196:199], v[92:95], a[4:7], v[196:199]
    ds_read_b64_tr_b16 v[58:59], v41 offset:13856
    v_mfma_f32_16x16x32_bf16 v[200:203], v[92:95], a[8:11], v[200:203]
    buffer_load_dwordx4 a[132:135], v36, s[20:23], s43 offen offset:0 sc1
    v_mfma_f32_16x16x32_bf16 v[204:207], v[92:95], a[12:15], v[204:207]
    s_waitcnt lgkmcnt(8)
    v_mfma_f32_16x16x32_bf16 v[208:211], v[96:99], a[0:3], v[208:211]
    ds_read_b64_tr_b16 v[60:61], v41 offset:9280
    v_mfma_f32_16x16x32_bf16 v[212:215], v[96:99], a[4:7], v[212:215]
    ds_read_b64_tr_b16 v[62:63], v41 offset:13888
    v_mfma_f32_16x16x32_bf16 v[216:219], v[96:99], a[8:11], v[216:219]
    buffer_load_dwordx4 a[136:139], v37, s[20:23], s43 offen offset:0 sc1
    v_mfma_f32_16x16x32_bf16 v[220:223], v[96:99], a[12:15], v[220:223]
    s_waitcnt lgkmcnt(8)
    v_mfma_f32_16x16x32_bf16 v[224:227], v[100:103], a[0:3], v[224:227]
    ds_read_b64_tr_b16 v[64:65], v41 offset:9312
    v_mfma_f32_16x16x32_bf16 v[228:231], v[100:103], a[4:7], v[228:231]
    ds_read_b64_tr_b16 v[66:67], v41 offset:13920
    v_mfma_f32_16x16x32_bf16 v[232:235], v[100:103], a[8:11], v[232:235]
    buffer_load_dwordx4 a[140:143], v38, s[20:23], s43 offen offset:0 sc1
    v_mfma_f32_16x16x32_bf16 v[236:239], v[100:103], a[12:15], v[236:239]
    s_waitcnt lgkmcnt(8)
    v_mfma_f32_16x16x32_bf16 v[240:243], v[48:51], a[0:3], v[240:243]
    ds_read_b64_tr_b16 v[68:69], v41 offset:9344
    v_mfma_f32_16x16x32_bf16 v[244:247], v[48:51], a[4:7], v[244:247]
    ds_read_b64_tr_b16 v[70:71], v41 offset:13952
    v_mfma_f32_16x16x32_bf16 v[248:251], v[48:51], a[8:11], v[248:251]
    v_mfma_f32_16x16x32_bf16 v[252:255], v[48:51], a[12:15], v[252:255]
    s_waitcnt vmcnt(46) lgkmcnt(8)
    v_mfma_f32_16x16x32_bf16 v[112:115], v[52:55], a[16:19], v[112:115]
    ds_read_b64_tr_b16 v[72:73], v41 offset:9376
    v_mfma_f32_16x16x32_bf16 v[116:119], v[52:55], a[20:23], v[116:119]
    ds_read_b64_tr_b16 v[74:75], v41 offset:13984
    v_mfma_f32_16x16x32_bf16 v[120:123], v[52:55], a[24:27], v[120:123]
    buffer_load_dwordx4 a[144:147], v35, s[20:23], s43 offen offset:1024 sc1
    v_mfma_f32_16x16x32_bf16 v[124:127], v[52:55], a[28:31], v[124:127]
    s_waitcnt lgkmcnt(8)
    v_mfma_f32_16x16x32_bf16 v[128:131], v[56:59], a[16:19], v[128:131]
    ds_read_b64_tr_b16 v[76:77], v41 offset:9408
    v_mfma_f32_16x16x32_bf16 v[132:135], v[56:59], a[20:23], v[132:135]
    ds_read_b64_tr_b16 v[78:79], v41 offset:14016
    v_mfma_f32_16x16x32_bf16 v[136:139], v[56:59], a[24:27], v[136:139]
    buffer_load_dwordx4 a[148:151], v36, s[20:23], s43 offen offset:1024 sc1
    v_mfma_f32_16x16x32_bf16 v[140:143], v[56:59], a[28:31], v[140:143]
    s_waitcnt lgkmcnt(8)
    v_mfma_f32_16x16x32_bf16 v[144:147], v[60:63], a[16:19], v[144:147]
    ds_read_b64_tr_b16 v[80:81], v41 offset:9440
    v_mfma_f32_16x16x32_bf16 v[148:151], v[60:63], a[20:23], v[148:151]
    ds_read_b64_tr_b16 v[82:83], v41 offset:14048
    v_mfma_f32_16x16x32_bf16 v[152:155], v[60:63], a[24:27], v[152:155]
    buffer_load_dwordx4 a[152:155], v37, s[20:23], s43 offen offset:1024 sc1
    v_mfma_f32_16x16x32_bf16 v[156:159], v[60:63], a[28:31], v[156:159]
    s_waitcnt lgkmcnt(8)
    v_mfma_f32_16x16x32_bf16 v[160:163], v[64:67], a[16:19], v[160:163]
    ds_read_b64_tr_b16 v[84:85], v41 offset:9472
    v_mfma_f32_16x16x32_bf16 v[164:167], v[64:67], a[20:23], v[164:167]
    ds_read_b64_tr_b16 v[86:87], v41 offset:14080
    v_mfma_f32_16x16x32_bf16 v[168:171], v[64:67], a[24:27], v[168:171]
    buffer_load_dwordx4 a[156:159], v38, s[20:23], s43 offen offset:1024 sc1
    v_mfma_f32_16x16x32_bf16 v[172:175], v[64:67], a[28:31], v[172:175]
    s_waitcnt lgkmcnt(8)
    v_mfma_f32_16x16x32_bf16 v[176:179], v[68:71], a[16:19], v[176:179]
    ds_read_b64_tr_b16 v[88:89], v41 offset:18432
    v_mfma_f32_16x16x32_bf16 v[180:183], v[68:71], a[20:23], v[180:183]
    ds_read_b64_tr_b16 v[90:91], v41 offset:23040
    v_mfma_f32_16x16x32_bf16 v[184:187], v[68:71], a[24:27], v[184:187]
    v_mfma_f32_16x16x32_bf16 v[188:191], v[68:71], a[28:31], v[188:191]
    s_waitcnt lgkmcnt(8)
    v_mfma_f32_16x16x32_bf16 v[192:195], v[72:75], a[16:19], v[192:195]
    ds_read_b64_tr_b16 v[92:93], v41 offset:18464
    v_mfma_f32_16x16x32_bf16 v[196:199], v[72:75], a[20:23], v[196:199]
    ds_read_b64_tr_b16 v[94:95], v41 offset:23072
    v_mfma_f32_16x16x32_bf16 v[200:203], v[72:75], a[24:27], v[200:203]
    v_mfma_f32_16x16x32_bf16 v[204:207], v[72:75], a[28:31], v[204:207]
    s_waitcnt lgkmcnt(8)
    v_mfma_f32_16x16x32_bf16 v[208:211], v[76:79], a[16:19], v[208:211]
    ds_read_b64_tr_b16 v[96:97], v41 offset:18496
    v_mfma_f32_16x16x32_bf16 v[212:215], v[76:79], a[20:23], v[212:215]
    ds_read_b64_tr_b16 v[98:99], v41 offset:23104
    v_mfma_f32_16x16x32_bf16 v[216:219], v[76:79], a[24:27], v[216:219]
    v_mfma_f32_16x16x32_bf16 v[220:223], v[76:79], a[28:31], v[220:223]
    s_waitcnt lgkmcnt(8)
    v_mfma_f32_16x16x32_bf16 v[224:227], v[80:83], a[16:19], v[224:227]
    ds_read_b64_tr_b16 v[100:101], v41 offset:18528
    v_mfma_f32_16x16x32_bf16 v[228:231], v[80:83], a[20:23], v[228:231]
    ds_read_b64_tr_b16 v[102:103], v41 offset:23136
    v_mfma_f32_16x16x32_bf16 v[232:235], v[80:83], a[24:27], v[232:235]
    v_mfma_f32_16x16x32_bf16 v[236:239], v[80:83], a[28:31], v[236:239]
    s_waitcnt lgkmcnt(8)
    v_mfma_f32_16x16x32_bf16 v[240:243], v[84:87], a[16:19], v[240:243]
    ds_read_b64_tr_b16 v[48:49], v41 offset:18560
    v_mfma_f32_16x16x32_bf16 v[244:247], v[84:87], a[20:23], v[244:247]
    ds_read_b64_tr_b16 v[50:51], v41 offset:23168
    v_mfma_f32_16x16x32_bf16 v[248:251], v[84:87], a[24:27], v[248:251]
    v_mfma_f32_16x16x32_bf16 v[252:255], v[84:87], a[28:31], v[252:255]
    s_waitcnt vmcnt(46) lgkmcnt(8)
    v_mfma_f32_16x16x32_bf16 v[112:115], v[88:91], a[32:35], v[112:115]
    ds_read_b64_tr_b16 v[52:53], v41 offset:18592
    v_mfma_f32_16x16x32_bf16 v[116:119], v[88:91], a[36:39], v[116:119]
    ds_read_b64_tr_b16 v[54:55], v41 offset:23200
    v_mfma_f32_16x16x32_bf16 v[120:123], v[88:91], a[40:43], v[120:123]
    buffer_load_dwordx4 a[160:163], v35, s[20:23], s43 offen offset:2048 sc1
    v_mfma_f32_16x16x32_bf16 v[124:127], v[88:91], a[44:47], v[124:127]
    s_waitcnt lgkmcnt(8)
    v_mfma_f32_16x16x32_bf16 v[128:131], v[92:95], a[32:35], v[128:131]
    ds_read_b64_tr_b16 v[56:57], v41 offset:18624
    v_mfma_f32_16x16x32_bf16 v[132:135], v[92:95], a[36:39], v[132:135]
    ds_read_b64_tr_b16 v[58:59], v41 offset:23232
    v_mfma_f32_16x16x32_bf16 v[136:139], v[92:95], a[40:43], v[136:139]
    buffer_load_dwordx4 a[164:167], v36, s[20:23], s43 offen offset:2048 sc1
    v_mfma_f32_16x16x32_bf16 v[140:143], v[92:95], a[44:47], v[140:143]
    s_waitcnt lgkmcnt(8)
    v_mfma_f32_16x16x32_bf16 v[144:147], v[96:99], a[32:35], v[144:147]
    ds_read_b64_tr_b16 v[60:61], v41 offset:18656
    v_mfma_f32_16x16x32_bf16 v[148:151], v[96:99], a[36:39], v[148:151]
    ds_read_b64_tr_b16 v[62:63], v41 offset:23264
    v_mfma_f32_16x16x32_bf16 v[152:155], v[96:99], a[40:43], v[152:155]
    buffer_load_dwordx4 a[168:171], v37, s[20:23], s43 offen offset:2048 sc1
    v_mfma_f32_16x16x32_bf16 v[156:159], v[96:99], a[44:47], v[156:159]
    s_waitcnt lgkmcnt(8)
    v_mfma_f32_16x16x32_bf16 v[160:163], v[100:103], a[32:35], v[160:163]
    ds_read_b64_tr_b16 v[64:65], v41 offset:18688
    v_mfma_f32_16x16x32_bf16 v[164:167], v[100:103], a[36:39], v[164:167]
    ds_read_b64_tr_b16 v[66:67], v41 offset:23296
    v_mfma_f32_16x16x32_bf16 v[168:171], v[100:103], a[40:43], v[168:171]
    buffer_load_dwordx4 a[172:175], v38, s[20:23], s43 offen offset:2048 sc1
    v_mfma_f32_16x16x32_bf16 v[172:175], v[100:103], a[44:47], v[172:175]
    s_waitcnt lgkmcnt(8)
    v_mfma_f32_16x16x32_bf16 v[176:179], v[48:51], a[32:35], v[176:179]
    ds_read_b64_tr_b16 v[68:69], v41 offset:27648
    v_mfma_f32_16x16x32_bf16 v[180:183], v[48:51], a[36:39], v[180:183]
    ds_read_b64_tr_b16 v[70:71], v41 offset:32256
    v_mfma_f32_16x16x32_bf16 v[184:187], v[48:51], a[40:43], v[184:187]
    v_mfma_f32_16x16x32_bf16 v[188:191], v[48:51], a[44:47], v[188:191]
    s_waitcnt lgkmcnt(8)
    v_mfma_f32_16x16x32_bf16 v[192:195], v[52:55], a[32:35], v[192:195]
    ds_read_b64_tr_b16 v[72:73], v41 offset:27680
    v_mfma_f32_16x16x32_bf16 v[196:199], v[52:55], a[36:39], v[196:199]
    ds_read_b64_tr_b16 v[74:75], v41 offset:32288
    v_mfma_f32_16x16x32_bf16 v[200:203], v[52:55], a[40:43], v[200:203]
    v_mfma_f32_16x16x32_bf16 v[204:207], v[52:55], a[44:47], v[204:207]
    s_waitcnt lgkmcnt(8)
    v_mfma_f32_16x16x32_bf16 v[208:211], v[56:59], a[32:35], v[208:211]
    ds_read_b64_tr_b16 v[76:77], v41 offset:27712
    v_mfma_f32_16x16x32_bf16 v[212:215], v[56:59], a[36:39], v[212:215]
    ds_read_b64_tr_b16 v[78:79], v41 offset:32320
    v_mfma_f32_16x16x32_bf16 v[216:219], v[56:59], a[40:43], v[216:219]
    v_mfma_f32_16x16x32_bf16 v[220:223], v[56:59], a[44:47], v[220:223]
    s_waitcnt lgkmcnt(8)
    v_mfma_f32_16x16x32_bf16 v[224:227], v[60:63], a[32:35], v[224:227]
    ds_read_b64_tr_b16 v[80:81], v41 offset:27744
    v_mfma_f32_16x16x32_bf16 v[228:231], v[60:63], a[36:39], v[228:231]
    ds_read_b64_tr_b16 v[82:83], v41 offset:32352
    v_mfma_f32_16x16x32_bf16 v[232:235], v[60:63], a[40:43], v[232:235]
    v_mfma_f32_16x16x32_bf16 v[236:239], v[60:63], a[44:47], v[236:239]
    s_waitcnt lgkmcnt(8)
    v_mfma_f32_16x16x32_bf16 v[240:243], v[64:67], a[32:35], v[240:243]
    ds_read_b64_tr_b16 v[84:85], v41 offset:27776
    v_mfma_f32_16x16x32_bf16 v[244:247], v[64:67], a[36:39], v[244:247]
    ds_read_b64_tr_b16 v[86:87], v41 offset:32384
    v_mfma_f32_16x16x32_bf16 v[248:251], v[64:67], a[40:43], v[248:251]
    v_mfma_f32_16x16x32_bf16 v[252:255], v[64:67], a[44:47], v[252:255]
    s_waitcnt vmcnt(46) lgkmcnt(8)
    v_mfma_f32_16x16x32_bf16 v[112:115], v[68:71], a[48:51], v[112:115]
    ds_read_b64_tr_b16 v[88:89], v41 offset:27808
    v_mfma_f32_16x16x32_bf16 v[116:119], v[68:71], a[52:55], v[116:119]
    ds_read_b64_tr_b16 v[90:91], v41 offset:32416
    v_mfma_f32_16x16x32_bf16 v[120:123], v[68:71], a[56:59], v[120:123]
    buffer_load_dwordx4 a[176:179], v35, s[20:23], s43 offen offset:3072 sc1
    v_mfma_f32_16x16x32_bf16 v[124:127], v[68:71], a[60:63], v[124:127]
    s_waitcnt lgkmcnt(8)
    v_mfma_f32_16x16x32_bf16 v[128:131], v[72:75], a[48:51], v[128:131]
    ds_read_b64_tr_b16 v[92:93], v41 offset:27840
    v_mfma_f32_16x16x32_bf16 v[132:135], v[72:75], a[52:55], v[132:135]
    ds_read_b64_tr_b16 v[94:95], v41 offset:32448
    v_mfma_f32_16x16x32_bf16 v[136:139], v[72:75], a[56:59], v[136:139]
    buffer_load_dwordx4 a[180:183], v36, s[20:23], s43 offen offset:3072 sc1
    v_mfma_f32_16x16x32_bf16 v[140:143], v[72:75], a[60:63], v[140:143]
    s_waitcnt lgkmcnt(8)
    v_mfma_f32_16x16x32_bf16 v[144:147], v[76:79], a[48:51], v[144:147]
    ds_read_b64_tr_b16 v[96:97], v41 offset:27872
    v_mfma_f32_16x16x32_bf16 v[148:151], v[76:79], a[52:55], v[148:151]
    ds_read_b64_tr_b16 v[98:99], v41 offset:32480
    v_mfma_f32_16x16x32_bf16 v[152:155], v[76:79], a[56:59], v[152:155]
    buffer_load_dwordx4 a[184:187], v37, s[20:23], s43 offen offset:3072 sc1
    v_mfma_f32_16x16x32_bf16 v[156:159], v[76:79], a[60:63], v[156:159]
    s_waitcnt lgkmcnt(8)
    v_mfma_f32_16x16x32_bf16 v[160:163], v[80:83], a[48:51], v[160:163]
    ds_read_b64_tr_b16 v[100:101], v41 offset:27904
    v_mfma_f32_16x16x32_bf16 v[164:167], v[80:83], a[52:55], v[164:167]
    ds_read_b64_tr_b16 v[102:103], v41 offset:32512
    v_mfma_f32_16x16x32_bf16 v[168:171], v[80:83], a[56:59], v[168:171]
    buffer_load_dwordx4 a[188:191], v38, s[20:23], s43 offen offset:3072 sc1
    v_mfma_f32_16x16x32_bf16 v[172:175], v[80:83], a[60:63], v[172:175]
    s_waitcnt lgkmcnt(8)
    v_mfma_f32_16x16x32_bf16 v[176:179], v[84:87], a[48:51], v[176:179]
    s_waitcnt vmcnt(41)
    s_barrier
    ds_read_b64_tr_b16 v[48:49], v42 offset:0
    v_mfma_f32_16x16x32_bf16 v[180:183], v[84:87], a[52:55], v[180:183]
    ds_read_b64_tr_b16 v[50:51], v42 offset:4608
    v_mfma_f32_16x16x32_bf16 v[184:187], v[84:87], a[56:59], v[184:187]
    v_mfma_f32_16x16x32_bf16 v[188:191], v[84:87], a[60:63], v[188:191]
    s_waitcnt lgkmcnt(8)
    v_mfma_f32_16x16x32_bf16 v[192:195], v[88:91], a[48:51], v[192:195]
    ds_read_b64_tr_b16 v[52:53], v42 offset:9216
    v_mfma_f32_16x16x32_bf16 v[196:199], v[88:91], a[52:55], v[196:199]
    ds_read_b64_tr_b16 v[54:55], v42 offset:13824
    v_mfma_f32_16x16x32_bf16 v[200:203], v[88:91], a[56:59], v[200:203]
    v_mfma_f32_16x16x32_bf16 v[204:207], v[88:91], a[60:63], v[204:207]
    s_waitcnt lgkmcnt(8)
    v_mfma_f32_16x16x32_bf16 v[208:211], v[92:95], a[48:51], v[208:211]
    ds_read_b64_tr_b16 v[56:57], v42 offset:18432
    v_mfma_f32_16x16x32_bf16 v[212:215], v[92:95], a[52:55], v[212:215]
    ds_read_b64_tr_b16 v[58:59], v42 offset:23040
    v_mfma_f32_16x16x32_bf16 v[216:219], v[92:95], a[56:59], v[216:219]
    v_mfma_f32_16x16x32_bf16 v[220:223], v[92:95], a[60:63], v[220:223]
    s_waitcnt lgkmcnt(8)
    v_mfma_f32_16x16x32_bf16 v[224:227], v[96:99], a[48:51], v[224:227]
    ds_read_b64_tr_b16 v[60:61], v42 offset:27648
    v_mfma_f32_16x16x32_bf16 v[228:231], v[96:99], a[52:55], v[228:231]
    ds_read_b64_tr_b16 v[62:63], v42 offset:32256
    v_mfma_f32_16x16x32_bf16 v[232:235], v[96:99], a[56:59], v[232:235]
    v_mfma_f32_16x16x32_bf16 v[236:239], v[96:99], a[60:63], v[236:239]
    s_waitcnt lgkmcnt(8)
    v_mfma_f32_16x16x32_bf16 v[240:243], v[100:103], a[48:51], v[240:243]
    ds_read_b64_tr_b16 v[64:65], v42 offset:32
    v_mfma_f32_16x16x32_bf16 v[244:247], v[100:103], a[52:55], v[244:247]
    ds_read_b64_tr_b16 v[66:67], v42 offset:4640
    v_mfma_f32_16x16x32_bf16 v[248:251], v[100:103], a[56:59], v[248:251]
    v_mfma_f32_16x16x32_bf16 v[252:255], v[100:103], a[60:63], v[252:255]
    s_cmp_lg_u32 s101, 0
    s_cbranch_scc1 L_g4y_32
    s_waitcnt vmcnt(37) lgkmcnt(8)
    v_mfma_f32_16x16x32_bf16 v[112:115], v[48:51], a[64:67], v[112:115]
    ds_read_b64_tr_b16 v[68:69], v42 offset:9248
    v_mfma_f32_16x16x32_bf16 v[116:119], v[48:51], a[68:71], v[116:119]
    ds_read_b64_tr_b16 v[70:71], v42 offset:13856
    v_mfma_f32_16x16x32_bf16 v[120:123], v[48:51], a[72:75], v[120:123]
    v_mfma_f32_16x16x32_bf16 v[124:127], v[48:51], a[76:79], v[124:127]
    s_waitcnt vmcnt(33) lgkmcnt(8)
    v_mfma_f32_16x16x32_bf16 v[112:115], v[52:55], a[80:83], v[112:115]
    ds_read_b64_tr_b16 v[72:73], v42 offset:18464
    v_mfma_f32_16x16x32_bf16 v[116:119], v[52:55], a[84:87], v[116:119]
    ds_read_b64_tr_b16 v[74:75], v42 offset:23072
    v_mfma_f32_16x16x32_bf16 v[120:123], v[52:55], a[88:91], v[120:123]
    v_mfma_f32_16x16x32_bf16 v[124:127], v[52:55], a[92:95], v[124:127]
    s_waitcnt vmcnt(29) lgkmcnt(8)
    v_mfma_f32_16x16x32_bf16 v[112:115], v[56:59], a[96:99], v[112:115]
    ds_read_b64_tr_b16 v[76:77], v42 offset:27680
    v_mfma_f32_16x16x32_bf16 v[116:119], v[56:59], a[100:103], v[116:119]
    ds_read_b64_tr_b16 v[78:79], v42 offset:32288
    v_mfma_f32_16x16x32_bf16 v[120:123], v[56:59], a[104:107], v[120:123]
    v_mfma_f32_16x16x32_bf16 v[124:127], v[56:59], a[108:111], v[124:127]
    s_waitcnt vmcnt(25) lgkmcnt(8)
    v_mfma_f32_16x16x32_bf16 v[112:115], v[60:63], a[112:115], v[112:115]
    ds_read_b64_tr_b16 v[80:81], v42 offset:64
    v_mfma_f32_16x16x32_bf16 v[116:119], v[60:63], a[116:119], v[116:119]
    ds_read_b64_tr_b16 v[82:83], v42 offset:4672
    v_mfma_f32_16x16x32_bf16 v[120:123], v[60:63], a[120:123], v[120:123]
    v_mfma_f32_16x16x32_bf16 v[124:127], v[60:63], a[124:127], v[124:127]
    s_waitcnt lgkmcnt(8)
    v_mfma_f32_16x16x32_bf16 v[128:131], v[64:67], a[64:67], v[128:131]
    ds_read_b64_tr_b16 v[84:85], v42 offset:9280
    v_mfma_f32_16x16x32_bf16 v[132:135], v[64:67], a[68:71], v[132:135]
    ds_read_b64_tr_b16 v[86:87], v42 offset:13888
    v_mfma_f32_16x16x32_bf16 v[136:139], v[64:67], a[72:75], v[136:139]
    v_mfma_f32_16x16x32_bf16 v[140:143], v[64:67], a[76:79], v[140:143]
    s_waitcnt lgkmcnt(8)
    v_mfma_f32_16x16x32_bf16 v[128:131], v[68:71], a[80:83], v[128:131]
    ds_read_b64_tr_b16 v[88:89], v42 offset:18496
    v_mfma_f32_16x16x32_bf16 v[132:135], v[68:71], a[84:87], v[132:135]
    ds_read_b64_tr_b16 v[90:91], v42 offset:23104
    v_mfma_f32_16x16x32_bf16 v[136:139], v[68:71], a[88:91], v[136:139]
    v_cvt_pk_bf16_f32 v104, v112, v113
    v_cvt_pk_bf16_f32 v105, v114, v115
    v_mfma_f32_16x16x32_bf16 v[140:143], v[68:71], a[92:95], v[140:143]
    v_cvt_pk_bf16_f32 v106, v116, v117
    v_cvt_pk_bf16_f32 v107, v118, v119
    s_nop 1
    s_waitcnt lgkmcnt(8)
    v_mfma_f32_16x16x32_bf16 v[128:131], v[72:75], a[96:99], v[128:131]
    ds_read_b64_tr_b16 v[92:93], v42 offset:27712
    v_mfma_f32_16x16x32_bf16 v[132:135], v[72:75], a[100:103], v[132:135]
    ds_read_b64_tr_b16 v[94:95], v42 offset:32320
    v_mfma_f32_16x16x32_bf16 v[136:139], v[72:75], a[104:107], v[136:139]
    v_permlane16_swap_b32 v104, v106
    v_permlane16_swap_b32 v105, v107
    v_mfma_f32_16x16x32_bf16 v[140:143], v[72:75], a[108:111], v[140:143]
    buffer_store_dwordx4 v[104:107], v43, s[16:19], 0 offen offset:0 sc1
    v_cvt_pk_bf16_f32 v108, v120, v121
    v_cvt_pk_bf16_f32 v109, v122, v123
    s_waitcnt lgkmcnt(8)
    v_mfma_f32_16x16x32_bf16 v[128:131], v[76:79], a[112:115], v[128:131]
    ds_read_b64_tr_b16 v[96:97], v42 offset:96
    v_mfma_f32_16x16x32_bf16 v[132:135], v[76:79], a[116:119], v[132:135]
    ds_read_b64_tr_b16 v[98:99], v42 offset:4704
    v_mfma_f32_16x16x32_bf16 v[136:139], v[76:79], a[120:123], v[136:139]
    v_cvt_pk_bf16_f32 v110, v124, v125
    v_cvt_pk_bf16_f32 v111, v126, v127
    v_mfma_f32_16x16x32_bf16 v[140:143], v[76:79], a[124:127], v[140:143]
    s_nop 1
    v_permlane16_swap_b32 v108, v110
    v_permlane16_swap_b32 v109, v111
    s_waitcnt lgkmcnt(8)
    v_mfma_f32_16x16x32_bf16 v[144:147], v[80:83], a[64:67], v[144:147]
    ds_read_b64_tr_b16 v[100:101], v42 offset:9312
    v_mfma_f32_16x16x32_bf16 v[148:151], v[80:83], a[68:71], v[148:151]
    ds_read_b64_tr_b16 v[102:103], v42 offset:13920
    v_mfma_f32_16x16x32_bf16 v[152:155], v[80:83], a[72:75], v[152:155]
    buffer_store_dwordx4 v[108:111], v44, s[16:19], 0 offen offset:0 sc1
    v_mfma_f32_16x16x32_bf16 v[156:159], v[80:83], a[76:79], v[156:159]
    s_waitcnt lgkmcnt(8)
    v_mfma_f32_16x16x32_bf16 v[144:147], v[84:87], a[80:83], v[144:147]
    ds_read_b64_tr_b16 v[48:49], v42 offset:18528
    v_mfma_f32_16x16x32_bf16 v[148:151], v[84:87], a[84:87], v[148:151]
    ds_read_b64_tr_b16 v[50:51], v42 offset:23136
    v_mfma_f32_16x16x32_bf16 v[152:155], v[84:87], a[88:91], v[152:155]
    v_cvt_pk_bf16_f32 v104, v128, v129
    v_cvt_pk_bf16_f32 v105, v130, v131
    v_mfma_f32_16x16x32_bf16 v[156:159], v[84:87], a[92:95], v[156:159]
    v_cvt_pk_bf16_f32 v106, v132, v133
    v_cvt_pk_bf16_f32 v107, v134, v135
    s_nop 1
    s_waitcnt lgkmcnt(8)
    v_mfma_f32_16x16x32_bf16 v[144:147], v[88:91], a[96:99], v[144:147]
    ds_read_b64_tr_b16 v[52:53], v42 offset:27744
    v_mfma_f32_16x16x32_bf16 v[148:151], v[88:91], a[100:103], v[148:151]
    ds_read_b64_tr_b16 v[54:55], v42 offset:32352
    v_mfma_f32_16x16x32_bf16 v[152:155], v[88:91], a[104:107], v[152:155]
    v_permlane16_swap_b32 v104, v106
    v_permlane16_swap_b32 v105, v107
    v_mfma_f32_16x16x32_bf16 v[156:159], v[88:91], a[108:111], v[156:159]
    buffer_store_dwordx4 v[104:107], v43, s[16:19], 0 offen offset:512 sc1
    v_cvt_pk_bf16_f32 v108, v136, v137
    v_cvt_pk_bf16_f32 v109, v138, v139
    s_waitcnt lgkmcnt(8)
    v_mfma_f32_16x16x32_bf16 v[144:147], v[92:95], a[112:115], v[144:147]
    ds_read_b64_tr_b16 v[56:57], v42 offset:128
    v_mfma_f32_16x16x32_bf16 v[148:151], v[92:95], a[116:119], v[148:151]
    ds_read_b64_tr_b16 v[58:59], v42 offset:4736
    v_mfma_f32_16x16x32_bf16 v[152:155], v[92:95], a[120:123], v[152:155]
    v_cvt_pk_bf16_f32 v110, v140, v141
    v_cvt_pk_bf16_f32 v111, v142, v143
    v_mfma_f32_16x16x32_bf16 v[156:159], v[92:95], a[124:127], v[156:159]
    s_nop 1
    v_permlane16_swap_b32 v108, v110
    v_permlane16_swap_b32 v109, v111
    s_waitcnt lgkmcnt(8)
    v_mfma_f32_16x16x32_bf16 v[160:163], v[96:99], a[64:67], v[160:163]
    ds_read_b64_tr_b16 v[60:61], v42 offset:9344
    v_mfma_f32_16x16x32_bf16 v[164:167], v[96:99], a[68:71], v[164:167]
    ds_read_b64_tr_b16 v[62:63], v42 offset:13952
    v_mfma_f32_16x16x32_bf16 v[168:171], v[96:99], a[72:75], v[168:171]
    buffer_store_dwordx4 v[108:111], v44, s[16:19], 0 offen offset:512 sc1
    v_mfma_f32_16x16x32_bf16 v[172:175], v[96:99], a[76:79], v[172:175]
    s_waitcnt lgkmcnt(8)
    v_mfma_f32_16x16x32_bf16 v[160:163], v[100:103], a[80:83], v[160:163]
    ds_read_b64_tr_b16 v[64:65], v42 offset:18560
    v_mfma_f32_16x16x32_bf16 v[164:167], v[100:103], a[84:87], v[164:167]
    ds_read_b64_tr_b16 v[66:67], v42 offset:23168
    v_mfma_f32_16x16x32_bf16 v[168:171], v[100:103], a[88:91], v[168:171]
    v_cvt_pk_bf16_f32 v104, v144, v145
    v_cvt_pk_bf16_f32 v105, v146, v147
    v_mfma_f32_16x16x32_bf16 v[172:175], v[100:103], a[92:95], v[172:175]
    v_cvt_pk_bf16_f32 v106, v148, v149
    v_cvt_pk_bf16_f32 v107, v150, v151
    s_nop 1
    s_waitcnt lgkmcnt(8)
    v_mfma_f32_16x16x32_bf16 v[160:163], v[48:51], a[96:99], v[160:163]
    ds_read_b64_tr_b16 v[68:69], v42 offset:27776
    v_mfma_f32_16x16x32_bf16 v[164:167], v[48:51], a[100:103], v[164:167]
    ds_read_b64_tr_b16 v[70:71], v42 offset:32384
    v_mfma_f32_16x16x32_bf16 v[168:171], v[48:51], a[104:107], v[168:171]
    v_permlane16_swap_b32 v104, v106
    v_permlane16_swap_b32 v105, v107
    v_mfma_f32_16x16x32_bf16 v[172:175], v[48:51], a[108:111], v[172:175]
    buffer_store_dwordx4 v[104:107], v43, s[16:19], 0 offen offset:1024 sc1
    v_cvt_pk_bf16_f32 v108, v152, v153
    v_cvt_pk_bf16_f32 v109, v154, v155
    s_waitcnt lgkmcnt(8)
    v_mfma_f32_16x16x32_bf16 v[160:163], v[52:55], a[112:115], v[160:163]
    ds_read_b64_tr_b16 v[72:73], v42 offset:160
    v_mfma_f32_16x16x32_bf16 v[164:167], v[52:55], a[116:119], v[164:167]
    ds_read_b64_tr_b16 v[74:75], v42 offset:4768
    v_mfma_f32_16x16x32_bf16 v[168:171], v[52:55], a[120:123], v[168:171]
    v_cvt_pk_bf16_f32 v110, v156, v157
    v_cvt_pk_bf16_f32 v111, v158, v159
    v_mfma_f32_16x16x32_bf16 v[172:175], v[52:55], a[124:127], v[172:175]
    s_nop 1
    v_permlane16_swap_b32 v108, v110
    v_permlane16_swap_b32 v109, v111
    s_waitcnt lgkmcnt(8)
    v_mfma_f32_16x16x32_bf16 v[176:179], v[56:59], a[64:67], v[176:179]
    ds_read_b64_tr_b16 v[76:77], v42 offset:9376
    v_mfma_f32_16x16x32_bf16 v[180:183], v[56:59], a[68:71], v[180:183]
    ds_read_b64_tr_b16 v[78:79], v42 offset:13984
    v_mfma_f32_16x16x32_bf16 v[184:187], v[56:59], a[72:75], v[184:187]
    buffer_store_dwordx4 v[108:111], v44, s[16:19], 0 offen offset:1024 sc1
    v_mfma_f32_16x16x32_bf16 v[188:191], v[56:59], a[76:79], v[188:191]
    s_waitcnt lgkmcnt(8)
    v_mfma_f32_16x16x32_bf16 v[176:179], v[60:63], a[80:83], v[176:179]
    ds_read_b64_tr_b16 v[80:81], v42 offset:18592
    v_mfma_f32_16x16x32_bf16 v[180:183], v[60:63], a[84:87], v[180:183]
    ds_read_b64_tr_b16 v[82:83], v42 offset:23200
    v_mfma_f32_16x16x32_bf16 v[184:187], v[60:63], a[88:91], v[184:187]
    v_cvt_pk_bf16_f32 v104, v160, v161
    v_cvt_pk_bf16_f32 v105, v162, v163
    v_mfma_f32_16x16x32_bf16 v[188:191], v[60:63], a[92:95], v[188:191]
    v_cvt_pk_bf16_f32 v106, v164, v165
    v_cvt_pk_bf16_f32 v107, v166, v167
    s_nop 1
    s_waitcnt lgkmcnt(8)
    v_mfma_f32_16x16x32_bf16 v[176:179], v[64:67], a[96:99], v[176:179]
    ds_read_b64_tr_b16 v[84:85], v42 offset:27808
    v_mfma_f32_16x16x32_bf16 v[180:183], v[64:67], a[100:103], v[180:183]
    ds_read_b64_tr_b16 v[86:87], v42 offset:32416
    v_mfma_f32_16x16x32_bf16 v[184:187], v[64:67], a[104:107], v[184:187]
    v_permlane16_swap_b32 v104, v106
    v_permlane16_swap_b32 v105, v107
    v_mfma_f32_16x16x32_bf16 v[188:191], v[64:67], a[108:111], v[188:191]
    buffer_store_dwordx4 v[104:107], v43, s[16:19], 0 offen offset:1536 sc1
    v_cvt_pk_bf16_f32 v108, v168, v169
    v_cvt_pk_bf16_f32 v109, v170, v171
    s_waitcnt lgkmcnt(8)
    v_mfma_f32_16x16x32_bf16 v[176:179], v[68:71], a[112:115], v[176:179]
    ds_read_b64_tr_b16 v[88:89], v42 offset:192
    v_mfma_f32_16x16x32_bf16 v[180:183], v[68:71], a[116:119], v[180:183]
    ds_read_b64_tr_b16 v[90:91], v42 offset:4800
    v_mfma_f32_16x16x32_bf16 v[184:187], v[68:71], a[120:123], v[184:187]
    v_cvt_pk_bf16_f32 v110, v172, v173
    v_cvt_pk_bf16_f32 v111, v174, v175
    v_mfma_f32_16x16x32_bf16 v[188:191], v[68:71], a[124:127], v[188:191]
    s_nop 1
    v_permlane16_swap_b32 v108, v110
    v_permlane16_swap_b32 v109, v111
    s_waitcnt lgkmcnt(8)
    v_mfma_f32_16x16x32_bf16 v[192:195], v[72:75], a[64:67], v[192:195]
    ds_read_b64_tr_b16 v[92:93], v42 offset:9408
    v_mfma_f32_16x16x32_bf16 v[196:199], v[72:75], a[68:71], v[196:199]
    ds_read_b64_tr_b16 v[94:95], v42 offset:14016
    v_mfma_f32_16x16x32_bf16 v[200:203], v[72:75], a[72:75], v[200:203]
    buffer_store_dwordx4 v[108:111], v44, s[16:19], 0 offen offset:1536 sc1
    v_mfma_f32_16x16x32_bf16 v[204:207], v[72:75], a[76:79], v[204:207]
    s_waitcnt lgkmcnt(8)
    v_mfma_f32_16x16x32_bf16 v[192:195], v[76:79], a[80:83], v[192:195]
    ds_read_b64_tr_b16 v[96:97], v42 offset:18624
    v_mfma_f32_16x16x32_bf16 v[196:199], v[76:79], a[84:87], v[196:199]
    ds_read_b64_tr_b16 v[98:99], v42 offset:23232
    v_mfma_f32_16x16x32_bf16 v[200:203], v[76:79], a[88:91], v[200:203]
    v_cvt_pk_bf16_f32 v104, v176, v177
    v_cvt_pk_bf16_f32 v105, v178, v179
    v_mfma_f32_16x16x32_bf16 v[204:207], v[76:79], a[92:95], v[204:207]
    v_cvt_pk_bf16_f32 v106, v180, v181
    v_cvt_pk_bf16_f32 v107, v182, v183
    s_nop 1
    s_waitcnt lgkmcnt(8)
    v_mfma_f32_16x16x32_bf16 v[192:195], v[80:83], a[96:99], v[192:195]
    ds_read_b64_tr_b16 v[100:101], v42 offset:27840
    v_mfma_f32_16x16x32_bf16 v[196:199], v[80:83], a[100:103], v[196:199]
    ds_read_b64_tr_b16 v[102:103], v42 offset:32448
    v_mfma_f32_16x16x32_bf16 v[200:203], v[80:83], a[104:107], v[200:203]
    v_permlane16_swap_b32 v104, v106
    v_permlane16_swap_b32 v105, v107
    v_mfma_f32_16x16x32_bf16 v[204:207], v[80:83], a[108:111], v[204:207]
    buffer_store_dwordx4 v[104:107], v43, s[16:19], 0 offen offset:2048 sc1
    v_cvt_pk_bf16_f32 v108, v184, v185
    v_cvt_pk_bf16_f32 v109, v186, v187
    s_waitcnt lgkmcnt(8)
    v_mfma_f32_16x16x32_bf16 v[192:195], v[84:87], a[112:115], v[192:195]
    ds_read_b64_tr_b16 v[48:49], v42 offset:224
    v_mfma_f32_16x16x32_bf16 v[196:199], v[84:87], a[116:119], v[196:199]
    ds_read_b64_tr_b16 v[50:51], v42 offset:4832
    v_mfma_f32_16x16x32_bf16 v[200:203], v[84:87], a[120:123], v[200:203]
    v_cvt_pk_bf16_f32 v110, v188, v189
    v_cvt_pk_bf16_f32 v111, v190, v191
    v_mfma_f32_16x16x32_bf16 v[204:207], v[84:87], a[124:127], v[204:207]
    s_nop 1
    v_permlane16_swap_b32 v108, v110
    v_permlane16_swap_b32 v109, v111
    s_waitcnt lgkmcnt(8)
    v_mfma_f32_16x16x32_bf16 v[208:211], v[88:91], a[64:67], v[208:211]
    ds_read_b64_tr_b16 v[52:53], v42 offset:9440
    v_mfma_f32_16x16x32_bf16 v[212:215], v[88:91], a[68:71], v[212:215]
    ds_read_b64_tr_b16 v[54:55], v42 offset:14048
    v_mfma_f32_16x16x32_bf16 v[216:219], v[88:91], a[72:75], v[216:219]
    buffer_store_dwordx4 v[108:111], v44, s[16:19], 0 offen offset:2048 sc1
    v_mfma_f32_16x16x32_bf16 v[220:223], v[88:91], a[76:79], v[220:223]
    s_waitcnt lgkmcnt(8)
    v_mfma_f32_16x16x32_bf16 v[208:211], v[92:95], a[80:83], v[208:211]
    ds_read_b64_tr_b16 v[56:57], v42 offset:18656
    v_mfma_f32_16x16x32_bf16 v[212:215], v[92:95], a[84:87], v[212:215]
    ds_read_b64_tr_b16 v[58:59], v42 offset:23264
    v_mfma_f32_16x16x32_bf16 v[216:219], v[92:95], a[88:91], v[216:219]
    v_cvt_pk_bf16_f32 v104, v192, v193
    v_cvt_pk_bf16_f32 v105, v194, v195
    v_mfma_f32_16x16x32_bf16 v[220:223], v[92:95], a[92:95], v[220:223]
    v_cvt_pk_bf16_f32 v106, v196, v197
    v_cvt_pk_bf16_f32 v107, v198, v199
    s_nop 1
    s_waitcnt lgkmcnt(8)
    v_mfma_f32_16x16x32_bf16 v[208:211], v[96:99], a[96:99], v[208:211]
    ds_read_b64_tr_b16 v[60:61], v42 offset:27872
    v_mfma_f32_16x16x32_bf16 v[212:215], v[96:99], a[100:103], v[212:215]
    ds_read_b64_tr_b16 v[62:63], v42 offset:32480
    v_mfma_f32_16x16x32_bf16 v[216:219], v[96:99], a[104:107], v[216:219]
    v_permlane16_swap_b32 v104, v106
    v_permlane16_swap_b32 v105, v107
    v_mfma_f32_16x16x32_bf16 v[220:223], v[96:99], a[108:111], v[220:223]
    buffer_store_dwordx4 v[104:107], v43, s[16:19], 0 offen offset:2560 sc1
    v_cvt_pk_bf16_f32 v108, v200, v201
    v_cvt_pk_bf16_f32 v109, v202, v203
    s_waitcnt lgkmcnt(8)
    v_mfma_f32_16x16x32_bf16 v[208:211], v[100:103], a[112:115], v[208:211]
    ds_read_b64_tr_b16 v[64:65], v42 offset:256
    v_mfma_f32_16x16x32_bf16 v[212:215], v[100:103], a[116:119], v[212:215]
    ds_read_b64_tr_b16 v[66:67], v42 offset:4864
    v_mfma_f32_16x16x32_bf16 v[216:219], v[100:103], a[120:123], v[216:219]
    v_cvt_pk_bf16_f32 v110, v204, v205
    v_cvt_pk_bf16_f32 v111, v206, v207
    v_mfma_f32_16x16x32_bf16 v[220:223], v[100:103], a[124:127], v[220:223]
    s_nop 1
    v_permlane16_swap_b32 v108, v110
    v_permlane16_swap_b32 v109, v111
    s_waitcnt lgkmcnt(8)
    v_mfma_f32_16x16x32_bf16 v[224:227], v[48:51], a[64:67], v[224:227]
    ds_read_b64_tr_b16 v[68:69], v42 offset:9472
    v_mfma_f32_16x16x32_bf16 v[228:231], v[48:51], a[68:71], v[228:231]
    ds_read_b64_tr_b16 v[70:71], v42 offset:14080
    v_mfma_f32_16x16x32_bf16 v[232:235], v[48:51], a[72:75], v[232:235]
    buffer_store_dwordx4 v[108:111], v44, s[16:19], 0 offen offset:2560 sc1
    v_mfma_f32_16x16x32_bf16 v[236:239], v[48:51], a[76:79], v[236:239]
    s_waitcnt lgkmcnt(8)
    v_mfma_f32_16x16x32_bf16 v[224:227], v[52:55], a[80:83], v[224:227]
    ds_read_b64_tr_b16 v[72:73], v42 offset:18688
    v_mfma_f32_16x16x32_bf16 v[228:231], v[52:55], a[84:87], v[228:231]
    ds_read_b64_tr_b16 v[74:75], v42 offset:23296
    v_mfma_f32_16x16x32_bf16 v[232:235], v[52:55], a[88:91], v[232:235]
    v_cvt_pk_bf16_f32 v104, v208, v209
    v_cvt_pk_bf16_f32 v105, v210, v211
    v_mfma_f32_16x16x32_bf16 v[236:239], v[52:55], a[92:95], v[236:239]
    v_cvt_pk_bf16_f32 v106, v212, v213
    v_cvt_pk_bf16_f32 v107, v214, v215
    s_nop 1
    s_waitcnt lgkmcnt(8)
    v_mfma_f32_16x16x32_bf16 v[224:227], v[56:59], a[96:99], v[224:227]
    ds_read_b64_tr_b16 v[76:77], v42 offset:27904
    v_mfma_f32_16x16x32_bf16 v[228:231], v[56:59], a[100:103], v[228:231]
    ds_read_b64_tr_b16 v[78:79], v42 offset:32512
    v_mfma_f32_16x16x32_bf16 v[232:235], v[56:59], a[104:107], v[232:235]
    v_permlane16_swap_b32 v104, v106
    v_permlane16_swap_b32 v105, v107
    v_mfma_f32_16x16x32_bf16 v[236:239], v[56:59], a[108:111], v[236:239]
    buffer_store_dwordx4 v[104:107], v43, s[16:19], 0 offen offset:3072 sc1
    v_cvt_pk_bf16_f32 v108, v216, v217
    v_cvt_pk_bf16_f32 v109, v218, v219
    s_waitcnt lgkmcnt(8)
    v_mfma_f32_16x16x32_bf16 v[224:227], v[60:63], a[112:115], v[224:227]
    v_mfma_f32_16x16x32_bf16 v[228:231], v[60:63], a[116:119], v[228:231]
    v_mfma_f32_16x16x32_bf16 v[232:235], v[60:63], a[120:123], v[232:235]
    v_cvt_pk_bf16_f32 v110, v220, v221
    v_cvt_pk_bf16_f32 v111, v222, v223
    v_mfma_f32_16x16x32_bf16 v[236:239], v[60:63], a[124:127], v[236:239]
    s_nop 1
    v_permlane16_swap_b32 v108, v110
    v_permlane16_swap_b32 v109, v111
    s_waitcnt lgkmcnt(6)
    v_mfma_f32_16x16x32_bf16 v[240:243], v[64:67], a[64:67], v[240:243]
    v_mfma_f32_16x16x32_bf16 v[244:247], v[64:67], a[68:71], v[244:247]
    v_mfma_f32_16x16x32_bf16 v[248:251], v[64:67], a[72:75], v[248:251]
    buffer_store_dwordx4 v[108:111], v44, s[16:19], 0 offen offset:3072 sc1
    v_mfma_f32_16x16x32_bf16 v[252:255], v[64:67], a[76:79], v[252:255]
    s_waitcnt lgkmcnt(4)
    v_mfma_f32_16x16x32_bf16 v[240:243], v[68:71], a[80:83], v[240:243]
    v_mfma_f32_16x16x32_bf16 v[244:247], v[68:71], a[84:87], v[244:247]
    v_mfma_f32_16x16x32_bf16 v[248:251], v[68:71], a[88:91], v[248:251]
    v_cvt_pk_bf16_f32 v104, v224, v225
    v_cvt_pk_bf16_f32 v105, v226, v227
    v_mfma_f32_16x16x32_bf16 v[252:255], v[68:71], a[92:95], v[252:255]
    v_cvt_pk_bf16_f32 v106, v228, v229
    v_cvt_pk_bf16_f32 v107, v230, v231
    s_nop 1
    s_waitcnt lgkmcnt(2)
    v_mfma_f32_16x16x32_bf16 v[240:243], v[72:75], a[96:99], v[240:243]
    v_mfma_f32_16x16x32_bf16 v[244:247], v[72:75], a[100:103], v[244:247]
    v_mfma_f32_16x16x32_bf16 v[248:251], v[72:75], a[104:107], v[248:251]
    v_permlane16_swap_b32 v104, v106
    v_permlane16_swap_b32 v105, v107
    v_mfma_f32_16x16x32_bf16 v[252:255], v[72:75], a[108:111], v[252:255]
    buffer_store_dwordx4 v[104:107], v43, s[16:19], 0 offen offset:3584 sc1
    v_cvt_pk_bf16_f32 v108, v232, v233
    v_cvt_pk_bf16_f32 v109, v234, v235
    s_waitcnt lgkmcnt(0)
    v_mfma_f32_16x16x32_bf16 v[240:243], v[76:79], a[112:115], v[240:243]
    v_mfma_f32_16x16x32_bf16 v[244:247], v[76:79], a[116:119], v[244:247]
    v_mfma_f32_16x16x32_bf16 v[248:251], v[76:79], a[120:123], v[248:251]
    v_cvt_pk_bf16_f32 v110, v236, v237
    v_cvt_pk_bf16_f32 v111, v238, v239
    v_mfma_f32_16x16x32_bf16 v[252:255], v[76:79], a[124:127], v[252:255]
    s_nop 1
    v_permlane16_swap_b32 v108, v110
    v_permlane16_swap_b32 v109, v111
    buffer_store_dwordx4 v[108:111], v44, s[16:19], 0 offen offset:3584 sc1
    s_nop 7
    v_cvt_pk_bf16_f32 v104, v240, v241
    v_cvt_pk_bf16_f32 v105, v242, v243
    v_cvt_pk_bf16_f32 v106, v244, v245
    v_cvt_pk_bf16_f32 v107, v246, v247
    s_nop 1
    v_permlane16_swap_b32 v104, v106
    v_permlane16_swap_b32 v105, v107
    buffer_store_dwordx4 v[104:107], v43, s[16:19], s34 offen offset:0 sc1
    v_cvt_pk_bf16_f32 v108, v248, v249
    v_cvt_pk_bf16_f32 v109, v250, v251
    v_cvt_pk_bf16_f32 v110, v252, v253
    v_cvt_pk_bf16_f32 v111, v254, v255
    s_nop 1
    v_permlane16_swap_b32 v108, v110
    v_permlane16_swap_b32 v109, v111
    buffer_store_dwordx4 v[108:111], v44, s[16:19], s34 offen offset:0 sc1
    s_branch L_g4done_33
L_g4y_32:
    s_waitcnt vmcnt(37) lgkmcnt(8)
    v_mfma_f32_16x16x32_bf16 v[112:115], v[48:51], a[64:67], v[112:115]
    ds_read_b64_tr_b16 v[68:69], v42 offset:9248
    v_mfma_f32_16x16x32_bf16 v[116:119], v[48:51], a[68:71], v[116:119]
    ds_read_b64_tr_b16 v[70:71], v42 offset:13856
    v_mfma_f32_16x16x32_bf16 v[120:123], v[48:51], a[72:75], v[120:123]
    v_mfma_f32_16x16x32_bf16 v[124:127], v[48:51], a[76:79], v[124:127]
    s_waitcnt vmcnt(33) lgkmcnt(8)
    v_mfma_f32_16x16x32_bf16 v[112:115], v[52:55], a[80:83], v[112:115]
    ds_read_b64_tr_b16 v[72:73], v42 offset:18464
    v_mfma_f32_16x16x32_bf16 v[116:119], v[52:55], a[84:87], v[116:119]
    ds_read_b64_tr_b16 v[74:75], v42 offset:23072
    v_mfma_f32_16x16x32_bf16 v[120:123], v[52:55], a[88:91], v[120:123]
    v_mfma_f32_16x16x32_bf16 v[124:127], v[52:55], a[92:95], v[124:127]
    s_waitcnt vmcnt(29) lgkmcnt(8)
    v_mfma_f32_16x16x32_bf16 v[112:115], v[56:59], a[96:99], v[112:115]
    ds_read_b64_tr_b16 v[76:77], v42 offset:27680
    v_mfma_f32_16x16x32_bf16 v[116:119], v[56:59], a[100:103], v[116:119]
    ds_read_b64_tr_b16 v[78:79], v42 offset:32288
    v_mfma_f32_16x16x32_bf16 v[120:123], v[56:59], a[104:107], v[120:123]
    v_mfma_f32_16x16x32_bf16 v[124:127], v[56:59], a[108:111], v[124:127]
    s_waitcnt vmcnt(25) lgkmcnt(8)
    v_mfma_f32_16x16x32_bf16 v[112:115], v[60:63], a[112:115], v[112:115]
    ds_read_b64_tr_b16 v[80:81], v42 offset:64
    v_mfma_f32_16x16x32_bf16 v[116:119], v[60:63], a[116:119], v[116:119]
    ds_read_b64_tr_b16 v[82:83], v42 offset:4672
    v_mfma_f32_16x16x32_bf16 v[120:123], v[60:63], a[120:123], v[120:123]
    v_mfma_f32_16x16x32_bf16 v[124:127], v[60:63], a[124:127], v[124:127]
    s_waitcnt lgkmcnt(8)
    v_mfma_f32_16x16x32_bf16 v[128:131], v[64:67], a[64:67], v[128:131]
    ds_read_b64_tr_b16 v[84:85], v42 offset:9280
    v_mfma_f32_16x16x32_bf16 v[132:135], v[64:67], a[68:71], v[132:135]
    ds_read_b64_tr_b16 v[86:87], v42 offset:13888
    v_mfma_f32_16x16x32_bf16 v[136:139], v[64:67], a[72:75], v[136:139]
    v_mfma_f32_16x16x32_bf16 v[140:143], v[64:67], a[76:79], v[140:143]
    s_waitcnt lgkmcnt(8)
    v_mfma_f32_16x16x32_bf16 v[128:131], v[68:71], a[80:83], v[128:131]
    ds_read_b64_tr_b16 v[88:89], v42 offset:18496
    v_mfma_f32_16x16x32_bf16 v[132:135], v[68:71], a[84:87], v[132:135]
    ds_read_b64_tr_b16 v[90:91], v42 offset:23104
    v_mfma_f32_16x16x32_bf16 v[136:139], v[68:71], a[88:91], v[136:139]
    v_mfma_f32_16x16x32_bf16 v[140:143], v[68:71], a[92:95], v[140:143]
    s_waitcnt lgkmcnt(8)
    v_mfma_f32_16x16x32_bf16 v[128:131], v[72:75], a[96:99], v[128:131]
    ds_read_b64_tr_b16 v[92:93], v42 offset:27712
    v_mfma_f32_16x16x32_bf16 v[132:135], v[72:75], a[100:103], v[132:135]
    ds_read_b64_tr_b16 v[94:95], v42 offset:32320
    v_mfma_f32_16x16x32_bf16 v[136:139], v[72:75], a[104:107], v[136:139]
    v_mfma_f32_16x16x32_bf16 v[140:143], v[72:75], a[108:111], v[140:143]
    s_waitcnt lgkmcnt(8)
    v_mfma_f32_16x16x32_bf16 v[128:131], v[76:79], a[112:115], v[128:131]
    ds_read_b64_tr_b16 v[96:97], v42 offset:96
    v_mfma_f32_16x16x32_bf16 v[132:135], v[76:79], a[116:119], v[132:135]
    ds_read_b64_tr_b16 v[98:99], v42 offset:4704
    v_mfma_f32_16x16x32_bf16 v[136:139], v[76:79], a[120:123], v[136:139]
    v_mfma_f32_16x16x32_bf16 v[140:143], v[76:79], a[124:127], v[140:143]
    s_waitcnt lgkmcnt(8)
    v_mfma_f32_16x16x32_bf16 v[144:147], v[80:83], a[64:67], v[144:147]
    ds_read_b64_tr_b16 v[100:101], v42 offset:9312
    v_mfma_f32_16x16x32_bf16 v[148:151], v[80:83], a[68:71], v[148:151]
    ds_read_b64_tr_b16 v[102:103], v42 offset:13920
    v_mfma_f32_16x16x32_bf16 v[152:155], v[80:83], a[72:75], v[152:155]
    v_mfma_f32_16x16x32_bf16 v[156:159], v[80:83], a[76:79], v[156:159]
    s_waitcnt lgkmcnt(8)
    v_mfma_f32_16x16x32_bf16 v[144:147], v[84:87], a[80:83], v[144:147]
    ds_read_b64_tr_b16 v[48:49], v42 offset:18528
    v_mfma_f32_16x16x32_bf16 v[148:151], v[84:87], a[84:87], v[148:151]
    ds_read_b64_tr_b16 v[50:51], v42 offset:23136
    v_mfma_f32_16x16x32_bf16 v[152:155], v[84:87], a[88:91], v[152:155]
    v_mfma_f32_16x16x32_bf16 v[156:159], v[84:87], a[92:95], v[156:159]
    s_waitcnt lgkmcnt(8)
    v_mfma_f32_16x16x32_bf16 v[144:147], v[88:91], a[96:99], v[144:147]
    ds_read_b64_tr_b16 v[52:53], v42 offset:27744
    v_mfma_f32_16x16x32_bf16 v[148:151], v[88:91], a[100:103], v[148:151]
    ds_read_b64_tr_b16 v[54:55], v42 offset:32352
    v_mfma_f32_16x16x32_bf16 v[152:155], v[88:91], a[104:107], v[152:155]
    v_mfma_f32_16x16x32_bf16 v[156:159], v[88:91], a[108:111], v[156:159]
    s_waitcnt lgkmcnt(8)
    v_mfma_f32_16x16x32_bf16 v[144:147], v[92:95], a[112:115], v[144:147]
    ds_read_b64_tr_b16 v[56:57], v42 offset:128
    v_mfma_f32_16x16x32_bf16 v[148:151], v[92:95], a[116:119], v[148:151]
    ds_read_b64_tr_b16 v[58:59], v42 offset:4736
    v_mfma_f32_16x16x32_bf16 v[152:155], v[92:95], a[120:123], v[152:155]
    v_mfma_f32_16x16x32_bf16 v[156:159], v[92:95], a[124:127], v[156:159]
    s_waitcnt lgkmcnt(8)
    v_mfma_f32_16x16x32_bf16 v[160:163], v[96:99], a[64:67], v[160:163]
    ds_read_b64_tr_b16 v[60:61], v42 offset:9344
    v_mfma_f32_16x16x32_bf16 v[164:167], v[96:99], a[68:71], v[164:167]
    ds_read_b64_tr_b16 v[62:63], v42 offset:13952
    v_mfma_f32_16x16x32_bf16 v[168:171], v[96:99], a[72:75], v[168:171]
    v_mfma_f32_16x16x32_bf16 v[172:175], v[96:99], a[76:79], v[172:175]
    s_waitcnt lgkmcnt(8)
    v_mfma_f32_16x16x32_bf16 v[160:163], v[100:103], a[80:83], v[160:163]
    ds_read_b64_tr_b16 v[64:65], v42 offset:18560
    v_mfma_f32_16x16x32_bf16 v[164:167], v[100:103], a[84:87], v[164:167]
    ds_read_b64_tr_b16 v[66:67], v42 offset:23168
    v_mfma_f32_16x16x32_bf16 v[168:171], v[100:103], a[88:91], v[168:171]
    v_mfma_f32_16x16x32_bf16 v[172:175], v[100:103], a[92:95], v[172:175]
    s_waitcnt lgkmcnt(8)
    v_mfma_f32_16x16x32_bf16 v[160:163], v[48:51], a[96:99], v[160:163]
    ds_read_b64_tr_b16 v[68:69], v42 offset:27776
    v_mfma_f32_16x16x32_bf16 v[164:167], v[48:51], a[100:103], v[164:167]
    ds_read_b64_tr_b16 v[70:71], v42 offset:32384
    v_mfma_f32_16x16x32_bf16 v[168:171], v[48:51], a[104:107], v[168:171]
    v_mfma_f32_16x16x32_bf16 v[172:175], v[48:51], a[108:111], v[172:175]
    s_waitcnt lgkmcnt(8)
    v_mfma_f32_16x16x32_bf16 v[160:163], v[52:55], a[112:115], v[160:163]
    ds_read_b64_tr_b16 v[72:73], v42 offset:160
    v_mfma_f32_16x16x32_bf16 v[164:167], v[52:55], a[116:119], v[164:167]
    ds_read_b64_tr_b16 v[74:75], v42 offset:4768
    v_mfma_f32_16x16x32_bf16 v[168:171], v[52:55], a[120:123], v[168:171]
    v_mfma_f32_16x16x32_bf16 v[172:175], v[52:55], a[124:127], v[172:175]
    s_waitcnt lgkmcnt(8)
    v_mfma_f32_16x16x32_bf16 v[176:179], v[56:59], a[64:67], v[176:179]
    ds_read_b64_tr_b16 v[76:77], v42 offset:9376
    v_mfma_f32_16x16x32_bf16 v[180:183], v[56:59], a[68:71], v[180:183]
    ds_read_b64_tr_b16 v[78:79], v42 offset:13984
    v_mfma_f32_16x16x32_bf16 v[184:187], v[56:59], a[72:75], v[184:187]
    v_mfma_f32_16x16x32_bf16 v[188:191], v[56:59], a[76:79], v[188:191]
    s_waitcnt lgkmcnt(8)
    v_mfma_f32_16x16x32_bf16 v[176:179], v[60:63], a[80:83], v[176:179]
    ds_read_b64_tr_b16 v[80:81], v42 offset:18592
    v_mfma_f32_16x16x32_bf16 v[180:183], v[60:63], a[84:87], v[180:183]
    ds_read_b64_tr_b16 v[82:83], v42 offset:23200
    v_mfma_f32_16x16x32_bf16 v[184:187], v[60:63], a[88:91], v[184:187]
    v_mfma_f32_16x16x32_bf16 v[188:191], v[60:63], a[92:95], v[188:191]
    s_waitcnt lgkmcnt(8)
    v_mfma_f32_16x16x32_bf16 v[176:179], v[64:67], a[96:99], v[176:179]
    ds_read_b64_tr_b16 v[84:85], v42 offset:27808
    v_mfma_f32_16x16x32_bf16 v[180:183], v[64:67], a[100:103], v[180:183]
    ds_read_b64_tr_b16 v[86:87], v42 offset:32416
    v_mfma_f32_16x16x32_bf16 v[184:187], v[64:67], a[104:107], v[184:187]
    v_mfma_f32_16x16x32_bf16 v[188:191], v[64:67], a[108:111], v[188:191]
    s_waitcnt lgkmcnt(8)
    v_mfma_f32_16x16x32_bf16 v[176:179], v[68:71], a[112:115], v[176:179]
    ds_read_b64_tr_b16 v[88:89], v42 offset:192
    v_mfma_f32_16x16x32_bf16 v[180:183], v[68:71], a[116:119], v[180:183]
    ds_read_b64_tr_b16 v[90:91], v42 offset:4800
    v_mfma_f32_16x16x32_bf16 v[184:187], v[68:71], a[120:123], v[184:187]
    v_mfma_f32_16x16x32_bf16 v[188:191], v[68:71], a[124:127], v[188:191]
    s_waitcnt lgkmcnt(8)
    v_mfma_f32_16x16x32_bf16 v[192:195], v[72:75], a[64:67], v[192:195]
    ds_read_b64_tr_b16 v[92:93], v42 offset:9408
    v_mfma_f32_16x16x32_bf16 v[196:199], v[72:75], a[68:71], v[196:199]
    ds_read_b64_tr_b16 v[94:95], v42 offset:14016
    v_mfma_f32_16x16x32_bf16 v[200:203], v[72:75], a[72:75], v[200:203]
    v_mfma_f32_16x16x32_bf16 v[204:207], v[72:75], a[76:79], v[204:207]
    s_waitcnt lgkmcnt(8)
    v_mfma_f32_16x16x32_bf16 v[192:195], v[76:79], a[80:83], v[192:195]
    ds_read_b64_tr_b16 v[96:97], v42 offset:18624
    v_mfma_f32_16x16x32_bf16 v[196:199], v[76:79], a[84:87], v[196:199]
    ds_read_b64_tr_b16 v[98:99], v42 offset:23232
    v_mfma_f32_16x16x32_bf16 v[200:203], v[76:79], a[88:91], v[200:203]
    v_mfma_f32_16x16x32_bf16 v[204:207], v[76:79], a[92:95], v[204:207]
    s_waitcnt lgkmcnt(8)
    v_mfma_f32_16x16x32_bf16 v[192:195], v[80:83], a[96:99], v[192:195]
    ds_read_b64_tr_b16 v[100:101], v42 offset:27840
    v_mfma_f32_16x16x32_bf16 v[196:199], v[80:83], a[100:103], v[196:199]
    ds_read_b64_tr_b16 v[102:103], v42 offset:32448
    v_mfma_f32_16x16x32_bf16 v[200:203], v[80:83], a[104:107], v[200:203]
    v_mfma_f32_16x16x32_bf16 v[204:207], v[80:83], a[108:111], v[204:207]
    s_waitcnt lgkmcnt(8)
    v_mfma_f32_16x16x32_bf16 v[192:195], v[84:87], a[112:115], v[192:195]
    ds_read_b64_tr_b16 v[48:49], v42 offset:224
    v_mfma_f32_16x16x32_bf16 v[196:199], v[84:87], a[116:119], v[196:199]
    ds_read_b64_tr_b16 v[50:51], v42 offset:4832
    v_mfma_f32_16x16x32_bf16 v[200:203], v[84:87], a[120:123], v[200:203]
    v_mfma_f32_16x16x32_bf16 v[204:207], v[84:87], a[124:127], v[204:207]
    s_waitcnt lgkmcnt(8)
    v_mfma_f32_16x16x32_bf16 v[208:211], v[88:91], a[64:67], v[208:211]
    ds_read_b64_tr_b16 v[52:53], v42 offset:9440
    v_mfma_f32_16x16x32_bf16 v[212:215], v[88:91], a[68:71], v[212:215]
    ds_read_b64_tr_b16 v[54:55], v42 offset:14048
    v_mfma_f32_16x16x32_bf16 v[216:219], v[88:91], a[72:75], v[216:219]
    v_mfma_f32_16x16x32_bf16 v[220:223], v[88:91], a[76:79], v[220:223]
    s_waitcnt lgkmcnt(8)
    v_mfma_f32_16x16x32_bf16 v[208:211], v[92:95], a[80:83], v[208:211]
    ds_read_b64_tr_b16 v[56:57], v42 offset:18656
    v_mfma_f32_16x16x32_bf16 v[212:215], v[92:95], a[84:87], v[212:215]
    ds_read_b64_tr_b16 v[58:59], v42 offset:23264
    v_mfma_f32_16x16x32_bf16 v[216:219], v[92:95], a[88:91], v[216:219]
    v_mfma_f32_16x16x32_bf16 v[220:223], v[92:95], a[92:95], v[220:223]
    s_waitcnt lgkmcnt(8)
    v_mfma_f32_16x16x32_bf16 v[208:211], v[96:99], a[96:99], v[208:211]
    ds_read_b64_tr_b16 v[60:61], v42 offset:27872
    v_mfma_f32_16x16x32_bf16 v[212:215], v[96:99], a[100:103], v[212:215]
    ds_read_b64_tr_b16 v[62:63], v42 offset:32480
    v_mfma_f32_16x16x32_bf16 v[216:219], v[96:99], a[104:107], v[216:219]
    v_mfma_f32_16x16x32_bf16 v[220:223], v[96:99], a[108:111], v[220:223]
    s_waitcnt lgkmcnt(8)
    v_mfma_f32_16x16x32_bf16 v[208:211], v[100:103], a[112:115], v[208:211]
    ds_read_b64_tr_b16 v[64:65], v42 offset:256
    v_mfma_f32_16x16x32_bf16 v[212:215], v[100:103], a[116:119], v[212:215]
    ds_read_b64_tr_b16 v[66:67], v42 offset:4864
    v_mfma_f32_16x16x32_bf16 v[216:219], v[100:103], a[120:123], v[216:219]
    v_mfma_f32_16x16x32_bf16 v[220:223], v[100:103], a[124:127], v[220:223]
    s_waitcnt lgkmcnt(8)
    v_mfma_f32_16x16x32_bf16 v[224:227], v[48:51], a[64:67], v[224:227]
    ds_read_b64_tr_b16 v[68:69], v42 offset:9472
    v_mfma_f32_16x16x32_bf16 v[228:231], v[48:51], a[68:71], v[228:231]
    ds_read_b64_tr_b16 v[70:71], v42 offset:14080
    v_mfma_f32_16x16x32_bf16 v[232:235], v[48:51], a[72:75], v[232:235]
    v_mfma_f32_16x16x32_bf16 v[236:239], v[48:51], a[76:79], v[236:239]
    s_waitcnt lgkmcnt(8)
    v_mfma_f32_16x16x32_bf16 v[224:227], v[52:55], a[80:83], v[224:227]
    ds_read_b64_tr_b16 v[72:73], v42 offset:18688
    v_mfma_f32_16x16x32_bf16 v[228:231], v[52:55], a[84:87], v[228:231]
    ds_read_b64_tr_b16 v[74:75], v42 offset:23296
    v_mfma_f32_16x16x32_bf16 v[232:235], v[52:55], a[88:91], v[232:235]
    v_mfma_f32_16x16x32_bf16 v[236:239], v[52:55], a[92:95], v[236:239]
    s_waitcnt lgkmcnt(8)
    v_mfma_f32_16x16x32_bf16 v[224:227], v[56:59], a[96:99], v[224:227]
    ds_read_b64_tr_b16 v[76:77], v42 offset:27904
    v_mfma_f32_16x16x32_bf16 v[228:231], v[56:59], a[100:103], v[228:231]
    ds_read_b64_tr_b16 v[78:79], v42 offset:32512
    v_mfma_f32_16x16x32_bf16 v[232:235], v[56:59], a[104:107], v[232:235]
    v_mfma_f32_16x16x32_bf16 v[236:239], v[56:59], a[108:111], v[236:239]
    s_waitcnt lgkmcnt(8)
    v_mfma_f32_16x16x32_bf16 v[224:227], v[60:63], a[112:115], v[224:227]
    s_waitcnt vmcnt(16)
    s_barrier
    ds_read_b64_tr_b16 v[80:81], v39 offset:0
    v_mfma_f32_16x16x32_bf16 v[228:231], v[60:63], a[116:119], v[228:231]
    ds_read_b64_tr_b16 v[82:83], v39 offset:4608
    v_mfma_f32_16x16x32_bf16 v[232:235], v[60:63], a[120:123], v[232:235]
    v_mfma_f32_16x16x32_bf16 v[236:239], v[60:63], a[124:127], v[236:239]
    s_waitcnt lgkmcnt(8)
    v_mfma_f32_16x16x32_bf16 v[240:243], v[64:67], a[64:67], v[240:243]
    ds_read_b64_tr_b16 v[84:85], v39 offset:9216
    v_mfma_f32_16x16x32_bf16 v[244:247], v[64:67], a[68:71], v[244:247]
    ds_read_b64_tr_b16 v[86:87], v39 offset:13824
    v_mfma_f32_16x16x32_bf16 v[248:251], v[64:67], a[72:75], v[248:251]
    v_mfma_f32_16x16x32_bf16 v[252:255], v[64:67], a[76:79], v[252:255]
    s_waitcnt lgkmcnt(8)
    v_mfma_f32_16x16x32_bf16 v[240:243], v[68:71], a[80:83], v[240:243]
    ds_read_b64_tr_b16 v[88:89], v39 offset:18432
    v_mfma_f32_16x16x32_bf16 v[244:247], v[68:71], a[84:87], v[244:247]
    ds_read_b64_tr_b16 v[90:91], v39 offset:23040
    v_mfma_f32_16x16x32_bf16 v[248:251], v[68:71], a[88:91], v[248:251]
    v_mfma_f32_16x16x32_bf16 v[252:255], v[68:71], a[92:95], v[252:255]
    s_waitcnt lgkmcnt(8)
    v_mfma_f32_16x16x32_bf16 v[240:243], v[72:75], a[96:99], v[240:243]
    ds_read_b64_tr_b16 v[92:93], v39 offset:27648
    v_mfma_f32_16x16x32_bf16 v[244:247], v[72:75], a[100:103], v[244:247]
    ds_read_b64_tr_b16 v[94:95], v39 offset:32256
    v_mfma_f32_16x16x32_bf16 v[248:251], v[72:75], a[104:107], v[248:251]
    v_mfma_f32_16x16x32_bf16 v[252:255], v[72:75], a[108:111], v[252:255]
    s_waitcnt lgkmcnt(8)
    v_mfma_f32_16x16x32_bf16 v[240:243], v[76:79], a[112:115], v[240:243]
    ds_read_b64_tr_b16 v[96:97], v39 offset:32
    v_mfma_f32_16x16x32_bf16 v[244:247], v[76:79], a[116:119], v[244:247]
    ds_read_b64_tr_b16 v[98:99], v39 offset:4640
    v_mfma_f32_16x16x32_bf16 v[248:251], v[76:79], a[120:123], v[248:251]
    v_mfma_f32_16x16x32_bf16 v[252:255], v[76:79], a[124:127], v[252:255]
    s_waitcnt vmcnt(12) lgkmcnt(8)
    v_mfma_f32_16x16x32_bf16 v[112:115], v[80:83], a[128:131], v[112:115]
    ds_read_b64_tr_b16 v[100:101], v39 offset:9248
    v_mfma_f32_16x16x32_bf16 v[116:119], v[80:83], a[132:135], v[116:119]
    ds_read_b64_tr_b16 v[102:103], v39 offset:13856
    v_mfma_f32_16x16x32_bf16 v[120:123], v[80:83], a[136:139], v[120:123]
    v_mfma_f32_16x16x32_bf16 v[124:127], v[80:83], a[140:143], v[124:127]
    s_waitcnt vmcnt(8) lgkmcnt(8)
    v_mfma_f32_16x16x32_bf16 v[112:115], v[84:87], a[144:147], v[112:115]
    ds_read_b64_tr_b16 v[48:49], v39 offset:18464
    v_mfma_f32_16x16x32_bf16 v[116:119], v[84:87], a[148:151], v[116:119]
    ds_read_b64_tr_b16 v[50:51], v39 offset:23072
    v_mfma_f32_16x16x32_bf16 v[120:123], v[84:87], a[152:155], v[120:123]
    v_mfma_f32_16x16x32_bf16 v[124:127], v[84:87], a[156:159], v[124:127]
    s_waitcnt vmcnt(4) lgkmcnt(8)
    v_mfma_f32_16x16x32_bf16 v[112:115], v[88:91], a[160:163], v[112:115]
    ds_read_b64_tr_b16 v[52:53], v39 offset:27680
    v_mfma_f32_16x16x32_bf16 v[116:119], v[88:91], a[164:167], v[116:119]
    ds_read_b64_tr_b16 v[54:55], v39 offset:32288
    v_mfma_f32_16x16x32_bf16 v[120:123], v[88:91], a[168:171], v[120:123]
    v_mfma_f32_16x16x32_bf16 v[124:127], v[88:91], a[172:175], v[124:127]
    s_waitcnt vmcnt(0) lgkmcnt(8)
    v_mfma_f32_16x16x32_bf16 v[112:115], v[92:95], a[176:179], v[112:115]
    ds_read_b64_tr_b16 v[56:57], v39 offset:64
    v_mfma_f32_16x16x32_bf16 v[116:119], v[92:95], a[180:183], v[116:119]
    ds_read_b64_tr_b16 v[58:59], v39 offset:4672
    v_mfma_f32_16x16x32_bf16 v[120:123], v[92:95], a[184:187], v[120:123]
    v_mfma_f32_16x16x32_bf16 v[124:127], v[92:95], a[188:191], v[124:127]
    s_waitcnt lgkmcnt(8)
    v_mfma_f32_16x16x32_bf16 v[128:131], v[96:99], a[128:131], v[128:131]
    ds_read_b64_tr_b16 v[60:61], v39 offset:9280
    v_mfma_f32_16x16x32_bf16 v[132:135], v[96:99], a[132:135], v[132:135]
    ds_read_b64_tr_b16 v[62:63], v39 offset:13888
    v_mfma_f32_16x16x32_bf16 v[136:139], v[96:99], a[136:139], v[136:139]
    v_mfma_f32_16x16x32_bf16 v[140:143], v[96:99], a[140:143], v[140:143]
    s_waitcnt lgkmcnt(8)
    v_mfma_f32_16x16x32_bf16 v[128:131], v[100:103], a[144:147], v[128:131]
    ds_read_b64_tr_b16 v[64:65], v39 offset:18496
    v_mfma_f32_16x16x32_bf16 v[132:135], v[100:103], a[148:151], v[132:135]
    ds_read_b64_tr_b16 v[66:67], v39 offset:23104
    v_mfma_f32_16x16x32_bf16 v[136:139], v[100:103], a[152:155], v[136:139]
    v_cvt_pk_bf16_f32 v104, v112, v113
    v_cvt_pk_bf16_f32 v105, v114, v115
    v_mfma_f32_16x16x32_bf16 v[140:143], v[100:103], a[156:159], v[140:143]
    v_cvt_pk_bf16_f32 v106, v116, v117
    v_cvt_pk_bf16_f32 v107, v118, v119
    s_nop 1
    s_waitcnt lgkmcnt(8)
    v_mfma_f32_16x16x32_bf16 v[128:131], v[48:51], a[160:163], v[128:131]
    ds_read_b64_tr_b16 v[68:69], v39 offset:27712
    v_mfma_f32_16x16x32_bf16 v[132:135], v[48:51], a[164:167], v[132:135]
    ds_read_b64_tr_b16 v[70:71], v39 offset:32320
    v_mfma_f32_16x16x32_bf16 v[136:139], v[48:51], a[168:171], v[136:139]
    v_permlane16_swap_b32 v104, v106
    v_permlane16_swap_b32 v105, v107
    v_mfma_f32_16x16x32_bf16 v[140:143], v[48:51], a[172:175], v[140:143]
    buffer_store_dwordx4 v[104:107], v43, s[16:19], 0 offen offset:0 sc1
    v_cvt_pk_bf16_f32 v108, v120, v121
    v_cvt_pk_bf16_f32 v109, v122, v123
    s_waitcnt lgkmcnt(8)
    v_mfma_f32_16x16x32_bf16 v[128:131], v[52:55], a[176:179], v[128:131]
    ds_read_b64_tr_b16 v[72:73], v39 offset:96
    v_mfma_f32_16x16x32_bf16 v[132:135], v[52:55], a[180:183], v[132:135]
    ds_read_b64_tr_b16 v[74:75], v39 offset:4704
    v_mfma_f32_16x16x32_bf16 v[136:139], v[52:55], a[184:187], v[136:139]
    v_cvt_pk_bf16_f32 v110, v124, v125
    v_cvt_pk_bf16_f32 v111, v126, v127
    v_mfma_f32_16x16x32_bf16 v[140:143], v[52:55], a[188:191], v[140:143]
    s_nop 1
    v_permlane16_swap_b32 v108, v110
    v_permlane16_swap_b32 v109, v111
    s_waitcnt lgkmcnt(8)
    v_mfma_f32_16x16x32_bf16 v[144:147], v[56:59], a[128:131], v[144:147]
    ds_read_b64_tr_b16 v[76:77], v39 offset:9312
    v_mfma_f32_16x16x32_bf16 v[148:151], v[56:59], a[132:135], v[148:151]
    ds_read_b64_tr_b16 v[78:79], v39 offset:13920
    v_mfma_f32_16x16x32_bf16 v[152:155], v[56:59], a[136:139], v[152:155]
    buffer_store_dwordx4 v[108:111], v44, s[16:19], 0 offen offset:0 sc1
    v_mfma_f32_16x16x32_bf16 v[156:159], v[56:59], a[140:143], v[156:159]
    s_waitcnt lgkmcnt(8)
    v_mfma_f32_16x16x32_bf16 v[144:147], v[60:63], a[144:147], v[144:147]
    ds_read_b64_tr_b16 v[80:81], v39 offset:18528
    v_mfma_f32_16x16x32_bf16 v[148:151], v[60:63], a[148:151], v[148:151]
    ds_read_b64_tr_b16 v[82:83], v39 offset:23136
    v_mfma_f32_16x16x32_bf16 v[152:155], v[60:63], a[152:155], v[152:155]
    v_cvt_pk_bf16_f32 v104, v128, v129
    v_cvt_pk_bf16_f32 v105, v130, v131
    v_mfma_f32_16x16x32_bf16 v[156:159], v[60:63], a[156:159], v[156:159]
    v_cvt_pk_bf16_f32 v106, v132, v133
    v_cvt_pk_bf16_f32 v107, v134, v135
    s_nop 1
    s_waitcnt lgkmcnt(8)
    v_mfma_f32_16x16x32_bf16 v[144:147], v[64:67], a[160:163], v[144:147]
    ds_read_b64_tr_b16 v[84:85], v39 offset:27744
    v_mfma_f32_16x16x32_bf16 v[148:151], v[64:67], a[164:167], v[148:151]
    ds_read_b64_tr_b16 v[86:87], v39 offset:32352
    v_mfma_f32_16x16x32_bf16 v[152:155], v[64:67], a[168:171], v[152:155]
    v_permlane16_swap_b32 v104, v106
    v_permlane16_swap_b32 v105, v107
    v_mfma_f32_16x16x32_bf16 v[156:159], v[64:67], a[172:175], v[156:159]
    buffer_store_dwordx4 v[104:107], v43, s[16:19], 0 offen offset:512 sc1
    v_cvt_pk_bf16_f32 v108, v136, v137
    v_cvt_pk_bf16_f32 v109, v138, v139
    s_waitcnt lgkmcnt(8)
    v_mfma_f32_16x16x32_bf16 v[144:147], v[68:71], a[176:179], v[144:147]
    ds_read_b64_tr_b16 v[88:89], v39 offset:128
    v_mfma_f32_16x16x32_bf16 v[148:151], v[68:71], a[180:183], v[148:151]
    ds_read_b64_tr_b16 v[90:91], v39 offset:4736
    v_mfma_f32_16x16x32_bf16 v[152:155], v[68:71], a[184:187], v[152:155]
    v_cvt_pk_bf16_f32 v110, v140, v141
    v_cvt_pk_bf16_f32 v111, v142, v143
    v_mfma_f32_16x16x32_bf16 v[156:159], v[68:71], a[188:191], v[156:159]
    s_nop 1
    v_permlane16_swap_b32 v108, v110
    v_permlane16_swap_b32 v109, v111
    s_waitcnt lgkmcnt(8)
    v_mfma_f32_16x16x32_bf16 v[160:163], v[72:75], a[128:131], v[160:163]
    ds_read_b64_tr_b16 v[92:93], v39 offset:9344
    v_mfma_f32_16x16x32_bf16 v[164:167], v[72:75], a[132:135], v[164:167]
    ds_read_b64_tr_b16 v[94:95], v39 offset:13952
    v_mfma_f32_16x16x32_bf16 v[168:171], v[72:75], a[136:139], v[168:171]
    buffer_store_dwordx4 v[108:111], v44, s[16:19], 0 offen offset:512 sc1
    v_mfma_f32_16x16x32_bf16 v[172:175], v[72:75], a[140:143], v[172:175]
    s_waitcnt lgkmcnt(8)
    v_mfma_f32_16x16x32_bf16 v[160:163], v[76:79], a[144:147], v[160:163]
    ds_read_b64_tr_b16 v[96:97], v39 offset:18560
    v_mfma_f32_16x16x32_bf16 v[164:167], v[76:79], a[148:151], v[164:167]
    ds_read_b64_tr_b16 v[98:99], v39 offset:23168
    v_mfma_f32_16x16x32_bf16 v[168:171], v[76:79], a[152:155], v[168:171]
    v_cvt_pk_bf16_f32 v104, v144, v145
    v_cvt_pk_bf16_f32 v105, v146, v147
    v_mfma_f32_16x16x32_bf16 v[172:175], v[76:79], a[156:159], v[172:175]
    v_cvt_pk_bf16_f32 v106, v148, v149
    v_cvt_pk_bf16_f32 v107, v150, v151
    s_nop 1
    s_waitcnt lgkmcnt(8)
    v_mfma_f32_16x16x32_bf16 v[160:163], v[80:83], a[160:163], v[160:163]
    ds_read_b64_tr_b16 v[100:101], v39 offset:27776
    v_mfma_f32_16x16x32_bf16 v[164:167], v[80:83], a[164:167], v[164:167]
    ds_read_b64_tr_b16 v[102:103], v39 offset:32384
    v_mfma_f32_16x16x32_bf16 v[168:171], v[80:83], a[168:171], v[168:171]
    v_permlane16_swap_b32 v104, v106
    v_permlane16_swap_b32 v105, v107
    v_mfma_f32_16x16x32_bf16 v[172:175], v[80:83], a[172:175], v[172:175]
    buffer_store_dwordx4 v[104:107], v43, s[16:19], 0 offen offset:1024 sc1
    v_cvt_pk_bf16_f32 v108, v152, v153
    v_cvt_pk_bf16_f32 v109, v154, v155
    s_waitcnt lgkmcnt(8)
    v_mfma_f32_16x16x32_bf16 v[160:163], v[84:87], a[176:179], v[160:163]
    ds_read_b64_tr_b16 v[48:49], v39 offset:160
    v_mfma_f32_16x16x32_bf16 v[164:167], v[84:87], a[180:183], v[164:167]
    ds_read_b64_tr_b16 v[50:51], v39 offset:4768
    v_mfma_f32_16x16x32_bf16 v[168:171], v[84:87], a[184:187], v[168:171]
    v_cvt_pk_bf16_f32 v110, v156, v157
    v_cvt_pk_bf16_f32 v111, v158, v159
    v_mfma_f32_16x16x32_bf16 v[172:175], v[84:87], a[188:191], v[172:175]
    s_nop 1
    v_permlane16_swap_b32 v108, v110
    v_permlane16_swap_b32 v109, v111
    s_waitcnt lgkmcnt(8)
    v_mfma_f32_16x16x32_bf16 v[176:179], v[88:91], a[128:131], v[176:179]
    ds_read_b64_tr_b16 v[52:53], v39 offset:9376
    v_mfma_f32_16x16x32_bf16 v[180:183], v[88:91], a[132:135], v[180:183]
    ds_read_b64_tr_b16 v[54:55], v39 offset:13984
    v_mfma_f32_16x16x32_bf16 v[184:187], v[88:91], a[136:139], v[184:187]
    buffer_store_dwordx4 v[108:111], v44, s[16:19], 0 offen offset:1024 sc1
    v_mfma_f32_16x16x32_bf16 v[188:191], v[88:91], a[140:143], v[188:191]
    s_waitcnt lgkmcnt(8)
    v_mfma_f32_16x16x32_bf16 v[176:179], v[92:95], a[144:147], v[176:179]
    ds_read_b64_tr_b16 v[56:57], v39 offset:18592
    v_mfma_f32_16x16x32_bf16 v[180:183], v[92:95], a[148:151], v[180:183]
    ds_read_b64_tr_b16 v[58:59], v39 offset:23200
    v_mfma_f32_16x16x32_bf16 v[184:187], v[92:95], a[152:155], v[184:187]
    v_cvt_pk_bf16_f32 v104, v160, v161
    v_cvt_pk_bf16_f32 v105, v162, v163
    v_mfma_f32_16x16x32_bf16 v[188:191], v[92:95], a[156:159], v[188:191]
    v_cvt_pk_bf16_f32 v106, v164, v165
    v_cvt_pk_bf16_f32 v107, v166, v167
    s_nop 1
    s_waitcnt lgkmcnt(8)
    v_mfma_f32_16x16x32_bf16 v[176:179], v[96:99], a[160:163], v[176:179]
    ds_read_b64_tr_b16 v[60:61], v39 offset:27808
    v_mfma_f32_16x16x32_bf16 v[180:183], v[96:99], a[164:167], v[180:183]
    ds_read_b64_tr_b16 v[62:63], v39 offset:32416
    v_mfma_f32_16x16x32_bf16 v[184:187], v[96:99], a[168:171], v[184:187]
    v_permlane16_swap_b32 v104, v106
    v_permlane16_swap_b32 v105, v107
    v_mfma_f32_16x16x32_bf16 v[188:191], v[96:99], a[172:175], v[188:191]
    buffer_store_dwordx4 v[104:107], v43, s[16:19], 0 offen offset:1536 sc1
    v_cvt_pk_bf16_f32 v108, v168, v169
    v_cvt_pk_bf16_f32 v109, v170, v171
    s_waitcnt lgkmcnt(8)
    v_mfma_f32_16x16x32_bf16 v[176:179], v[100:103], a[176:179], v[176:179]
    ds_read_b64_tr_b16 v[64:65], v39 offset:192
    v_mfma_f32_16x16x32_bf16 v[180:183], v[100:103], a[180:183], v[180:183]
    ds_read_b64_tr_b16 v[66:67], v39 offset:4800
    v_mfma_f32_16x16x32_bf16 v[184:187], v[100:103], a[184:187], v[184:187]
    v_cvt_pk_bf16_f32 v110, v172, v173
    v_cvt_pk_bf16_f32 v111, v174, v175
    v_mfma_f32_16x16x32_bf16 v[188:191], v[100:103], a[188:191], v[188:191]
    s_nop 1
    v_permlane16_swap_b32 v108, v110
    v_permlane16_swap_b32 v109, v111
    s_waitcnt lgkmcnt(8)
    v_mfma_f32_16x16x32_bf16 v[192:195], v[48:51], a[128:131], v[192:195]
    ds_read_b64_tr_b16 v[68:69], v39 offset:9408
    v_mfma_f32_16x16x32_bf16 v[196:199], v[48:51], a[132:135], v[196:199]
    ds_read_b64_tr_b16 v[70:71], v39 offset:14016
    v_mfma_f32_16x16x32_bf16 v[200:203], v[48:51], a[136:139], v[200:203]
    buffer_store_dwordx4 v[108:111], v44, s[16:19], 0 offen offset:1536 sc1
    v_mfma_f32_16x16x32_bf16 v[204:207], v[48:51], a[140:143], v[204:207]
    s_waitcnt lgkmcnt(8)
    v_mfma_f32_16x16x32_bf16 v[192:195], v[52:55], a[144:147], v[192:195]
    ds_read_b64_tr_b16 v[72:73], v39 offset:18624
    v_mfma_f32_16x16x32_bf16 v[196:199], v[52:55], a[148:151], v[196:199]
    ds_read_b64_tr_b16 v[74:75], v39 offset:23232
    v_mfma_f32_16x16x32_bf16 v[200:203], v[52:55], a[152:155], v[200:203]
    v_cvt_pk_bf16_f32 v104, v176, v177
    v_cvt_pk_bf16_f32 v105, v178, v179
    v_mfma_f32_16x16x32_bf16 v[204:207], v[52:55], a[156:159], v[204:207]
    v_cvt_pk_bf16_f32 v106, v180, v181
    v_cvt_pk_bf16_f32 v107, v182, v183
    s_nop 1
    s_waitcnt lgkmcnt(8)
    v_mfma_f32_16x16x32_bf16 v[192:195], v[56:59], a[160:163], v[192:195]
    ds_read_b64_tr_b16 v[76:77], v39 offset:27840
    v_mfma_f32_16x16x32_bf16 v[196:199], v[56:59], a[164:167], v[196:199]
    ds_read_b64_tr_b16 v[78:79], v39 offset:32448
    v_mfma_f32_16x16x32_bf16 v[200:203], v[56:59], a[168:171], v[200:203]
    v_permlane16_swap_b32 v104, v106
    v_permlane16_swap_b32 v105, v107
    v_mfma_f32_16x16x32_bf16 v[204:207], v[56:59], a[172:175], v[204:207]
    buffer_store_dwordx4 v[104:107], v43, s[16:19], 0 offen offset:2048 sc1
    v_cvt_pk_bf16_f32 v108, v184, v185
    v_cvt_pk_bf16_f32 v109, v186, v187
    s_waitcnt lgkmcnt(8)
    v_mfma_f32_16x16x32_bf16 v[192:195], v[60:63], a[176:179], v[192:195]
    ds_read_b64_tr_b16 v[80:81], v39 offset:224
    v_mfma_f32_16x16x32_bf16 v[196:199], v[60:63], a[180:183], v[196:199]
    ds_read_b64_tr_b16 v[82:83], v39 offset:4832
    v_mfma_f32_16x16x32_bf16 v[200:203], v[60:63], a[184:187], v[200:203]
    v_cvt_pk_bf16_f32 v110, v188, v189
    v_cvt_pk_bf16_f32 v111, v190, v191
    v_mfma_f32_16x16x32_bf16 v[204:207], v[60:63], a[188:191], v[204:207]
    s_nop 1
    v_permlane16_swap_b32 v108, v110
    v_permlane16_swap_b32 v109, v111
    s_waitcnt lgkmcnt(8)
    v_mfma_f32_16x16x32_bf16 v[208:211], v[64:67], a[128:131], v[208:211]
    ds_read_b64_tr_b16 v[84:85], v39 offset:9440
    v_mfma_f32_16x16x32_bf16 v[212:215], v[64:67], a[132:135], v[212:215]
    ds_read_b64_tr_b16 v[86:87], v39 offset:14048
    v_mfma_f32_16x16x32_bf16 v[216:219], v[64:67], a[136:139], v[216:219]
    buffer_store_dwordx4 v[108:111], v44, s[16:19], 0 offen offset:2048 sc1
    v_mfma_f32_16x16x32_bf16 v[220:223], v[64:67], a[140:143], v[220:223]
    s_waitcnt lgkmcnt(8)
    v_mfma_f32_16x16x32_bf16 v[208:211], v[68:71], a[144:147], v[208:211]
    ds_read_b64_tr_b16 v[88:89], v39 offset:18656
    v_mfma_f32_16x16x32_bf16 v[212:215], v[68:71], a[148:151], v[212:215]
    ds_read_b64_tr_b16 v[90:91], v39 offset:23264
    v_mfma_f32_16x16x32_bf16 v[216:219], v[68:71], a[152:155], v[216:219]
    v_cvt_pk_bf16_f32 v104, v192, v193
    v_cvt_pk_bf16_f32 v105, v194, v195
    v_mfma_f32_16x16x32_bf16 v[220:223], v[68:71], a[156:159], v[220:223]
    v_cvt_pk_bf16_f32 v106, v196, v197
    v_cvt_pk_bf16_f32 v107, v198, v199
    s_nop 1
    s_waitcnt lgkmcnt(8)
    v_mfma_f32_16x16x32_bf16 v[208:211], v[72:75], a[160:163], v[208:211]
    ds_read_b64_tr_b16 v[92:93], v39 offset:27872
    v_mfma_f32_16x16x32_bf16 v[212:215], v[72:75], a[164:167], v[212:215]
    ds_read_b64_tr_b16 v[94:95], v39 offset:32480
    v_mfma_f32_16x16x32_bf16 v[216:219], v[72:75], a[168:171], v[216:219]
    v_permlane16_swap_b32 v104, v106
    v_permlane16_swap_b32 v105, v107
    v_mfma_f32_16x16x32_bf16 v[220:223], v[72:75], a[172:175], v[220:223]
    buffer_store_dwordx4 v[104:107], v43, s[16:19], 0 offen offset:2560 sc1
    v_cvt_pk_bf16_f32 v108, v200, v201
    v_cvt_pk_bf16_f32 v109, v202, v203
    s_waitcnt lgkmcnt(8)
    v_mfma_f32_16x16x32_bf16 v[208:211], v[76:79], a[176:179], v[208:211]
    ds_read_b64_tr_b16 v[96:97], v39 offset:256
    v_mfma_f32_16x16x32_bf16 v[212:215], v[76:79], a[180:183], v[212:215]
    ds_read_b64_tr_b16 v[98:99], v39 offset:4864
    v_mfma_f32_16x16x32_bf16 v[216:219], v[76:79], a[184:187], v[216:219]
    v_cvt_pk_bf16_f32 v110, v204, v205
    v_cvt_pk_bf16_f32 v111, v206, v207
    v_mfma_f32_16x16x32_bf16 v[220:223], v[76:79], a[188:191], v[220:223]
    s_nop 1
    v_permlane16_swap_b32 v108, v110
    v_permlane16_swap_b32 v109, v111
    s_waitcnt lgkmcnt(8)
    v_mfma_f32_16x16x32_bf16 v[224:227], v[80:83], a[128:131], v[224:227]
    ds_read_b64_tr_b16 v[100:101], v39 offset:9472
    v_mfma_f32_16x16x32_bf16 v[228:231], v[80:83], a[132:135], v[228:231]
    ds_read_b64_tr_b16 v[102:103], v39 offset:14080
    v_mfma_f32_16x16x32_bf16 v[232:235], v[80:83], a[136:139], v[232:235]
    buffer_store_dwordx4 v[108:111], v44, s[16:19], 0 offen offset:2560 sc1
    v_mfma_f32_16x16x32_bf16 v[236:239], v[80:83], a[140:143], v[236:239]
    s_waitcnt lgkmcnt(8)
    v_mfma_f32_16x16x32_bf16 v[224:227], v[84:87], a[144:147], v[224:227]
    ds_read_b64_tr_b16 v[48:49], v39 offset:18688
    v_mfma_f32_16x16x32_bf16 v[228:231], v[84:87], a[148:151], v[228:231]
    ds_read_b64_tr_b16 v[50:51], v39 offset:23296
    v_mfma_f32_16x16x32_bf16 v[232:235], v[84:87], a[152:155], v[232:235]
    v_cvt_pk_bf16_f32 v104, v208, v209
    v_cvt_pk_bf16_f32 v105, v210, v211
    v_mfma_f32_16x16x32_bf16 v[236:239], v[84:87], a[156:159], v[236:239]
    v_cvt_pk_bf16_f32 v106, v212, v213
    v_cvt_pk_bf16_f32 v107, v214, v215
    s_nop 1
    s_waitcnt lgkmcnt(8)
    v_mfma_f32_16x16x32_bf16 v[224:227], v[88:91], a[160:163], v[224:227]
    ds_read_b64_tr_b16 v[52:53], v39 offset:27904
    v_mfma_f32_16x16x32_bf16 v[228:231], v[88:91], a[164:167], v[228:231]
    ds_read_b64_tr_b16 v[54:55], v39 offset:32512
    v_mfma_f32_16x16x32_bf16 v[232:235], v[88:91], a[168:171], v[232:235]
    v_permlane16_swap_b32 v104, v106
    v_permlane16_swap_b32 v105, v107
    v_mfma_f32_16x16x32_bf16 v[236:239], v[88:91], a[172:175], v[236:239]
    buffer_store_dwordx4 v[104:107], v43, s[16:19], 0 offen offset:3072 sc1
    v_cvt_pk_bf16_f32 v108, v216, v217
    v_cvt_pk_bf16_f32 v109, v218, v219
    s_waitcnt lgkmcnt(8)
    v_mfma_f32_16x16x32_bf16 v[224:227], v[92:95], a[176:179], v[224:227]
    v_mfma_f32_16x16x32_bf16 v[228:231], v[92:95], a[180:183], v[228:231]
    v_mfma_f32_16x16x32_bf16 v[232:235], v[92:95], a[184:187], v[232:235]
    v_cvt_pk_bf16_f32 v110, v220, v221
    v_cvt_pk_bf16_f32 v111, v222, v223
    v_mfma_f32_16x16x32_bf16 v[236:239], v[92:95], a[188:191], v[236:239]
    s_nop 1
    v_permlane16_swap_b32 v108, v110
    v_permlane16_swap_b32 v109, v111
    s_waitcnt lgkmcnt(6)
    v_mfma_f32_16x16x32_bf16 v[240:243], v[96:99], a[128:131], v[240:243]
    v_mfma_f32_16x16x32_bf16 v[244:247], v[96:99], a[132:135], v[244:247]
    v_mfma_f32_16x16x32_bf16 v[248:251], v[96:99], a[136:139], v[248:251]
    buffer_store_dwordx4 v[108:111], v44, s[16:19], 0 offen offset:3072 sc1
    v_mfma_f32_16x16x32_bf16 v[252:255], v[96:99], a[140:143], v[252:255]
    s_waitcnt lgkmcnt(4)
    v_mfma_f32_16x16x32_bf16 v[240:243], v[100:103], a[144:147], v[240:243]
    v_mfma_f32_16x16x32_bf16 v[244:247], v[100:103], a[148:151], v[244:247]
    v_mfma_f32_16x16x32_bf16 v[248:251], v[100:103], a[152:155], v[248:251]
    v_cvt_pk_bf16_f32 v104, v224, v225
    v_cvt_pk_bf16_f32 v105, v226, v227
    v_mfma_f32_16x16x32_bf16 v[252:255], v[100:103], a[156:159], v[252:255]
    v_cvt_pk_bf16_f32 v106, v228, v229
    v_cvt_pk_bf16_f32 v107, v230, v231
    s_nop 1
    s_waitcnt lgkmcnt(2)
    v_mfma_f32_16x16x32_bf16 v[240:243], v[48:51], a[160:163], v[240:243]
    v_mfma_f32_16x16x32_bf16 v[244:247], v[48:51], a[164:167], v[244:247]
    v_mfma_f32_16x16x32_bf16 v[248:251], v[48:51], a[168:171], v[248:251]
    v_permlane16_swap_b32 v104, v106
    v_permlane16_swap_b32 v105, v107
    v_mfma_f32_16x16x32_bf16 v[252:255], v[48:51], a[172:175], v[252:255]
    buffer_store_dwordx4 v[104:107], v43, s[16:19], 0 offen offset:3584 sc1
    v_cvt_pk_bf16_f32 v108, v232, v233
    v_cvt_pk_bf16_f32 v109, v234, v235
    s_waitcnt lgkmcnt(0)
    v_mfma_f32_16x16x32_bf16 v[240:243], v[52:55], a[176:179], v[240:243]
    v_mfma_f32_16x16x32_bf16 v[244:247], v[52:55], a[180:183], v[244:247]
    v_mfma_f32_16x16x32_bf16 v[248:251], v[52:55], a[184:187], v[248:251]
    v_cvt_pk_bf16_f32 v110, v236, v237
    v_cvt_pk_bf16_f32 v111, v238, v239
    v_mfma_f32_16x16x32_bf16 v[252:255], v[52:55], a[188:191], v[252:255]
    s_nop 1
    v_permlane16_swap_b32 v108, v110
    v_permlane16_swap_b32 v109, v111
    buffer_store_dwordx4 v[108:111], v44, s[16:19], 0 offen offset:3584 sc1
    s_nop 7
    v_cvt_pk_bf16_f32 v104, v240, v241
    v_cvt_pk_bf16_f32 v105, v242, v243
    v_cvt_pk_bf16_f32 v106, v244, v245
    v_cvt_pk_bf16_f32 v107, v246, v247
    s_nop 1
    v_permlane16_swap_b32 v104, v106
    v_permlane16_swap_b32 v105, v107
    buffer_store_dwordx4 v[104:107], v43, s[16:19], s34 offen offset:0 sc1
    v_cvt_pk_bf16_f32 v108, v248, v249
    v_cvt_pk_bf16_f32 v109, v250, v251
    v_cvt_pk_bf16_f32 v110, v252, v253
    v_cvt_pk_bf16_f32 v111, v254, v255
    s_nop 1
    v_permlane16_swap_b32 v108, v110
    v_permlane16_swap_b32 v109, v111
    buffer_store_dwordx4 v[108:111], v44, s[16:19], s34 offen offset:0 sc1
L_g4done_33:
    s_and_b32 s35, s2, 7
    s_bfe_u32 s29, s2, 0x30003
    s_lshr_b32 s30, s2, 6
    s_add_u32 s36, s88, 0x5000000
    s_addc_u32 s37, s89, 0
    s_mov_b32 s38, 0x1200000
    s_mov_b32 s39, 0x20000
    s_mov_b32 s12, s64
    s_mov_b32 s13, s65
    s_mov_b32 s14, 0x240000
    s_mov_b32 s15, 0x20000
    s_mov_b32 s8, s84
    s_mov_b32 s9, s85
    s_mov_b32 s10, 0x240000
    s_mov_b32 s11, 0x20000
    s_add_u32 s20, s88, 0x6c0000
    s_addc_u32 s21, s89, 0
    s_mov_b32 s22, 0x240000
    s_mov_b32 s23, 0x20000
    s_add_u32 s24, s88, 0x9c0000
    s_addc_u32 s25, s89, 0
    s_mov_b32 s26, 0x2000
    s_mov_b32 s27, 0x20000
    s_lshl_b32 s31, s29, 8
    s_lshl_b32 s32, s35, 5
    s_add_u32 s31, s31, s32
    s_mul_i32 s32, s30, 18
    v_and_b32 v1, 31, v0
    v_add_u32 v1, s31, v1
    v_lshrrev_b32 v2, 4, v1
    v_mul_u32_u24 v2, 18432, v2
    v_and_b32 v3, 15, v1
    v_lshl_add_u32 v2, v3, 4, v2
    v_mul_u32_u24 v3, 1152, v1
    v_lshlrev_b32 v4, 2, v1
    v_lshrrev_b32 v5, 5, v0
    v_add_u32 v5, s32, v5
    v_mov_b32 v7, 0x40000000
    v_cmp_gt_u32 vcc, 64, v0
    v_add_u32 v6, 0, v5
    v_lshl_add_u32 v56, v6, 8, v2
    v_lshl_add_u32 v58, v6, 4, v3
    buffer_load_dwordx4 v[52:55], v58, s[12:15], 0 offen
    buffer_load_dwordx4 v[48:51], v56, s[20:23], 0 offen sc1
    v_add_u32 v6, 8, v5
    v_lshl_add_u32 v120, v6, 8, v2
    v_lshl_add_u32 v122, v6, 4, v3
    buffer_load_dwordx4 v[116:119], v122, s[12:15], 0 offen
    buffer_load_dwordx4 v[112:115], v120, s[20:23], 0 offen sc1
    v_add_u32 v6, 16, v5
    v_lshl_add_u32 v184, v6, 8, v2
    v_lshl_add_u32 v186, v6, 4, v3
    v_cndmask_b32 v184, v7, v184, vcc
    v_cndmask_b32 v186, v7, v186, vcc
    buffer_load_dwordx4 v[180:183], v186, s[12:15], 0 offen
    buffer_load_dwordx4 v[176:179], v184, s[20:23], 0 offen sc1
    buffer_load_dword v13, v4, s[24:27], 0 offen sc1
    v_and_b32 v10, 3, v0
    s_andn2_b32 s31, s2, 7
    v_add_u32 v10, s31, v10
    v_add_u32 v12, 4, v10
    s_waitcnt vmcnt(7)
    s_barrier
    s_cmp_lg_u32 s4, 0
    s_cbranch_scc1 L_fs_35
    s_lshl_b32 s3, s2, 7
    s_mov_b64 exec, 1
    v_mov_b32 v2, s62
    v_mov_b32 v3, s63
    v_mov_b32 v1, 131072
    buffer_store_dwordx2 v[2:3], v1, s[44:47], s3 offen sc1
    s_mov_b64 exec, -1
L_fs_35:
    v_lshlrev_b32 v10, 7, v10
    s_mov_b32 s3, 0x40000
    s_mov_b32 s5, 131072
L_fw_36:
    buffer_load_dwordx2 v[14:15], v10, s[44:47], s5 offen sc1
    s_sub_u32 s3, s3, 1
    s_cbranch_scc1 L_fd_37
    s_waitcnt vmcnt(0)
    v_cmp_eq_u64 vcc, s[62:63], v[14:15]
    s_nop 1
    s_cmp_eq_u64 vcc, exec
    s_cbranch_scc0 L_fw_36
L_fd_37:
    s_waitcnt vmcnt(0)
    s_mov_b32 s28, 0
    buffer_load_dwordx4 v[16:19], v56, s[36:39], s28 offen sc1
    s_add_u32 s28, s28, 2359296
    buffer_load_dwordx4 v[20:23], v56, s[36:39], s28 offen sc1
    s_add_u32 s28, s28, 2359296
    buffer_load_dwordx4 v[24:27], v56, s[36:39], s28 offen sc1
    s_add_u32 s28, s28, 2359296
    buffer_load_dwordx4 v[28:31], v56, s[36:39], s28 offen sc1
    s_add_u32 s28, s28, 2359296
    s_mov_b32 s28, 0
    buffer_load_dwordx4 v[80:83], v120, s[36:39], s28 offen sc1
    s_add_u32 s28, s28, 2359296
    buffer_load_dwordx4 v[84:87], v120, s[36:39], s28 offen sc1
    s_add_u32 s28, s28, 2359296
    buffer_load_dwordx4 v[88:91], v120, s[36:39], s28 offen sc1
    s_add_u32 s28, s28, 2359296
    buffer_load_dwordx4 v[92:95], v120, s[36:39], s28 offen sc1
    s_add_u32 s28, s28, 2359296
    s_mov_b32 s28, 0
    buffer_load_dwordx4 v[144:147], v184, s[36:39], s28 offen sc1
    s_add_u32 s28, s28, 2359296
    buffer_load_dwordx4 v[148:151], v184, s[36:39], s28 offen sc1
    s_add_u32 s28, s28, 2359296
    buffer_load_dwordx4 v[152:155], v184, s[36:39], s28 offen sc1
    s_add_u32 s28, s28, 2359296
    buffer_load_dwordx4 v[156:159], v184, s[36:39], s28 offen sc1
    s_add_u32 s28, s28, 2359296
    v_lshlrev_b32 v12, 7, v12
    s_mov_b32 s3, 0x40000
    s_mov_b32 s5, 131072
L_fw_38:
    buffer_load_dwordx2 v[14:15], v12, s[44:47], s5 offen sc1
    s_sub_u32 s3, s3, 1
    s_cbranch_scc1 L_fd_39
    s_waitcnt vmcnt(0)
    v_cmp_eq_u64 vcc, s[62:63], v[14:15]
    s_nop 1
    s_cmp_eq_u64 vcc, exec
    s_cbranch_scc0 L_fw_38
L_fd_39:
    s_waitcnt vmcnt(0)
    s_mov_b32 s28, 9437184
    buffer_load_dwordx4 v[32:35], v56, s[36:39], s28 offen sc1
    s_add_u32 s28, s28, 2359296
    buffer_load_dwordx4 v[36:39], v56, s[36:39], s28 offen sc1
    s_add_u32 s28, s28, 2359296
    buffer_load_dwordx4 v[40:43], v56, s[36:39], s28 offen sc1
    s_add_u32 s28, s28, 2359296
    buffer_load_dwordx4 v[44:47], v56, s[36:39], s28 offen sc1
    s_add_u32 s28, s28, 2359296
    s_mov_b32 s28, 9437184
    buffer_load_dwordx4 v[96:99], v120, s[36:39], s28 offen sc1
    s_add_u32 s28, s28, 2359296
    buffer_load_dwordx4 v[100:103], v120, s[36:39], s28 offen sc1
    s_add_u32 s28, s28, 2359296
    buffer_load_dwordx4 v[104:107], v120, s[36:39], s28 offen sc1
    s_add_u32 s28, s28, 2359296
    buffer_load_dwordx4 v[108:111], v120, s[36:39], s28 offen sc1
    s_add_u32 s28, s28, 2359296
    s_mov_b32 s28, 9437184
    buffer_load_dwordx4 v[160:163], v184, s[36:39], s28 offen sc1
    s_add_u32 s28, s28, 2359296
    buffer_load_dwordx4 v[164:167], v184, s[36:39], s28 offen sc1
    s_add_u32 s28, s28, 2359296
    buffer_load_dwordx4 v[168:171], v184, s[36:39], s28 offen sc1
    s_add_u32 s28, s28, 2359296
    buffer_load_dwordx4 v[172:175], v184, s[36:39], s28 offen sc1
    s_add_u32 s28, s28, 2359296
    v_lshlrev_b32 v60, 16, v16
    v_and_b32 v61, 0xffff0000, v16
    v_lshlrev_b32 v62, 16, v17
    v_and_b32 v63, 0xffff0000, v17
    v_lshlrev_b32 v64, 16, v18
    v_and_b32 v65, 0xffff0000, v18
    v_lshlrev_b32 v66, 16, v19
    v_and_b32 v67, 0xffff0000, v19
    v_lshlrev_b32 v8, 16, v20
    v_and_b32 v9, 0xffff0000, v20
    v_add_f32 v60, v60, v8
    v_add_f32 v61, v61, v9
    v_lshlrev_b32 v8, 16, v21
    v_and_b32 v9, 0xffff0000, v21
    v_add_f32 v62, v62, v8
    v_add_f32 v63, v63, v9
    v_lshlrev_b32 v8, 16, v22
    v_and_b32 v9, 0xffff0000, v22
    v_add_f32 v64, v64, v8
    v_add_f32 v65, v65, v9
    v_lshlrev_b32 v8, 16, v23
    v_and_b32 v9, 0xffff0000, v23
    v_add_f32 v66, v66, v8
    v_add_f32 v67, v67, v9
    v_lshlrev_b32 v8, 16, v24
    v_and_b32 v9, 0xffff0000, v24
    v_add_f32 v60, v60, v8
    v_add_f32 v61, v61, v9
    v_lshlrev_b32 v8, 16, v25
    v_and_b32 v9, 0xffff0000, v25
    v_add_f32 v62, v62, v8
    v_add_f32 v63, v63, v9
    v_lshlrev_b32 v8, 16, v26
    v_and_b32 v9, 0xffff0000, v26
    v_add_f32 v64, v64, v8
    v_add_f32 v65, v65, v9
    v_lshlrev_b32 v8, 16, v27
    v_and_b32 v9, 0xffff0000, v27
    v_add_f32 v66, v66, v8
    v_add_f32 v67, v67, v9
    v_lshlrev_b32 v8, 16, v28
    v_and_b32 v9, 0xffff0000, v28
    v_add_f32 v60, v60, v8
    v_add_f32 v61, v61, v9
    v_lshlrev_b32 v8, 16, v29
    v_and_b32 v9, 0xffff0000, v29
    v_add_f32 v62, v62, v8
    v_add_f32 v63, v63, v9
    v_lshlrev_b32 v8, 16, v30
    v_and_b32 v9, 0xffff0000, v30
    v_add_f32 v64, v64, v8
    v_add_f32 v65, v65, v9
    v_lshlrev_b32 v8, 16, v31
    v_and_b32 v9, 0xffff0000, v31
    v_add_f32 v66, v66, v8
    v_add_f32 v67, v67, v9
    s_waitcnt vmcnt(11)
    v_lshlrev_b32 v68, 16, v32
    v_and_b32 v69, 0xffff0000, v32
    v_lshlrev_b32 v70, 16, v33
    v_and_b32 v71, 0xffff0000, v33
    v_lshlrev_b32 v72, 16, v34
    v_and_b32 v73, 0xffff0000, v34
    v_lshlrev_b32 v74, 16, v35
    v_and_b32 v75, 0xffff0000, v35
    s_waitcnt vmcnt(10)
    v_lshlrev_b32 v8, 16, v36
    v_and_b32 v9, 0xffff0000, v36
    v_add_f32 v68, v68, v8
    v_add_f32 v69, v69, v9
    v_lshlrev_b32 v8, 16, v37
    v_and_b32 v9, 0xffff0000, v37
    v_add_f32 v70, v70, v8
    v_add_f32 v71, v71, v9
    v_lshlrev_b32 v8, 16, v38
    v_and_b32 v9, 0xffff0000, v38
    v_add_f32 v72, v72, v8
    v_add_f32 v73, v73, v9
    v_lshlrev_b32 v8, 16, v39
    v_and_b32 v9, 0xffff0000, v39
    v_add_f32 v74, v74, v8
    v_add_f32 v75, v75, v9
    s_waitcnt vmcnt(9)
    v_lshlrev_b32 v8, 16, v40
    v_and_b32 v9, 0xffff0000, v40
    v_add_f32 v68, v68, v8
    v_add_f32 v69, v69, v9
    v_lshlrev_b32 v8, 16, v41
    v_and_b32 v9, 0xffff0000, v41
    v_add_f32 v70, v70, v8
    v_add_f32 v71, v71, v9
    v_lshlrev_b32 v8, 16, v42
    v_and_b32 v9, 0xffff0000, v42
    v_add_f32 v72, v72, v8
    v_add_f32 v73, v73, v9
    v_lshlrev_b32 v8, 16, v43
    v_and_b32 v9, 0xffff0000, v43
    v_add_f32 v74, v74, v8
    v_add_f32 v75, v75, v9
    s_waitcnt vmcnt(8)
    v_lshlrev_b32 v8, 16, v44
    v_and_b32 v9, 0xffff0000, v44
    v_add_f32 v68, v68, v8
    v_add_f32 v69, v69, v9
    v_lshlrev_b32 v8, 16, v45
    v_and_b32 v9, 0xffff0000, v45
    v_add_f32 v70, v70, v8
    v_add_f32 v71, v71, v9
    v_lshlrev_b32 v8, 16, v46
    v_and_b32 v9, 0xffff0000, v46
    v_add_f32 v72, v72, v8
    v_add_f32 v73, v73, v9
    v_lshlrev_b32 v8, 16, v47
    v_and_b32 v9, 0xffff0000, v47
    v_add_f32 v74, v74, v8
    v_add_f32 v75, v75, v9
    v_lshlrev_b32 v16, 16, v48
    v_and_b32 v17, 0xffff0000, v48
    v_lshlrev_b32 v24, 16, v52
    v_and_b32 v25, 0xffff0000, v52
    v_lshlrev_b32 v18, 16, v49
    v_and_b32 v19, 0xffff0000, v49
    v_lshlrev_b32 v26, 16, v53
    v_and_b32 v27, 0xffff0000, v53
    v_lshlrev_b32 v20, 16, v50
    v_and_b32 v21, 0xffff0000, v50
    v_lshlrev_b32 v28, 16, v54
    v_and_b32 v29, 0xffff0000, v54
    v_lshlrev_b32 v22, 16, v51
    v_and_b32 v23, 0xffff0000, v51
    v_lshlrev_b32 v30, 16, v55
    v_and_b32 v31, 0xffff0000, v55
    v_fma_f32 v68, v68, v13, v16
    v_fma_f32 v69, v69, v13, v17
    v_fma_f32 v70, v70, v13, v18
    v_fma_f32 v71, v71, v13, v19
    v_fma_f32 v72, v72, v13, v20
    v_fma_f32 v73, v73, v13, v21
    v_fma_f32 v74, v74, v13, v22
    v_fma_f32 v75, v75, v13, v23
    v_mul_f32 v16, 0xbfb8aa3b, v68
    v_mul_f32 v17, 0xbfb8aa3b, v69
    v_mul_f32 v18, 0xbfb8aa3b, v70
    v_mul_f32 v19, 0xbfb8aa3b, v71
    v_mul_f32 v20, 0xbfb8aa3b, v72
    v_mul_f32 v21, 0xbfb8aa3b, v73
    v_mul_f32 v22, 0xbfb8aa3b, v74
    v_mul_f32 v23, 0xbfb8aa3b, v75
    v_exp_f32 v16, v16
    v_exp_f32 v17, v17
    v_exp_f32 v18, v18
    v_exp_f32 v19, v19
    v_exp_f32 v20, v20
    v_exp_f32 v21, v21
    v_exp_f32 v22, v22
    v_exp_f32 v23, v23
    v_add_f32 v16, 1.0, v16
    v_add_f32 v17, 1.0, v17
    v_add_f32 v18, 1.0, v18
    v_add_f32 v19, 1.0, v19
    v_add_f32 v20, 1.0, v20
    v_add_f32 v21, 1.0, v21
    v_add_f32 v22, 1.0, v22
    v_add_f32 v23, 1.0, v23
    v_rcp_f32 v16, v16
    v_rcp_f32 v17, v17
    v_rcp_f32 v18, v18
    v_rcp_f32 v19, v19
    v_rcp_f32 v20, v20
    v_rcp_f32 v21, v21
    v_rcp_f32 v22, v22
    v_rcp_f32 v23, v23
    v_mul_f32 v68, v68, v60
    v_mul_f32 v69, v69, v61
    v_mul_f32 v70, v70, v62
    v_mul_f32 v71, v71, v63
    v_mul_f32 v72, v72, v64
    v_mul_f32 v73, v73, v65
    v_mul_f32 v74, v74, v66
    v_mul_f32 v75, v75, v67
    v_fma_f32 v68, v68, v16, v24
    v_fma_f32 v69, v69, v17, v25
    v_fma_f32 v70, v70, v18, v26
    v_fma_f32 v71, v71, v19, v27
    v_fma_f32 v72, v72, v20, v28
    v_fma_f32 v73, v73, v21, v29
    v_fma_f32 v74, v74, v22, v30
    v_fma_f32 v75, v75, v23, v31
    v_cvt_pk_bf16_f32 v32, v68, v69
    v_cvt_pk_bf16_f32 v33, v70, v71
    v_cvt_pk_bf16_f32 v34, v72, v73
    v_cvt_pk_bf16_f32 v35, v74, v75
    buffer_store_dwordx4 v[32:35], v58, s[8:11], 0 offen
    v_lshlrev_b32 v124, 16, v80
    v_and_b32 v125, 0xffff0000, v80
    v_lshlrev_b32 v126, 16, v81
    v_and_b32 v127, 0xffff0000, v81
    v_lshlrev_b32 v128, 16, v82
    v_and_b32 v129, 0xffff0000, v82
    v_lshlrev_b32 v130, 16, v83
    v_and_b32 v131, 0xffff0000, v83
    v_lshlrev_b32 v8, 16, v84
    v_and_b32 v9, 0xffff0000, v84
    v_add_f32 v124, v124, v8
    v_add_f32 v125, v125, v9
    v_lshlrev_b32 v8, 16, v85
    v_and_b32 v9, 0xffff0000, v85
    v_add_f32 v126, v126, v8
    v_add_f32 v127, v127, v9
    v_lshlrev_b32 v8, 16, v86
    v_and_b32 v9, 0xffff0000, v86
    v_add_f32 v128, v128, v8
    v_add_f32 v129, v129, v9
    v_lshlrev_b32 v8, 16, v87
    v_and_b32 v9, 0xffff0000, v87
    v_add_f32 v130, v130, v8
    v_add_f32 v131, v131, v9
    v_lshlrev_b32 v8, 16, v88
    v_and_b32 v9, 0xffff0000, v88
    v_add_f32 v124, v124, v8
    v_add_f32 v125, v125, v9
    v_lshlrev_b32 v8, 16, v89
    v_and_b32 v9, 0xffff0000, v89
    v_add_f32 v126, v126, v8
    v_add_f32 v127, v127, v9
    v_lshlrev_b32 v8, 16, v90
    v_and_b32 v9, 0xffff0000, v90
    v_add_f32 v128, v128, v8
    v_add_f32 v129, v129, v9
    v_lshlrev_b32 v8, 16, v91
    v_and_b32 v9, 0xffff0000, v91
    v_add_f32 v130, v130, v8
    v_add_f32 v131, v131, v9
    v_lshlrev_b32 v8, 16, v92
    v_and_b32 v9, 0xffff0000, v92
    v_add_f32 v124, v124, v8
    v_add_f32 v125, v125, v9
    v_lshlrev_b32 v8, 16, v93
    v_and_b32 v9, 0xffff0000, v93
    v_add_f32 v126, v126, v8
    v_add_f32 v127, v127, v9
    v_lshlrev_b32 v8, 16, v94
    v_and_b32 v9, 0xffff0000, v94
    v_add_f32 v128, v128, v8
    v_add_f32 v129, v129, v9
    v_lshlrev_b32 v8, 16, v95
    v_and_b32 v9, 0xffff0000, v95
    v_add_f32 v130, v130, v8
    v_add_f32 v131, v131, v9
    s_waitcnt vmcnt(8)
    v_lshlrev_b32 v132, 16, v96
    v_and_b32 v133, 0xffff0000, v96
    v_lshlrev_b32 v134, 16, v97
    v_and_b32 v135, 0xffff0000, v97
    v_lshlrev_b32 v136, 16, v98
    v_and_b32 v137, 0xffff0000, v98
    v_lshlrev_b32 v138, 16, v99
    v_and_b32 v139, 0xffff0000, v99
    s_waitcnt vmcnt(7)
    v_lshlrev_b32 v8, 16, v100
    v_and_b32 v9, 0xffff0000, v100
    v_add_f32 v132, v132, v8
    v_add_f32 v133, v133, v9
    v_lshlrev_b32 v8, 16, v101
    v_and_b32 v9, 0xffff0000, v101
    v_add_f32 v134, v134, v8
    v_add_f32 v135, v135, v9
    v_lshlrev_b32 v8, 16, v102
    v_and_b32 v9, 0xffff0000, v102
    v_add_f32 v136, v136, v8
    v_add_f32 v137, v137, v9
    v_lshlrev_b32 v8, 16, v103
    v_and_b32 v9, 0xffff0000, v103
    v_add_f32 v138, v138, v8
    v_add_f32 v139, v139, v9
    s_waitcnt vmcnt(6)
    v_lshlrev_b32 v8, 16, v104
    v_and_b32 v9, 0xffff0000, v104
    v_add_f32 v132, v132, v8
    v_add_f32 v133, v133, v9
    v_lshlrev_b32 v8, 16, v105
    v_and_b32 v9, 0xffff0000, v105
    v_add_f32 v134, v134, v8
    v_add_f32 v135, v135, v9
    v_lshlrev_b32 v8, 16, v106
    v_and_b32 v9, 0xffff0000, v106
    v_add_f32 v136, v136, v8
    v_add_f32 v137, v137, v9
    v_lshlrev_b32 v8, 16, v107
    v_and_b32 v9, 0xffff0000, v107
    v_add_f32 v138, v138, v8
    v_add_f32 v139, v139, v9
    s_waitcnt vmcnt(5)
    v_lshlrev_b32 v8, 16, v108
    v_and_b32 v9, 0xffff0000, v108
    v_add_f32 v132, v132, v8
    v_add_f32 v133, v133, v9
    v_lshlrev_b32 v8, 16, v109
    v_and_b32 v9, 0xffff0000, v109
    v_add_f32 v134, v134, v8
    v_add_f32 v135, v135, v9
    v_lshlrev_b32 v8, 16, v110
    v_and_b32 v9, 0xffff0000, v110
    v_add_f32 v136, v136, v8
    v_add_f32 v137, v137, v9
    v_lshlrev_b32 v8, 16, v111
    v_and_b32 v9, 0xffff0000, v111
    v_add_f32 v138, v138, v8
    v_add_f32 v139, v139, v9
    v_lshlrev_b32 v80, 16, v112
    v_and_b32 v81, 0xffff0000, v112
    v_lshlrev_b32 v88, 16, v116
    v_and_b32 v89, 0xffff0000, v116
    v_lshlrev_b32 v82, 16, v113
    v_and_b32 v83, 0xffff0000, v113
    v_lshlrev_b32 v90, 16, v117
    v_and_b32 v91, 0xffff0000, v117
    v_lshlrev_b32 v84, 16, v114
    v_and_b32 v85, 0xffff0000, v114
    v_lshlrev_b32 v92, 16, v118
    v_and_b32 v93, 0xffff0000, v118
    v_lshlrev_b32 v86, 16, v115
    v_and_b32 v87, 0xffff0000, v115
    v_lshlrev_b32 v94, 16, v119
    v_and_b32 v95, 0xffff0000, v119
    v_fma_f32 v132, v132, v13, v80
    v_fma_f32 v133, v133, v13, v81
    v_fma_f32 v134, v134, v13, v82
    v_fma_f32 v135, v135, v13, v83
    v_fma_f32 v136, v136, v13, v84
    v_fma_f32 v137, v137, v13, v85
    v_fma_f32 v138, v138, v13, v86
    v_fma_f32 v139, v139, v13, v87
    v_mul_f32 v80, 0xbfb8aa3b, v132
    v_mul_f32 v81, 0xbfb8aa3b, v133
    v_mul_f32 v82, 0xbfb8aa3b, v134
    v_mul_f32 v83, 0xbfb8aa3b, v135
    v_mul_f32 v84, 0xbfb8aa3b, v136
    v_mul_f32 v85, 0xbfb8aa3b, v137
    v_mul_f32 v86, 0xbfb8aa3b, v138
    v_mul_f32 v87, 0xbfb8aa3b, v139
    v_exp_f32 v80, v80
    v_exp_f32 v81, v81
    v_exp_f32 v82, v82
    v_exp_f32 v83, v83
    v_exp_f32 v84, v84
    v_exp_f32 v85, v85
    v_exp_f32 v86, v86
    v_exp_f32 v87, v87
    v_add_f32 v80, 1.0, v80
    v_add_f32 v81, 1.0, v81
    v_add_f32 v82, 1.0, v82
    v_add_f32 v83, 1.0, v83
    v_add_f32 v84, 1.0, v84
    v_add_f32 v85, 1.0, v85
    v_add_f32 v86, 1.0, v86
    v_add_f32 v87, 1.0, v87
    v_rcp_f32 v80, v80
    v_rcp_f32 v81, v81
    v_rcp_f32 v82, v82
    v_rcp_f32 v83, v83
    v_rcp_f32 v84, v84
    v_rcp_f32 v85, v85
    v_rcp_f32 v86, v86
    v_rcp_f32 v87, v87
    v_mul_f32 v132, v132, v124
    v_mul_f32 v133, v133, v125
    v_mul_f32 v134, v134, v126
    v_mul_f32 v135, v135, v127
    v_mul_f32 v136, v136, v128
    v_mul_f32 v137, v137, v129
    v_mul_f32 v138, v138, v130
    v_mul_f32 v139, v139, v131
    v_fma_f32 v132, v132, v80, v88
    v_fma_f32 v133, v133, v81, v89
    v_fma_f32 v134, v134, v82, v90
    v_fma_f32 v135, v135, v83, v91
    v_fma_f32 v136, v136, v84, v92
    v_fma_f32 v137, v137, v85, v93
    v_fma_f32 v138, v138, v86, v94
    v_fma_f32 v139, v139, v87, v95
    v_cvt_pk_bf16_f32 v96, v132, v133
    v_cvt_pk_bf16_f32 v97, v134, v135
    v_cvt_pk_bf16_f32 v98, v136, v137
    v_cvt_pk_bf16_f32 v99, v138, v139
    buffer_store_dwordx4 v[96:99], v122, s[8:11], 0 offen
    v_lshlrev_b32 v188, 16, v144
    v_and_b32 v189, 0xffff0000, v144
    v_lshlrev_b32 v190, 16, v145
    v_and_b32 v191, 0xffff0000, v145
    v_lshlrev_b32 v192, 16, v146
    v_and_b32 v193, 0xffff0000, v146
    v_lshlrev_b32 v194, 16, v147
    v_and_b32 v195, 0xffff0000, v147
    v_lshlrev_b32 v8, 16, v148
    v_and_b32 v9, 0xffff0000, v148
    v_add_f32 v188, v188, v8
    v_add_f32 v189, v189, v9
    v_lshlrev_b32 v8, 16, v149
    v_and_b32 v9, 0xffff0000, v149
    v_add_f32 v190, v190, v8
    v_add_f32 v191, v191, v9
    v_lshlrev_b32 v8, 16, v150
    v_and_b32 v9, 0xffff0000, v150
    v_add_f32 v192, v192, v8
    v_add_f32 v193, v193, v9
    v_lshlrev_b32 v8, 16, v151
    v_and_b32 v9, 0xffff0000, v151
    v_add_f32 v194, v194, v8
    v_add_f32 v195, v195, v9
    v_lshlrev_b32 v8, 16, v152
    v_and_b32 v9, 0xffff0000, v152
    v_add_f32 v188, v188, v8
    v_add_f32 v189, v189, v9
    v_lshlrev_b32 v8, 16, v153
    v_and_b32 v9, 0xffff0000, v153
    v_add_f32 v190, v190, v8
    v_add_f32 v191, v191, v9
    v_lshlrev_b32 v8, 16, v154
    v_and_b32 v9, 0xffff0000, v154
    v_add_f32 v192, v192, v8
    v_add_f32 v193, v193, v9
    v_lshlrev_b32 v8, 16, v155
    v_and_b32 v9, 0xffff0000, v155
    v_add_f32 v194, v194, v8
    v_add_f32 v195, v195, v9
    v_lshlrev_b32 v8, 16, v156
    v_and_b32 v9, 0xffff0000, v156
    v_add_f32 v188, v188, v8
    v_add_f32 v189, v189, v9
    v_lshlrev_b32 v8, 16, v157
    v_and_b32 v9, 0xffff0000, v157
    v_add_f32 v190, v190, v8
    v_add_f32 v191, v191, v9
    v_lshlrev_b32 v8, 16, v158
    v_and_b32 v9, 0xffff0000, v158
    v_add_f32 v192, v192, v8
    v_add_f32 v193, v193, v9
    v_lshlrev_b32 v8, 16, v159
    v_and_b32 v9, 0xffff0000, v159
    v_add_f32 v194, v194, v8
    v_add_f32 v195, v195, v9
    s_waitcnt vmcnt(5)
    v_lshlrev_b32 v196, 16, v160
    v_and_b32 v197, 0xffff0000, v160
    v_lshlrev_b32 v198, 16, v161
    v_and_b32 v199, 0xffff0000, v161
    v_lshlrev_b32 v200, 16, v162
    v_and_b32 v201, 0xffff0000, v162
    v_lshlrev_b32 v202, 16, v163
    v_and_b32 v203, 0xffff0000, v163
    s_waitcnt vmcnt(4)
    v_lshlrev_b32 v8, 16, v164
    v_and_b32 v9, 0xffff0000, v164
    v_add_f32 v196, v196, v8
    v_add_f32 v197, v197, v9
    v_lshlrev_b32 v8, 16, v165
    v_and_b32 v9, 0xffff0000, v165
    v_add_f32 v198, v198, v8
    v_add_f32 v199, v199, v9
    v_lshlrev_b32 v8, 16, v166
    v_and_b32 v9, 0xffff0000, v166
    v_add_f32 v200, v200, v8
    v_add_f32 v201, v201, v9
    v_lshlrev_b32 v8, 16, v167
    v_and_b32 v9, 0xffff0000, v167
    v_add_f32 v202, v202, v8
    v_add_f32 v203, v203, v9
    s_waitcnt vmcnt(3)
    v_lshlrev_b32 v8, 16, v168
    v_and_b32 v9, 0xffff0000, v168
    v_add_f32 v196, v196, v8
    v_add_f32 v197, v197, v9
    v_lshlrev_b32 v8, 16, v169
    v_and_b32 v9, 0xffff0000, v169
    v_add_f32 v198, v198, v8
    v_add_f32 v199, v199, v9
    v_lshlrev_b32 v8, 16, v170
    v_and_b32 v9, 0xffff0000, v170
    v_add_f32 v200, v200, v8
    v_add_f32 v201, v201, v9
    v_lshlrev_b32 v8, 16, v171
    v_and_b32 v9, 0xffff0000, v171
    v_add_f32 v202, v202, v8
    v_add_f32 v203, v203, v9
    s_waitcnt vmcnt(2)
    v_lshlrev_b32 v8, 16, v172
    v_and_b32 v9, 0xffff0000, v172
    v_add_f32 v196, v196, v8
    v_add_f32 v197, v197, v9
    v_lshlrev_b32 v8, 16, v173
    v_and_b32 v9, 0xffff0000, v173
    v_add_f32 v198, v198, v8
    v_add_f32 v199, v199, v9
    v_lshlrev_b32 v8, 16, v174
    v_and_b32 v9, 0xffff0000, v174
    v_add_f32 v200, v200, v8
    v_add_f32 v201, v201, v9
    v_lshlrev_b32 v8, 16, v175
    v_and_b32 v9, 0xffff0000, v175
    v_add_f32 v202, v202, v8
    v_add_f32 v203, v203, v9
    v_lshlrev_b32 v144, 16, v176
    v_and_b32 v145, 0xffff0000, v176
    v_lshlrev_b32 v152, 16, v180
    v_and_b32 v153, 0xffff0000, v180
    v_lshlrev_b32 v146, 16, v177
    v_and_b32 v147, 0xffff0000, v177
    v_lshlrev_b32 v154, 16, v181
    v_and_b32 v155, 0xffff0000, v181
    v_lshlrev_b32 v148, 16, v178
    v_and_b32 v149, 0xffff0000, v178
    v_lshlrev_b32 v156, 16, v182
    v_and_b32 v157, 0xffff0000, v182
    v_lshlrev_b32 v150, 16, v179
    v_and_b32 v151, 0xffff0000, v179
    v_lshlrev_b32 v158, 16, v183
    v_and_b32 v159, 0xffff0000, v183
    v_fma_f32 v196, v196, v13, v144
    v_fma_f32 v197, v197, v13, v145
    v_fma_f32 v198, v198, v13, v146
    v_fma_f32 v199, v199, v13, v147
    v_fma_f32 v200, v200, v13, v148
    v_fma_f32 v201, v201, v13, v149
    v_fma_f32 v202, v202, v13, v150
    v_fma_f32 v203, v203, v13, v151
    v_mul_f32 v144, 0xbfb8aa3b, v196
    v_mul_f32 v145, 0xbfb8aa3b, v197
    v_mul_f32 v146, 0xbfb8aa3b, v198
    v_mul_f32 v147, 0xbfb8aa3b, v199
    v_mul_f32 v148, 0xbfb8aa3b, v200
    v_mul_f32 v149, 0xbfb8aa3b, v201
    v_mul_f32 v150, 0xbfb8aa3b, v202
    v_mul_f32 v151, 0xbfb8aa3b, v203
    v_exp_f32 v144, v144
    v_exp_f32 v145, v145
    v_exp_f32 v146, v146
    v_exp_f32 v147, v147
    v_exp_f32 v148, v148
    v_exp_f32 v149, v149
    v_exp_f32 v150, v150
    v_exp_f32 v151, v151
    v_add_f32 v144, 1.0, v144
    v_add_f32 v145, 1.0, v145
    v_add_f32 v146, 1.0, v146
    v_add_f32 v147, 1.0, v147
    v_add_f32 v148, 1.0, v148
    v_add_f32 v149, 1.0, v149
    v_add_f32 v150, 1.0, v150
    v_add_f32 v151, 1.0, v151
    v_rcp_f32 v144, v144
    v_rcp_f32 v145, v145
    v_rcp_f32 v146, v146
    v_rcp_f32 v147, v147
    v_rcp_f32 v148, v148
    v_rcp_f32 v149, v149
    v_rcp_f32 v150, v150
    v_rcp_f32 v151, v151
    v_mul_f32 v196, v196, v188
    v_mul_f32 v197, v197, v189
    v_mul_f32 v198, v198, v190
    v_mul_f32 v199, v199, v191
    v_mul_f32 v200, v200, v192
    v_mul_f32 v201, v201, v193
    v_mul_f32 v202, v202, v194
    v_mul_f32 v203, v203, v195
    v_fma_f32 v196, v196, v144, v152
    v_fma_f32 v197, v197, v145, v153
    v_fma_f32 v198, v198, v146, v154
    v_fma_f32 v199, v199, v147, v155
    v_fma_f32 v200, v200, v148, v156
    v_fma_f32 v201, v201, v149, v157
    v_fma_f32 v202, v202, v150, v158
    v_fma_f32 v203, v203, v151, v159
    v_cvt_pk_bf16_f32 v160, v196, v197
    v_cvt_pk_bf16_f32 v161, v198, v199
    v_cvt_pk_bf16_f32 v162, v200, v201
    v_cvt_pk_bf16_f32 v163, v202, v203
    buffer_store_dwordx4 v[160:163], v186, s[8:11], 0 offen
    s_endpgm
L_fb_22:
    s_mov_b32 s34, 1
    v_mov_b32 v46, 0xff800000
    v_mov_b32 v47, 0xff800000
    v_mov_b32 v48, 0xff800000
    v_mov_b32 v49, 0xff800000
    s_mov_b32 s29, 0
L_maxloop_40:
    s_add_u32 m0, s31, 0x10000
    s_nop 0
    buffer_load_dwordx4 v20, s[8:11], s29 offen offset:0 lds
    buffer_load_dwordx4 v21, s[8:11], s29 offen offset:1024 lds
    buffer_load_dwordx4 v22, s[8:11], s29 offen offset:2048 lds
    buffer_load_dwordx4 v23, s[8:11], s29 offen offset:3072 lds
    s_waitcnt vmcnt(0)
    s_barrier
    ds_read_b128 a[128:131], v8 offset:0
    ds_read_b128 a[132:135], v9 offset:0
    ds_read_b128 a[136:139], v10 offset:0
    ds_read_b128 a[140:143], v11 offset:0
    s_waitcnt lgkmcnt(0)
    v_mfma_f32_16x16x32_bf16 v[144:147], a[128:131], a[192:195], 0
    v_mfma_f32_16x16x32_bf16 v[144:147], a[132:135], a[196:199], v[144:147]
    v_mfma_f32_16x16x32_bf16 v[144:147], a[136:139], a[200:203], v[144:147]
    v_mfma_f32_16x16x32_bf16 v[144:147], a[140:143], a[204:207], v[144:147]
    v_mfma_f32_16x16x32_bf16 v[148:151], a[128:131], a[208:211], 0
    v_mfma_f32_16x16x32_bf16 v[148:151], a[132:135], a[212:215], v[148:151]
    v_mfma_f32_16x16x32_bf16 v[148:151], a[136:139], a[216:219], v[148:151]
    v_mfma_f32_16x16x32_bf16 v[148:151], a[140:143], a[220:223], v[148:151]
    v_mfma_f32_16x16x32_bf16 v[152:155], a[128:131], a[224:227], 0
    v_mfma_f32_16x16x32_bf16 v[152:155], a[132:135], a[228:231], v[152:155]
    v_mfma_f32_16x16x32_bf16 v[152:155], a[136:139], a[232:235], v[152:155]
    v_mfma_f32_16x16x32_bf16 v[152:155], a[140:143], a[236:239], v[152:155]
    v_mfma_f32_16x16x32_bf16 v[156:159], a[128:131], a[240:243], 0
    v_mfma_f32_16x16x32_bf16 v[156:159], a[132:135], a[244:247], v[156:159]
    v_mfma_f32_16x16x32_bf16 v[156:159], a[136:139], a[248:251], v[156:159]
    v_mfma_f32_16x16x32_bf16 v[156:159], a[140:143], a[252:255], v[156:159]
    s_nop 7
    v_max3_f32 v46, v46, v144, v145
    v_max3_f32 v46, v46, v146, v147
    v_max3_f32 v47, v47, v148, v149
    v_max3_f32 v47, v47, v150, v151
    v_max3_f32 v48, v48, v152, v153
    v_max3_f32 v48, v48, v154, v155
    v_max3_f32 v49, v49, v156, v157
    v_max3_f32 v49, v49, v158, v159
    s_nop 3
    ds_read_b128 a[144:147], v8 offset:4096
    ds_read_b128 a[148:151], v9 offset:4096
    ds_read_b128 a[152:155], v10 offset:4096
    ds_read_b128 a[156:159], v11 offset:4096
    s_waitcnt lgkmcnt(0)
    v_mfma_f32_16x16x32_bf16 v[144:147], a[144:147], a[192:195], 0
    v_mfma_f32_16x16x32_bf16 v[144:147], a[148:151], a[196:199], v[144:147]
    v_mfma_f32_16x16x32_bf16 v[144:147], a[152:155], a[200:203], v[144:147]
    v_mfma_f32_16x16x32_bf16 v[144:147], a[156:159], a[204:207], v[144:147]
    v_mfma_f32_16x16x32_bf16 v[148:151], a[144:147], a[208:211], 0
    v_mfma_f32_16x16x32_bf16 v[148:151], a[148:151], a[212:215], v[148:151]
    v_mfma_f32_16x16x32_bf16 v[148:151], a[152:155], a[216:219], v[148:151]
    v_mfma_f32_16x16x32_bf16 v[148:151], a[156:159], a[220:223], v[148:151]
    v_mfma_f32_16x16x32_bf16 v[152:155], a[144:147], a[224:227], 0
    v_mfma_f32_16x16x32_bf16 v[152:155], a[148:151], a[228:231], v[152:155]
    v_mfma_f32_16x16x32_bf16 v[152:155], a[152:155], a[232:235], v[152:155]
    v_mfma_f32_16x16x32_bf16 v[152:155], a[156:159], a[236:239], v[152:155]
    v_mfma_f32_16x16x32_bf16 v[156:159], a[144:147], a[240:243], 0
    v_mfma_f32_16x16x32_bf16 v[156:159], a[148:151], a[244:247], v[156:159]
    v_mfma_f32_16x16x32_bf16 v[156:159], a[152:155], a[248:251], v[156:159]
    v_mfma_f32_16x16x32_bf16 v[156:159], a[156:159], a[252:255], v[156:159]
    s_nop 7
    v_max3_f32 v46, v46, v144, v145
    v_max3_f32 v46, v46, v146, v147
    v_max3_f32 v47, v47, v148, v149
    v_max3_f32 v47, v47, v150, v151
    v_max3_f32 v48, v48, v152, v153
    v_max3_f32 v48, v48, v154, v155
    v_max3_f32 v49, v49, v156, v157
    v_max3_f32 v49, v49, v158, v159
    s_nop 3
    ds_read_b128 a[128:131], v8 offset:8192
    ds_read_b128 a[132:135], v9 offset:8192
    ds_read_b128 a[136:139], v10 offset:8192
    ds_read_b128 a[140:143], v11 offset:8192
    s_waitcnt lgkmcnt(0)
    v_mfma_f32_16x16x32_bf16 v[144:147], a[128:131], a[192:195], 0
    v_mfma_f32_16x16x32_bf16 v[144:147], a[132:135], a[196:199], v[144:147]
    v_mfma_f32_16x16x32_bf16 v[144:147], a[136:139], a[200:203], v[144:147]
    v_mfma_f32_16x16x32_bf16 v[144:147], a[140:143], a[204:207], v[144:147]
    v_mfma_f32_16x16x32_bf16 v[148:151], a[128:131], a[208:211], 0
    v_mfma_f32_16x16x32_bf16 v[148:151], a[132:135], a[212:215], v[148:151]
    v_mfma_f32_16x16x32_bf16 v[148:151], a[136:139], a[216:219], v[148:151]
    v_mfma_f32_16x16x32_bf16 v[148:151], a[140:143], a[220:223], v[148:151]
    v_mfma_f32_16x16x32_bf16 v[152:155], a[128:131], a[224:227], 0
    v_mfma_f32_16x16x32_bf16 v[152:155], a[132:135], a[228:231], v[152:155]
    v_mfma_f32_16x16x32_bf16 v[152:155], a[136:139], a[232:235], v[152:155]
    v_mfma_f32_16x16x32_bf16 v[152:155], a[140:143], a[236:239], v[152:155]
    v_mfma_f32_16x16x32_bf16 v[156:159], a[128:131], a[240:243], 0
    v_mfma_f32_16x16x32_bf16 v[156:159], a[132:135], a[244:247], v[156:159]
    v_mfma_f32_16x16x32_bf16 v[156:159], a[136:139], a[248:251], v[156:159]
    v_mfma_f32_16x16x32_bf16 v[156:159], a[140:143], a[252:255], v[156:159]
    s_nop 7
    v_max3_f32 v46, v46, v144, v145
    v_max3_f32 v46, v46, v146, v147
    v_max3_f32 v47, v47, v148, v149
    v_max3_f32 v47, v47, v150, v151
    v_max3_f32 v48, v48, v152, v153
    v_max3_f32 v48, v48, v154, v155
    v_max3_f32 v49, v49, v156, v157
    v_max3_f32 v49, v49, v158, v159
    s_nop 3
    ds_read_b128 a[144:147], v8 offset:12288
    ds_read_b128 a[148:151], v9 offset:12288
    ds_read_b128 a[152:155], v10 offset:12288
    ds_read_b128 a[156:159], v11 offset:12288
    s_waitcnt lgkmcnt(0)
    v_mfma_f32_16x16x32_bf16 v[144:147], a[144:147], a[192:195], 0
    v_mfma_f32_16x16x32_bf16 v[144:147], a[148:151], a[196:199], v[144:147]
    v_mfma_f32_16x16x32_bf16 v[144:147], a[152:155], a[200:203], v[144:147]
    v_mfma_f32_16x16x32_bf16 v[144:147], a[156:159], a[204:207], v[144:147]
    v_mfma_f32_16x16x32_bf16 v[148:151], a[144:147], a[208:211], 0
    v_mfma_f32_16x16x32_bf16 v[148:151], a[148:151], a[212:215], v[148:151]
    v_mfma_f32_16x16x32_bf16 v[148:151], a[152:155], a[216:219], v[148:151]
    v_mfma_f32_16x16x32_bf16 v[148:151], a[156:159], a[220:223], v[148:151]
    v_mfma_f32_16x16x32_bf16 v[152:155], a[144:147], a[224:227], 0
    v_mfma_f32_16x16x32_bf16 v[152:155], a[148:151], a[228:231], v[152:155]
    v_mfma_f32_16x16x32_bf16 v[152:155], a[152:155], a[232:235], v[152:155]
    v_mfma_f32_16x16x32_bf16 v[152:155], a[156:159], a[236:239], v[152:155]
    v_mfma_f32_16x16x32_bf16 v[156:159], a[144:147], a[240:243], 0
    v_mfma_f32_16x16x32_bf16 v[156:159], a[148:151], a[244:247], v[156:159]
    v_mfma_f32_16x16x32_bf16 v[156:159], a[152:155], a[248:251], v[156:159]
    v_mfma_f32_16x16x32_bf16 v[156:159], a[156:159], a[252:255], v[156:159]
    s_nop 7
    v_max3_f32 v46, v46, v144, v145
    v_max3_f32 v46, v46, v146, v147
    v_max3_f32 v47, v47, v148, v149
    v_max3_f32 v47, v47, v150, v151
    v_max3_f32 v48, v48, v152, v153
    v_max3_f32 v48, v48, v154, v155
    v_max3_f32 v49, v49, v156, v157
    v_max3_f32 v49, v49, v158, v159
    s_nop 3
    s_barrier
    s_add_u32 s29, s29, 16384
    s_cmp_lt_u32 s29, 524288
    s_cbranch_scc1 L_maxloop_40
    v_mov_b32 v50, v46
    v_mov_b32 v51, v47
    v_mov_b32 v52, v48
    v_mov_b32 v53, v49
    s_nop 1
    v_permlane16_swap_b32 v46, v50
    v_permlane16_swap_b32 v47, v51
    v_permlane16_swap_b32 v48, v52
    v_permlane16_swap_b32 v49, v53
    v_max_f32 v46, v46, v50
    v_max_f32 v47, v47, v51
    v_max_f32 v48, v48, v52
    v_max_f32 v49, v49, v53
    v_mov_b32 v50, v46
    v_mov_b32 v51, v47
    v_mov_b32 v52, v48
    v_mov_b32 v53, v49
    s_nop 1
    v_permlane32_swap_b32 v46, v50
    v_permlane32_swap_b32 v47, v51
    v_permlane32_swap_b32 v48, v52
    v_permlane32_swap_b32 v49, v53
    v_max_f32 v46, v46, v50
    v_max_f32 v47, v47, v51
    v_max_f32 v48, v48, v52
    v_max_f32 v49, v49, v53
    v_sub_f32 v112, 0, v46
    v_sub_f32 v113, 0, v46
    v_sub_f32 v114, 0, v46
    v_sub_f32 v115, 0, v46
    v_sub_f32 v116, 0, v47
    v_sub_f32 v117, 0, v47
    v_sub_f32 v118, 0, v47
    v_sub_f32 v119, 0, v47
    v_sub_f32 v120, 0, v48
    v_sub_f32 v121, 0, v48
    v_sub_f32 v122, 0, v48
    v_sub_f32 v123, 0, v48
    v_sub_f32 v124, 0, v49
    v_sub_f32 v125, 0, v49
    v_sub_f32 v126, 0, v49
    v_sub_f32 v127, 0, v49
    s_add_u32 m0, s31, 65536
    s_mov_b32 s29, 0
    buffer_load_dwordx4 v20, s[8:11], s29 offen offset:0 lds
    buffer_load_dwordx4 v21, s[8:11], s29 offen offset:1024 lds
    buffer_load_dwordx4 v22, s[8:11], s29 offen offset:2048 lds
    buffer_load_dwordx4 v23, s[8:11], s29 offen offset:3072 lds
    s_add_u32 m0, s31, 81920
    v_subrev_u32 v46, 8192, v24
    v_subrev_u32 v47, 8192, v25
    buffer_load_dwordx4 v46, s[12:15], 0 offen offset:0 lds
    buffer_load_dwordx4 v47, s[12:15], 0 offen offset:1024 lds
    buffer_load_dwordx4 v46, s[12:15], 0 offen offset:2048 lds
    buffer_load_dwordx4 v47, s[12:15], 0 offen offset:3072 lds
    s_add_u32 m0, s31, 98304
    s_mov_b32 s29, 16384
    buffer_load_dwordx4 v20, s[8:11], s29 offen offset:0 lds
    buffer_load_dwordx4 v21, s[8:11], s29 offen offset:1024 lds
    buffer_load_dwordx4 v22, s[8:11], s29 offen offset:2048 lds
    buffer_load_dwordx4 v23, s[8:11], s29 offen offset:3072 lds
    s_add_u32 m0, s31, 114688
    s_mov_b32 s30, 8192
    buffer_load_dwordx4 v24, s[12:15], s30 offen offset:0 lds
    buffer_load_dwordx4 v25, s[12:15], s30 offen offset:1024 lds
    buffer_load_dwordx4 v24, s[12:15], s30 offen offset:2048 lds
    buffer_load_dwordx4 v25, s[12:15], s30 offen offset:3072 lds
    s_add_u32 m0, s31, 0
    s_mov_b32 s29, 32768
    buffer_load_dwordx4 v20, s[8:11], s29 offen offset:0 lds
    buffer_load_dwordx4 v21, s[8:11], s29 offen offset:1024 lds
    buffer_load_dwordx4 v22, s[8:11], s29 offen offset:2048 lds
    buffer_load_dwordx4 v23, s[8:11], s29 offen offset:3072 lds
    s_add_u32 m0, s31, 16384
    s_mov_b32 s30, 24576
    buffer_load_dwordx4 v24, s[12:15], s30 offen offset:0 lds
    buffer_load_dwordx4 v25, s[12:15], s30 offen offset:1024 lds
    buffer_load_dwordx4 v24, s[12:15], s30 offen offset:2048 lds
    buffer_load_dwordx4 v25, s[12:15], s30 offen offset:3072 lds
    s_waitcnt vmcnt(0)
    s_branch L_start_20
L_end_1:
    s_endpgm
CODE_END:

.section .rodata,"a"
.p2align 6
.amdhsa_kernel recurrent_scan__mha_block_cached__mixer_s_mlp__prompt_kernel
  .amdhsa_next_free_vgpr 512
  .amdhsa_next_free_sgpr 102
  .amdhsa_accum_offset 256
  .amdhsa_group_segment_fixed_size 0
  .amdhsa_kernarg_size 104
  .amdhsa_user_sgpr_count 2
  .amdhsa_user_sgpr_kernarg_segment_ptr 1
  .amdhsa_system_sgpr_workgroup_id_x 1
.end_amdhsa_kernel
```
